```python
import torch

def _softmax(x, axis=-1):
    return torch.softmax(x, dim=axis)

def _gelu(x):
    return torch.nn.functional.gelu(x, approximate='tanh')

def _silu(x):
    return torch.nn.functional.silu(x)

def _sigmoid(x):
    return torch.sigmoid(x)

def _layernorm(x, axis=-1, eps=1e-05):
    m = x.mean(dim=axis, keepdim=True)
    v = x.var(dim=axis, keepdim=True, unbiased=False)
    return (x - m) / torch.sqrt(v + eps)

def _scatter_add(tgt, idx, src, axis=0):
    return tgt.clone().index_add_(axis, idx, src)

def _segment_sum(src, seg, n):
    out = torch.zeros((n,) + src.shape[1:], dtype=src.dtype)
    return out.index_add_(0, seg, src)

def _pad(x, pw):
    flat = tuple((v for pair in reversed(pw) for v in pair))
    return torch.nn.functional.pad(x, flat)
kernel_name = 'adaLN_cond__mha_block_cached__dense_activation_silu__prompt'

def setup_inputs():

    _w = lambda a: (lambda t: t.to(torch.bfloat16) if t.is_floating_point() else t)(torch.as_tensor(a))

    def _A_setup():
        B, Sq, D = (1, 2048, 576)
        H, Sk, Dh = (32, 2048, 128)
        return {'x': _w((lambda *s: torch.randn(*s, dtype=torch.bfloat16) * 0.1)(B, Sq, D)), 'k_cache': _w((lambda *s: torch.randn(*s, dtype=torch.bfloat16) * 0.8)(B, H, Sk, Dh)), 'v_cache': _w((lambda *s: torch.randn(*s, dtype=torch.bfloat16) * 3.2)(B, H, Sk, Dh)), 'wq': _w((lambda *s: torch.randn(*s, dtype=torch.bfloat16) * 0.8)(D, H * Dh) * D ** (-0.5)), 'wo': _w((lambda *s: torch.randn(*s, dtype=torch.bfloat16) * 3.2)(H * Dh, D) * (H * Dh) ** (-0.5))}
    _A_in = _A_setup()

    def _B_setup():
        B, S, D, F = (1, 2048, 576, 4608)
        return {'x': _w((lambda *s: torch.randn(*s, dtype=torch.bfloat16) * 0.1)(B, S, D)), 'w1': _w((lambda *s: torch.randn(*s, dtype=torch.bfloat16) * 3.2)(D, F) * D ** (-0.5)), 'w2': _w((lambda *s: torch.randn(*s, dtype=torch.bfloat16) * 3.2)(F, D) * F ** (-0.5))}
    _B_in = _B_setup()
    return {'A_x': _A_in['x'], 'A_k_cache': _A_in['k_cache'], 'A_v_cache': _A_in['v_cache'], 'A_wq': _A_in['wq'], 'A_wo': _A_in['wo'], 'B_x': _B_in['x'], 'B_w1': _B_in['w1'], 'B_w2': _B_in['w2'], 'c': _w((lambda *s: torch.randn(*s, dtype=torch.bfloat16) * 0.2)(1, 576) * 8.0), 'w_mod': _w((lambda *s: torch.randn(*s, dtype=torch.bfloat16) * 0.2)(576, 6 * 576) * 576 ** (-0.5) * 8.0)}

def reference(A_x, A_k_cache, A_v_cache, A_wq, A_wo, B_x, B_w1, B_w2, c, w_mod):

    def _A_ref(x, k_cache, v_cache, wq, wo):
        B, Sq, D = x.shape
        H, Dh = (32, 128)
        q = (lambda x, *d: x.permute(*d))((x @ wq).reshape(B, Sq, H, Dh), 0, 2, 1, 3)
        scores = torch.einsum('bhqd,bhkd->bhqk', q, k_cache) * Dh ** (-0.5)
        p = _softmax(scores, axis=-1)
        o = torch.einsum('bhqk,bhkd->bhqd', p, v_cache)
        return (lambda x, *d: x.permute(*d))(o, 0, 2, 1, 3).reshape(B, Sq, H * Dh) @ wo

    def _B_ref(x, w1, w2):
        h = torch.einsum('bsd,df->bsf', x, w1)
        h = _silu(h)
        out = torch.einsum('bsf,fd->bsd', h, w2)
        return out
    x = A_x
    mod = (_silu(c) @ w_mod).reshape(c.shape[0], 6, 1, -1)
    sa, ca, ga, sb, cb, gb = (mod[:, 0].clone(), mod[:, 1].clone(), mod[:, 2].clone(), mod[:, 3].clone(), mod[:, 4].clone(), mod[:, 5].clone())
    h = _layernorm(x, axis=-1) * (1 + ca) + sa
    x = x + ga * _A_ref(h, A_k_cache, A_v_cache, A_wq, A_wo)
    h = _layernorm(x, axis=-1) * (1 + cb) + sb
    x = x + gb * _B_ref(h, B_w1, B_w2)
    return x
```

```asm
; @launch kernel=mod_kernel grid=(108,1,1) block=(1024,1,1) lds=9216
; @launch kernel=ln1_kernel grid=(512,1,1) block=(256,1,1) lds=0
; @launch kernel=attn_kernel grid=(256,1,1) block=(256,1,1) lds=147456
; @launch kernel=oproj_kernel grid=(256,1,1) block=(512,1,1) lds=135168
; @launch kernel=ln2_kernel grid=(512,1,1) block=(256,1,1) lds=0
; @launch kernel=ffn1_kernel grid=(256,1,1) block=(512,1,1) lds=153600
; @launch kernel=ffn2_kernel grid=(256,1,1) block=(512,1,1) lds=135168
; @launch kernel=final_kernel grid=(1152,1,1) block=(256,1,1) lds=0
.amdgcn_target "amdgcn-amd-amdhsa--gfx950"
.text
.globl mod_kernel
.p2align 8
.type mod_kernel,@function
mod_kernel:
    s_cmp_ge_u32 s2, 108
    s_cbranch_scc1 mod_done
    s_load_dwordx2 s[8:9], s[0:1], 64
    s_load_dwordx2 s[12:13], s[0:1], 72
    s_load_dwordx2 s[16:17], s[0:1], 96
    v_and_b32 v1, 15, v0
    v_lshrrev_b32 v2, 4, v0
    v_mul_u32_u24 v3, 9, v2
    v_lshlrev_b32 v4, 1, v3
    s_mov_b32 s20, 6912
    v_mul_lo_u32 v5, v3, s20
    s_lshl_b32 s3, s2, 6
    v_lshl_add_u32 v5, v1, 2, v5
    v_add_u32 v5, s3, v5
    s_mov_b32 s21, 0
    s_mov_b32 s22, 6912
    s_mov_b32 s23, 13824
    s_mov_b32 s24, 20736
    s_mov_b32 s25, 27648
    s_mov_b32 s26, 34560
    s_mov_b32 s27, 41472
    s_mov_b32 s28, 48384
    s_mov_b32 s29, 55296
    s_waitcnt lgkmcnt(0)
    s_and_b32 s9, s9, 0xffff
    s_mov_b32 s10, 0x480
    s_mov_b32 s11, 0x00020000
    s_and_b32 s13, s13, 0xffff
    s_mov_b32 s14, 0x3cc000
    s_mov_b32 s15, 0x00020000
    s_and_b32 s17, s17, 0xffff
    s_mov_b32 s18, 0x3600
    s_mov_b32 s19, 0x00020000
    buffer_load_ushort v10, v4, s[8:11], 0 offen offset:0
    buffer_load_ushort v11, v4, s[8:11], 0 offen offset:2
    buffer_load_ushort v12, v4, s[8:11], 0 offen offset:4
    buffer_load_ushort v13, v4, s[8:11], 0 offen offset:6
    buffer_load_ushort v14, v4, s[8:11], 0 offen offset:8
    buffer_load_ushort v15, v4, s[8:11], 0 offen offset:10
    buffer_load_ushort v16, v4, s[8:11], 0 offen offset:12
    buffer_load_ushort v17, v4, s[8:11], 0 offen offset:14
    buffer_load_ushort v18, v4, s[8:11], 0 offen offset:16
    buffer_load_dword v20, v5, s[12:15], s21 offen
    buffer_load_dword v21, v5, s[12:15], s22 offen
    buffer_load_dword v22, v5, s[12:15], s23 offen
    buffer_load_dword v23, v5, s[12:15], s24 offen
    buffer_load_dword v24, v5, s[12:15], s25 offen
    buffer_load_dword v25, v5, s[12:15], s26 offen
    buffer_load_dword v26, v5, s[12:15], s27 offen
    buffer_load_dword v27, v5, s[12:15], s28 offen
    buffer_load_dword v28, v5, s[12:15], s29 offen
    s_waitcnt vmcnt(9)
    s_mov_b32 s30, 0xbfb8aa3b
    v_lshlrev_b32 v10, 16, v10
    v_mul_f32 v30, s30, v10
    v_exp_f32 v30, v30
    s_nop 0
    v_add_f32 v30, 1.0, v30
    v_rcp_f32 v30, v30
    s_nop 0
    v_mul_f32 v10, v10, v30
    v_cvt_pk_bf16_f32 v10, v10, v10
    v_lshlrev_b32 v10, 16, v10
    v_lshlrev_b32 v11, 16, v11
    v_mul_f32 v30, s30, v11
    v_exp_f32 v30, v30
    s_nop 0
    v_add_f32 v30, 1.0, v30
    v_rcp_f32 v30, v30
    s_nop 0
    v_mul_f32 v11, v11, v30
    v_cvt_pk_bf16_f32 v11, v11, v11
    v_lshlrev_b32 v11, 16, v11
    v_lshlrev_b32 v12, 16, v12
    v_mul_f32 v30, s30, v12
    v_exp_f32 v30, v30
    s_nop 0
    v_add_f32 v30, 1.0, v30
    v_rcp_f32 v30, v30
    s_nop 0
    v_mul_f32 v12, v12, v30
    v_cvt_pk_bf16_f32 v12, v12, v12
    v_lshlrev_b32 v12, 16, v12
    v_lshlrev_b32 v13, 16, v13
    v_mul_f32 v30, s30, v13
    v_exp_f32 v30, v30
    s_nop 0
    v_add_f32 v30, 1.0, v30
    v_rcp_f32 v30, v30
    s_nop 0
    v_mul_f32 v13, v13, v30
    v_cvt_pk_bf16_f32 v13, v13, v13
    v_lshlrev_b32 v13, 16, v13
    v_lshlrev_b32 v14, 16, v14
    v_mul_f32 v30, s30, v14
    v_exp_f32 v30, v30
    s_nop 0
    v_add_f32 v30, 1.0, v30
    v_rcp_f32 v30, v30
    s_nop 0
    v_mul_f32 v14, v14, v30
    v_cvt_pk_bf16_f32 v14, v14, v14
    v_lshlrev_b32 v14, 16, v14
    v_lshlrev_b32 v15, 16, v15
    v_mul_f32 v30, s30, v15
    v_exp_f32 v30, v30
    s_nop 0
    v_add_f32 v30, 1.0, v30
    v_rcp_f32 v30, v30
    s_nop 0
    v_mul_f32 v15, v15, v30
    v_cvt_pk_bf16_f32 v15, v15, v15
    v_lshlrev_b32 v15, 16, v15
    v_lshlrev_b32 v16, 16, v16
    v_mul_f32 v30, s30, v16
    v_exp_f32 v30, v30
    s_nop 0
    v_add_f32 v30, 1.0, v30
    v_rcp_f32 v30, v30
    s_nop 0
    v_mul_f32 v16, v16, v30
    v_cvt_pk_bf16_f32 v16, v16, v16
    v_lshlrev_b32 v16, 16, v16
    v_lshlrev_b32 v17, 16, v17
    v_mul_f32 v30, s30, v17
    v_exp_f32 v30, v30
    s_nop 0
    v_add_f32 v30, 1.0, v30
    v_rcp_f32 v30, v30
    s_nop 0
    v_mul_f32 v17, v17, v30
    v_cvt_pk_bf16_f32 v17, v17, v17
    v_lshlrev_b32 v17, 16, v17
    v_lshlrev_b32 v18, 16, v18
    v_mul_f32 v30, s30, v18
    v_exp_f32 v30, v30
    s_nop 0
    v_add_f32 v30, 1.0, v30
    v_rcp_f32 v30, v30
    s_nop 0
    v_mul_f32 v18, v18, v30
    v_cvt_pk_bf16_f32 v18, v18, v18
    v_lshlrev_b32 v18, 16, v18
    v_mov_b32 v32, 0
    v_mov_b32 v33, 0
    s_waitcnt vmcnt(0)
    v_lshlrev_b32 v34, 16, v20
    v_and_b32 v35, 0xffff0000, v20
    v_fmac_f32 v32, v10, v34
    v_fmac_f32 v33, v10, v35
    v_lshlrev_b32 v34, 16, v21
    v_and_b32 v35, 0xffff0000, v21
    v_fmac_f32 v32, v11, v34
    v_fmac_f32 v33, v11, v35
    v_lshlrev_b32 v34, 16, v22
    v_and_b32 v35, 0xffff0000, v22
    v_fmac_f32 v32, v12, v34
    v_fmac_f32 v33, v12, v35
    v_lshlrev_b32 v34, 16, v23
    v_and_b32 v35, 0xffff0000, v23
    v_fmac_f32 v32, v13, v34
    v_fmac_f32 v33, v13, v35
    v_lshlrev_b32 v34, 16, v24
    v_and_b32 v35, 0xffff0000, v24
    v_fmac_f32 v32, v14, v34
    v_fmac_f32 v33, v14, v35
    v_lshlrev_b32 v34, 16, v25
    v_and_b32 v35, 0xffff0000, v25
    v_fmac_f32 v32, v15, v34
    v_fmac_f32 v33, v15, v35
    v_lshlrev_b32 v34, 16, v26
    v_and_b32 v35, 0xffff0000, v26
    v_fmac_f32 v32, v16, v34
    v_fmac_f32 v33, v16, v35
    v_lshlrev_b32 v34, 16, v27
    v_and_b32 v35, 0xffff0000, v27
    v_fmac_f32 v32, v17, v34
    v_fmac_f32 v33, v17, v35
    v_lshlrev_b32 v34, 16, v28
    v_and_b32 v35, 0xffff0000, v28
    v_fmac_f32 v32, v18, v34
    v_fmac_f32 v33, v18, v35
    v_lshlrev_b32 v6, 7, v2
    v_lshl_add_u32 v6, v1, 3, v6
    ds_write_b64 v6, v[32:33]
    s_waitcnt lgkmcnt(0)
    s_barrier
    v_cmp_gt_u32 vcc, 256, v0
    s_and_saveexec_b64 s[32:33], vcc
    s_cbranch_execz mod_skip1
    v_and_b32 v7, 31, v0
    v_lshrrev_b32 v8, 5, v0
    v_lshlrev_b32 v9, 10, v8
    v_lshl_add_u32 v9, v7, 2, v9
    ds_read_b32 v20, v9 offset:0
    ds_read_b32 v21, v9 offset:128
    ds_read_b32 v22, v9 offset:256
    ds_read_b32 v23, v9 offset:384
    ds_read_b32 v24, v9 offset:512
    ds_read_b32 v25, v9 offset:640
    ds_read_b32 v26, v9 offset:768
    ds_read_b32 v27, v9 offset:896
    s_waitcnt lgkmcnt(0)
    v_add_f32 v20, v20, v21
    v_add_f32 v20, v20, v22
    v_add_f32 v20, v20, v23
    v_add_f32 v20, v20, v24
    v_add_f32 v20, v20, v25
    v_add_f32 v20, v20, v26
    v_add_f32 v20, v20, v27
    v_lshlrev_b32 v9, 2, v0
    ds_write_b32 v9, v20 offset:8192
    s_waitcnt lgkmcnt(0)
mod_skip1:
    s_mov_b64 exec, s[32:33]
    s_barrier
    v_cmp_gt_u32 vcc, 32, v0
    s_and_saveexec_b64 s[32:33], vcc
    s_cbranch_execz mod_done
    v_lshlrev_b32 v9, 2, v0
    ds_read_b32 v20, v9 offset:8192
    ds_read_b32 v21, v9 offset:8320
    ds_read_b32 v22, v9 offset:8448
    ds_read_b32 v23, v9 offset:8576
    ds_read_b32 v24, v9 offset:8704
    ds_read_b32 v25, v9 offset:8832
    ds_read_b32 v26, v9 offset:8960
    ds_read_b32 v27, v9 offset:9088
    s_waitcnt lgkmcnt(0)
    v_add_f32 v20, v20, v21
    v_add_f32 v20, v20, v22
    v_add_f32 v20, v20, v23
    v_add_f32 v20, v20, v24
    v_add_f32 v20, v20, v25
    v_add_f32 v20, v20, v26
    v_add_f32 v20, v20, v27
    v_cvt_pk_bf16_f32 v20, v20, v20
    v_lshlrev_b32 v20, 16, v20
    s_lshl_b32 s3, s2, 7
    v_add_u32 v9, s3, v9
    buffer_store_dword v20, v9, s[16:19], 0 offen
mod_done:
    s_endpgm

.globl ln1_kernel
.p2align 8
.type ln1_kernel,@function
ln1_kernel:
    s_cmp_ge_u32 s2, 512
    s_cbranch_scc1 ln1_done
    s_load_dwordx2 s[8:9], s[0:1], 0
    s_load_dwordx2 s[12:13], s[0:1], 96
    s_load_dwordx2 s[16:17], s[0:1], 96
    s_load_dwordx2 s[24:25], s[0:1], 24
    v_and_b32 v1, 63, v0
    v_lshrrev_b32 v2, 6, v0
    s_lshl_b32 s3, s2, 2
    v_add_u32 v2, s3, v2
    s_movk_i32 s4, 1152
    v_mul_lo_u32 v2, v2, s4
    v_lshl_add_u32 v2, v1, 2, v2
    v_lshlrev_b32 v3, 3, v1
    v_cmp_gt_u32 s[20:21], 32, v1
    v_mov_b32 v10, 0
    v_mov_b32 v11, 0
    v_mov_b32 v12, 0
    v_mov_b32 v13, 0
    v_mov_b32 v14, 0
    v_mov_b32 v15, 0
    v_mov_b32 v16, 0
    v_mov_b32 v17, 0
    v_mov_b32 v18, 0
    v_mov_b32 v19, 0
    v_mov_b32 v8, 0
    s_movk_i32 s5, 2304
    s_waitcnt lgkmcnt(0)
    s_and_b32 s9, s9, 0xffff
    s_mov_b32 s10, 0x240000
    s_mov_b32 s11, 0x00020000
    s_and_b32 s13, s13, 0xffff
    s_mov_b32 s14, 0x3600
    s_mov_b32 s15, 0x00020000
    s_add_u32 s16, s16, 0x100000
    s_addc_u32 s17, s17, 0
    s_and_b32 s17, s17, 0xffff
    s_mov_b32 s18, 0x240000
    s_mov_b32 s19, 0x00020000
    s_and_b32 s25, s25, 0xffff
    s_mov_b32 s26, 0x480000
    s_mov_b32 s27, 0x00020000
    buffer_load_dword v4, v2, s[8:11], 0 offen offset:0
    buffer_load_dword v5, v2, s[8:11], 0 offen offset:256
    buffer_load_dword v6, v2, s[8:11], 0 offen offset:512
    buffer_load_dword v7, v2, s[8:11], 0 offen offset:768
    buffer_load_dwordx2 v[20:21], v3, s[12:15], s5 offen offset:0
    buffer_load_dwordx2 v[30:31], v3, s[12:15], 0 offen offset:0
    buffer_load_dwordx2 v[22:23], v3, s[12:15], s5 offen offset:512
    buffer_load_dwordx2 v[32:33], v3, s[12:15], 0 offen offset:512
    buffer_load_dwordx2 v[24:25], v3, s[12:15], s5 offen offset:1024
    buffer_load_dwordx2 v[34:35], v3, s[12:15], 0 offen offset:1024
    buffer_load_dwordx2 v[26:27], v3, s[12:15], s5 offen offset:1536
    buffer_load_dwordx2 v[36:37], v3, s[12:15], 0 offen offset:1536
    s_mov_b64 s[22:23], exec
    s_mov_b64 exec, s[20:21]
    buffer_load_dword v8, v2, s[8:11], 0 offen offset:1024
    buffer_load_dwordx2 v[28:29], v3, s[12:15], s5 offen offset:2048
    buffer_load_dwordx2 v[38:39], v3, s[12:15], 0 offen offset:2048
    s_mov_b64 exec, s[22:23]
    s_mul_i32 s6, s2, 9216
    v_lshlrev_b32 v9, 7, v0
    v_cmp_gt_u32 vcc, 72, v0
    s_and_saveexec_b64 s[28:29], vcc
    s_cbranch_execz ln1_nopf
    buffer_load_dword v60, v9, s[24:27], s6 offen
ln1_nopf:
    s_mov_b64 exec, s[28:29]
    s_waitcnt vmcnt(0)
    v_lshlrev_b32 v10, 16, v4
    v_and_b32 v11, 0xffff0000, v4
    v_lshlrev_b32 v12, 16, v5
    v_and_b32 v13, 0xffff0000, v5
    v_lshlrev_b32 v14, 16, v6
    v_and_b32 v15, 0xffff0000, v6
    v_lshlrev_b32 v16, 16, v7
    v_and_b32 v17, 0xffff0000, v7
    v_lshlrev_b32 v18, 16, v8
    v_and_b32 v19, 0xffff0000, v8
    v_add_f32 v48, v10, v11
    v_add_f32 v48, v48, v12
    v_add_f32 v48, v48, v13
    v_add_f32 v48, v48, v14
    v_add_f32 v48, v48, v15
    v_add_f32 v48, v48, v16
    v_add_f32 v48, v48, v17
    v_add_f32 v48, v48, v18
    v_add_f32 v48, v48, v19
    s_nop 1
    v_add_f32_dpp v48, v48, v48 quad_perm:[1,0,3,2] row_mask:0xf bank_mask:0xf
    s_nop 1
    v_add_f32_dpp v48, v48, v48 quad_perm:[2,3,0,1] row_mask:0xf bank_mask:0xf
    s_nop 1
    v_add_f32_dpp v48, v48, v48 row_half_mirror row_mask:0xf bank_mask:0xf
    s_nop 1
    v_add_f32_dpp v48, v48, v48 row_mirror row_mask:0xf bank_mask:0xf
    s_nop 1
    v_readlane_b32 s40, v48, 0
    v_readlane_b32 s41, v48, 16
    v_readlane_b32 s42, v48, 32
    v_readlane_b32 s43, v48, 48
    s_nop 1
    v_mov_b32 v48, s40
    v_add_f32 v48, s41, v48
    v_add_f32 v48, s42, v48
    v_add_f32 v48, s43, v48
    s_mov_b32 s44, 0x3ae38e39
    v_mul_f32 v48, s44, v48
    v_mov_b32 v49, 0
    v_sub_f32 v50, v10, v48
    v_fmac_f32 v49, v50, v50
    v_sub_f32 v50, v11, v48
    v_fmac_f32 v49, v50, v50
    v_sub_f32 v50, v12, v48
    v_fmac_f32 v49, v50, v50
    v_sub_f32 v50, v13, v48
    v_fmac_f32 v49, v50, v50
    v_sub_f32 v50, v14, v48
    v_fmac_f32 v49, v50, v50
    v_sub_f32 v50, v15, v48
    v_fmac_f32 v49, v50, v50
    v_sub_f32 v50, v16, v48
    v_fmac_f32 v49, v50, v50
    v_sub_f32 v50, v17, v48
    v_fmac_f32 v49, v50, v50
    s_mov_b64 s[46:47], exec
    s_mov_b64 exec, s[20:21]
    v_sub_f32 v50, v18, v48
    v_fmac_f32 v49, v50, v50
    v_sub_f32 v50, v19, v48
    v_fmac_f32 v49, v50, v50
    s_mov_b64 exec, s[46:47]
    s_nop 1
    v_add_f32_dpp v49, v49, v49 quad_perm:[1,0,3,2] row_mask:0xf bank_mask:0xf
    s_nop 1
    v_add_f32_dpp v49, v49, v49 quad_perm:[2,3,0,1] row_mask:0xf bank_mask:0xf
    s_nop 1
    v_add_f32_dpp v49, v49, v49 row_half_mirror row_mask:0xf bank_mask:0xf
    s_nop 1
    v_add_f32_dpp v49, v49, v49 row_mirror row_mask:0xf bank_mask:0xf
    s_nop 1
    v_readlane_b32 s40, v49, 0
    v_readlane_b32 s41, v49, 16
    v_readlane_b32 s42, v49, 32
    v_readlane_b32 s43, v49, 48
    s_nop 1
    v_mov_b32 v49, s40
    v_add_f32 v49, s41, v49
    v_add_f32 v49, s42, v49
    v_add_f32 v49, s43, v49
    v_mul_f32 v49, s44, v49
    v_cvt_pk_bf16_f32 v50, v48, v49
    v_lshlrev_b32 v48, 16, v50
    v_and_b32 v49, 0xffff0000, v50
    s_mov_b32 s45, 0x3727c5ac
    v_add_f32 v49, s45, v49
    v_cvt_pk_bf16_f32 v49, v49, v49
    v_lshlrev_b32 v49, 16, v49
    v_sqrt_f32 v49, v49
    s_nop 0
    v_cvt_pk_bf16_f32 v49, v49, v49
    v_lshlrev_b32 v49, 16, v49
    v_rcp_f32 v50, v49
    s_nop 0
    v_sub_f32 v10, v10, v48
    v_sub_f32 v11, v11, v48
    v_cvt_pk_bf16_f32 v51, v10, v11
    v_lshlrev_b32 v10, 16, v51
    v_and_b32 v11, 0xffff0000, v51
    v_mul_f32 v52, v10, v50
    v_fma_f32 v53, -v52, v49, v10
    v_fma_f32 v10, v53, v50, v52
    v_mul_f32 v52, v11, v50
    v_fma_f32 v53, -v52, v49, v11
    v_fma_f32 v11, v53, v50, v52
    v_cvt_pk_bf16_f32 v51, v10, v11
    v_lshlrev_b32 v10, 16, v51
    v_and_b32 v11, 0xffff0000, v51
    v_add_f32 v20, 1.0, v20
    v_add_f32 v21, 1.0, v21
    v_cvt_pk_bf16_f32 v51, v20, v21
    v_lshlrev_b32 v20, 16, v51
    v_and_b32 v21, 0xffff0000, v51
    v_mul_f32 v10, v10, v20
    v_mul_f32 v11, v11, v21
    v_cvt_pk_bf16_f32 v51, v10, v11
    v_lshlrev_b32 v10, 16, v51
    v_and_b32 v11, 0xffff0000, v51
    v_add_f32 v10, v10, v30
    v_add_f32 v11, v11, v31
    v_cvt_pk_bf16_f32 v40, v10, v11
    v_sub_f32 v12, v12, v48
    v_sub_f32 v13, v13, v48
    v_cvt_pk_bf16_f32 v51, v12, v13
    v_lshlrev_b32 v12, 16, v51
    v_and_b32 v13, 0xffff0000, v51
    v_mul_f32 v52, v12, v50
    v_fma_f32 v53, -v52, v49, v12
    v_fma_f32 v12, v53, v50, v52
    v_mul_f32 v52, v13, v50
    v_fma_f32 v53, -v52, v49, v13
    v_fma_f32 v13, v53, v50, v52
    v_cvt_pk_bf16_f32 v51, v12, v13
    v_lshlrev_b32 v12, 16, v51
    v_and_b32 v13, 0xffff0000, v51
    v_add_f32 v22, 1.0, v22
    v_add_f32 v23, 1.0, v23
    v_cvt_pk_bf16_f32 v51, v22, v23
    v_lshlrev_b32 v22, 16, v51
    v_and_b32 v23, 0xffff0000, v51
    v_mul_f32 v12, v12, v22
    v_mul_f32 v13, v13, v23
    v_cvt_pk_bf16_f32 v51, v12, v13
    v_lshlrev_b32 v12, 16, v51
    v_and_b32 v13, 0xffff0000, v51
    v_add_f32 v12, v12, v32
    v_add_f32 v13, v13, v33
    v_cvt_pk_bf16_f32 v41, v12, v13
    v_sub_f32 v14, v14, v48
    v_sub_f32 v15, v15, v48
    v_cvt_pk_bf16_f32 v51, v14, v15
    v_lshlrev_b32 v14, 16, v51
    v_and_b32 v15, 0xffff0000, v51
    v_mul_f32 v52, v14, v50
    v_fma_f32 v53, -v52, v49, v14
    v_fma_f32 v14, v53, v50, v52
    v_mul_f32 v52, v15, v50
    v_fma_f32 v53, -v52, v49, v15
    v_fma_f32 v15, v53, v50, v52
    v_cvt_pk_bf16_f32 v51, v14, v15
    v_lshlrev_b32 v14, 16, v51
    v_and_b32 v15, 0xffff0000, v51
    v_add_f32 v24, 1.0, v24
    v_add_f32 v25, 1.0, v25
    v_cvt_pk_bf16_f32 v51, v24, v25
    v_lshlrev_b32 v24, 16, v51
    v_and_b32 v25, 0xffff0000, v51
    v_mul_f32 v14, v14, v24
    v_mul_f32 v15, v15, v25
    v_cvt_pk_bf16_f32 v51, v14, v15
    v_lshlrev_b32 v14, 16, v51
    v_and_b32 v15, 0xffff0000, v51
    v_add_f32 v14, v14, v34
    v_add_f32 v15, v15, v35
    v_cvt_pk_bf16_f32 v42, v14, v15
    v_sub_f32 v16, v16, v48
    v_sub_f32 v17, v17, v48
    v_cvt_pk_bf16_f32 v51, v16, v17
    v_lshlrev_b32 v16, 16, v51
    v_and_b32 v17, 0xffff0000, v51
    v_mul_f32 v52, v16, v50
    v_fma_f32 v53, -v52, v49, v16
    v_fma_f32 v16, v53, v50, v52
    v_mul_f32 v52, v17, v50
    v_fma_f32 v53, -v52, v49, v17
    v_fma_f32 v17, v53, v50, v52
    v_cvt_pk_bf16_f32 v51, v16, v17
    v_lshlrev_b32 v16, 16, v51
    v_and_b32 v17, 0xffff0000, v51
    v_add_f32 v26, 1.0, v26
    v_add_f32 v27, 1.0, v27
    v_cvt_pk_bf16_f32 v51, v26, v27
    v_lshlrev_b32 v26, 16, v51
    v_and_b32 v27, 0xffff0000, v51
    v_mul_f32 v16, v16, v26
    v_mul_f32 v17, v17, v27
    v_cvt_pk_bf16_f32 v51, v16, v17
    v_lshlrev_b32 v16, 16, v51
    v_and_b32 v17, 0xffff0000, v51
    v_add_f32 v16, v16, v36
    v_add_f32 v17, v17, v37
    v_cvt_pk_bf16_f32 v43, v16, v17
    v_sub_f32 v18, v18, v48
    v_sub_f32 v19, v19, v48
    v_cvt_pk_bf16_f32 v51, v18, v19
    v_lshlrev_b32 v18, 16, v51
    v_and_b32 v19, 0xffff0000, v51
    v_mul_f32 v52, v18, v50
    v_fma_f32 v53, -v52, v49, v18
    v_fma_f32 v18, v53, v50, v52
    v_mul_f32 v52, v19, v50
    v_fma_f32 v53, -v52, v49, v19
    v_fma_f32 v19, v53, v50, v52
    v_cvt_pk_bf16_f32 v51, v18, v19
    v_lshlrev_b32 v18, 16, v51
    v_and_b32 v19, 0xffff0000, v51
    v_add_f32 v28, 1.0, v28
    v_add_f32 v29, 1.0, v29
    v_cvt_pk_bf16_f32 v51, v28, v29
    v_lshlrev_b32 v28, 16, v51
    v_and_b32 v29, 0xffff0000, v51
    v_mul_f32 v18, v18, v28
    v_mul_f32 v19, v19, v29
    v_cvt_pk_bf16_f32 v51, v18, v19
    v_lshlrev_b32 v18, 16, v51
    v_and_b32 v19, 0xffff0000, v51
    v_add_f32 v18, v18, v38
    v_add_f32 v19, v19, v39
    v_cvt_pk_bf16_f32 v44, v18, v19
    buffer_store_dword v40, v2, s[16:19], 0 offen offset:0
    buffer_store_dword v41, v2, s[16:19], 0 offen offset:256
    buffer_store_dword v42, v2, s[16:19], 0 offen offset:512
    buffer_store_dword v43, v2, s[16:19], 0 offen offset:768
    s_mov_b64 exec, s[20:21]
    buffer_store_dword v44, v2, s[16:19], 0 offen offset:1024
ln1_done:
    s_endpgm

.globl attn_kernel
.p2align 8
.type attn_kernel,@function
attn_kernel:
    s_cmp_ge_u32 s2, 256
    s_cbranch_scc1 attn_done
    s_load_dwordx2 s[8:9], s[0:1], 8
    s_load_dwordx2 s[12:13], s[0:1], 16
    s_load_dwordx2 s[16:17], s[0:1], 24
    s_load_dwordx2 s[20:21], s[0:1], 96
    s_load_dwordx2 s[24:25], s[0:1], 96
    s_load_dwordx2 s[40:41], s[0:1], 32
    s_load_dwordx2 s[44:45], s[0:1], 48
    s_load_dwordx2 s[48:49], s[0:1], 56
    s_and_b32 s3, s2, 31
    s_lshr_b32 s4, s2, 5
    v_lshrrev_b32 v4, 6, v0
    v_and_b32 v1, 63, v0
    v_readfirstlane_b32 s5, v4
    v_and_b32 v2, 31, v0
    v_lshrrev_b32 v3, 5, v1
    v_and_b32 v4, 15, v2
    v_lshlrev_b32 v5, 8, v2
    v_add_u32 v6, 0, v3
    v_xor_b32 v6, v6, v4
    v_lshl_add_u32 v8, v6, 4, v5
    v_add_u32 v6, 2, v3
    v_xor_b32 v6, v6, v4
    v_lshl_add_u32 v9, v6, 4, v5
    v_add_u32 v6, 4, v3
    v_xor_b32 v6, v6, v4
    v_lshl_add_u32 v10, v6, 4, v5
    v_add_u32 v6, 6, v3
    v_xor_b32 v6, v6, v4
    v_lshl_add_u32 v11, v6, 4, v5
    v_add_u32 v6, 8, v3
    v_xor_b32 v6, v6, v4
    v_lshl_add_u32 v12, v6, 4, v5
    v_add_u32 v6, 10, v3
    v_xor_b32 v6, v6, v4
    v_lshl_add_u32 v13, v6, 4, v5
    v_add_u32 v6, 12, v3
    v_xor_b32 v6, v6, v4
    v_lshl_add_u32 v14, v6, 4, v5
    v_add_u32 v6, 14, v3
    v_xor_b32 v6, v6, v4
    v_lshl_add_u32 v15, v6, 4, v5
    v_bfe_u32 v4, v1, 2, 2
    v_and_b32 v5, 3, v1
    v_bfe_u32 v6, v1, 4, 1
    v_lshlrev_b32 v5, 3, v5
    v_lshl_add_u32 v5, v6, 5, v5
    v_lshl_add_u32 v5, v4, 8, v5
    v_xor_b32 v6, 0, v4
    v_lshl_add_u32 v6, v6, 6, v5
    v_lshl_add_u32 v200, v3, 11, v6
    v_lshl_add_u32 v16, v3, 10, v6
    v_add_u32 v16, 0x10000, v16
    v_xor_b32 v6, 1, v4
    v_lshl_add_u32 v6, v6, 6, v5
    v_lshl_add_u32 v201, v3, 11, v6
    v_lshl_add_u32 v17, v3, 10, v6
    v_add_u32 v17, 0x10000, v17
    v_xor_b32 v6, 2, v4
    v_lshl_add_u32 v6, v6, 6, v5
    v_lshl_add_u32 v202, v3, 11, v6
    v_lshl_add_u32 v18, v3, 10, v6
    v_add_u32 v18, 0x10000, v18
    v_xor_b32 v6, 3, v4
    v_lshl_add_u32 v6, v6, 6, v5
    v_lshl_add_u32 v203, v3, 11, v6
    v_lshl_add_u32 v19, v3, 10, v6
    v_add_u32 v19, 0x10000, v19
    v_lshrrev_b32 v4, 4, v1
    v_and_b32 v5, 15, v1
    v_add_u32 v6, 0, v4
    v_xor_b32 v6, v6, v5
    v_lshlrev_b32 v6, 4, v6
    v_lshl_add_u32 v20, v4, 8, v6
    v_add_u32 v6, 4, v4
    v_xor_b32 v6, v6, v5
    v_lshlrev_b32 v6, 4, v6
    v_lshl_add_u32 v21, v4, 8, v6
    v_add_u32 v6, 8, v4
    v_xor_b32 v6, v6, v5
    v_lshlrev_b32 v6, 4, v6
    v_lshl_add_u32 v22, v4, 8, v6
    v_add_u32 v6, 12, v4
    v_xor_b32 v6, v6, v5
    v_lshlrev_b32 v6, 4, v6
    v_lshl_add_u32 v23, v4, 8, v6
    v_lshlrev_b32 v6, 2, v4
    v_xor_b32 v6, v6, v5
    v_lshlrev_b32 v6, 4, v6
    v_lshl_add_u32 v24, v4, 8, v6
    v_lshl_add_u32 v25, v4, 13, v6
    v_lshrrev_b32 v4, 3, v1
    v_and_b32 v5, 7, v1
    v_lshrrev_b32 v6, 4, v1
    s_movk_i32 s6, 1152
    v_add_u32 v7, 0, v6
    v_xor_b32 v7, v7, v5
    v_lshlrev_b32 v7, 4, v7
    v_add_u32 v204, 0, v4
    v_mul_lo_u32 v204, v204, s6
    v_add_u32 v204, v204, v7
    v_add_u32 v7, 4, v6
    v_xor_b32 v7, v7, v5
    v_lshlrev_b32 v7, 4, v7
    v_add_u32 v205, 8, v4
    v_mul_lo_u32 v205, v205, s6
    v_add_u32 v205, v205, v7
    v_subrev_u32 v205, 1024, v205
    v_add_u32 v7, 0, v6
    v_xor_b32 v7, v7, v5
    v_lshlrev_b32 v7, 4, v7
    v_add_u32 v206, 16, v4
    v_mul_lo_u32 v206, v206, s6
    v_add_u32 v206, v206, v7
    v_subrev_u32 v206, 2048, v206
    v_add_u32 v7, 4, v6
    v_xor_b32 v7, v7, v5
    v_lshlrev_b32 v7, 4, v7
    v_add_u32 v207, 24, v4
    v_mul_lo_u32 v207, v207, s6
    v_add_u32 v207, v207, v7
    v_subrev_u32 v207, 3072, v207
    v_add_u32 v232, 0, v25
    v_add_u32 v233, 31744, v25
    v_add_u32 v234, 63488, v25
    v_add_u32 v235, 95232, v25
    v_bfe_u32 v4, v2, 1, 3
    v_lshlrev_b32 v5, 7, v2
    s_lshl_b32 s6, s5, 13
    v_add_u32 v5, s6, v5
    v_add_u32 v6, 0, v3
    v_xor_b32 v6, v6, v4
    v_lshl_add_u32 v236, v6, 4, v5
    v_add_u32 v6, 2, v3
    v_xor_b32 v6, v6, v4
    v_lshl_add_u32 v237, v6, 4, v5
    v_add_u32 v6, 4, v3
    v_xor_b32 v6, v6, v4
    v_lshl_add_u32 v238, v6, 4, v5
    v_add_u32 v6, 6, v3
    v_xor_b32 v6, v6, v4
    v_lshl_add_u32 v239, v6, 4, v5
    v_add_u32 v200, 32768, v200
    v_add_u32 v201, 32768, v201
    v_add_u32 v202, 32768, v202
    v_add_u32 v203, 32768, v203
    s_lshl_b32 s30, s5, 12
    s_lshl_b32 s28, s3, 19
    s_add_u32 s28, s28, s30
    s_mov_b32 s29, s28
    s_mov_b32 s32, 0x4b800000
    s_lshl_b32 s33, s3, 8
    s_lshl_b32 s6, s5, 17
    s_add_u32 s33, s33, s6
    s_lshl_b32 s37, s5, 13
    s_lshl_b32 s6, s4, 8
    s_lshl_b32 s7, s5, 6
    s_add_u32 s6, s6, s7
    s_mul_i32 s34, s6, 1152
    s_lshl_b32 s35, s6, 8
    s_lshl_b32 s7, s3, 19
    s_add_u32 s35, s35, s7
    s_waitcnt lgkmcnt(0)
    s_and_b32 s9, s9, 0xffff
    s_mov_b32 s10, 0x1000000
    s_mov_b32 s11, 0x00020000
    s_and_b32 s13, s13, 0xffff
    s_mov_b32 s14, 0x1000000
    s_mov_b32 s15, 0x00020000
    s_and_b32 s17, s17, 0xffff
    s_mov_b32 s18, 0x480000
    s_mov_b32 s19, 0x00020000
    s_add_u32 s20, s20, 0x100000
    s_addc_u32 s21, s21, 0
    s_and_b32 s21, s21, 0xffff
    s_mov_b32 s22, 0x240000
    s_mov_b32 s23, 0x00020000
    s_add_u32 s24, s24, 0x1000000
    s_addc_u32 s25, s25, 0
    s_and_b32 s25, s25, 0xffff
    s_mov_b32 s26, 0x1000000
    s_mov_b32 s27, 0x00020000
    s_and_b32 s41, s41, 0xffff
    s_mov_b32 s42, 0x480000
    s_mov_b32 s43, 0x00020000
    s_and_b32 s45, s45, 0xffff
    s_mov_b32 s46, 0x510000
    s_mov_b32 s47, 0x00020000
    s_and_b32 s49, s49, 0xffff
    s_mov_b32 s50, 0x510000
    s_mov_b32 s51, 0x00020000
    s_add_u32 s38, s34, 36864
    s_add_u32 m0, s37, 0
    s_nop 0
    buffer_load_dwordx4 v204, s[20:23], s34 offen offset:0 lds
    buffer_load_dwordx4 v205, s[20:23], s34 offen offset:1024 lds
    buffer_load_dwordx4 v206, s[20:23], s34 offen offset:2048 lds
    buffer_load_dwordx4 v207, s[20:23], s34 offen offset:3072 lds
    s_add_u32 m0, s37, 4096
    s_nop 0
    buffer_load_dwordx4 v204, s[20:23], s38 offen offset:0 lds
    buffer_load_dwordx4 v205, s[20:23], s38 offen offset:1024 lds
    buffer_load_dwordx4 v206, s[20:23], s38 offen offset:2048 lds
    buffer_load_dwordx4 v207, s[20:23], s38 offen offset:3072 lds
    s_add_u32 m0, s30, 32768
    s_nop 0
    buffer_load_dwordx4 v232, s[16:19], s33 offen offset:0 lds
    buffer_load_dwordx4 v233, s[16:19], s33 offen offset:1024 lds
    buffer_load_dwordx4 v234, s[16:19], s33 offen offset:2048 lds
    buffer_load_dwordx4 v235, s[16:19], s33 offen offset:3072 lds
    s_add_u32 s34, s34, 128
    s_add_u32 s38, s38, 128
    s_add_u32 s33, s33, 524288
    s_add_u32 m0, s37, 49152
    s_nop 0
    buffer_load_dwordx4 v204, s[20:23], s34 offen offset:0 lds
    buffer_load_dwordx4 v205, s[20:23], s34 offen offset:1024 lds
    buffer_load_dwordx4 v206, s[20:23], s34 offen offset:2048 lds
    buffer_load_dwordx4 v207, s[20:23], s34 offen offset:3072 lds
    s_add_u32 m0, s37, 53248
    s_nop 0
    buffer_load_dwordx4 v204, s[20:23], s38 offen offset:0 lds
    buffer_load_dwordx4 v205, s[20:23], s38 offen offset:1024 lds
    buffer_load_dwordx4 v206, s[20:23], s38 offen offset:2048 lds
    buffer_load_dwordx4 v207, s[20:23], s38 offen offset:3072 lds
    s_add_u32 m0, s30, 81920
    s_nop 0
    buffer_load_dwordx4 v232, s[16:19], s33 offen offset:0 lds
    buffer_load_dwordx4 v233, s[16:19], s33 offen offset:1024 lds
    buffer_load_dwordx4 v234, s[16:19], s33 offen offset:2048 lds
    buffer_load_dwordx4 v235, s[16:19], s33 offen offset:3072 lds
    s_add_u32 s34, s34, 128
    s_add_u32 s38, s38, 128
    s_add_u32 s33, s33, 524288
    s_add_u32 m0, s37, 98304
    s_nop 0
    buffer_load_dwordx4 v204, s[20:23], s34 offen offset:0 lds
    buffer_load_dwordx4 v205, s[20:23], s34 offen offset:1024 lds
    buffer_load_dwordx4 v206, s[20:23], s34 offen offset:2048 lds
    buffer_load_dwordx4 v207, s[20:23], s34 offen offset:3072 lds
    s_add_u32 m0, s37, 102400
    s_nop 0
    buffer_load_dwordx4 v204, s[20:23], s38 offen offset:0 lds
    buffer_load_dwordx4 v205, s[20:23], s38 offen offset:1024 lds
    buffer_load_dwordx4 v206, s[20:23], s38 offen offset:2048 lds
    buffer_load_dwordx4 v207, s[20:23], s38 offen offset:3072 lds
    s_add_u32 m0, s30, 131072
    s_nop 0
    buffer_load_dwordx4 v232, s[16:19], s33 offen offset:0 lds
    buffer_load_dwordx4 v233, s[16:19], s33 offen offset:1024 lds
    buffer_load_dwordx4 v234, s[16:19], s33 offen offset:2048 lds
    buffer_load_dwordx4 v235, s[16:19], s33 offen offset:3072 lds
    s_add_u32 s34, s34, 128
    s_add_u32 s38, s38, 128
    s_add_u32 s33, s33, 524288
    s_waitcnt vmcnt(24)
    s_barrier
    ds_read_b128 v[240:243], v236 offset:0
    ds_read_b128 v[244:247], v236 offset:4096
    ds_read_b64_tr_b16 v[168:169], v200 offset:0
    ds_read_b64_tr_b16 v[170:171], v200 offset:1024
    ds_read_b64_tr_b16 v[172:173], v201 offset:0
    ds_read_b64_tr_b16 v[174:175], v201 offset:1024
    ds_read_b64_tr_b16 v[176:177], v202 offset:0
    ds_read_b64_tr_b16 v[178:179], v202 offset:1024
    ds_read_b64_tr_b16 v[180:181], v203 offset:0
    ds_read_b64_tr_b16 v[182:183], v203 offset:1024
    ds_read_b64_tr_b16 v[184:185], v200 offset:4096
    ds_read_b64_tr_b16 v[186:187], v200 offset:5120
    s_waitcnt lgkmcnt(8)
    v_mfma_f32_32x32x16_bf16 v[40:55], v[168:171], v[240:243], 0
    ds_read_b128 v[248:251], v237 offset:0
    ds_read_b128 v[252:255], v237 offset:4096
    ds_read_b64_tr_b16 v[188:189], v201 offset:4096
    ds_read_b64_tr_b16 v[190:191], v201 offset:5120
    v_accvgpr_write_b32 a0, 0
    v_mfma_f32_32x32x16_bf16 v[104:119], v[168:171], v[244:247], 0
    v_accvgpr_write_b32 a1, 0
    s_waitcnt lgkmcnt(10)
    v_mfma_f32_32x32x16_bf16 v[56:71], v[172:175], v[240:243], 0
    ds_read_b64_tr_b16 v[192:193], v202 offset:4096
    ds_read_b64_tr_b16 v[194:195], v202 offset:5120
    v_accvgpr_write_b32 a2, 0
    v_mfma_f32_32x32x16_bf16 v[120:135], v[172:175], v[244:247], 0
    v_accvgpr_write_b32 a3, 0
    s_waitcnt lgkmcnt(10)
    v_mfma_f32_32x32x16_bf16 v[72:87], v[176:179], v[240:243], 0
    ds_read_b64_tr_b16 v[196:197], v203 offset:4096
    ds_read_b64_tr_b16 v[198:199], v203 offset:5120
    v_accvgpr_write_b32 a4, 0
    v_mfma_f32_32x32x16_bf16 v[136:151], v[176:179], v[244:247], 0
    v_accvgpr_write_b32 a5, 0
    s_waitcnt lgkmcnt(10)
    v_mfma_f32_32x32x16_bf16 v[88:103], v[180:183], v[240:243], 0
    ds_read_b64_tr_b16 v[168:169], v200 offset:8192
    ds_read_b64_tr_b16 v[170:171], v200 offset:9216
    v_accvgpr_write_b32 a6, 0
    v_mfma_f32_32x32x16_bf16 v[152:167], v[180:183], v[244:247], 0
    v_accvgpr_write_b32 a7, 0
    s_waitcnt lgkmcnt(8)
    v_mfma_f32_32x32x16_bf16 v[40:55], v[184:187], v[248:251], v[40:55]
    ds_read_b128 v[240:243], v238 offset:0
    ds_read_b128 v[244:247], v238 offset:4096
    ds_read_b64_tr_b16 v[172:173], v201 offset:8192
    ds_read_b64_tr_b16 v[174:175], v201 offset:9216
    v_accvgpr_write_b32 a8, 0
    v_mfma_f32_32x32x16_bf16 v[104:119], v[184:187], v[252:255], v[104:119]
    v_accvgpr_write_b32 a9, 0
    s_waitcnt lgkmcnt(10)
    v_mfma_f32_32x32x16_bf16 v[56:71], v[188:191], v[248:251], v[56:71]
    ds_read_b64_tr_b16 v[176:177], v202 offset:8192
    ds_read_b64_tr_b16 v[178:179], v202 offset:9216
    v_accvgpr_write_b32 a10, 0
    v_mfma_f32_32x32x16_bf16 v[120:135], v[188:191], v[252:255], v[120:135]
    v_accvgpr_write_b32 a11, 0
    s_waitcnt lgkmcnt(10)
    v_mfma_f32_32x32x16_bf16 v[72:87], v[192:195], v[248:251], v[72:87]
    ds_read_b64_tr_b16 v[180:181], v203 offset:8192
    ds_read_b64_tr_b16 v[182:183], v203 offset:9216
    v_accvgpr_write_b32 a12, 0
    v_mfma_f32_32x32x16_bf16 v[136:151], v[192:195], v[252:255], v[136:151]
    v_accvgpr_write_b32 a13, 0
    s_waitcnt lgkmcnt(10)
    v_mfma_f32_32x32x16_bf16 v[88:103], v[196:199], v[248:251], v[88:103]
    ds_read_b64_tr_b16 v[184:185], v200 offset:12288
    ds_read_b64_tr_b16 v[186:187], v200 offset:13312
    v_accvgpr_write_b32 a14, 0
    v_mfma_f32_32x32x16_bf16 v[152:167], v[196:199], v[252:255], v[152:167]
    v_accvgpr_write_b32 a15, 0
    s_waitcnt lgkmcnt(8)
    v_mfma_f32_32x32x16_bf16 v[40:55], v[168:171], v[240:243], v[40:55]
    ds_read_b128 v[248:251], v239 offset:0
    ds_read_b128 v[252:255], v239 offset:4096
    ds_read_b64_tr_b16 v[188:189], v201 offset:12288
    ds_read_b64_tr_b16 v[190:191], v201 offset:13312
    v_accvgpr_write_b32 a16, 0
    v_mfma_f32_32x32x16_bf16 v[104:119], v[168:171], v[244:247], v[104:119]
    v_accvgpr_write_b32 a17, 0
    s_waitcnt lgkmcnt(10)
    v_mfma_f32_32x32x16_bf16 v[56:71], v[172:175], v[240:243], v[56:71]
    ds_read_b64_tr_b16 v[192:193], v202 offset:12288
    ds_read_b64_tr_b16 v[194:195], v202 offset:13312
    v_accvgpr_write_b32 a18, 0
    v_mfma_f32_32x32x16_bf16 v[120:135], v[172:175], v[244:247], v[120:135]
    v_accvgpr_write_b32 a19, 0
    s_waitcnt lgkmcnt(10)
    v_mfma_f32_32x32x16_bf16 v[72:87], v[176:179], v[240:243], v[72:87]
    ds_read_b64_tr_b16 v[196:197], v203 offset:12288
    ds_read_b64_tr_b16 v[198:199], v203 offset:13312
    v_accvgpr_write_b32 a20, 0
    v_mfma_f32_32x32x16_bf16 v[136:151], v[176:179], v[244:247], v[136:151]
    v_accvgpr_write_b32 a21, 0
    s_waitcnt lgkmcnt(10)
    v_mfma_f32_32x32x16_bf16 v[88:103], v[180:183], v[240:243], v[88:103]
    v_accvgpr_write_b32 a22, 0
    v_mfma_f32_32x32x16_bf16 v[152:167], v[180:183], v[244:247], v[152:167]
    v_accvgpr_write_b32 a23, 0
    s_waitcnt lgkmcnt(6)
    v_mfma_f32_32x32x16_bf16 v[40:55], v[184:187], v[248:251], v[40:55]
    s_waitcnt vmcnt(12) lgkmcnt(0)
    s_barrier
    v_add_u32 v236, 49152, v236
    v_add_u32 v237, 49152, v237
    v_add_u32 v238, 49152, v238
    v_add_u32 v239, 49152, v239
    v_add_u32 v200, 49152, v200
    v_add_u32 v201, 49152, v201
    v_add_u32 v202, 49152, v202
    v_add_u32 v203, 49152, v203
    ds_read_b128 v[240:243], v236 offset:0
    ds_read_b128 v[244:247], v236 offset:4096
    ds_read_b64_tr_b16 v[168:169], v200 offset:0
    ds_read_b64_tr_b16 v[170:171], v200 offset:1024
    ds_read_b64_tr_b16 v[172:173], v201 offset:0
    ds_read_b64_tr_b16 v[174:175], v201 offset:1024
    s_add_u32 m0, s37, 0
    s_nop 0
    v_accvgpr_write_b32 a24, 0
    v_mfma_f32_32x32x16_bf16 v[104:119], v[184:187], v[252:255], v[104:119]
    buffer_load_dwordx4 v204, s[20:23], s34 offen offset:0 lds
    v_accvgpr_write_b32 a25, 0
    s_waitcnt lgkmcnt(10)
    v_mfma_f32_32x32x16_bf16 v[56:71], v[188:191], v[248:251], v[56:71]
    ds_read_b64_tr_b16 v[176:177], v202 offset:0
    ds_read_b64_tr_b16 v[178:179], v202 offset:1024
    buffer_load_dwordx4 v205, s[20:23], s34 offen offset:1024 lds
    v_accvgpr_write_b32 a26, 0
    v_mfma_f32_32x32x16_bf16 v[120:135], v[188:191], v[252:255], v[120:135]
    buffer_load_dwordx4 v206, s[20:23], s34 offen offset:2048 lds
    v_accvgpr_write_b32 a27, 0
    s_waitcnt lgkmcnt(10)
    v_mfma_f32_32x32x16_bf16 v[72:87], v[192:195], v[248:251], v[72:87]
    ds_read_b64_tr_b16 v[180:181], v203 offset:0
    ds_read_b64_tr_b16 v[182:183], v203 offset:1024
    buffer_load_dwordx4 v207, s[20:23], s34 offen offset:3072 lds
    v_accvgpr_write_b32 a28, 0
    v_mfma_f32_32x32x16_bf16 v[136:151], v[192:195], v[252:255], v[136:151]
    s_add_u32 m0, s37, 4096
    s_nop 0
    v_accvgpr_write_b32 a29, 0
    s_waitcnt lgkmcnt(10)
    v_mfma_f32_32x32x16_bf16 v[88:103], v[196:199], v[248:251], v[88:103]
    ds_read_b64_tr_b16 v[184:185], v200 offset:4096
    ds_read_b64_tr_b16 v[186:187], v200 offset:5120
    buffer_load_dwordx4 v204, s[20:23], s38 offen offset:0 lds
    v_accvgpr_write_b32 a30, 0
    v_mfma_f32_32x32x16_bf16 v[152:167], v[196:199], v[252:255], v[152:167]
    buffer_load_dwordx4 v205, s[20:23], s38 offen offset:1024 lds
    v_accvgpr_write_b32 a31, 0
    s_waitcnt lgkmcnt(8)
    v_mfma_f32_32x32x16_bf16 v[40:55], v[168:171], v[240:243], v[40:55]
    ds_read_b128 v[248:251], v237 offset:0
    ds_read_b128 v[252:255], v237 offset:4096
    ds_read_b64_tr_b16 v[188:189], v201 offset:4096
    ds_read_b64_tr_b16 v[190:191], v201 offset:5120
    buffer_load_dwordx4 v206, s[20:23], s38 offen offset:2048 lds
    v_accvgpr_write_b32 a32, 0
    v_mfma_f32_32x32x16_bf16 v[104:119], v[168:171], v[244:247], v[104:119]
    buffer_load_dwordx4 v207, s[20:23], s38 offen offset:3072 lds
    v_accvgpr_write_b32 a33, 0
    s_waitcnt lgkmcnt(10)
    v_mfma_f32_32x32x16_bf16 v[56:71], v[172:175], v[240:243], v[56:71]
    ds_read_b64_tr_b16 v[192:193], v202 offset:4096
    ds_read_b64_tr_b16 v[194:195], v202 offset:5120
    s_add_u32 m0, s30, 32768
    s_nop 0
    v_accvgpr_write_b32 a34, 0
    v_mfma_f32_32x32x16_bf16 v[120:135], v[172:175], v[244:247], v[120:135]
    buffer_load_dwordx4 v232, s[16:19], s33 offen offset:0 lds
    v_accvgpr_write_b32 a35, 0
    s_waitcnt lgkmcnt(10)
    v_mfma_f32_32x32x16_bf16 v[72:87], v[176:179], v[240:243], v[72:87]
    ds_read_b64_tr_b16 v[196:197], v203 offset:4096
    ds_read_b64_tr_b16 v[198:199], v203 offset:5120
    buffer_load_dwordx4 v233, s[16:19], s33 offen offset:1024 lds
    v_accvgpr_write_b32 a36, 0
    v_mfma_f32_32x32x16_bf16 v[136:151], v[176:179], v[244:247], v[136:151]
    buffer_load_dwordx4 v234, s[16:19], s33 offen offset:2048 lds
    v_accvgpr_write_b32 a37, 0
    s_waitcnt lgkmcnt(10)
    v_mfma_f32_32x32x16_bf16 v[88:103], v[180:183], v[240:243], v[88:103]
    ds_read_b64_tr_b16 v[168:169], v200 offset:8192
    ds_read_b64_tr_b16 v[170:171], v200 offset:9216
    buffer_load_dwordx4 v235, s[16:19], s33 offen offset:3072 lds
    v_accvgpr_write_b32 a38, 0
    v_mfma_f32_32x32x16_bf16 v[152:167], v[180:183], v[244:247], v[152:167]
    s_add_u32 s34, s34, 128
    v_accvgpr_write_b32 a39, 0
    s_waitcnt lgkmcnt(8)
    v_mfma_f32_32x32x16_bf16 v[40:55], v[184:187], v[248:251], v[40:55]
    ds_read_b128 v[240:243], v238 offset:0
    ds_read_b128 v[244:247], v238 offset:4096
    ds_read_b64_tr_b16 v[172:173], v201 offset:8192
    ds_read_b64_tr_b16 v[174:175], v201 offset:9216
    s_add_u32 s38, s38, 128
    v_accvgpr_write_b32 a40, 0
    v_mfma_f32_32x32x16_bf16 v[104:119], v[184:187], v[252:255], v[104:119]
    s_add_u32 s33, s33, 524288
    v_accvgpr_write_b32 a41, 0
    s_waitcnt lgkmcnt(10)
    v_mfma_f32_32x32x16_bf16 v[56:71], v[188:191], v[248:251], v[56:71]
    ds_read_b64_tr_b16 v[176:177], v202 offset:8192
    ds_read_b64_tr_b16 v[178:179], v202 offset:9216
    v_accvgpr_write_b32 a42, 0
    v_mfma_f32_32x32x16_bf16 v[120:135], v[188:191], v[252:255], v[120:135]
    v_accvgpr_write_b32 a43, 0
    s_waitcnt lgkmcnt(10)
    v_mfma_f32_32x32x16_bf16 v[72:87], v[192:195], v[248:251], v[72:87]
    ds_read_b64_tr_b16 v[180:181], v203 offset:8192
    ds_read_b64_tr_b16 v[182:183], v203 offset:9216
    v_accvgpr_write_b32 a44, 0
    v_mfma_f32_32x32x16_bf16 v[136:151], v[192:195], v[252:255], v[136:151]
    v_accvgpr_write_b32 a45, 0
    s_waitcnt lgkmcnt(10)
    v_mfma_f32_32x32x16_bf16 v[88:103], v[196:199], v[248:251], v[88:103]
    ds_read_b64_tr_b16 v[184:185], v200 offset:12288
    ds_read_b64_tr_b16 v[186:187], v200 offset:13312
    v_accvgpr_write_b32 a46, 0
    v_mfma_f32_32x32x16_bf16 v[152:167], v[196:199], v[252:255], v[152:167]
    v_accvgpr_write_b32 a47, 0
    s_waitcnt lgkmcnt(8)
    v_mfma_f32_32x32x16_bf16 v[40:55], v[168:171], v[240:243], v[40:55]
    ds_read_b128 v[248:251], v239 offset:0
    ds_read_b128 v[252:255], v239 offset:4096
    ds_read_b64_tr_b16 v[188:189], v201 offset:12288
    ds_read_b64_tr_b16 v[190:191], v201 offset:13312
    v_accvgpr_write_b32 a48, 0
    v_mfma_f32_32x32x16_bf16 v[104:119], v[168:171], v[244:247], v[104:119]
    v_accvgpr_write_b32 a49, 0
    s_waitcnt lgkmcnt(10)
    v_mfma_f32_32x32x16_bf16 v[56:71], v[172:175], v[240:243], v[56:71]
    ds_read_b64_tr_b16 v[192:193], v202 offset:12288
    ds_read_b64_tr_b16 v[194:195], v202 offset:13312
    v_accvgpr_write_b32 a50, 0
    v_mfma_f32_32x32x16_bf16 v[120:135], v[172:175], v[244:247], v[120:135]
    v_accvgpr_write_b32 a51, 0
    s_waitcnt lgkmcnt(10)
    v_mfma_f32_32x32x16_bf16 v[72:87], v[176:179], v[240:243], v[72:87]
    ds_read_b64_tr_b16 v[196:197], v203 offset:12288
    ds_read_b64_tr_b16 v[198:199], v203 offset:13312
    v_accvgpr_write_b32 a52, 0
    v_mfma_f32_32x32x16_bf16 v[136:151], v[176:179], v[244:247], v[136:151]
    v_accvgpr_write_b32 a53, 0
    s_waitcnt lgkmcnt(10)
    v_mfma_f32_32x32x16_bf16 v[88:103], v[180:183], v[240:243], v[88:103]
    v_accvgpr_write_b32 a54, 0
    v_mfma_f32_32x32x16_bf16 v[152:167], v[180:183], v[244:247], v[152:167]
    v_accvgpr_write_b32 a55, 0
    s_waitcnt lgkmcnt(6)
    v_mfma_f32_32x32x16_bf16 v[40:55], v[184:187], v[248:251], v[40:55]
    s_waitcnt vmcnt(12) lgkmcnt(0)
    s_barrier
    v_add_u32 v236, 49152, v236
    v_add_u32 v237, 49152, v237
    v_add_u32 v238, 49152, v238
    v_add_u32 v239, 49152, v239
    v_add_u32 v200, 49152, v200
    v_add_u32 v201, 49152, v201
    v_add_u32 v202, 49152, v202
    v_add_u32 v203, 49152, v203
    ds_read_b128 v[240:243], v236 offset:0
    ds_read_b128 v[244:247], v236 offset:4096
    ds_read_b64_tr_b16 v[168:169], v200 offset:0
    ds_read_b64_tr_b16 v[170:171], v200 offset:1024
    ds_read_b64_tr_b16 v[172:173], v201 offset:0
    ds_read_b64_tr_b16 v[174:175], v201 offset:1024
    s_add_u32 m0, s37, 49152
    s_nop 0
    v_accvgpr_write_b32 a56, 0
    v_mfma_f32_32x32x16_bf16 v[104:119], v[184:187], v[252:255], v[104:119]
    buffer_load_dwordx4 v204, s[20:23], s34 offen offset:0 lds
    v_accvgpr_write_b32 a57, 0
    s_waitcnt lgkmcnt(10)
    v_mfma_f32_32x32x16_bf16 v[56:71], v[188:191], v[248:251], v[56:71]
    ds_read_b64_tr_b16 v[176:177], v202 offset:0
    ds_read_b64_tr_b16 v[178:179], v202 offset:1024
    buffer_load_dwordx4 v205, s[20:23], s34 offen offset:1024 lds
    v_accvgpr_write_b32 a58, 0
    v_mfma_f32_32x32x16_bf16 v[120:135], v[188:191], v[252:255], v[120:135]
    buffer_load_dwordx4 v206, s[20:23], s34 offen offset:2048 lds
    v_accvgpr_write_b32 a59, 0
    s_waitcnt lgkmcnt(10)
    v_mfma_f32_32x32x16_bf16 v[72:87], v[192:195], v[248:251], v[72:87]
    ds_read_b64_tr_b16 v[180:181], v203 offset:0
    ds_read_b64_tr_b16 v[182:183], v203 offset:1024
    buffer_load_dwordx4 v207, s[20:23], s34 offen offset:3072 lds
    v_accvgpr_write_b32 a60, 0
    v_mfma_f32_32x32x16_bf16 v[136:151], v[192:195], v[252:255], v[136:151]
    s_add_u32 m0, s37, 53248
    s_nop 0
    v_accvgpr_write_b32 a61, 0
    s_waitcnt lgkmcnt(10)
    v_mfma_f32_32x32x16_bf16 v[88:103], v[196:199], v[248:251], v[88:103]
    ds_read_b64_tr_b16 v[184:185], v200 offset:4096
    ds_read_b64_tr_b16 v[186:187], v200 offset:5120
    buffer_load_dwordx4 v204, s[20:23], s38 offen offset:0 lds
    v_accvgpr_write_b32 a62, 0
    v_mfma_f32_32x32x16_bf16 v[152:167], v[196:199], v[252:255], v[152:167]
    buffer_load_dwordx4 v205, s[20:23], s38 offen offset:1024 lds
    v_accvgpr_write_b32 a63, 0
    s_waitcnt lgkmcnt(8)
    v_mfma_f32_32x32x16_bf16 v[40:55], v[168:171], v[240:243], v[40:55]
    ds_read_b128 v[248:251], v237 offset:0
    ds_read_b128 v[252:255], v237 offset:4096
    ds_read_b64_tr_b16 v[188:189], v201 offset:4096
    ds_read_b64_tr_b16 v[190:191], v201 offset:5120
    buffer_load_dwordx4 v206, s[20:23], s38 offen offset:2048 lds
    v_accvgpr_write_b32 a64, 0
    v_mfma_f32_32x32x16_bf16 v[104:119], v[168:171], v[244:247], v[104:119]
    buffer_load_dwordx4 v207, s[20:23], s38 offen offset:3072 lds
    v_accvgpr_write_b32 a65, 0
    s_waitcnt lgkmcnt(10)
    v_mfma_f32_32x32x16_bf16 v[56:71], v[172:175], v[240:243], v[56:71]
    ds_read_b64_tr_b16 v[192:193], v202 offset:4096
    ds_read_b64_tr_b16 v[194:195], v202 offset:5120
    s_add_u32 m0, s30, 81920
    s_nop 0
    v_accvgpr_write_b32 a66, 0
    v_mfma_f32_32x32x16_bf16 v[120:135], v[172:175], v[244:247], v[120:135]
    buffer_load_dwordx4 v232, s[16:19], s33 offen offset:0 lds
    v_accvgpr_write_b32 a67, 0
    s_waitcnt lgkmcnt(10)
    v_mfma_f32_32x32x16_bf16 v[72:87], v[176:179], v[240:243], v[72:87]
    ds_read_b64_tr_b16 v[196:197], v203 offset:4096
    ds_read_b64_tr_b16 v[198:199], v203 offset:5120
    buffer_load_dwordx4 v233, s[16:19], s33 offen offset:1024 lds
    v_accvgpr_write_b32 a68, 0
    v_mfma_f32_32x32x16_bf16 v[136:151], v[176:179], v[244:247], v[136:151]
    buffer_load_dwordx4 v234, s[16:19], s33 offen offset:2048 lds
    v_accvgpr_write_b32 a69, 0
    s_waitcnt lgkmcnt(10)
    v_mfma_f32_32x32x16_bf16 v[88:103], v[180:183], v[240:243], v[88:103]
    ds_read_b64_tr_b16 v[168:169], v200 offset:8192
    ds_read_b64_tr_b16 v[170:171], v200 offset:9216
    buffer_load_dwordx4 v235, s[16:19], s33 offen offset:3072 lds
    v_accvgpr_write_b32 a70, 0
    v_mfma_f32_32x32x16_bf16 v[152:167], v[180:183], v[244:247], v[152:167]
    s_add_u32 s34, s34, 128
    v_accvgpr_write_b32 a71, 0
    s_waitcnt lgkmcnt(8)
    v_mfma_f32_32x32x16_bf16 v[40:55], v[184:187], v[248:251], v[40:55]
    ds_read_b128 v[240:243], v238 offset:0
    ds_read_b128 v[244:247], v238 offset:4096
    ds_read_b64_tr_b16 v[172:173], v201 offset:8192
    ds_read_b64_tr_b16 v[174:175], v201 offset:9216
    s_add_u32 s38, s38, 128
    v_accvgpr_write_b32 a72, 0
    v_mfma_f32_32x32x16_bf16 v[104:119], v[184:187], v[252:255], v[104:119]
    s_add_u32 s33, s33, 524288
    v_accvgpr_write_b32 a73, 0
    s_waitcnt lgkmcnt(10)
    v_mfma_f32_32x32x16_bf16 v[56:71], v[188:191], v[248:251], v[56:71]
    ds_read_b64_tr_b16 v[176:177], v202 offset:8192
    ds_read_b64_tr_b16 v[178:179], v202 offset:9216
    v_accvgpr_write_b32 a74, 0
    v_mfma_f32_32x32x16_bf16 v[120:135], v[188:191], v[252:255], v[120:135]
    v_accvgpr_write_b32 a75, 0
    s_waitcnt lgkmcnt(10)
    v_mfma_f32_32x32x16_bf16 v[72:87], v[192:195], v[248:251], v[72:87]
    ds_read_b64_tr_b16 v[180:181], v203 offset:8192
    ds_read_b64_tr_b16 v[182:183], v203 offset:9216
    v_accvgpr_write_b32 a76, 0
    v_mfma_f32_32x32x16_bf16 v[136:151], v[192:195], v[252:255], v[136:151]
    v_accvgpr_write_b32 a77, 0
    s_waitcnt lgkmcnt(10)
    v_mfma_f32_32x32x16_bf16 v[88:103], v[196:199], v[248:251], v[88:103]
    ds_read_b64_tr_b16 v[184:185], v200 offset:12288
    ds_read_b64_tr_b16 v[186:187], v200 offset:13312
    v_accvgpr_write_b32 a78, 0
    v_mfma_f32_32x32x16_bf16 v[152:167], v[196:199], v[252:255], v[152:167]
    v_accvgpr_write_b32 a79, 0
    s_waitcnt lgkmcnt(8)
    v_mfma_f32_32x32x16_bf16 v[40:55], v[168:171], v[240:243], v[40:55]
    ds_read_b128 v[248:251], v239 offset:0
    ds_read_b128 v[252:255], v239 offset:4096
    ds_read_b64_tr_b16 v[188:189], v201 offset:12288
    ds_read_b64_tr_b16 v[190:191], v201 offset:13312
    v_accvgpr_write_b32 a80, 0
    v_mfma_f32_32x32x16_bf16 v[104:119], v[168:171], v[244:247], v[104:119]
    v_accvgpr_write_b32 a81, 0
    s_waitcnt lgkmcnt(10)
    v_mfma_f32_32x32x16_bf16 v[56:71], v[172:175], v[240:243], v[56:71]
    ds_read_b64_tr_b16 v[192:193], v202 offset:12288
    ds_read_b64_tr_b16 v[194:195], v202 offset:13312
    v_accvgpr_write_b32 a82, 0
    v_mfma_f32_32x32x16_bf16 v[120:135], v[172:175], v[244:247], v[120:135]
    v_accvgpr_write_b32 a83, 0
    s_waitcnt lgkmcnt(10)
    v_mfma_f32_32x32x16_bf16 v[72:87], v[176:179], v[240:243], v[72:87]
    ds_read_b64_tr_b16 v[196:197], v203 offset:12288
    ds_read_b64_tr_b16 v[198:199], v203 offset:13312
    v_accvgpr_write_b32 a84, 0
    v_mfma_f32_32x32x16_bf16 v[136:151], v[176:179], v[244:247], v[136:151]
    v_accvgpr_write_b32 a85, 0
    s_waitcnt lgkmcnt(10)
    v_mfma_f32_32x32x16_bf16 v[88:103], v[180:183], v[240:243], v[88:103]
    v_accvgpr_write_b32 a86, 0
    v_mfma_f32_32x32x16_bf16 v[152:167], v[180:183], v[244:247], v[152:167]
    v_accvgpr_write_b32 a87, 0
    s_waitcnt lgkmcnt(6)
    v_mfma_f32_32x32x16_bf16 v[40:55], v[184:187], v[248:251], v[40:55]
    s_waitcnt vmcnt(12) lgkmcnt(0)
    s_barrier
    v_subrev_u32 v236, 98304, v236
    v_subrev_u32 v237, 98304, v237
    v_subrev_u32 v238, 98304, v238
    v_subrev_u32 v239, 98304, v239
    v_subrev_u32 v200, 98304, v200
    v_subrev_u32 v201, 98304, v201
    v_subrev_u32 v202, 98304, v202
    v_subrev_u32 v203, 98304, v203
    ds_read_b128 v[240:243], v236 offset:0
    ds_read_b128 v[244:247], v236 offset:4096
    ds_read_b64_tr_b16 v[168:169], v200 offset:0
    ds_read_b64_tr_b16 v[170:171], v200 offset:1024
    ds_read_b64_tr_b16 v[172:173], v201 offset:0
    ds_read_b64_tr_b16 v[174:175], v201 offset:1024
    s_add_u32 m0, s37, 98304
    s_nop 0
    v_accvgpr_write_b32 a88, 0
    v_mfma_f32_32x32x16_bf16 v[104:119], v[184:187], v[252:255], v[104:119]
    buffer_load_dwordx4 v204, s[20:23], s34 offen offset:0 lds
    v_accvgpr_write_b32 a89, 0
    s_waitcnt lgkmcnt(10)
    v_mfma_f32_32x32x16_bf16 v[56:71], v[188:191], v[248:251], v[56:71]
    ds_read_b64_tr_b16 v[176:177], v202 offset:0
    ds_read_b64_tr_b16 v[178:179], v202 offset:1024
    buffer_load_dwordx4 v205, s[20:23], s34 offen offset:1024 lds
    v_accvgpr_write_b32 a90, 0
    v_mfma_f32_32x32x16_bf16 v[120:135], v[188:191], v[252:255], v[120:135]
    buffer_load_dwordx4 v206, s[20:23], s34 offen offset:2048 lds
    v_accvgpr_write_b32 a91, 0
    s_waitcnt lgkmcnt(10)
    v_mfma_f32_32x32x16_bf16 v[72:87], v[192:195], v[248:251], v[72:87]
    ds_read_b64_tr_b16 v[180:181], v203 offset:0
    ds_read_b64_tr_b16 v[182:183], v203 offset:1024
    buffer_load_dwordx4 v207, s[20:23], s34 offen offset:3072 lds
    v_accvgpr_write_b32 a92, 0
    v_mfma_f32_32x32x16_bf16 v[136:151], v[192:195], v[252:255], v[136:151]
    s_add_u32 m0, s37, 102400
    s_nop 0
    v_accvgpr_write_b32 a93, 0
    s_waitcnt lgkmcnt(10)
    v_mfma_f32_32x32x16_bf16 v[88:103], v[196:199], v[248:251], v[88:103]
    ds_read_b64_tr_b16 v[184:185], v200 offset:4096
    ds_read_b64_tr_b16 v[186:187], v200 offset:5120
    buffer_load_dwordx4 v204, s[20:23], s38 offen offset:0 lds
    v_accvgpr_write_b32 a94, 0
    v_mfma_f32_32x32x16_bf16 v[152:167], v[196:199], v[252:255], v[152:167]
    buffer_load_dwordx4 v205, s[20:23], s38 offen offset:1024 lds
    v_accvgpr_write_b32 a95, 0
    s_waitcnt lgkmcnt(8)
    v_mfma_f32_32x32x16_bf16 v[40:55], v[168:171], v[240:243], v[40:55]
    ds_read_b128 v[248:251], v237 offset:0
    ds_read_b128 v[252:255], v237 offset:4096
    ds_read_b64_tr_b16 v[188:189], v201 offset:4096
    ds_read_b64_tr_b16 v[190:191], v201 offset:5120
    buffer_load_dwordx4 v206, s[20:23], s38 offen offset:2048 lds
    v_accvgpr_write_b32 a96, 0
    v_mfma_f32_32x32x16_bf16 v[104:119], v[168:171], v[244:247], v[104:119]
    buffer_load_dwordx4 v207, s[20:23], s38 offen offset:3072 lds
    v_accvgpr_write_b32 a97, 0
    s_waitcnt lgkmcnt(10)
    v_mfma_f32_32x32x16_bf16 v[56:71], v[172:175], v[240:243], v[56:71]
    ds_read_b64_tr_b16 v[192:193], v202 offset:4096
    ds_read_b64_tr_b16 v[194:195], v202 offset:5120
    s_add_u32 m0, s30, 131072
    s_nop 0
    v_accvgpr_write_b32 a98, 0
    v_mfma_f32_32x32x16_bf16 v[120:135], v[172:175], v[244:247], v[120:135]
    buffer_load_dwordx4 v232, s[16:19], s33 offen offset:0 lds
    v_accvgpr_write_b32 a99, 0
    s_waitcnt lgkmcnt(10)
    v_mfma_f32_32x32x16_bf16 v[72:87], v[176:179], v[240:243], v[72:87]
    ds_read_b64_tr_b16 v[196:197], v203 offset:4096
    ds_read_b64_tr_b16 v[198:199], v203 offset:5120
    buffer_load_dwordx4 v233, s[16:19], s33 offen offset:1024 lds
    v_accvgpr_write_b32 a100, 0
    v_mfma_f32_32x32x16_bf16 v[136:151], v[176:179], v[244:247], v[136:151]
    buffer_load_dwordx4 v234, s[16:19], s33 offen offset:2048 lds
    v_accvgpr_write_b32 a101, 0
    s_waitcnt lgkmcnt(10)
    v_mfma_f32_32x32x16_bf16 v[88:103], v[180:183], v[240:243], v[88:103]
    ds_read_b64_tr_b16 v[168:169], v200 offset:8192
    ds_read_b64_tr_b16 v[170:171], v200 offset:9216
    buffer_load_dwordx4 v235, s[16:19], s33 offen offset:3072 lds
    v_accvgpr_write_b32 a102, 0
    v_mfma_f32_32x32x16_bf16 v[152:167], v[180:183], v[244:247], v[152:167]
    s_add_u32 s34, s34, 128
    v_accvgpr_write_b32 a103, 0
    s_waitcnt lgkmcnt(8)
    v_mfma_f32_32x32x16_bf16 v[40:55], v[184:187], v[248:251], v[40:55]
    ds_read_b128 v[240:243], v238 offset:0
    ds_read_b128 v[244:247], v238 offset:4096
    ds_read_b64_tr_b16 v[172:173], v201 offset:8192
    ds_read_b64_tr_b16 v[174:175], v201 offset:9216
    s_add_u32 s38, s38, 128
    v_accvgpr_write_b32 a104, 0
    v_mfma_f32_32x32x16_bf16 v[104:119], v[184:187], v[252:255], v[104:119]
    s_add_u32 s33, s33, 524288
    v_accvgpr_write_b32 a105, 0
    s_waitcnt lgkmcnt(10)
    v_mfma_f32_32x32x16_bf16 v[56:71], v[188:191], v[248:251], v[56:71]
    ds_read_b64_tr_b16 v[176:177], v202 offset:8192
    ds_read_b64_tr_b16 v[178:179], v202 offset:9216
    v_accvgpr_write_b32 a106, 0
    v_mfma_f32_32x32x16_bf16 v[120:135], v[188:191], v[252:255], v[120:135]
    v_accvgpr_write_b32 a107, 0
    s_waitcnt lgkmcnt(10)
    v_mfma_f32_32x32x16_bf16 v[72:87], v[192:195], v[248:251], v[72:87]
    ds_read_b64_tr_b16 v[180:181], v203 offset:8192
    ds_read_b64_tr_b16 v[182:183], v203 offset:9216
    v_accvgpr_write_b32 a108, 0
    v_mfma_f32_32x32x16_bf16 v[136:151], v[192:195], v[252:255], v[136:151]
    v_accvgpr_write_b32 a109, 0
    s_waitcnt lgkmcnt(10)
    v_mfma_f32_32x32x16_bf16 v[88:103], v[196:199], v[248:251], v[88:103]
    ds_read_b64_tr_b16 v[184:185], v200 offset:12288
    ds_read_b64_tr_b16 v[186:187], v200 offset:13312
    v_accvgpr_write_b32 a110, 0
    v_mfma_f32_32x32x16_bf16 v[152:167], v[196:199], v[252:255], v[152:167]
    v_accvgpr_write_b32 a111, 0
    s_waitcnt lgkmcnt(8)
    v_mfma_f32_32x32x16_bf16 v[40:55], v[168:171], v[240:243], v[40:55]
    ds_read_b128 v[248:251], v239 offset:0
    ds_read_b128 v[252:255], v239 offset:4096
    ds_read_b64_tr_b16 v[188:189], v201 offset:12288
    ds_read_b64_tr_b16 v[190:191], v201 offset:13312
    v_accvgpr_write_b32 a112, 0
    v_mfma_f32_32x32x16_bf16 v[104:119], v[168:171], v[244:247], v[104:119]
    v_accvgpr_write_b32 a113, 0
    s_waitcnt lgkmcnt(10)
    v_mfma_f32_32x32x16_bf16 v[56:71], v[172:175], v[240:243], v[56:71]
    ds_read_b64_tr_b16 v[192:193], v202 offset:12288
    ds_read_b64_tr_b16 v[194:195], v202 offset:13312
    v_accvgpr_write_b32 a114, 0
    v_mfma_f32_32x32x16_bf16 v[120:135], v[172:175], v[244:247], v[120:135]
    v_accvgpr_write_b32 a115, 0
    s_waitcnt lgkmcnt(10)
    v_mfma_f32_32x32x16_bf16 v[72:87], v[176:179], v[240:243], v[72:87]
    ds_read_b64_tr_b16 v[196:197], v203 offset:12288
    ds_read_b64_tr_b16 v[198:199], v203 offset:13312
    v_accvgpr_write_b32 a116, 0
    v_mfma_f32_32x32x16_bf16 v[136:151], v[176:179], v[244:247], v[136:151]
    v_accvgpr_write_b32 a117, 0
    s_waitcnt lgkmcnt(10)
    v_mfma_f32_32x32x16_bf16 v[88:103], v[180:183], v[240:243], v[88:103]
    v_accvgpr_write_b32 a118, 0
    v_mfma_f32_32x32x16_bf16 v[152:167], v[180:183], v[244:247], v[152:167]
    v_accvgpr_write_b32 a119, 0
    s_waitcnt lgkmcnt(6)
    v_mfma_f32_32x32x16_bf16 v[40:55], v[184:187], v[248:251], v[40:55]
    s_waitcnt vmcnt(12) lgkmcnt(0)
    s_barrier
    v_add_u32 v236, 49152, v236
    v_add_u32 v237, 49152, v237
    v_add_u32 v238, 49152, v238
    v_add_u32 v239, 49152, v239
    v_add_u32 v200, 49152, v200
    v_add_u32 v201, 49152, v201
    v_add_u32 v202, 49152, v202
    v_add_u32 v203, 49152, v203
    ds_read_b128 v[240:243], v236 offset:0
    ds_read_b128 v[244:247], v236 offset:4096
    ds_read_b64_tr_b16 v[168:169], v200 offset:0
    ds_read_b64_tr_b16 v[170:171], v200 offset:1024
    ds_read_b64_tr_b16 v[172:173], v201 offset:0
    ds_read_b64_tr_b16 v[174:175], v201 offset:1024
    s_add_u32 m0, s37, 0
    s_nop 0
    v_accvgpr_write_b32 a120, 0
    v_mfma_f32_32x32x16_bf16 v[104:119], v[184:187], v[252:255], v[104:119]
    buffer_load_dwordx4 v204, s[20:23], s34 offen offset:0 lds
    v_accvgpr_write_b32 a121, 0
    s_waitcnt lgkmcnt(10)
    v_mfma_f32_32x32x16_bf16 v[56:71], v[188:191], v[248:251], v[56:71]
    ds_read_b64_tr_b16 v[176:177], v202 offset:0
    ds_read_b64_tr_b16 v[178:179], v202 offset:1024
    buffer_load_dwordx4 v205, s[20:23], s34 offen offset:1024 lds
    v_accvgpr_write_b32 a122, 0
    v_mfma_f32_32x32x16_bf16 v[120:135], v[188:191], v[252:255], v[120:135]
    buffer_load_dwordx4 v206, s[20:23], s34 offen offset:2048 lds
    v_accvgpr_write_b32 a123, 0
    s_waitcnt lgkmcnt(10)
    v_mfma_f32_32x32x16_bf16 v[72:87], v[192:195], v[248:251], v[72:87]
    ds_read_b64_tr_b16 v[180:181], v203 offset:0
    ds_read_b64_tr_b16 v[182:183], v203 offset:1024
    buffer_load_dwordx4 v207, s[20:23], s34 offen offset:3072 lds
    v_accvgpr_write_b32 a124, 0
    v_mfma_f32_32x32x16_bf16 v[136:151], v[192:195], v[252:255], v[136:151]
    s_add_u32 m0, s37, 4096
    s_nop 0
    v_accvgpr_write_b32 a125, 0
    s_waitcnt lgkmcnt(10)
    v_mfma_f32_32x32x16_bf16 v[88:103], v[196:199], v[248:251], v[88:103]
    ds_read_b64_tr_b16 v[184:185], v200 offset:4096
    ds_read_b64_tr_b16 v[186:187], v200 offset:5120
    buffer_load_dwordx4 v204, s[20:23], s38 offen offset:0 lds
    v_accvgpr_write_b32 a126, 0
    v_mfma_f32_32x32x16_bf16 v[152:167], v[196:199], v[252:255], v[152:167]
    buffer_load_dwordx4 v205, s[20:23], s38 offen offset:1024 lds
    v_accvgpr_write_b32 a127, 0
    s_waitcnt lgkmcnt(8)
    v_mfma_f32_32x32x16_bf16 v[40:55], v[168:171], v[240:243], v[40:55]
    ds_read_b128 v[248:251], v237 offset:0
    ds_read_b128 v[252:255], v237 offset:4096
    ds_read_b64_tr_b16 v[188:189], v201 offset:4096
    ds_read_b64_tr_b16 v[190:191], v201 offset:5120
    buffer_load_dwordx4 v206, s[20:23], s38 offen offset:2048 lds
    v_mfma_f32_32x32x16_bf16 v[104:119], v[168:171], v[244:247], v[104:119]
    buffer_load_dwordx4 v207, s[20:23], s38 offen offset:3072 lds
    s_waitcnt lgkmcnt(10)
    v_mfma_f32_32x32x16_bf16 v[56:71], v[172:175], v[240:243], v[56:71]
    ds_read_b64_tr_b16 v[192:193], v202 offset:4096
    ds_read_b64_tr_b16 v[194:195], v202 offset:5120
    s_add_u32 m0, s30, 32768
    s_nop 0
    v_mfma_f32_32x32x16_bf16 v[120:135], v[172:175], v[244:247], v[120:135]
    buffer_load_dwordx4 v232, s[16:19], s33 offen offset:0 lds
    s_waitcnt lgkmcnt(10)
    v_mfma_f32_32x32x16_bf16 v[72:87], v[176:179], v[240:243], v[72:87]
    ds_read_b64_tr_b16 v[196:197], v203 offset:4096
    ds_read_b64_tr_b16 v[198:199], v203 offset:5120
    buffer_load_dwordx4 v233, s[16:19], s33 offen offset:1024 lds
    v_mfma_f32_32x32x16_bf16 v[136:151], v[176:179], v[244:247], v[136:151]
    buffer_load_dwordx4 v234, s[16:19], s33 offen offset:2048 lds
    s_waitcnt lgkmcnt(10)
    v_mfma_f32_32x32x16_bf16 v[88:103], v[180:183], v[240:243], v[88:103]
    ds_read_b64_tr_b16 v[168:169], v200 offset:8192
    ds_read_b64_tr_b16 v[170:171], v200 offset:9216
    buffer_load_dwordx4 v235, s[16:19], s33 offen offset:3072 lds
    v_mfma_f32_32x32x16_bf16 v[152:167], v[180:183], v[244:247], v[152:167]
    s_add_u32 s34, s34, 128
    s_waitcnt lgkmcnt(8)
    v_mfma_f32_32x32x16_bf16 v[40:55], v[184:187], v[248:251], v[40:55]
    ds_read_b128 v[240:243], v238 offset:0
    ds_read_b128 v[244:247], v238 offset:4096
    ds_read_b64_tr_b16 v[172:173], v201 offset:8192
    ds_read_b64_tr_b16 v[174:175], v201 offset:9216
    s_add_u32 s38, s38, 128
    v_mfma_f32_32x32x16_bf16 v[104:119], v[184:187], v[252:255], v[104:119]
    s_add_u32 s33, s33, 524288
    s_waitcnt lgkmcnt(10)
    v_mfma_f32_32x32x16_bf16 v[56:71], v[188:191], v[248:251], v[56:71]
    ds_read_b64_tr_b16 v[176:177], v202 offset:8192
    ds_read_b64_tr_b16 v[178:179], v202 offset:9216
    v_mfma_f32_32x32x16_bf16 v[120:135], v[188:191], v[252:255], v[120:135]
    s_waitcnt lgkmcnt(10)
    v_mfma_f32_32x32x16_bf16 v[72:87], v[192:195], v[248:251], v[72:87]
    ds_read_b64_tr_b16 v[180:181], v203 offset:8192
    ds_read_b64_tr_b16 v[182:183], v203 offset:9216
    v_mfma_f32_32x32x16_bf16 v[136:151], v[192:195], v[252:255], v[136:151]
    s_waitcnt lgkmcnt(10)
    v_mfma_f32_32x32x16_bf16 v[88:103], v[196:199], v[248:251], v[88:103]
    ds_read_b64_tr_b16 v[184:185], v200 offset:12288
    ds_read_b64_tr_b16 v[186:187], v200 offset:13312
    v_mfma_f32_32x32x16_bf16 v[152:167], v[196:199], v[252:255], v[152:167]
    s_waitcnt lgkmcnt(8)
    v_mfma_f32_32x32x16_bf16 v[40:55], v[168:171], v[240:243], v[40:55]
    ds_read_b128 v[248:251], v239 offset:0
    ds_read_b128 v[252:255], v239 offset:4096
    ds_read_b64_tr_b16 v[188:189], v201 offset:12288
    ds_read_b64_tr_b16 v[190:191], v201 offset:13312
    v_mfma_f32_32x32x16_bf16 v[104:119], v[168:171], v[244:247], v[104:119]
    s_waitcnt lgkmcnt(10)
    v_mfma_f32_32x32x16_bf16 v[56:71], v[172:175], v[240:243], v[56:71]
    ds_read_b64_tr_b16 v[192:193], v202 offset:12288
    ds_read_b64_tr_b16 v[194:195], v202 offset:13312
    v_mfma_f32_32x32x16_bf16 v[120:135], v[172:175], v[244:247], v[120:135]
    s_waitcnt lgkmcnt(10)
    v_mfma_f32_32x32x16_bf16 v[72:87], v[176:179], v[240:243], v[72:87]
    ds_read_b64_tr_b16 v[196:197], v203 offset:12288
    ds_read_b64_tr_b16 v[198:199], v203 offset:13312
    v_mfma_f32_32x32x16_bf16 v[136:151], v[176:179], v[244:247], v[136:151]
    s_waitcnt lgkmcnt(10)
    v_mfma_f32_32x32x16_bf16 v[88:103], v[180:183], v[240:243], v[88:103]
    v_mfma_f32_32x32x16_bf16 v[152:167], v[180:183], v[244:247], v[152:167]
    s_waitcnt lgkmcnt(6)
    v_mfma_f32_32x32x16_bf16 v[40:55], v[184:187], v[248:251], v[40:55]
    s_waitcnt vmcnt(12) lgkmcnt(0)
    s_barrier
    v_add_u32 v236, 49152, v236
    v_add_u32 v237, 49152, v237
    v_add_u32 v238, 49152, v238
    v_add_u32 v239, 49152, v239
    v_add_u32 v200, 49152, v200
    v_add_u32 v201, 49152, v201
    v_add_u32 v202, 49152, v202
    v_add_u32 v203, 49152, v203
    ds_read_b128 v[240:243], v236 offset:0
    ds_read_b128 v[244:247], v236 offset:4096
    ds_read_b64_tr_b16 v[168:169], v200 offset:0
    ds_read_b64_tr_b16 v[170:171], v200 offset:1024
    ds_read_b64_tr_b16 v[172:173], v201 offset:0
    ds_read_b64_tr_b16 v[174:175], v201 offset:1024
    s_add_u32 m0, s37, 49152
    s_nop 0
    v_mfma_f32_32x32x16_bf16 v[104:119], v[184:187], v[252:255], v[104:119]
    buffer_load_dwordx4 v204, s[20:23], s34 offen offset:0 lds
    s_waitcnt lgkmcnt(10)
    v_mfma_f32_32x32x16_bf16 v[56:71], v[188:191], v[248:251], v[56:71]
    ds_read_b64_tr_b16 v[176:177], v202 offset:0
    ds_read_b64_tr_b16 v[178:179], v202 offset:1024
    buffer_load_dwordx4 v205, s[20:23], s34 offen offset:1024 lds
    v_mfma_f32_32x32x16_bf16 v[120:135], v[188:191], v[252:255], v[120:135]
    buffer_load_dwordx4 v206, s[20:23], s34 offen offset:2048 lds
    s_waitcnt lgkmcnt(10)
    v_mfma_f32_32x32x16_bf16 v[72:87], v[192:195], v[248:251], v[72:87]
    ds_read_b64_tr_b16 v[180:181], v203 offset:0
    ds_read_b64_tr_b16 v[182:183], v203 offset:1024
    buffer_load_dwordx4 v207, s[20:23], s34 offen offset:3072 lds
    v_mfma_f32_32x32x16_bf16 v[136:151], v[192:195], v[252:255], v[136:151]
    s_add_u32 m0, s37, 53248
    s_nop 0
    s_waitcnt lgkmcnt(10)
    v_mfma_f32_32x32x16_bf16 v[88:103], v[196:199], v[248:251], v[88:103]
    ds_read_b64_tr_b16 v[184:185], v200 offset:4096
    ds_read_b64_tr_b16 v[186:187], v200 offset:5120
    buffer_load_dwordx4 v204, s[20:23], s38 offen offset:0 lds
    v_mfma_f32_32x32x16_bf16 v[152:167], v[196:199], v[252:255], v[152:167]
    buffer_load_dwordx4 v205, s[20:23], s38 offen offset:1024 lds
    s_waitcnt lgkmcnt(8)
    v_mfma_f32_32x32x16_bf16 v[40:55], v[168:171], v[240:243], v[40:55]
    ds_read_b128 v[248:251], v237 offset:0
    ds_read_b128 v[252:255], v237 offset:4096
    ds_read_b64_tr_b16 v[188:189], v201 offset:4096
    ds_read_b64_tr_b16 v[190:191], v201 offset:5120
    buffer_load_dwordx4 v206, s[20:23], s38 offen offset:2048 lds
    v_mfma_f32_32x32x16_bf16 v[104:119], v[168:171], v[244:247], v[104:119]
    buffer_load_dwordx4 v207, s[20:23], s38 offen offset:3072 lds
    s_waitcnt lgkmcnt(10)
    v_mfma_f32_32x32x16_bf16 v[56:71], v[172:175], v[240:243], v[56:71]
    ds_read_b64_tr_b16 v[192:193], v202 offset:4096
    ds_read_b64_tr_b16 v[194:195], v202 offset:5120
    s_add_u32 m0, s30, 81920
    s_nop 0
    v_mfma_f32_32x32x16_bf16 v[120:135], v[172:175], v[244:247], v[120:135]
    buffer_load_dwordx4 v232, s[16:19], s33 offen offset:0 lds
    s_waitcnt lgkmcnt(10)
    v_mfma_f32_32x32x16_bf16 v[72:87], v[176:179], v[240:243], v[72:87]
    ds_read_b64_tr_b16 v[196:197], v203 offset:4096
    ds_read_b64_tr_b16 v[198:199], v203 offset:5120
    buffer_load_dwordx4 v233, s[16:19], s33 offen offset:1024 lds
    v_mfma_f32_32x32x16_bf16 v[136:151], v[176:179], v[244:247], v[136:151]
    buffer_load_dwordx4 v234, s[16:19], s33 offen offset:2048 lds
    s_waitcnt lgkmcnt(10)
    v_mfma_f32_32x32x16_bf16 v[88:103], v[180:183], v[240:243], v[88:103]
    ds_read_b64_tr_b16 v[168:169], v200 offset:8192
    ds_read_b64_tr_b16 v[170:171], v200 offset:9216
    buffer_load_dwordx4 v235, s[16:19], s33 offen offset:3072 lds
    v_mfma_f32_32x32x16_bf16 v[152:167], v[180:183], v[244:247], v[152:167]
    s_add_u32 s34, s34, 128
    s_waitcnt lgkmcnt(8)
    v_mfma_f32_32x32x16_bf16 v[40:55], v[184:187], v[248:251], v[40:55]
    ds_read_b128 v[240:243], v238 offset:0
    ds_read_b128 v[244:247], v238 offset:4096
    ds_read_b64_tr_b16 v[172:173], v201 offset:8192
    ds_read_b64_tr_b16 v[174:175], v201 offset:9216
    s_add_u32 s38, s38, 128
    v_mfma_f32_32x32x16_bf16 v[104:119], v[184:187], v[252:255], v[104:119]
    s_add_u32 s33, s33, 524288
    s_waitcnt lgkmcnt(10)
    v_mfma_f32_32x32x16_bf16 v[56:71], v[188:191], v[248:251], v[56:71]
    ds_read_b64_tr_b16 v[176:177], v202 offset:8192
    ds_read_b64_tr_b16 v[178:179], v202 offset:9216
    v_mfma_f32_32x32x16_bf16 v[120:135], v[188:191], v[252:255], v[120:135]
    s_waitcnt lgkmcnt(10)
    v_mfma_f32_32x32x16_bf16 v[72:87], v[192:195], v[248:251], v[72:87]
    ds_read_b64_tr_b16 v[180:181], v203 offset:8192
    ds_read_b64_tr_b16 v[182:183], v203 offset:9216
    v_mfma_f32_32x32x16_bf16 v[136:151], v[192:195], v[252:255], v[136:151]
    s_waitcnt lgkmcnt(10)
    v_mfma_f32_32x32x16_bf16 v[88:103], v[196:199], v[248:251], v[88:103]
    ds_read_b64_tr_b16 v[184:185], v200 offset:12288
    ds_read_b64_tr_b16 v[186:187], v200 offset:13312
    v_mfma_f32_32x32x16_bf16 v[152:167], v[196:199], v[252:255], v[152:167]
    s_waitcnt lgkmcnt(8)
    v_mfma_f32_32x32x16_bf16 v[40:55], v[168:171], v[240:243], v[40:55]
    ds_read_b128 v[248:251], v239 offset:0
    ds_read_b128 v[252:255], v239 offset:4096
    ds_read_b64_tr_b16 v[188:189], v201 offset:12288
    ds_read_b64_tr_b16 v[190:191], v201 offset:13312
    v_mfma_f32_32x32x16_bf16 v[104:119], v[168:171], v[244:247], v[104:119]
    s_waitcnt lgkmcnt(10)
    v_mfma_f32_32x32x16_bf16 v[56:71], v[172:175], v[240:243], v[56:71]
    ds_read_b64_tr_b16 v[192:193], v202 offset:12288
    ds_read_b64_tr_b16 v[194:195], v202 offset:13312
    v_mfma_f32_32x32x16_bf16 v[120:135], v[172:175], v[244:247], v[120:135]
    s_waitcnt lgkmcnt(10)
    v_mfma_f32_32x32x16_bf16 v[72:87], v[176:179], v[240:243], v[72:87]
    ds_read_b64_tr_b16 v[196:197], v203 offset:12288
    ds_read_b64_tr_b16 v[198:199], v203 offset:13312
    v_mfma_f32_32x32x16_bf16 v[136:151], v[176:179], v[244:247], v[136:151]
    s_waitcnt lgkmcnt(10)
    v_mfma_f32_32x32x16_bf16 v[88:103], v[180:183], v[240:243], v[88:103]
    v_mfma_f32_32x32x16_bf16 v[152:167], v[180:183], v[244:247], v[152:167]
    s_waitcnt lgkmcnt(6)
    v_mfma_f32_32x32x16_bf16 v[40:55], v[184:187], v[248:251], v[40:55]
    s_waitcnt vmcnt(12) lgkmcnt(0)
    s_barrier
    v_subrev_u32 v236, 98304, v236
    v_subrev_u32 v237, 98304, v237
    v_subrev_u32 v238, 98304, v238
    v_subrev_u32 v239, 98304, v239
    v_subrev_u32 v200, 98304, v200
    v_subrev_u32 v201, 98304, v201
    v_subrev_u32 v202, 98304, v202
    v_subrev_u32 v203, 98304, v203
    ds_read_b128 v[240:243], v236 offset:0
    ds_read_b128 v[244:247], v236 offset:4096
    ds_read_b64_tr_b16 v[168:169], v200 offset:0
    ds_read_b64_tr_b16 v[170:171], v200 offset:1024
    ds_read_b64_tr_b16 v[172:173], v201 offset:0
    ds_read_b64_tr_b16 v[174:175], v201 offset:1024
    s_add_u32 m0, s37, 98304
    s_nop 0
    v_mfma_f32_32x32x16_bf16 v[104:119], v[184:187], v[252:255], v[104:119]
    buffer_load_dwordx4 v204, s[20:23], s34 offen offset:0 lds
    s_waitcnt lgkmcnt(10)
    v_mfma_f32_32x32x16_bf16 v[56:71], v[188:191], v[248:251], v[56:71]
    ds_read_b64_tr_b16 v[176:177], v202 offset:0
    ds_read_b64_tr_b16 v[178:179], v202 offset:1024
    buffer_load_dwordx4 v205, s[20:23], s34 offen offset:1024 lds
    v_mfma_f32_32x32x16_bf16 v[120:135], v[188:191], v[252:255], v[120:135]
    buffer_load_dwordx4 v206, s[20:23], s34 offen offset:2048 lds
    s_waitcnt lgkmcnt(10)
    v_mfma_f32_32x32x16_bf16 v[72:87], v[192:195], v[248:251], v[72:87]
    ds_read_b64_tr_b16 v[180:181], v203 offset:0
    ds_read_b64_tr_b16 v[182:183], v203 offset:1024
    buffer_load_dwordx4 v207, s[20:23], s34 offen offset:3072 lds
    v_mfma_f32_32x32x16_bf16 v[136:151], v[192:195], v[252:255], v[136:151]
    s_add_u32 m0, s37, 102400
    s_nop 0
    s_waitcnt lgkmcnt(10)
    v_mfma_f32_32x32x16_bf16 v[88:103], v[196:199], v[248:251], v[88:103]
    ds_read_b64_tr_b16 v[184:185], v200 offset:4096
    ds_read_b64_tr_b16 v[186:187], v200 offset:5120
    buffer_load_dwordx4 v204, s[20:23], s38 offen offset:0 lds
    v_mfma_f32_32x32x16_bf16 v[152:167], v[196:199], v[252:255], v[152:167]
    buffer_load_dwordx4 v205, s[20:23], s38 offen offset:1024 lds
    s_waitcnt lgkmcnt(8)
    v_mfma_f32_32x32x16_bf16 v[40:55], v[168:171], v[240:243], v[40:55]
    ds_read_b128 v[248:251], v237 offset:0
    ds_read_b128 v[252:255], v237 offset:4096
    ds_read_b64_tr_b16 v[188:189], v201 offset:4096
    ds_read_b64_tr_b16 v[190:191], v201 offset:5120
    buffer_load_dwordx4 v206, s[20:23], s38 offen offset:2048 lds
    v_mfma_f32_32x32x16_bf16 v[104:119], v[168:171], v[244:247], v[104:119]
    buffer_load_dwordx4 v207, s[20:23], s38 offen offset:3072 lds
    s_waitcnt lgkmcnt(10)
    v_mfma_f32_32x32x16_bf16 v[56:71], v[172:175], v[240:243], v[56:71]
    ds_read_b64_tr_b16 v[192:193], v202 offset:4096
    ds_read_b64_tr_b16 v[194:195], v202 offset:5120
    s_add_u32 m0, s30, 131072
    s_nop 0
    v_mfma_f32_32x32x16_bf16 v[120:135], v[172:175], v[244:247], v[120:135]
    buffer_load_dwordx4 v232, s[16:19], s33 offen offset:0 lds
    s_waitcnt lgkmcnt(10)
    v_mfma_f32_32x32x16_bf16 v[72:87], v[176:179], v[240:243], v[72:87]
    ds_read_b64_tr_b16 v[196:197], v203 offset:4096
    ds_read_b64_tr_b16 v[198:199], v203 offset:5120
    buffer_load_dwordx4 v233, s[16:19], s33 offen offset:1024 lds
    v_mfma_f32_32x32x16_bf16 v[136:151], v[176:179], v[244:247], v[136:151]
    buffer_load_dwordx4 v234, s[16:19], s33 offen offset:2048 lds
    s_waitcnt lgkmcnt(10)
    v_mfma_f32_32x32x16_bf16 v[88:103], v[180:183], v[240:243], v[88:103]
    ds_read_b64_tr_b16 v[168:169], v200 offset:8192
    ds_read_b64_tr_b16 v[170:171], v200 offset:9216
    buffer_load_dwordx4 v235, s[16:19], s33 offen offset:3072 lds
    v_mfma_f32_32x32x16_bf16 v[152:167], v[180:183], v[244:247], v[152:167]
    s_add_u32 s34, s34, 128
    s_waitcnt lgkmcnt(8)
    v_mfma_f32_32x32x16_bf16 v[40:55], v[184:187], v[248:251], v[40:55]
    ds_read_b128 v[240:243], v238 offset:0
    ds_read_b128 v[244:247], v238 offset:4096
    ds_read_b64_tr_b16 v[172:173], v201 offset:8192
    ds_read_b64_tr_b16 v[174:175], v201 offset:9216
    s_add_u32 s38, s38, 128
    v_mfma_f32_32x32x16_bf16 v[104:119], v[184:187], v[252:255], v[104:119]
    s_add_u32 s33, s33, 524288
    s_waitcnt lgkmcnt(10)
    v_mfma_f32_32x32x16_bf16 v[56:71], v[188:191], v[248:251], v[56:71]
    ds_read_b64_tr_b16 v[176:177], v202 offset:8192
    ds_read_b64_tr_b16 v[178:179], v202 offset:9216
    v_mfma_f32_32x32x16_bf16 v[120:135], v[188:191], v[252:255], v[120:135]
    s_waitcnt lgkmcnt(10)
    v_mfma_f32_32x32x16_bf16 v[72:87], v[192:195], v[248:251], v[72:87]
    ds_read_b64_tr_b16 v[180:181], v203 offset:8192
    ds_read_b64_tr_b16 v[182:183], v203 offset:9216
    v_mfma_f32_32x32x16_bf16 v[136:151], v[192:195], v[252:255], v[136:151]
    s_waitcnt lgkmcnt(10)
    v_mfma_f32_32x32x16_bf16 v[88:103], v[196:199], v[248:251], v[88:103]
    ds_read_b64_tr_b16 v[184:185], v200 offset:12288
    ds_read_b64_tr_b16 v[186:187], v200 offset:13312
    v_mfma_f32_32x32x16_bf16 v[152:167], v[196:199], v[252:255], v[152:167]
    s_waitcnt lgkmcnt(8)
    v_mfma_f32_32x32x16_bf16 v[40:55], v[168:171], v[240:243], v[40:55]
    ds_read_b128 v[248:251], v239 offset:0
    ds_read_b128 v[252:255], v239 offset:4096
    ds_read_b64_tr_b16 v[188:189], v201 offset:12288
    ds_read_b64_tr_b16 v[190:191], v201 offset:13312
    v_mfma_f32_32x32x16_bf16 v[104:119], v[168:171], v[244:247], v[104:119]
    s_waitcnt lgkmcnt(10)
    v_mfma_f32_32x32x16_bf16 v[56:71], v[172:175], v[240:243], v[56:71]
    ds_read_b64_tr_b16 v[192:193], v202 offset:12288
    ds_read_b64_tr_b16 v[194:195], v202 offset:13312
    v_mfma_f32_32x32x16_bf16 v[120:135], v[172:175], v[244:247], v[120:135]
    s_waitcnt lgkmcnt(10)
    v_mfma_f32_32x32x16_bf16 v[72:87], v[176:179], v[240:243], v[72:87]
    ds_read_b64_tr_b16 v[196:197], v203 offset:12288
    ds_read_b64_tr_b16 v[198:199], v203 offset:13312
    v_mfma_f32_32x32x16_bf16 v[136:151], v[176:179], v[244:247], v[136:151]
    s_waitcnt lgkmcnt(10)
    v_mfma_f32_32x32x16_bf16 v[88:103], v[180:183], v[240:243], v[88:103]
    v_mfma_f32_32x32x16_bf16 v[152:167], v[180:183], v[244:247], v[152:167]
    s_waitcnt lgkmcnt(6)
    v_mfma_f32_32x32x16_bf16 v[40:55], v[184:187], v[248:251], v[40:55]
    s_waitcnt vmcnt(12) lgkmcnt(0)
    s_barrier
    v_add_u32 v236, 49152, v236
    v_add_u32 v237, 49152, v237
    v_add_u32 v238, 49152, v238
    v_add_u32 v239, 49152, v239
    v_add_u32 v200, 49152, v200
    v_add_u32 v201, 49152, v201
    v_add_u32 v202, 49152, v202
    v_add_u32 v203, 49152, v203
    ds_read_b128 v[240:243], v236 offset:0
    ds_read_b128 v[244:247], v236 offset:4096
    ds_read_b64_tr_b16 v[168:169], v200 offset:0
    ds_read_b64_tr_b16 v[170:171], v200 offset:1024
    ds_read_b64_tr_b16 v[172:173], v201 offset:0
    ds_read_b64_tr_b16 v[174:175], v201 offset:1024
    s_add_u32 m0, s30, 0
    s_nop 0
    v_mfma_f32_32x32x16_bf16 v[104:119], v[184:187], v[252:255], v[104:119]
    buffer_load_dwordx4 v20, s[8:11], s28 offen offset:0 lds
    s_waitcnt lgkmcnt(10)
    v_mfma_f32_32x32x16_bf16 v[56:71], v[188:191], v[248:251], v[56:71]
    ds_read_b64_tr_b16 v[176:177], v202 offset:0
    ds_read_b64_tr_b16 v[178:179], v202 offset:1024
    buffer_load_dwordx4 v21, s[8:11], s28 offen offset:1024 lds
    v_mfma_f32_32x32x16_bf16 v[120:135], v[188:191], v[252:255], v[120:135]
    buffer_load_dwordx4 v22, s[8:11], s28 offen offset:2048 lds
    s_waitcnt lgkmcnt(10)
    v_mfma_f32_32x32x16_bf16 v[72:87], v[192:195], v[248:251], v[72:87]
    ds_read_b64_tr_b16 v[180:181], v203 offset:0
    ds_read_b64_tr_b16 v[182:183], v203 offset:1024
    buffer_load_dwordx4 v23, s[8:11], s28 offen offset:3072 lds
    v_mfma_f32_32x32x16_bf16 v[136:151], v[192:195], v[252:255], v[136:151]
    s_add_u32 s28, s28, 16384
    s_waitcnt lgkmcnt(10)
    v_mfma_f32_32x32x16_bf16 v[88:103], v[196:199], v[248:251], v[88:103]
    ds_read_b64_tr_b16 v[184:185], v200 offset:4096
    ds_read_b64_tr_b16 v[186:187], v200 offset:5120
    s_add_u32 m0, s30, 16384
    s_nop 0
    v_mfma_f32_32x32x16_bf16 v[152:167], v[196:199], v[252:255], v[152:167]
    buffer_load_dwordx4 v20, s[8:11], s28 offen offset:0 lds
    s_waitcnt lgkmcnt(8)
    v_mfma_f32_32x32x16_bf16 v[40:55], v[168:171], v[240:243], v[40:55]
    ds_read_b128 v[248:251], v237 offset:0
    ds_read_b128 v[252:255], v237 offset:4096
    ds_read_b64_tr_b16 v[188:189], v201 offset:4096
    ds_read_b64_tr_b16 v[190:191], v201 offset:5120
    buffer_load_dwordx4 v21, s[8:11], s28 offen offset:1024 lds
    v_mfma_f32_32x32x16_bf16 v[104:119], v[168:171], v[244:247], v[104:119]
    buffer_load_dwordx4 v22, s[8:11], s28 offen offset:2048 lds
    s_waitcnt lgkmcnt(10)
    v_mfma_f32_32x32x16_bf16 v[56:71], v[172:175], v[240:243], v[56:71]
    ds_read_b64_tr_b16 v[192:193], v202 offset:4096
    ds_read_b64_tr_b16 v[194:195], v202 offset:5120
    buffer_load_dwordx4 v23, s[8:11], s28 offen offset:3072 lds
    v_mfma_f32_32x32x16_bf16 v[120:135], v[172:175], v[244:247], v[120:135]
    s_add_u32 s28, s28, 16384
    s_waitcnt lgkmcnt(10)
    v_mfma_f32_32x32x16_bf16 v[72:87], v[176:179], v[240:243], v[72:87]
    ds_read_b64_tr_b16 v[196:197], v203 offset:4096
    ds_read_b64_tr_b16 v[198:199], v203 offset:5120
    s_add_u32 m0, s30, 32768
    s_nop 0
    v_mfma_f32_32x32x16_bf16 v[136:151], v[176:179], v[244:247], v[136:151]
    buffer_load_dwordx4 v20, s[8:11], s28 offen offset:0 lds
    s_waitcnt lgkmcnt(10)
    v_mfma_f32_32x32x16_bf16 v[88:103], v[180:183], v[240:243], v[88:103]
    ds_read_b64_tr_b16 v[168:169], v200 offset:8192
    ds_read_b64_tr_b16 v[170:171], v200 offset:9216
    buffer_load_dwordx4 v21, s[8:11], s28 offen offset:1024 lds
    v_mfma_f32_32x32x16_bf16 v[152:167], v[180:183], v[244:247], v[152:167]
    buffer_load_dwordx4 v22, s[8:11], s28 offen offset:2048 lds
    s_waitcnt lgkmcnt(8)
    v_mfma_f32_32x32x16_bf16 v[40:55], v[184:187], v[248:251], v[40:55]
    ds_read_b128 v[240:243], v238 offset:0
    ds_read_b128 v[244:247], v238 offset:4096
    ds_read_b64_tr_b16 v[172:173], v201 offset:8192
    ds_read_b64_tr_b16 v[174:175], v201 offset:9216
    buffer_load_dwordx4 v23, s[8:11], s28 offen offset:3072 lds
    v_mfma_f32_32x32x16_bf16 v[104:119], v[184:187], v[252:255], v[104:119]
    s_add_u32 s28, s28, 16384
    s_waitcnt lgkmcnt(10)
    v_mfma_f32_32x32x16_bf16 v[56:71], v[188:191], v[248:251], v[56:71]
    ds_read_b64_tr_b16 v[176:177], v202 offset:8192
    ds_read_b64_tr_b16 v[178:179], v202 offset:9216
    v_mfma_f32_32x32x16_bf16 v[120:135], v[188:191], v[252:255], v[120:135]
    s_waitcnt lgkmcnt(10)
    v_mfma_f32_32x32x16_bf16 v[72:87], v[192:195], v[248:251], v[72:87]
    ds_read_b64_tr_b16 v[180:181], v203 offset:8192
    ds_read_b64_tr_b16 v[182:183], v203 offset:9216
    v_mfma_f32_32x32x16_bf16 v[136:151], v[192:195], v[252:255], v[136:151]
    s_waitcnt lgkmcnt(10)
    v_mfma_f32_32x32x16_bf16 v[88:103], v[196:199], v[248:251], v[88:103]
    ds_read_b64_tr_b16 v[184:185], v200 offset:12288
    ds_read_b64_tr_b16 v[186:187], v200 offset:13312
    v_mfma_f32_32x32x16_bf16 v[152:167], v[196:199], v[252:255], v[152:167]
    s_waitcnt lgkmcnt(8)
    v_mfma_f32_32x32x16_bf16 v[40:55], v[168:171], v[240:243], v[40:55]
    ds_read_b128 v[248:251], v239 offset:0
    ds_read_b128 v[252:255], v239 offset:4096
    ds_read_b64_tr_b16 v[188:189], v201 offset:12288
    ds_read_b64_tr_b16 v[190:191], v201 offset:13312
    v_mfma_f32_32x32x16_bf16 v[104:119], v[168:171], v[244:247], v[104:119]
    s_waitcnt lgkmcnt(10)
    v_mfma_f32_32x32x16_bf16 v[56:71], v[172:175], v[240:243], v[56:71]
    ds_read_b64_tr_b16 v[192:193], v202 offset:12288
    ds_read_b64_tr_b16 v[194:195], v202 offset:13312
    v_mfma_f32_32x32x16_bf16 v[120:135], v[172:175], v[244:247], v[120:135]
    s_waitcnt lgkmcnt(10)
    v_mfma_f32_32x32x16_bf16 v[72:87], v[176:179], v[240:243], v[72:87]
    ds_read_b64_tr_b16 v[196:197], v203 offset:12288
    ds_read_b64_tr_b16 v[198:199], v203 offset:13312
    v_mfma_f32_32x32x16_bf16 v[136:151], v[176:179], v[244:247], v[136:151]
    s_waitcnt lgkmcnt(10)
    v_mfma_f32_32x32x16_bf16 v[88:103], v[180:183], v[240:243], v[88:103]
    v_mfma_f32_32x32x16_bf16 v[152:167], v[180:183], v[244:247], v[152:167]
    s_waitcnt lgkmcnt(6)
    v_mfma_f32_32x32x16_bf16 v[40:55], v[184:187], v[248:251], v[40:55]
    s_waitcnt vmcnt(12) lgkmcnt(0)
    s_barrier
    v_add_u32 v236, 49152, v236
    v_add_u32 v237, 49152, v237
    v_add_u32 v238, 49152, v238
    v_add_u32 v239, 49152, v239
    v_add_u32 v200, 49152, v200
    v_add_u32 v201, 49152, v201
    v_add_u32 v202, 49152, v202
    v_add_u32 v203, 49152, v203
    ds_read_b128 v[240:243], v236 offset:0
    ds_read_b128 v[244:247], v236 offset:4096
    ds_read_b64_tr_b16 v[168:169], v200 offset:0
    ds_read_b64_tr_b16 v[170:171], v200 offset:1024
    ds_read_b64_tr_b16 v[172:173], v201 offset:0
    ds_read_b64_tr_b16 v[174:175], v201 offset:1024
    s_add_u32 m0, s30, 65536
    s_nop 0
    v_mfma_f32_32x32x16_bf16 v[104:119], v[184:187], v[252:255], v[104:119]
    buffer_load_dwordx4 v24, s[12:15], s29 offen offset:0 lds
    s_waitcnt lgkmcnt(10)
    v_mfma_f32_32x32x16_bf16 v[56:71], v[188:191], v[248:251], v[56:71]
    ds_read_b64_tr_b16 v[176:177], v202 offset:0
    ds_read_b64_tr_b16 v[178:179], v202 offset:1024
    buffer_load_dwordx4 v24, s[12:15], s29 offen offset:1024 lds
    v_mfma_f32_32x32x16_bf16 v[120:135], v[188:191], v[252:255], v[120:135]
    buffer_load_dwordx4 v24, s[12:15], s29 offen offset:2048 lds
    s_waitcnt lgkmcnt(10)
    v_mfma_f32_32x32x16_bf16 v[72:87], v[192:195], v[248:251], v[72:87]
    ds_read_b64_tr_b16 v[180:181], v203 offset:0
    ds_read_b64_tr_b16 v[182:183], v203 offset:1024
    buffer_load_dwordx4 v24, s[12:15], s29 offen offset:3072 lds
    v_mfma_f32_32x32x16_bf16 v[136:151], v[192:195], v[252:255], v[136:151]
    s_add_u32 s29, s29, 16384
    s_waitcnt lgkmcnt(10)
    v_mfma_f32_32x32x16_bf16 v[88:103], v[196:199], v[248:251], v[88:103]
    ds_read_b64_tr_b16 v[184:185], v200 offset:4096
    ds_read_b64_tr_b16 v[186:187], v200 offset:5120
    s_add_u32 m0, s30, 81920
    s_nop 0
    v_mfma_f32_32x32x16_bf16 v[152:167], v[196:199], v[252:255], v[152:167]
    buffer_load_dwordx4 v24, s[12:15], s29 offen offset:0 lds
    s_waitcnt lgkmcnt(8)
    v_mfma_f32_32x32x16_bf16 v[40:55], v[168:171], v[240:243], v[40:55]
    ds_read_b128 v[248:251], v237 offset:0
    ds_read_b128 v[252:255], v237 offset:4096
    ds_read_b64_tr_b16 v[188:189], v201 offset:4096
    ds_read_b64_tr_b16 v[190:191], v201 offset:5120
    buffer_load_dwordx4 v24, s[12:15], s29 offen offset:1024 lds
    v_mfma_f32_32x32x16_bf16 v[104:119], v[168:171], v[244:247], v[104:119]
    buffer_load_dwordx4 v24, s[12:15], s29 offen offset:2048 lds
    s_waitcnt lgkmcnt(10)
    v_mfma_f32_32x32x16_bf16 v[56:71], v[172:175], v[240:243], v[56:71]
    ds_read_b64_tr_b16 v[192:193], v202 offset:4096
    ds_read_b64_tr_b16 v[194:195], v202 offset:5120
    buffer_load_dwordx4 v24, s[12:15], s29 offen offset:3072 lds
    v_mfma_f32_32x32x16_bf16 v[120:135], v[172:175], v[244:247], v[120:135]
    s_add_u32 s29, s29, 16384
    s_waitcnt lgkmcnt(10)
    v_mfma_f32_32x32x16_bf16 v[72:87], v[176:179], v[240:243], v[72:87]
    ds_read_b64_tr_b16 v[196:197], v203 offset:4096
    ds_read_b64_tr_b16 v[198:199], v203 offset:5120
    v_mfma_f32_32x32x16_bf16 v[136:151], v[176:179], v[244:247], v[136:151]
    s_waitcnt lgkmcnt(10)
    v_mfma_f32_32x32x16_bf16 v[88:103], v[180:183], v[240:243], v[88:103]
    ds_read_b64_tr_b16 v[168:169], v200 offset:8192
    ds_read_b64_tr_b16 v[170:171], v200 offset:9216
    v_mfma_f32_32x32x16_bf16 v[152:167], v[180:183], v[244:247], v[152:167]
    s_waitcnt lgkmcnt(8)
    v_mfma_f32_32x32x16_bf16 v[40:55], v[184:187], v[248:251], v[40:55]
    ds_read_b128 v[240:243], v238 offset:0
    ds_read_b128 v[244:247], v238 offset:4096
    ds_read_b64_tr_b16 v[172:173], v201 offset:8192
    ds_read_b64_tr_b16 v[174:175], v201 offset:9216
    v_mfma_f32_32x32x16_bf16 v[104:119], v[184:187], v[252:255], v[104:119]
    s_waitcnt lgkmcnt(10)
    v_mfma_f32_32x32x16_bf16 v[56:71], v[188:191], v[248:251], v[56:71]
    ds_read_b64_tr_b16 v[176:177], v202 offset:8192
    ds_read_b64_tr_b16 v[178:179], v202 offset:9216
    v_mfma_f32_32x32x16_bf16 v[120:135], v[188:191], v[252:255], v[120:135]
    s_waitcnt lgkmcnt(10)
    v_mfma_f32_32x32x16_bf16 v[72:87], v[192:195], v[248:251], v[72:87]
    ds_read_b64_tr_b16 v[180:181], v203 offset:8192
    ds_read_b64_tr_b16 v[182:183], v203 offset:9216
    v_mfma_f32_32x32x16_bf16 v[136:151], v[192:195], v[252:255], v[136:151]
    s_waitcnt lgkmcnt(10)
    v_mfma_f32_32x32x16_bf16 v[88:103], v[196:199], v[248:251], v[88:103]
    ds_read_b64_tr_b16 v[184:185], v200 offset:12288
    ds_read_b64_tr_b16 v[186:187], v200 offset:13312
    v_mfma_f32_32x32x16_bf16 v[152:167], v[196:199], v[252:255], v[152:167]
    s_waitcnt lgkmcnt(8)
    v_mfma_f32_32x32x16_bf16 v[40:55], v[168:171], v[240:243], v[40:55]
    ds_read_b128 v[248:251], v239 offset:0
    ds_read_b128 v[252:255], v239 offset:4096
    ds_read_b64_tr_b16 v[188:189], v201 offset:12288
    ds_read_b64_tr_b16 v[190:191], v201 offset:13312
    v_mfma_f32_32x32x16_bf16 v[104:119], v[168:171], v[244:247], v[104:119]
    s_waitcnt lgkmcnt(10)
    v_mfma_f32_32x32x16_bf16 v[56:71], v[172:175], v[240:243], v[56:71]
    ds_read_b64_tr_b16 v[192:193], v202 offset:12288
    ds_read_b64_tr_b16 v[194:195], v202 offset:13312
    v_mfma_f32_32x32x16_bf16 v[120:135], v[172:175], v[244:247], v[120:135]
    s_waitcnt lgkmcnt(10)
    v_mfma_f32_32x32x16_bf16 v[72:87], v[176:179], v[240:243], v[72:87]
    ds_read_b64_tr_b16 v[196:197], v203 offset:12288
    ds_read_b64_tr_b16 v[198:199], v203 offset:13312
    v_mfma_f32_32x32x16_bf16 v[136:151], v[176:179], v[244:247], v[136:151]
    s_waitcnt lgkmcnt(10)
    v_mfma_f32_32x32x16_bf16 v[88:103], v[180:183], v[240:243], v[88:103]
    v_mfma_f32_32x32x16_bf16 v[152:167], v[180:183], v[244:247], v[152:167]
    s_waitcnt lgkmcnt(6)
    v_mfma_f32_32x32x16_bf16 v[40:55], v[184:187], v[248:251], v[40:55]
    s_waitcnt lgkmcnt(0)
    s_barrier
    v_mfma_f32_32x32x16_bf16 v[104:119], v[184:187], v[252:255], v[104:119]
    s_waitcnt lgkmcnt(4)
    v_mfma_f32_32x32x16_bf16 v[56:71], v[188:191], v[248:251], v[56:71]
    v_mfma_f32_32x32x16_bf16 v[120:135], v[188:191], v[252:255], v[120:135]
    s_waitcnt lgkmcnt(2)
    v_mfma_f32_32x32x16_bf16 v[72:87], v[192:195], v[248:251], v[72:87]
    v_mfma_f32_32x32x16_bf16 v[136:151], v[192:195], v[252:255], v[136:151]
    s_waitcnt lgkmcnt(0)
    v_mfma_f32_32x32x16_bf16 v[88:103], v[196:199], v[248:251], v[88:103]
    v_mfma_f32_32x32x16_bf16 v[152:167], v[196:199], v[252:255], v[152:167]
    s_nop 15
    s_mov_b32 s6, 0x3e0293ee
    v_mul_f32 v40, s6, v40
    v_mul_f32 v41, s6, v41
    v_mul_f32 v42, s6, v42
    v_mul_f32 v43, s6, v43
    v_mul_f32 v44, s6, v44
    v_mul_f32 v45, s6, v45
    v_mul_f32 v46, s6, v46
    v_mul_f32 v47, s6, v47
    v_cvt_pk_bf16_f32 v208, v40, v41
    v_cvt_pk_bf16_f32 v209, v42, v43
    v_cvt_pk_bf16_f32 v210, v44, v45
    v_cvt_pk_bf16_f32 v211, v46, v47
    s_nop 1
    v_permlane32_swap_b32 v208, v210
    v_permlane32_swap_b32 v209, v211
    s_nop 1
    v_accvgpr_write_b32 a128, v208
    v_accvgpr_write_b32 a129, v209
    v_accvgpr_write_b32 a130, v210
    v_accvgpr_write_b32 a131, v211
    v_mul_f32 v48, s6, v48
    v_mul_f32 v49, s6, v49
    v_mul_f32 v50, s6, v50
    v_mul_f32 v51, s6, v51
    v_mul_f32 v52, s6, v52
    v_mul_f32 v53, s6, v53
    v_mul_f32 v54, s6, v54
    v_mul_f32 v55, s6, v55
    v_cvt_pk_bf16_f32 v208, v48, v49
    v_cvt_pk_bf16_f32 v209, v50, v51
    v_cvt_pk_bf16_f32 v210, v52, v53
    v_cvt_pk_bf16_f32 v211, v54, v55
    s_nop 1
    v_permlane32_swap_b32 v208, v210
    v_permlane32_swap_b32 v209, v211
    s_nop 1
    v_accvgpr_write_b32 a132, v208
    v_accvgpr_write_b32 a133, v209
    v_accvgpr_write_b32 a134, v210
    v_accvgpr_write_b32 a135, v211
    v_mul_f32 v56, s6, v56
    v_mul_f32 v57, s6, v57
    v_mul_f32 v58, s6, v58
    v_mul_f32 v59, s6, v59
    v_mul_f32 v60, s6, v60
    v_mul_f32 v61, s6, v61
    v_mul_f32 v62, s6, v62
    v_mul_f32 v63, s6, v63
    v_cvt_pk_bf16_f32 v208, v56, v57
    v_cvt_pk_bf16_f32 v209, v58, v59
    v_cvt_pk_bf16_f32 v210, v60, v61
    v_cvt_pk_bf16_f32 v211, v62, v63
    s_nop 1
    v_permlane32_swap_b32 v208, v210
    v_permlane32_swap_b32 v209, v211
    s_nop 1
    v_accvgpr_write_b32 a136, v208
    v_accvgpr_write_b32 a137, v209
    v_accvgpr_write_b32 a138, v210
    v_accvgpr_write_b32 a139, v211
    v_mul_f32 v64, s6, v64
    v_mul_f32 v65, s6, v65
    v_mul_f32 v66, s6, v66
    v_mul_f32 v67, s6, v67
    v_mul_f32 v68, s6, v68
    v_mul_f32 v69, s6, v69
    v_mul_f32 v70, s6, v70
    v_mul_f32 v71, s6, v71
    v_cvt_pk_bf16_f32 v208, v64, v65
    v_cvt_pk_bf16_f32 v209, v66, v67
    v_cvt_pk_bf16_f32 v210, v68, v69
    v_cvt_pk_bf16_f32 v211, v70, v71
    s_nop 1
    v_permlane32_swap_b32 v208, v210
    v_permlane32_swap_b32 v209, v211
    s_nop 1
    v_accvgpr_write_b32 a140, v208
    v_accvgpr_write_b32 a141, v209
    v_accvgpr_write_b32 a142, v210
    v_accvgpr_write_b32 a143, v211
    v_mul_f32 v72, s6, v72
    v_mul_f32 v73, s6, v73
    v_mul_f32 v74, s6, v74
    v_mul_f32 v75, s6, v75
    v_mul_f32 v76, s6, v76
    v_mul_f32 v77, s6, v77
    v_mul_f32 v78, s6, v78
    v_mul_f32 v79, s6, v79
    v_cvt_pk_bf16_f32 v208, v72, v73
    v_cvt_pk_bf16_f32 v209, v74, v75
    v_cvt_pk_bf16_f32 v210, v76, v77
    v_cvt_pk_bf16_f32 v211, v78, v79
    s_nop 1
    v_permlane32_swap_b32 v208, v210
    v_permlane32_swap_b32 v209, v211
    s_nop 1
    v_accvgpr_write_b32 a144, v208
    v_accvgpr_write_b32 a145, v209
    v_accvgpr_write_b32 a146, v210
    v_accvgpr_write_b32 a147, v211
    v_mul_f32 v80, s6, v80
    v_mul_f32 v81, s6, v81
    v_mul_f32 v82, s6, v82
    v_mul_f32 v83, s6, v83
    v_mul_f32 v84, s6, v84
    v_mul_f32 v85, s6, v85
    v_mul_f32 v86, s6, v86
    v_mul_f32 v87, s6, v87
    v_cvt_pk_bf16_f32 v208, v80, v81
    v_cvt_pk_bf16_f32 v209, v82, v83
    v_cvt_pk_bf16_f32 v210, v84, v85
    v_cvt_pk_bf16_f32 v211, v86, v87
    s_nop 1
    v_permlane32_swap_b32 v208, v210
    v_permlane32_swap_b32 v209, v211
    s_nop 1
    v_accvgpr_write_b32 a148, v208
    v_accvgpr_write_b32 a149, v209
    v_accvgpr_write_b32 a150, v210
    v_accvgpr_write_b32 a151, v211
    v_mul_f32 v88, s6, v88
    v_mul_f32 v89, s6, v89
    v_mul_f32 v90, s6, v90
    v_mul_f32 v91, s6, v91
    v_mul_f32 v92, s6, v92
    v_mul_f32 v93, s6, v93
    v_mul_f32 v94, s6, v94
    v_mul_f32 v95, s6, v95
    v_cvt_pk_bf16_f32 v208, v88, v89
    v_cvt_pk_bf16_f32 v209, v90, v91
    v_cvt_pk_bf16_f32 v210, v92, v93
    v_cvt_pk_bf16_f32 v211, v94, v95
    s_nop 1
    v_permlane32_swap_b32 v208, v210
    v_permlane32_swap_b32 v209, v211
    s_nop 1
    v_accvgpr_write_b32 a152, v208
    v_accvgpr_write_b32 a153, v209
    v_accvgpr_write_b32 a154, v210
    v_accvgpr_write_b32 a155, v211
    v_mul_f32 v96, s6, v96
    v_mul_f32 v97, s6, v97
    v_mul_f32 v98, s6, v98
    v_mul_f32 v99, s6, v99
    v_mul_f32 v100, s6, v100
    v_mul_f32 v101, s6, v101
    v_mul_f32 v102, s6, v102
    v_mul_f32 v103, s6, v103
    v_cvt_pk_bf16_f32 v208, v96, v97
    v_cvt_pk_bf16_f32 v209, v98, v99
    v_cvt_pk_bf16_f32 v210, v100, v101
    v_cvt_pk_bf16_f32 v211, v102, v103
    s_nop 1
    v_permlane32_swap_b32 v208, v210
    v_permlane32_swap_b32 v209, v211
    s_nop 1
    v_accvgpr_write_b32 a156, v208
    v_accvgpr_write_b32 a157, v209
    v_accvgpr_write_b32 a158, v210
    v_accvgpr_write_b32 a159, v211
    v_mul_f32 v104, s6, v104
    v_mul_f32 v105, s6, v105
    v_mul_f32 v106, s6, v106
    v_mul_f32 v107, s6, v107
    v_mul_f32 v108, s6, v108
    v_mul_f32 v109, s6, v109
    v_mul_f32 v110, s6, v110
    v_mul_f32 v111, s6, v111
    v_cvt_pk_bf16_f32 v208, v104, v105
    v_cvt_pk_bf16_f32 v209, v106, v107
    v_cvt_pk_bf16_f32 v210, v108, v109
    v_cvt_pk_bf16_f32 v211, v110, v111
    s_nop 1
    v_permlane32_swap_b32 v208, v210
    v_permlane32_swap_b32 v209, v211
    s_nop 1
    v_accvgpr_write_b32 a160, v208
    v_accvgpr_write_b32 a161, v209
    v_accvgpr_write_b32 a162, v210
    v_accvgpr_write_b32 a163, v211
    v_mul_f32 v112, s6, v112
    v_mul_f32 v113, s6, v113
    v_mul_f32 v114, s6, v114
    v_mul_f32 v115, s6, v115
    v_mul_f32 v116, s6, v116
    v_mul_f32 v117, s6, v117
    v_mul_f32 v118, s6, v118
    v_mul_f32 v119, s6, v119
    v_cvt_pk_bf16_f32 v208, v112, v113
    v_cvt_pk_bf16_f32 v209, v114, v115
    v_cvt_pk_bf16_f32 v210, v116, v117
    v_cvt_pk_bf16_f32 v211, v118, v119
    s_nop 1
    v_permlane32_swap_b32 v208, v210
    v_permlane32_swap_b32 v209, v211
    s_nop 1
    v_accvgpr_write_b32 a164, v208
    v_accvgpr_write_b32 a165, v209
    v_accvgpr_write_b32 a166, v210
    v_accvgpr_write_b32 a167, v211
    v_mul_f32 v120, s6, v120
    v_mul_f32 v121, s6, v121
    v_mul_f32 v122, s6, v122
    v_mul_f32 v123, s6, v123
    v_mul_f32 v124, s6, v124
    v_mul_f32 v125, s6, v125
    v_mul_f32 v126, s6, v126
    v_mul_f32 v127, s6, v127
    v_cvt_pk_bf16_f32 v208, v120, v121
    v_cvt_pk_bf16_f32 v209, v122, v123
    v_cvt_pk_bf16_f32 v210, v124, v125
    v_cvt_pk_bf16_f32 v211, v126, v127
    s_nop 1
    v_permlane32_swap_b32 v208, v210
    v_permlane32_swap_b32 v209, v211
    s_nop 1
    v_accvgpr_write_b32 a168, v208
    v_accvgpr_write_b32 a169, v209
    v_accvgpr_write_b32 a170, v210
    v_accvgpr_write_b32 a171, v211
    v_mul_f32 v128, s6, v128
    v_mul_f32 v129, s6, v129
    v_mul_f32 v130, s6, v130
    v_mul_f32 v131, s6, v131
    v_mul_f32 v132, s6, v132
    v_mul_f32 v133, s6, v133
    v_mul_f32 v134, s6, v134
    v_mul_f32 v135, s6, v135
    v_cvt_pk_bf16_f32 v208, v128, v129
    v_cvt_pk_bf16_f32 v209, v130, v131
    v_cvt_pk_bf16_f32 v210, v132, v133
    v_cvt_pk_bf16_f32 v211, v134, v135
    s_nop 1
    v_permlane32_swap_b32 v208, v210
    v_permlane32_swap_b32 v209, v211
    s_nop 1
    v_accvgpr_write_b32 a172, v208
    v_accvgpr_write_b32 a173, v209
    v_accvgpr_write_b32 a174, v210
    v_accvgpr_write_b32 a175, v211
    v_mul_f32 v136, s6, v136
    v_mul_f32 v137, s6, v137
    v_mul_f32 v138, s6, v138
    v_mul_f32 v139, s6, v139
    v_mul_f32 v140, s6, v140
    v_mul_f32 v141, s6, v141
    v_mul_f32 v142, s6, v142
    v_mul_f32 v143, s6, v143
    v_cvt_pk_bf16_f32 v208, v136, v137
    v_cvt_pk_bf16_f32 v209, v138, v139
    v_cvt_pk_bf16_f32 v210, v140, v141
    v_cvt_pk_bf16_f32 v211, v142, v143
    s_nop 1
    v_permlane32_swap_b32 v208, v210
    v_permlane32_swap_b32 v209, v211
    s_nop 1
    v_accvgpr_write_b32 a176, v208
    v_accvgpr_write_b32 a177, v209
    v_accvgpr_write_b32 a178, v210
    v_accvgpr_write_b32 a179, v211
    v_mul_f32 v144, s6, v144
    v_mul_f32 v145, s6, v145
    v_mul_f32 v146, s6, v146
    v_mul_f32 v147, s6, v147
    v_mul_f32 v148, s6, v148
    v_mul_f32 v149, s6, v149
    v_mul_f32 v150, s6, v150
    v_mul_f32 v151, s6, v151
    v_cvt_pk_bf16_f32 v208, v144, v145
    v_cvt_pk_bf16_f32 v209, v146, v147
    v_cvt_pk_bf16_f32 v210, v148, v149
    v_cvt_pk_bf16_f32 v211, v150, v151
    s_nop 1
    v_permlane32_swap_b32 v208, v210
    v_permlane32_swap_b32 v209, v211
    s_nop 1
    v_accvgpr_write_b32 a180, v208
    v_accvgpr_write_b32 a181, v209
    v_accvgpr_write_b32 a182, v210
    v_accvgpr_write_b32 a183, v211
    v_mul_f32 v152, s6, v152
    v_mul_f32 v153, s6, v153
    v_mul_f32 v154, s6, v154
    v_mul_f32 v155, s6, v155
    v_mul_f32 v156, s6, v156
    v_mul_f32 v157, s6, v157
    v_mul_f32 v158, s6, v158
    v_mul_f32 v159, s6, v159
    v_cvt_pk_bf16_f32 v208, v152, v153
    v_cvt_pk_bf16_f32 v209, v154, v155
    v_cvt_pk_bf16_f32 v210, v156, v157
    v_cvt_pk_bf16_f32 v211, v158, v159
    s_nop 1
    v_permlane32_swap_b32 v208, v210
    v_permlane32_swap_b32 v209, v211
    s_nop 1
    v_accvgpr_write_b32 a184, v208
    v_accvgpr_write_b32 a185, v209
    v_accvgpr_write_b32 a186, v210
    v_accvgpr_write_b32 a187, v211
    v_mul_f32 v160, s6, v160
    v_mul_f32 v161, s6, v161
    v_mul_f32 v162, s6, v162
    v_mul_f32 v163, s6, v163
    v_mul_f32 v164, s6, v164
    v_mul_f32 v165, s6, v165
    v_mul_f32 v166, s6, v166
    v_mul_f32 v167, s6, v167
    v_cvt_pk_bf16_f32 v208, v160, v161
    v_cvt_pk_bf16_f32 v209, v162, v163
    v_cvt_pk_bf16_f32 v210, v164, v165
    v_cvt_pk_bf16_f32 v211, v166, v167
    s_nop 1
    v_permlane32_swap_b32 v208, v210
    v_permlane32_swap_b32 v209, v211
    s_nop 1
    v_accvgpr_write_b32 a188, v208
    v_accvgpr_write_b32 a189, v209
    v_accvgpr_write_b32 a190, v210
    v_accvgpr_write_b32 a191, v211
    v_mov_b32 v26, 0
    v_mov_b32 v27, 0
    s_waitcnt vmcnt(0)
    s_barrier
    s_lshl_b32 s6, s2, 2
    s_add_u32 s6, s6, s5
    s_mul_i32 s52, s6, 4608
    s_mul_i32 s53, s6, 5184
    v_lshlrev_b32 v38, 7, v1
    ds_read_b128 v[168:171], v8
    ds_read_b128 v[172:175], v9
    ds_read_b128 v[176:179], v10
    ds_read_b128 v[180:183], v11
    ds_read_b128 v[184:187], v12
    ds_read_b128 v[188:191], v13
    ds_read_b128 v[192:195], v14
    ds_read_b128 v[196:199], v15
    s_waitcnt lgkmcnt(7)
    v_mfma_f32_32x32x16_bf16 v[40:55], v[168:171], a[128:131], 0
    v_mfma_f32_32x32x16_bf16 v[56:71], v[168:171], a[160:163], 0
    s_waitcnt lgkmcnt(6)
    v_mfma_f32_32x32x16_bf16 v[40:55], v[172:175], a[132:135], v[40:55]
    v_mfma_f32_32x32x16_bf16 v[56:71], v[172:175], a[164:167], v[56:71]
    s_waitcnt lgkmcnt(5)
    v_mfma_f32_32x32x16_bf16 v[40:55], v[176:179], a[136:139], v[40:55]
    v_mfma_f32_32x32x16_bf16 v[56:71], v[176:179], a[168:171], v[56:71]
    s_waitcnt lgkmcnt(4)
    v_mfma_f32_32x32x16_bf16 v[40:55], v[180:183], a[140:143], v[40:55]
    v_mfma_f32_32x32x16_bf16 v[56:71], v[180:183], a[172:175], v[56:71]
    s_waitcnt lgkmcnt(3)
    v_mfma_f32_32x32x16_bf16 v[40:55], v[184:187], a[144:147], v[40:55]
    v_mfma_f32_32x32x16_bf16 v[56:71], v[184:187], a[176:179], v[56:71]
    s_waitcnt lgkmcnt(2)
    v_mfma_f32_32x32x16_bf16 v[40:55], v[188:191], a[148:151], v[40:55]
    v_mfma_f32_32x32x16_bf16 v[56:71], v[188:191], a[180:183], v[56:71]
    s_waitcnt lgkmcnt(1)
    v_mfma_f32_32x32x16_bf16 v[40:55], v[192:195], a[152:155], v[40:55]
    v_mfma_f32_32x32x16_bf16 v[56:71], v[192:195], a[184:187], v[56:71]
    s_waitcnt lgkmcnt(0)
    v_mfma_f32_32x32x16_bf16 v[40:55], v[196:199], a[156:159], v[40:55]
    v_mfma_f32_32x32x16_bf16 v[56:71], v[196:199], a[188:191], v[56:71]
    s_nop 15
    v_max3_f32 v208, v40, v41, v42
    v_max3_f32 v208, v208, v43, v44
    v_max3_f32 v208, v208, v45, v46
    v_max3_f32 v208, v208, v47, v48
    v_max3_f32 v208, v208, v49, v50
    v_max3_f32 v208, v208, v51, v52
    v_max3_f32 v208, v208, v53, v54
    v_max_f32 v208, v208, v55
    v_mov_b32 v209, v208
    s_nop 1
    v_permlane32_swap_b32 v209, v208
    s_nop 1
    v_max_f32 v208, v208, v209
    v_sub_f32 v136, 0, v208
    v_sub_f32 v40, v40, v208
    v_sub_f32 v137, 0, v208
    v_sub_f32 v41, v41, v208
    v_sub_f32 v138, 0, v208
    v_sub_f32 v42, v42, v208
    v_sub_f32 v139, 0, v208
    v_sub_f32 v43, v43, v208
    v_sub_f32 v140, 0, v208
    v_sub_f32 v44, v44, v208
    v_sub_f32 v141, 0, v208
    v_sub_f32 v45, v45, v208
    v_sub_f32 v142, 0, v208
    v_sub_f32 v46, v46, v208
    v_sub_f32 v143, 0, v208
    v_sub_f32 v47, v47, v208
    v_sub_f32 v144, 0, v208
    v_sub_f32 v48, v48, v208
    v_sub_f32 v145, 0, v208
    v_sub_f32 v49, v49, v208
    v_sub_f32 v146, 0, v208
    v_sub_f32 v50, v50, v208
    v_sub_f32 v147, 0, v208
    v_sub_f32 v51, v51, v208
    v_sub_f32 v148, 0, v208
    v_sub_f32 v52, v52, v208
    v_sub_f32 v149, 0, v208
    v_sub_f32 v53, v53, v208
    v_sub_f32 v150, 0, v208
    v_sub_f32 v54, v54, v208
    v_sub_f32 v151, 0, v208
    v_sub_f32 v55, v55, v208
    v_max3_f32 v208, v56, v57, v58
    v_max3_f32 v208, v208, v59, v60
    v_max3_f32 v208, v208, v61, v62
    v_max3_f32 v208, v208, v63, v64
    v_max3_f32 v208, v208, v65, v66
    v_max3_f32 v208, v208, v67, v68
    v_max3_f32 v208, v208, v69, v70
    v_max_f32 v208, v208, v71
    v_mov_b32 v209, v208
    s_nop 1
    v_permlane32_swap_b32 v209, v208
    s_nop 1
    v_max_f32 v208, v208, v209
    v_sub_f32 v152, 0, v208
    v_sub_f32 v56, v56, v208
    v_sub_f32 v153, 0, v208
    v_sub_f32 v57, v57, v208
    v_sub_f32 v154, 0, v208
    v_sub_f32 v58, v58, v208
    v_sub_f32 v155, 0, v208
    v_sub_f32 v59, v59, v208
    v_sub_f32 v156, 0, v208
    v_sub_f32 v60, v60, v208
    v_sub_f32 v157, 0, v208
    v_sub_f32 v61, v61, v208
    v_sub_f32 v158, 0, v208
    v_sub_f32 v62, v62, v208
    v_sub_f32 v159, 0, v208
    v_sub_f32 v63, v63, v208
    v_sub_f32 v160, 0, v208
    v_sub_f32 v64, v64, v208
    v_sub_f32 v161, 0, v208
    v_sub_f32 v65, v65, v208
    v_sub_f32 v162, 0, v208
    v_sub_f32 v66, v66, v208
    v_sub_f32 v163, 0, v208
    v_sub_f32 v67, v67, v208
    v_sub_f32 v164, 0, v208
    v_sub_f32 v68, v68, v208
    v_sub_f32 v165, 0, v208
    v_sub_f32 v69, v69, v208
    v_sub_f32 v166, 0, v208
    v_sub_f32 v70, v70, v208
    v_sub_f32 v167, 0, v208
    v_sub_f32 v71, v71, v208
    v_exp_f32 v30, v40
    v_exp_f32 v31, v41
    s_nop 0
    v_add_f32 v28, v30, v31
    v_cvt_pk_bf16_f32 v104, v30, v31
    v_exp_f32 v32, v42
    v_exp_f32 v33, v43
    v_add_f32 v28, v28, v32
    v_add_f32 v28, v28, v33
    v_cvt_pk_bf16_f32 v105, v32, v33
    v_exp_f32 v30, v44
    v_exp_f32 v31, v45
    v_add_f32 v28, v28, v30
    v_add_f32 v28, v28, v31
    v_cvt_pk_bf16_f32 v106, v30, v31
    v_exp_f32 v32, v46
    v_exp_f32 v33, v47
    v_add_f32 v28, v28, v32
    v_add_f32 v28, v28, v33
    v_cvt_pk_bf16_f32 v107, v32, v33
    v_exp_f32 v30, v48
    v_exp_f32 v31, v49
    v_add_f32 v28, v28, v30
    v_add_f32 v28, v28, v31
    v_cvt_pk_bf16_f32 v108, v30, v31
    v_exp_f32 v32, v50
    v_exp_f32 v33, v51
    v_add_f32 v28, v28, v32
    v_add_f32 v28, v28, v33
    v_cvt_pk_bf16_f32 v109, v32, v33
    v_exp_f32 v30, v52
    v_exp_f32 v31, v53
    v_add_f32 v28, v28, v30
    v_add_f32 v28, v28, v31
    v_cvt_pk_bf16_f32 v110, v30, v31
    v_exp_f32 v32, v54
    v_exp_f32 v33, v55
    v_add_f32 v28, v28, v32
    ds_read_b128 v[168:171], v8 offset:8192
    ds_read_b128 v[172:175], v9 offset:8192
    ds_read_b128 v[176:179], v10 offset:8192
    ds_read_b128 v[180:183], v11 offset:8192
    ds_read_b128 v[184:187], v12 offset:8192
    ds_read_b128 v[188:191], v13 offset:8192
    s_mov_b32 s31, 8
    .p2align 6
attn_loop:
    s_waitcnt vmcnt(8)
    s_barrier
    s_waitcnt lgkmcnt(5)
    v_mfma_f32_32x32x16_bf16 v[72:87], v[168:171], a[128:131], v[136:151]
    ds_read_b128 v[192:195], v14 offset:8192
    v_add_f32 v28, v28, v33
    v_cvt_pk_bf16_f32 v111, v32, v33
    v_exp_f32 v30, v56
    v_mfma_f32_32x32x16_bf16 v[88:103], v[168:171], a[160:163], v[152:167]
    v_exp_f32 v31, v57
    s_nop 0
    v_add_f32 v29, v30, v31
    s_waitcnt lgkmcnt(5)
    v_mfma_f32_32x32x16_bf16 v[72:87], v[172:175], a[132:135], v[72:87]
    ds_read_b128 v[196:199], v15 offset:8192
    v_cvt_pk_bf16_f32 v112, v30, v31
    v_exp_f32 v32, v58
    v_exp_f32 v33, v59
    v_mfma_f32_32x32x16_bf16 v[88:103], v[172:175], a[164:167], v[88:103]
    v_add_f32 v29, v29, v32
    v_add_f32 v29, v29, v33
    v_cvt_pk_bf16_f32 v113, v32, v33
    s_waitcnt lgkmcnt(5)
    v_mfma_f32_32x32x16_bf16 v[72:87], v[176:179], a[136:139], v[72:87]
    ds_read_b64_tr_b16 v[168:169], v16 offset:0
    ds_read_b64_tr_b16 v[170:171], v16 offset:2048
    v_exp_f32 v30, v60
    v_exp_f32 v31, v61
    v_add_f32 v29, v29, v30
    v_mfma_f32_32x32x16_bf16 v[88:103], v[176:179], a[168:171], v[88:103]
    v_add_f32 v29, v29, v31
    v_cvt_pk_bf16_f32 v114, v30, v31
    v_exp_f32 v32, v62
    s_waitcnt lgkmcnt(6)
    v_mfma_f32_32x32x16_bf16 v[72:87], v[180:183], a[140:143], v[72:87]
    ds_read_b64_tr_b16 v[172:173], v17 offset:0
    ds_read_b64_tr_b16 v[174:175], v17 offset:2048
    v_exp_f32 v33, v63
    v_add_f32 v29, v29, v32
    v_add_f32 v29, v29, v33
    v_mfma_f32_32x32x16_bf16 v[88:103], v[180:183], a[172:175], v[88:103]
    v_cvt_pk_bf16_f32 v115, v32, v33
    v_exp_f32 v30, v64
    v_exp_f32 v31, v65
    s_waitcnt lgkmcnt(7)
    v_mfma_f32_32x32x16_bf16 v[72:87], v[184:187], a[144:147], v[72:87]
    ds_read_b64_tr_b16 v[176:177], v18 offset:0
    ds_read_b64_tr_b16 v[178:179], v18 offset:2048
    v_add_f32 v29, v29, v30
    v_add_f32 v29, v29, v31
    v_cvt_pk_bf16_f32 v116, v30, v31
    v_mfma_f32_32x32x16_bf16 v[88:103], v[184:187], a[176:179], v[88:103]
    v_exp_f32 v32, v66
    v_exp_f32 v33, v67
    s_waitcnt lgkmcnt(8)
    v_mfma_f32_32x32x16_bf16 v[72:87], v[188:191], a[148:151], v[72:87]
    ds_read_b64_tr_b16 v[180:181], v19 offset:0
    ds_read_b64_tr_b16 v[182:183], v19 offset:2048
    v_add_f32 v29, v29, v32
    v_add_f32 v29, v29, v33
    v_cvt_pk_bf16_f32 v117, v32, v33
    v_exp_f32 v30, v68
    v_mfma_f32_32x32x16_bf16 v[88:103], v[188:191], a[180:183], v[88:103]
    v_exp_f32 v31, v69
    v_add_f32 v29, v29, v30
    v_add_f32 v29, v29, v31
    s_waitcnt lgkmcnt(9)
    v_mfma_f32_32x32x16_bf16 v[72:87], v[192:195], a[152:155], v[72:87]
    ds_read_b64_tr_b16 v[184:185], v16 offset:4096
    ds_read_b64_tr_b16 v[186:187], v16 offset:6144
    v_cvt_pk_bf16_f32 v118, v30, v31
    v_exp_f32 v32, v70
    v_mfma_f32_32x32x16_bf16 v[88:103], v[192:195], a[184:187], v[88:103]
    v_exp_f32 v33, v71
    v_add_f32 v29, v29, v32
    v_add_f32 v29, v29, v33
    v_cvt_pk_bf16_f32 v119, v32, v33
    s_waitcnt lgkmcnt(10)
    v_mfma_f32_32x32x16_bf16 v[72:87], v[196:199], a[156:159], v[72:87]
    ds_read_b64_tr_b16 v[188:189], v17 offset:4096
    ds_read_b64_tr_b16 v[190:191], v17 offset:6144
    v_max_f32 v34, v28, v29
    v_cmp_lt_f32 vcc, s32, v34
    s_cbranch_vccnz attn_kernel_rare1
attn_kernel_ret2:
    v_add_f32 v26, v26, v28
    v_add_f32 v27, v27, v29
    v_mfma_f32_32x32x16_bf16 v[88:103], v[196:199], a[188:191], v[88:103]
    s_add_u32 m0, s30, 49152
    s_nop 0
    buffer_load_dwordx4 v20, s[8:11], s28 offen offset:0 lds
    s_waitcnt lgkmcnt(10)
    v_mfma_f32_32x32x16_bf16 a[0:15], v[168:171], v[104:107], a[0:15]
    ds_read_b64_tr_b16 v[192:193], v18 offset:4096
    ds_read_b64_tr_b16 v[194:195], v18 offset:6144
    buffer_load_dwordx4 v21, s[8:11], s28 offen offset:1024 lds
    v_mfma_f32_32x32x16_bf16 a[64:79], v[168:171], v[112:115], a[64:79]
    buffer_load_dwordx4 v22, s[8:11], s28 offen offset:2048 lds
    s_waitcnt lgkmcnt(10)
    v_mfma_f32_32x32x16_bf16 a[16:31], v[172:175], v[104:107], a[16:31]
    ds_read_b64_tr_b16 v[196:197], v19 offset:4096
    ds_read_b64_tr_b16 v[198:199], v19 offset:6144
    buffer_load_dwordx4 v23, s[8:11], s28 offen offset:3072 lds
    s_add_u32 s28, s28, 16384
    v_mfma_f32_32x32x16_bf16 a[80:95], v[172:175], v[112:115], a[80:95]
    v_exp_f32 v30, v72
    v_exp_f32 v31, v73
    s_waitcnt lgkmcnt(10)
    v_mfma_f32_32x32x16_bf16 a[32:47], v[176:179], v[104:107], a[32:47]
    ds_read_b128 v[168:171], v8 offset:16384
    s_nop 0
    v_add_f32 v28, v30, v31
    v_cvt_pk_bf16_f32 v120, v30, v31
    v_exp_f32 v32, v74
    v_mfma_f32_32x32x16_bf16 a[96:111], v[176:179], v[112:115], a[96:111]
    v_exp_f32 v33, v75
    v_add_f32 v28, v28, v32
    s_waitcnt lgkmcnt(9)
    v_mfma_f32_32x32x16_bf16 a[48:63], v[180:183], v[104:107], a[48:63]
    ds_read_b128 v[172:175], v9 offset:16384
    v_add_f32 v28, v28, v33
    v_cvt_pk_bf16_f32 v121, v32, v33
    v_exp_f32 v30, v76
    v_mfma_f32_32x32x16_bf16 a[112:127], v[180:183], v[112:115], a[112:127]
    v_exp_f32 v31, v77
    v_add_f32 v28, v28, v30
    v_add_f32 v28, v28, v31
    v_cvt_pk_bf16_f32 v122, v30, v31
    s_waitcnt lgkmcnt(8)
    v_mfma_f32_32x32x16_bf16 a[0:15], v[184:187], v[108:111], a[0:15]
    ds_read_b128 v[176:179], v10 offset:16384
    v_exp_f32 v32, v78
    v_exp_f32 v33, v79
    v_mfma_f32_32x32x16_bf16 a[64:79], v[184:187], v[116:119], a[64:79]
    v_add_f32 v28, v28, v32
    v_add_f32 v28, v28, v33
    v_cvt_pk_bf16_f32 v123, v32, v33
    v_exp_f32 v30, v80
    s_waitcnt lgkmcnt(7)
    v_mfma_f32_32x32x16_bf16 a[16:31], v[188:191], v[108:111], a[16:31]
    ds_read_b128 v[180:183], v11 offset:16384
    v_exp_f32 v31, v81
    v_add_f32 v28, v28, v30
    v_mfma_f32_32x32x16_bf16 a[80:95], v[188:191], v[116:119], a[80:95]
    v_add_f32 v28, v28, v31
    v_cvt_pk_bf16_f32 v124, v30, v31
    v_exp_f32 v32, v82
    s_waitcnt lgkmcnt(6)
    v_mfma_f32_32x32x16_bf16 a[32:47], v[192:195], v[108:111], a[32:47]
    ds_read_b128 v[184:187], v12 offset:16384
    v_exp_f32 v33, v83
    v_add_f32 v28, v28, v32
    v_add_f32 v28, v28, v33
    v_mfma_f32_32x32x16_bf16 a[96:111], v[192:195], v[116:119], a[96:111]
    v_cvt_pk_bf16_f32 v125, v32, v33
    v_exp_f32 v30, v84
    v_exp_f32 v31, v85
    s_waitcnt lgkmcnt(5)
    v_mfma_f32_32x32x16_bf16 a[48:63], v[196:199], v[108:111], a[48:63]
    ds_read_b128 v[188:191], v13 offset:16384
    v_add_f32 v28, v28, v30
    v_add_f32 v28, v28, v31
    v_cvt_pk_bf16_f32 v126, v30, v31
    v_mfma_f32_32x32x16_bf16 a[112:127], v[196:199], v[116:119], a[112:127]
    v_exp_f32 v32, v86
    v_exp_f32 v33, v87
    v_add_f32 v28, v28, v32
    s_waitcnt lgkmcnt(5)
    v_mfma_f32_32x32x16_bf16 v[40:55], v[168:171], a[128:131], v[136:151]
    ds_read_b128 v[192:195], v14 offset:16384
    v_add_f32 v28, v28, v33
    v_cvt_pk_bf16_f32 v127, v32, v33
    v_exp_f32 v30, v88
    v_mfma_f32_32x32x16_bf16 v[56:71], v[168:171], a[160:163], v[152:167]
    v_exp_f32 v31, v89
    s_nop 0
    v_add_f32 v29, v30, v31
    s_waitcnt lgkmcnt(5)
    v_mfma_f32_32x32x16_bf16 v[40:55], v[172:175], a[132:135], v[40:55]
    ds_read_b128 v[196:199], v15 offset:16384
    v_cvt_pk_bf16_f32 v128, v30, v31
    v_exp_f32 v32, v90
    v_exp_f32 v33, v91
    v_mfma_f32_32x32x16_bf16 v[56:71], v[172:175], a[164:167], v[56:71]
    v_add_f32 v29, v29, v32
    v_add_f32 v29, v29, v33
    v_cvt_pk_bf16_f32 v129, v32, v33
    s_waitcnt lgkmcnt(5)
    v_mfma_f32_32x32x16_bf16 v[40:55], v[176:179], a[136:139], v[40:55]
    ds_read_b64_tr_b16 v[168:169], v16 offset:8192
    ds_read_b64_tr_b16 v[170:171], v16 offset:10240
    v_exp_f32 v30, v92
    v_exp_f32 v31, v93
    v_add_f32 v29, v29, v30
    v_mfma_f32_32x32x16_bf16 v[56:71], v[176:179], a[168:171], v[56:71]
    v_add_f32 v29, v29, v31
    v_cvt_pk_bf16_f32 v130, v30, v31
    v_exp_f32 v32, v94
    s_waitcnt lgkmcnt(6)
    v_mfma_f32_32x32x16_bf16 v[40:55], v[180:183], a[140:143], v[40:55]
    ds_read_b64_tr_b16 v[172:173], v17 offset:8192
    ds_read_b64_tr_b16 v[174:175], v17 offset:10240
    v_exp_f32 v33, v95
    v_add_f32 v29, v29, v32
    v_add_f32 v29, v29, v33
    v_mfma_f32_32x32x16_bf16 v[56:71], v[180:183], a[172:175], v[56:71]
    v_cvt_pk_bf16_f32 v131, v32, v33
    v_exp_f32 v30, v96
    v_exp_f32 v31, v97
    s_waitcnt lgkmcnt(7)
    v_mfma_f32_32x32x16_bf16 v[40:55], v[184:187], a[144:147], v[40:55]
    ds_read_b64_tr_b16 v[176:177], v18 offset:8192
    ds_read_b64_tr_b16 v[178:179], v18 offset:10240
    v_add_f32 v29, v29, v30
    v_add_f32 v29, v29, v31
    v_cvt_pk_bf16_f32 v132, v30, v31
    v_mfma_f32_32x32x16_bf16 v[56:71], v[184:187], a[176:179], v[56:71]
    v_exp_f32 v32, v98
    v_exp_f32 v33, v99
    s_waitcnt lgkmcnt(8)
    v_mfma_f32_32x32x16_bf16 v[40:55], v[188:191], a[148:151], v[40:55]
    ds_read_b64_tr_b16 v[180:181], v19 offset:8192
    ds_read_b64_tr_b16 v[182:183], v19 offset:10240
    v_add_f32 v29, v29, v32
    v_add_f32 v29, v29, v33
    v_cvt_pk_bf16_f32 v133, v32, v33
    v_exp_f32 v30, v100
    v_mfma_f32_32x32x16_bf16 v[56:71], v[188:191], a[180:183], v[56:71]
    v_exp_f32 v31, v101
    v_add_f32 v29, v29, v30
    v_add_f32 v29, v29, v31
    s_waitcnt lgkmcnt(9)
    v_mfma_f32_32x32x16_bf16 v[40:55], v[192:195], a[152:155], v[40:55]
    ds_read_b64_tr_b16 v[184:185], v16 offset:12288
    ds_read_b64_tr_b16 v[186:187], v16 offset:14336
    v_cvt_pk_bf16_f32 v134, v30, v31
    v_exp_f32 v32, v102
    v_mfma_f32_32x32x16_bf16 v[56:71], v[192:195], a[184:187], v[56:71]
    v_exp_f32 v33, v103
    v_add_f32 v29, v29, v32
    v_add_f32 v29, v29, v33
    v_cvt_pk_bf16_f32 v135, v32, v33
    s_waitcnt lgkmcnt(10)
    v_mfma_f32_32x32x16_bf16 v[40:55], v[196:199], a[156:159], v[40:55]
    ds_read_b64_tr_b16 v[188:189], v17 offset:12288
    ds_read_b64_tr_b16 v[190:191], v17 offset:14336
    v_max_f32 v34, v28, v29
    v_cmp_lt_f32 vcc, s32, v34
    s_cbranch_vccnz attn_kernel_rare3
attn_kernel_ret4:
    v_add_f32 v26, v26, v28
    v_add_f32 v27, v27, v29
    v_mfma_f32_32x32x16_bf16 v[56:71], v[196:199], a[188:191], v[56:71]
    s_add_u32 m0, s30, 98304
    s_nop 0
    buffer_load_dwordx4 v24, s[12:15], s29 offen offset:0 lds
    s_waitcnt lgkmcnt(10)
    v_mfma_f32_32x32x16_bf16 a[0:15], v[168:171], v[120:123], a[0:15]
    ds_read_b64_tr_b16 v[192:193], v18 offset:12288
    ds_read_b64_tr_b16 v[194:195], v18 offset:14336
    buffer_load_dwordx4 v24, s[12:15], s29 offen offset:1024 lds
    v_mfma_f32_32x32x16_bf16 a[64:79], v[168:171], v[128:131], a[64:79]
    buffer_load_dwordx4 v24, s[12:15], s29 offen offset:2048 lds
    s_waitcnt lgkmcnt(10)
    v_mfma_f32_32x32x16_bf16 a[16:31], v[172:175], v[120:123], a[16:31]
    ds_read_b64_tr_b16 v[196:197], v19 offset:12288
    ds_read_b64_tr_b16 v[198:199], v19 offset:14336
    buffer_load_dwordx4 v24, s[12:15], s29 offen offset:3072 lds
    s_add_u32 s29, s29, 16384
    v_mfma_f32_32x32x16_bf16 a[80:95], v[172:175], v[128:131], a[80:95]
    v_exp_f32 v30, v40
    v_exp_f32 v31, v41
    s_waitcnt lgkmcnt(10)
    v_mfma_f32_32x32x16_bf16 a[32:47], v[176:179], v[120:123], a[32:47]
    ds_read_b128 v[168:171], v8 offset:24576
    s_nop 0
    v_add_f32 v28, v30, v31
    v_cvt_pk_bf16_f32 v104, v30, v31
    v_exp_f32 v32, v42
    v_mfma_f32_32x32x16_bf16 a[96:111], v[176:179], v[128:131], a[96:111]
    v_exp_f32 v33, v43
    v_add_f32 v28, v28, v32
    s_waitcnt lgkmcnt(9)
    v_mfma_f32_32x32x16_bf16 a[48:63], v[180:183], v[120:123], a[48:63]
    ds_read_b128 v[172:175], v9 offset:24576
    v_add_f32 v28, v28, v33
    v_cvt_pk_bf16_f32 v105, v32, v33
    v_exp_f32 v30, v44
    v_mfma_f32_32x32x16_bf16 a[112:127], v[180:183], v[128:131], a[112:127]
    v_exp_f32 v31, v45
    v_add_f32 v28, v28, v30
    v_add_f32 v28, v28, v31
    v_cvt_pk_bf16_f32 v106, v30, v31
    s_waitcnt lgkmcnt(8)
    v_mfma_f32_32x32x16_bf16 a[0:15], v[184:187], v[124:127], a[0:15]
    ds_read_b128 v[176:179], v10 offset:24576
    v_exp_f32 v32, v46
    v_exp_f32 v33, v47
    v_mfma_f32_32x32x16_bf16 a[64:79], v[184:187], v[132:135], a[64:79]
    v_add_f32 v28, v28, v32
    v_add_f32 v28, v28, v33
    v_cvt_pk_bf16_f32 v107, v32, v33
    v_exp_f32 v30, v48
    s_waitcnt lgkmcnt(7)
    v_mfma_f32_32x32x16_bf16 a[16:31], v[188:191], v[124:127], a[16:31]
    ds_read_b128 v[180:183], v11 offset:24576
    v_exp_f32 v31, v49
    v_add_f32 v28, v28, v30
    v_mfma_f32_32x32x16_bf16 a[80:95], v[188:191], v[132:135], a[80:95]
    v_add_f32 v28, v28, v31
    v_cvt_pk_bf16_f32 v108, v30, v31
    v_exp_f32 v32, v50
    s_waitcnt lgkmcnt(6)
    v_mfma_f32_32x32x16_bf16 a[32:47], v[192:195], v[124:127], a[32:47]
    ds_read_b128 v[184:187], v12 offset:24576
    v_exp_f32 v33, v51
    v_add_f32 v28, v28, v32
    v_add_f32 v28, v28, v33
    v_mfma_f32_32x32x16_bf16 a[96:111], v[192:195], v[132:135], a[96:111]
    v_cvt_pk_bf16_f32 v109, v32, v33
    v_exp_f32 v30, v52
    v_exp_f32 v31, v53
    s_waitcnt lgkmcnt(5)
    v_mfma_f32_32x32x16_bf16 a[48:63], v[196:199], v[124:127], a[48:63]
    ds_read_b128 v[188:191], v13 offset:24576
    buffer_load_dword v39, v38, s[40:43], s52 offen
    s_mov_b64 s[40:41], s[44:45]
    s_mov_b32 s42, s46
    s_mov_b64 s[44:45], s[48:49]
    s_mov_b32 s46, s50
    s_mov_b32 s50, 0
    s_mov_b32 s52, s53
    v_add_f32 v28, v28, v30
    v_add_f32 v28, v28, v31
    v_cvt_pk_bf16_f32 v110, v30, v31
    v_mfma_f32_32x32x16_bf16 a[112:127], v[196:199], v[132:135], a[112:127]
    v_exp_f32 v32, v54
    v_exp_f32 v33, v55
    v_add_f32 v28, v28, v32
    s_waitcnt vmcnt(9)
    s_barrier
    s_waitcnt lgkmcnt(5)
    v_mfma_f32_32x32x16_bf16 v[72:87], v[168:171], a[128:131], v[136:151]
    ds_read_b128 v[192:195], v14 offset:24576
    v_add_f32 v28, v28, v33
    v_cvt_pk_bf16_f32 v111, v32, v33
    v_exp_f32 v30, v56
    v_mfma_f32_32x32x16_bf16 v[88:103], v[168:171], a[160:163], v[152:167]
    v_exp_f32 v31, v57
    s_nop 0
    v_add_f32 v29, v30, v31
    s_waitcnt lgkmcnt(5)
    v_mfma_f32_32x32x16_bf16 v[72:87], v[172:175], a[132:135], v[72:87]
    ds_read_b128 v[196:199], v15 offset:24576
    v_cvt_pk_bf16_f32 v112, v30, v31
    v_exp_f32 v32, v58
    v_exp_f32 v33, v59
    v_mfma_f32_32x32x16_bf16 v[88:103], v[172:175], a[164:167], v[88:103]
    v_add_f32 v29, v29, v32
    v_add_f32 v29, v29, v33
    v_cvt_pk_bf16_f32 v113, v32, v33
    s_waitcnt lgkmcnt(5)
    v_mfma_f32_32x32x16_bf16 v[72:87], v[176:179], a[136:139], v[72:87]
    ds_read_b64_tr_b16 v[168:169], v16 offset:16384
    ds_read_b64_tr_b16 v[170:171], v16 offset:18432
    v_exp_f32 v30, v60
    v_exp_f32 v31, v61
    v_add_f32 v29, v29, v30
    v_mfma_f32_32x32x16_bf16 v[88:103], v[176:179], a[168:171], v[88:103]
    v_add_f32 v29, v29, v31
    v_cvt_pk_bf16_f32 v114, v30, v31
    v_exp_f32 v32, v62
    s_waitcnt lgkmcnt(6)
    v_mfma_f32_32x32x16_bf16 v[72:87], v[180:183], a[140:143], v[72:87]
    ds_read_b64_tr_b16 v[172:173], v17 offset:16384
    ds_read_b64_tr_b16 v[174:175], v17 offset:18432
    v_exp_f32 v33, v63
    v_add_f32 v29, v29, v32
    v_add_f32 v29, v29, v33
    v_mfma_f32_32x32x16_bf16 v[88:103], v[180:183], a[172:175], v[88:103]
    v_cvt_pk_bf16_f32 v115, v32, v33
    v_exp_f32 v30, v64
    v_exp_f32 v31, v65
    s_waitcnt lgkmcnt(7)
    v_mfma_f32_32x32x16_bf16 v[72:87], v[184:187], a[144:147], v[72:87]
    ds_read_b64_tr_b16 v[176:177], v18 offset:16384
    ds_read_b64_tr_b16 v[178:179], v18 offset:18432
    v_add_f32 v29, v29, v30
    v_add_f32 v29, v29, v31
    v_cvt_pk_bf16_f32 v116, v30, v31
    v_mfma_f32_32x32x16_bf16 v[88:103], v[184:187], a[176:179], v[88:103]
    v_exp_f32 v32, v66
    v_exp_f32 v33, v67
    s_waitcnt lgkmcnt(8)
    v_mfma_f32_32x32x16_bf16 v[72:87], v[188:191], a[148:151], v[72:87]
    ds_read_b64_tr_b16 v[180:181], v19 offset:16384
    ds_read_b64_tr_b16 v[182:183], v19 offset:18432
    v_add_f32 v29, v29, v32
    v_add_f32 v29, v29, v33
    v_cvt_pk_bf16_f32 v117, v32, v33
    v_exp_f32 v30, v68
    v_mfma_f32_32x32x16_bf16 v[88:103], v[188:191], a[180:183], v[88:103]
    v_exp_f32 v31, v69
    v_add_f32 v29, v29, v30
    v_add_f32 v29, v29, v31
    s_waitcnt lgkmcnt(9)
    v_mfma_f32_32x32x16_bf16 v[72:87], v[192:195], a[152:155], v[72:87]
    ds_read_b64_tr_b16 v[184:185], v16 offset:20480
    ds_read_b64_tr_b16 v[186:187], v16 offset:22528
    v_cvt_pk_bf16_f32 v118, v30, v31
    v_exp_f32 v32, v70
    v_mfma_f32_32x32x16_bf16 v[88:103], v[192:195], a[184:187], v[88:103]
    v_exp_f32 v33, v71
    v_add_f32 v29, v29, v32
    v_add_f32 v29, v29, v33
    v_cvt_pk_bf16_f32 v119, v32, v33
    s_waitcnt lgkmcnt(10)
    v_mfma_f32_32x32x16_bf16 v[72:87], v[196:199], a[156:159], v[72:87]
    ds_read_b64_tr_b16 v[188:189], v17 offset:20480
    ds_read_b64_tr_b16 v[190:191], v17 offset:22528
    v_max_f32 v34, v28, v29
    v_cmp_lt_f32 vcc, s32, v34
    s_cbranch_vccnz attn_kernel_rare5
attn_kernel_ret6:
    v_add_f32 v26, v26, v28
    v_add_f32 v27, v27, v29
    v_mfma_f32_32x32x16_bf16 v[88:103], v[196:199], a[188:191], v[88:103]
    s_add_u32 m0, s30, 0
    s_nop 0
    buffer_load_dwordx4 v20, s[8:11], s28 offen offset:0 lds
    s_waitcnt lgkmcnt(10)
    v_mfma_f32_32x32x16_bf16 a[0:15], v[168:171], v[104:107], a[0:15]
    ds_read_b64_tr_b16 v[192:193], v18 offset:20480
    ds_read_b64_tr_b16 v[194:195], v18 offset:22528
    buffer_load_dwordx4 v21, s[8:11], s28 offen offset:1024 lds
    v_mfma_f32_32x32x16_bf16 a[64:79], v[168:171], v[112:115], a[64:79]
    buffer_load_dwordx4 v22, s[8:11], s28 offen offset:2048 lds
    s_waitcnt lgkmcnt(10)
    v_mfma_f32_32x32x16_bf16 a[16:31], v[172:175], v[104:107], a[16:31]
    ds_read_b64_tr_b16 v[196:197], v19 offset:20480
    ds_read_b64_tr_b16 v[198:199], v19 offset:22528
    buffer_load_dwordx4 v23, s[8:11], s28 offen offset:3072 lds
    s_add_u32 s28, s28, 16384
    v_mfma_f32_32x32x16_bf16 a[80:95], v[172:175], v[112:115], a[80:95]
    v_exp_f32 v30, v72
    v_exp_f32 v31, v73
    s_waitcnt lgkmcnt(10)
    v_mfma_f32_32x32x16_bf16 a[32:47], v[176:179], v[104:107], a[32:47]
    ds_read_b128 v[168:171], v8 offset:32768
    s_nop 0
    v_add_f32 v28, v30, v31
    v_cvt_pk_bf16_f32 v120, v30, v31
    v_exp_f32 v32, v74
    v_mfma_f32_32x32x16_bf16 a[96:111], v[176:179], v[112:115], a[96:111]
    v_exp_f32 v33, v75
    v_add_f32 v28, v28, v32
    s_waitcnt lgkmcnt(9)
    v_mfma_f32_32x32x16_bf16 a[48:63], v[180:183], v[104:107], a[48:63]
    ds_read_b128 v[172:175], v9 offset:32768
    v_add_f32 v28, v28, v33
    v_cvt_pk_bf16_f32 v121, v32, v33
    v_exp_f32 v30, v76
    v_mfma_f32_32x32x16_bf16 a[112:127], v[180:183], v[112:115], a[112:127]
    v_exp_f32 v31, v77
    v_add_f32 v28, v28, v30
    v_add_f32 v28, v28, v31
    v_cvt_pk_bf16_f32 v122, v30, v31
    s_waitcnt lgkmcnt(8)
    v_mfma_f32_32x32x16_bf16 a[0:15], v[184:187], v[108:111], a[0:15]
    ds_read_b128 v[176:179], v10 offset:32768
    v_exp_f32 v32, v78
    v_exp_f32 v33, v79
    v_mfma_f32_32x32x16_bf16 a[64:79], v[184:187], v[116:119], a[64:79]
    v_add_f32 v28, v28, v32
    v_add_f32 v28, v28, v33
    v_cvt_pk_bf16_f32 v123, v32, v33
    v_exp_f32 v30, v80
    s_waitcnt lgkmcnt(7)
    v_mfma_f32_32x32x16_bf16 a[16:31], v[188:191], v[108:111], a[16:31]
    ds_read_b128 v[180:183], v11 offset:32768
    v_exp_f32 v31, v81
    v_add_f32 v28, v28, v30
    v_mfma_f32_32x32x16_bf16 a[80:95], v[188:191], v[116:119], a[80:95]
    v_add_f32 v28, v28, v31
    v_cvt_pk_bf16_f32 v124, v30, v31
    v_exp_f32 v32, v82
    s_waitcnt lgkmcnt(6)
    v_mfma_f32_32x32x16_bf16 a[32:47], v[192:195], v[108:111], a[32:47]
    ds_read_b128 v[184:187], v12 offset:32768
    v_exp_f32 v33, v83
    v_add_f32 v28, v28, v32
    v_add_f32 v28, v28, v33
    v_mfma_f32_32x32x16_bf16 a[96:111], v[192:195], v[116:119], a[96:111]
    v_cvt_pk_bf16_f32 v125, v32, v33
    v_exp_f32 v30, v84
    v_exp_f32 v31, v85
    s_waitcnt lgkmcnt(5)
    v_mfma_f32_32x32x16_bf16 a[48:63], v[196:199], v[108:111], a[48:63]
    ds_read_b128 v[188:191], v13 offset:32768
    v_add_f32 v28, v28, v30
    v_add_f32 v28, v28, v31
    v_cvt_pk_bf16_f32 v126, v30, v31
    v_mfma_f32_32x32x16_bf16 a[112:127], v[196:199], v[116:119], a[112:127]
    v_exp_f32 v32, v86
    v_exp_f32 v33, v87
    v_add_f32 v28, v28, v32
    s_waitcnt lgkmcnt(5)
    v_mfma_f32_32x32x16_bf16 v[40:55], v[168:171], a[128:131], v[136:151]
    ds_read_b128 v[192:195], v14 offset:32768
    v_add_f32 v28, v28, v33
    v_cvt_pk_bf16_f32 v127, v32, v33
    v_exp_f32 v30, v88
    v_mfma_f32_32x32x16_bf16 v[56:71], v[168:171], a[160:163], v[152:167]
    v_exp_f32 v31, v89
    s_nop 0
    v_add_f32 v29, v30, v31
    s_waitcnt lgkmcnt(5)
    v_mfma_f32_32x32x16_bf16 v[40:55], v[172:175], a[132:135], v[40:55]
    ds_read_b128 v[196:199], v15 offset:32768
    v_cvt_pk_bf16_f32 v128, v30, v31
    v_exp_f32 v32, v90
    v_exp_f32 v33, v91
    v_mfma_f32_32x32x16_bf16 v[56:71], v[172:175], a[164:167], v[56:71]
    v_add_f32 v29, v29, v32
    v_add_f32 v29, v29, v33
    v_cvt_pk_bf16_f32 v129, v32, v33
    s_waitcnt lgkmcnt(5)
    v_mfma_f32_32x32x16_bf16 v[40:55], v[176:179], a[136:139], v[40:55]
    ds_read_b64_tr_b16 v[168:169], v16 offset:24576
    ds_read_b64_tr_b16 v[170:171], v16 offset:26624
    v_exp_f32 v30, v92
    v_exp_f32 v31, v93
    v_add_f32 v29, v29, v30
    v_mfma_f32_32x32x16_bf16 v[56:71], v[176:179], a[168:171], v[56:71]
    v_add_f32 v29, v29, v31
    v_cvt_pk_bf16_f32 v130, v30, v31
    v_exp_f32 v32, v94
    s_waitcnt lgkmcnt(6)
    v_mfma_f32_32x32x16_bf16 v[40:55], v[180:183], a[140:143], v[40:55]
    ds_read_b64_tr_b16 v[172:173], v17 offset:24576
    ds_read_b64_tr_b16 v[174:175], v17 offset:26624
    v_exp_f32 v33, v95
    v_add_f32 v29, v29, v32
    v_add_f32 v29, v29, v33
    v_mfma_f32_32x32x16_bf16 v[56:71], v[180:183], a[172:175], v[56:71]
    v_cvt_pk_bf16_f32 v131, v32, v33
    v_exp_f32 v30, v96
    v_exp_f32 v31, v97
    s_waitcnt lgkmcnt(7)
    v_mfma_f32_32x32x16_bf16 v[40:55], v[184:187], a[144:147], v[40:55]
    ds_read_b64_tr_b16 v[176:177], v18 offset:24576
    ds_read_b64_tr_b16 v[178:179], v18 offset:26624
    v_add_f32 v29, v29, v30
    v_add_f32 v29, v29, v31
    v_cvt_pk_bf16_f32 v132, v30, v31
    v_mfma_f32_32x32x16_bf16 v[56:71], v[184:187], a[176:179], v[56:71]
    v_exp_f32 v32, v98
    v_exp_f32 v33, v99
    s_waitcnt lgkmcnt(8)
    v_mfma_f32_32x32x16_bf16 v[40:55], v[188:191], a[148:151], v[40:55]
    ds_read_b64_tr_b16 v[180:181], v19 offset:24576
    ds_read_b64_tr_b16 v[182:183], v19 offset:26624
    v_add_f32 v29, v29, v32
    v_add_f32 v29, v29, v33
    v_cvt_pk_bf16_f32 v133, v32, v33
    v_exp_f32 v30, v100
    v_mfma_f32_32x32x16_bf16 v[56:71], v[188:191], a[180:183], v[56:71]
    v_exp_f32 v31, v101
    v_add_f32 v29, v29, v30
    v_add_f32 v29, v29, v31
    s_waitcnt lgkmcnt(9)
    v_mfma_f32_32x32x16_bf16 v[40:55], v[192:195], a[152:155], v[40:55]
    ds_read_b64_tr_b16 v[184:185], v16 offset:28672
    ds_read_b64_tr_b16 v[186:187], v16 offset:30720
    v_cvt_pk_bf16_f32 v134, v30, v31
    v_exp_f32 v32, v102
    v_mfma_f32_32x32x16_bf16 v[56:71], v[192:195], a[184:187], v[56:71]
    v_exp_f32 v33, v103
    v_add_f32 v29, v29, v32
    v_add_f32 v29, v29, v33
    v_cvt_pk_bf16_f32 v135, v32, v33
    s_waitcnt lgkmcnt(10)
    v_mfma_f32_32x32x16_bf16 v[40:55], v[196:199], a[156:159], v[40:55]
    ds_read_b64_tr_b16 v[188:189], v17 offset:28672
    ds_read_b64_tr_b16 v[190:191], v17 offset:30720
    v_max_f32 v34, v28, v29
    v_cmp_lt_f32 vcc, s32, v34
    s_cbranch_vccnz attn_kernel_rare7
attn_kernel_ret8:
    v_add_f32 v26, v26, v28
    v_add_f32 v27, v27, v29
    v_mfma_f32_32x32x16_bf16 v[56:71], v[196:199], a[188:191], v[56:71]
    s_add_u32 m0, s30, 114688
    s_nop 0
    buffer_load_dwordx4 v24, s[12:15], s29 offen offset:0 lds
    s_waitcnt lgkmcnt(10)
    v_mfma_f32_32x32x16_bf16 a[0:15], v[168:171], v[120:123], a[0:15]
    ds_read_b64_tr_b16 v[192:193], v18 offset:28672
    ds_read_b64_tr_b16 v[194:195], v18 offset:30720
    buffer_load_dwordx4 v24, s[12:15], s29 offen offset:1024 lds
    v_mfma_f32_32x32x16_bf16 a[64:79], v[168:171], v[128:131], a[64:79]
    buffer_load_dwordx4 v24, s[12:15], s29 offen offset:2048 lds
    s_waitcnt lgkmcnt(10)
    v_mfma_f32_32x32x16_bf16 a[16:31], v[172:175], v[120:123], a[16:31]
    ds_read_b64_tr_b16 v[196:197], v19 offset:28672
    ds_read_b64_tr_b16 v[198:199], v19 offset:30720
    buffer_load_dwordx4 v24, s[12:15], s29 offen offset:3072 lds
    s_add_u32 s29, s29, 16384
    v_mfma_f32_32x32x16_bf16 a[80:95], v[172:175], v[128:131], a[80:95]
    v_exp_f32 v30, v40
    v_exp_f32 v31, v41
    s_waitcnt lgkmcnt(10)
    v_mfma_f32_32x32x16_bf16 a[32:47], v[176:179], v[120:123], a[32:47]
    ds_read_b128 v[168:171], v8 offset:40960
    s_nop 0
    v_add_f32 v28, v30, v31
    v_cvt_pk_bf16_f32 v104, v30, v31
    v_exp_f32 v32, v42
    v_mfma_f32_32x32x16_bf16 a[96:111], v[176:179], v[128:131], a[96:111]
    v_exp_f32 v33, v43
    v_add_f32 v28, v28, v32
    s_waitcnt lgkmcnt(9)
    v_mfma_f32_32x32x16_bf16 a[48:63], v[180:183], v[120:123], a[48:63]
    ds_read_b128 v[172:175], v9 offset:40960
    v_add_f32 v28, v28, v33
    v_cvt_pk_bf16_f32 v105, v32, v33
    v_exp_f32 v30, v44
    v_mfma_f32_32x32x16_bf16 a[112:127], v[180:183], v[128:131], a[112:127]
    v_exp_f32 v31, v45
    v_add_f32 v28, v28, v30
    v_add_f32 v28, v28, v31
    v_cvt_pk_bf16_f32 v106, v30, v31
    s_waitcnt lgkmcnt(8)
    v_mfma_f32_32x32x16_bf16 a[0:15], v[184:187], v[124:127], a[0:15]
    ds_read_b128 v[176:179], v10 offset:40960
    v_exp_f32 v32, v46
    v_exp_f32 v33, v47
    v_mfma_f32_32x32x16_bf16 a[64:79], v[184:187], v[132:135], a[64:79]
    v_add_f32 v28, v28, v32
    v_add_f32 v28, v28, v33
    v_cvt_pk_bf16_f32 v107, v32, v33
    v_exp_f32 v30, v48
    s_waitcnt lgkmcnt(7)
    v_mfma_f32_32x32x16_bf16 a[16:31], v[188:191], v[124:127], a[16:31]
    ds_read_b128 v[180:183], v11 offset:40960
    v_exp_f32 v31, v49
    v_add_f32 v28, v28, v30
    v_mfma_f32_32x32x16_bf16 a[80:95], v[188:191], v[132:135], a[80:95]
    v_add_f32 v28, v28, v31
    v_cvt_pk_bf16_f32 v108, v30, v31
    v_exp_f32 v32, v50
    s_waitcnt lgkmcnt(6)
    v_mfma_f32_32x32x16_bf16 a[32:47], v[192:195], v[124:127], a[32:47]
    ds_read_b128 v[184:187], v12 offset:40960
    v_exp_f32 v33, v51
    v_add_f32 v28, v28, v32
    v_add_f32 v28, v28, v33
    v_mfma_f32_32x32x16_bf16 a[96:111], v[192:195], v[132:135], a[96:111]
    v_cvt_pk_bf16_f32 v109, v32, v33
    v_exp_f32 v30, v52
    v_exp_f32 v31, v53
    s_waitcnt lgkmcnt(5)
    v_mfma_f32_32x32x16_bf16 a[48:63], v[196:199], v[124:127], a[48:63]
    ds_read_b128 v[188:191], v13 offset:40960
    v_add_f32 v28, v28, v30
    v_add_f32 v28, v28, v31
    v_cvt_pk_bf16_f32 v110, v30, v31
    v_mfma_f32_32x32x16_bf16 a[112:127], v[196:199], v[132:135], a[112:127]
    v_exp_f32 v32, v54
    v_exp_f32 v33, v55
    v_add_f32 v28, v28, v32
    s_waitcnt vmcnt(9)
    s_barrier
    s_waitcnt lgkmcnt(5)
    v_mfma_f32_32x32x16_bf16 v[72:87], v[168:171], a[128:131], v[136:151]
    ds_read_b128 v[192:195], v14 offset:40960
    v_add_f32 v28, v28, v33
    v_cvt_pk_bf16_f32 v111, v32, v33
    v_exp_f32 v30, v56
    v_mfma_f32_32x32x16_bf16 v[88:103], v[168:171], a[160:163], v[152:167]
    v_exp_f32 v31, v57
    s_nop 0
    v_add_f32 v29, v30, v31
    s_waitcnt lgkmcnt(5)
    v_mfma_f32_32x32x16_bf16 v[72:87], v[172:175], a[132:135], v[72:87]
    ds_read_b128 v[196:199], v15 offset:40960
    v_cvt_pk_bf16_f32 v112, v30, v31
    v_exp_f32 v32, v58
    v_exp_f32 v33, v59
    v_mfma_f32_32x32x16_bf16 v[88:103], v[172:175], a[164:167], v[88:103]
    v_add_f32 v29, v29, v32
    v_add_f32 v29, v29, v33
    v_cvt_pk_bf16_f32 v113, v32, v33
    s_waitcnt lgkmcnt(5)
    v_mfma_f32_32x32x16_bf16 v[72:87], v[176:179], a[136:139], v[72:87]
    ds_read_b64_tr_b16 v[168:169], v16 offset:32768
    ds_read_b64_tr_b16 v[170:171], v16 offset:34816
    v_exp_f32 v30, v60
    v_exp_f32 v31, v61
    v_add_f32 v29, v29, v30
    v_mfma_f32_32x32x16_bf16 v[88:103], v[176:179], a[168:171], v[88:103]
    v_add_f32 v29, v29, v31
    v_cvt_pk_bf16_f32 v114, v30, v31
    v_exp_f32 v32, v62
    s_waitcnt lgkmcnt(6)
    v_mfma_f32_32x32x16_bf16 v[72:87], v[180:183], a[140:143], v[72:87]
    ds_read_b64_tr_b16 v[172:173], v17 offset:32768
    ds_read_b64_tr_b16 v[174:175], v17 offset:34816
    v_exp_f32 v33, v63
    v_add_f32 v29, v29, v32
    v_add_f32 v29, v29, v33
    v_mfma_f32_32x32x16_bf16 v[88:103], v[180:183], a[172:175], v[88:103]
    v_cvt_pk_bf16_f32 v115, v32, v33
    v_exp_f32 v30, v64
    v_exp_f32 v31, v65
    s_waitcnt lgkmcnt(7)
    v_mfma_f32_32x32x16_bf16 v[72:87], v[184:187], a[144:147], v[72:87]
    ds_read_b64_tr_b16 v[176:177], v18 offset:32768
    ds_read_b64_tr_b16 v[178:179], v18 offset:34816
    v_add_f32 v29, v29, v30
    v_add_f32 v29, v29, v31
    v_cvt_pk_bf16_f32 v116, v30, v31
    v_mfma_f32_32x32x16_bf16 v[88:103], v[184:187], a[176:179], v[88:103]
    v_exp_f32 v32, v66
    v_exp_f32 v33, v67
    s_waitcnt lgkmcnt(8)
    v_mfma_f32_32x32x16_bf16 v[72:87], v[188:191], a[148:151], v[72:87]
    ds_read_b64_tr_b16 v[180:181], v19 offset:32768
    ds_read_b64_tr_b16 v[182:183], v19 offset:34816
    v_add_f32 v29, v29, v32
    v_add_f32 v29, v29, v33
    v_cvt_pk_bf16_f32 v117, v32, v33
    v_exp_f32 v30, v68
    v_mfma_f32_32x32x16_bf16 v[88:103], v[188:191], a[180:183], v[88:103]
    v_exp_f32 v31, v69
    v_add_f32 v29, v29, v30
    v_add_f32 v29, v29, v31
    s_waitcnt lgkmcnt(9)
    v_mfma_f32_32x32x16_bf16 v[72:87], v[192:195], a[152:155], v[72:87]
    ds_read_b64_tr_b16 v[184:185], v16 offset:36864
    ds_read_b64_tr_b16 v[186:187], v16 offset:38912
    v_cvt_pk_bf16_f32 v118, v30, v31
    v_exp_f32 v32, v70
    v_mfma_f32_32x32x16_bf16 v[88:103], v[192:195], a[184:187], v[88:103]
    v_exp_f32 v33, v71
    v_add_f32 v29, v29, v32
    v_add_f32 v29, v29, v33
    v_cvt_pk_bf16_f32 v119, v32, v33
    s_waitcnt lgkmcnt(10)
    v_mfma_f32_32x32x16_bf16 v[72:87], v[196:199], a[156:159], v[72:87]
    ds_read_b64_tr_b16 v[188:189], v17 offset:36864
    ds_read_b64_tr_b16 v[190:191], v17 offset:38912
    v_max_f32 v34, v28, v29
    v_cmp_lt_f32 vcc, s32, v34
    s_cbranch_vccnz attn_kernel_rare9
attn_kernel_ret10:
    v_add_f32 v26, v26, v28
    v_add_f32 v27, v27, v29
    v_mfma_f32_32x32x16_bf16 v[88:103], v[196:199], a[188:191], v[88:103]
    s_add_u32 m0, s30, 16384
    s_nop 0
    buffer_load_dwordx4 v20, s[8:11], s28 offen offset:0 lds
    s_waitcnt lgkmcnt(10)
    v_mfma_f32_32x32x16_bf16 a[0:15], v[168:171], v[104:107], a[0:15]
    ds_read_b64_tr_b16 v[192:193], v18 offset:36864
    ds_read_b64_tr_b16 v[194:195], v18 offset:38912
    buffer_load_dwordx4 v21, s[8:11], s28 offen offset:1024 lds
    v_mfma_f32_32x32x16_bf16 a[64:79], v[168:171], v[112:115], a[64:79]
    buffer_load_dwordx4 v22, s[8:11], s28 offen offset:2048 lds
    s_waitcnt lgkmcnt(10)
    v_mfma_f32_32x32x16_bf16 a[16:31], v[172:175], v[104:107], a[16:31]
    ds_read_b64_tr_b16 v[196:197], v19 offset:36864
    ds_read_b64_tr_b16 v[198:199], v19 offset:38912
    buffer_load_dwordx4 v23, s[8:11], s28 offen offset:3072 lds
    s_add_u32 s28, s28, 16384
    v_mfma_f32_32x32x16_bf16 a[80:95], v[172:175], v[112:115], a[80:95]
    v_exp_f32 v30, v72
    v_exp_f32 v31, v73
    s_waitcnt lgkmcnt(10)
    v_mfma_f32_32x32x16_bf16 a[32:47], v[176:179], v[104:107], a[32:47]
    ds_read_b128 v[168:171], v8 offset:49152
    s_nop 0
    v_add_f32 v28, v30, v31
    v_cvt_pk_bf16_f32 v120, v30, v31
    v_exp_f32 v32, v74
    v_mfma_f32_32x32x16_bf16 a[96:111], v[176:179], v[112:115], a[96:111]
    v_exp_f32 v33, v75
    v_add_f32 v28, v28, v32
    s_waitcnt lgkmcnt(9)
    v_mfma_f32_32x32x16_bf16 a[48:63], v[180:183], v[104:107], a[48:63]
    ds_read_b128 v[172:175], v9 offset:49152
    v_add_f32 v28, v28, v33
    v_cvt_pk_bf16_f32 v121, v32, v33
    v_exp_f32 v30, v76
    v_mfma_f32_32x32x16_bf16 a[112:127], v[180:183], v[112:115], a[112:127]
    v_exp_f32 v31, v77
    v_add_f32 v28, v28, v30
    v_add_f32 v28, v28, v31
    v_cvt_pk_bf16_f32 v122, v30, v31
    s_waitcnt lgkmcnt(8)
    v_mfma_f32_32x32x16_bf16 a[0:15], v[184:187], v[108:111], a[0:15]
    ds_read_b128 v[176:179], v10 offset:49152
    v_exp_f32 v32, v78
    v_exp_f32 v33, v79
    v_mfma_f32_32x32x16_bf16 a[64:79], v[184:187], v[116:119], a[64:79]
    v_add_f32 v28, v28, v32
    v_add_f32 v28, v28, v33
    v_cvt_pk_bf16_f32 v123, v32, v33
    v_exp_f32 v30, v80
    s_waitcnt lgkmcnt(7)
    v_mfma_f32_32x32x16_bf16 a[16:31], v[188:191], v[108:111], a[16:31]
    ds_read_b128 v[180:183], v11 offset:49152
    v_exp_f32 v31, v81
    v_add_f32 v28, v28, v30
    v_mfma_f32_32x32x16_bf16 a[80:95], v[188:191], v[116:119], a[80:95]
    v_add_f32 v28, v28, v31
    v_cvt_pk_bf16_f32 v124, v30, v31
    v_exp_f32 v32, v82
    s_waitcnt lgkmcnt(6)
    v_mfma_f32_32x32x16_bf16 a[32:47], v[192:195], v[108:111], a[32:47]
    ds_read_b128 v[184:187], v12 offset:49152
    v_exp_f32 v33, v83
    v_add_f32 v28, v28, v32
    v_add_f32 v28, v28, v33
    v_mfma_f32_32x32x16_bf16 a[96:111], v[192:195], v[116:119], a[96:111]
    v_cvt_pk_bf16_f32 v125, v32, v33
    v_exp_f32 v30, v84
    v_exp_f32 v31, v85
    s_waitcnt lgkmcnt(5)
    v_mfma_f32_32x32x16_bf16 a[48:63], v[196:199], v[108:111], a[48:63]
    ds_read_b128 v[188:191], v13 offset:49152
    v_add_f32 v28, v28, v30
    v_add_f32 v28, v28, v31
    v_cvt_pk_bf16_f32 v126, v30, v31
    v_mfma_f32_32x32x16_bf16 a[112:127], v[196:199], v[116:119], a[112:127]
    v_exp_f32 v32, v86
    v_exp_f32 v33, v87
    v_add_f32 v28, v28, v32
    s_waitcnt lgkmcnt(5)
    v_mfma_f32_32x32x16_bf16 v[40:55], v[168:171], a[128:131], v[136:151]
    ds_read_b128 v[192:195], v14 offset:49152
    v_add_f32 v28, v28, v33
    v_cvt_pk_bf16_f32 v127, v32, v33
    v_exp_f32 v30, v88
    v_mfma_f32_32x32x16_bf16 v[56:71], v[168:171], a[160:163], v[152:167]
    v_exp_f32 v31, v89
    s_nop 0
    v_add_f32 v29, v30, v31
    s_waitcnt lgkmcnt(5)
    v_mfma_f32_32x32x16_bf16 v[40:55], v[172:175], a[132:135], v[40:55]
    ds_read_b128 v[196:199], v15 offset:49152
    v_cvt_pk_bf16_f32 v128, v30, v31
    v_exp_f32 v32, v90
    v_exp_f32 v33, v91
    v_mfma_f32_32x32x16_bf16 v[56:71], v[172:175], a[164:167], v[56:71]
    v_add_f32 v29, v29, v32
    v_add_f32 v29, v29, v33
    v_cvt_pk_bf16_f32 v129, v32, v33
    s_waitcnt lgkmcnt(5)
    v_mfma_f32_32x32x16_bf16 v[40:55], v[176:179], a[136:139], v[40:55]
    ds_read_b64_tr_b16 v[168:169], v16 offset:40960
    ds_read_b64_tr_b16 v[170:171], v16 offset:43008
    v_exp_f32 v30, v92
    v_exp_f32 v31, v93
    v_add_f32 v29, v29, v30
    v_mfma_f32_32x32x16_bf16 v[56:71], v[176:179], a[168:171], v[56:71]
    v_add_f32 v29, v29, v31
    v_cvt_pk_bf16_f32 v130, v30, v31
    v_exp_f32 v32, v94
    s_waitcnt lgkmcnt(6)
    v_mfma_f32_32x32x16_bf16 v[40:55], v[180:183], a[140:143], v[40:55]
    ds_read_b64_tr_b16 v[172:173], v17 offset:40960
    ds_read_b64_tr_b16 v[174:175], v17 offset:43008
    v_exp_f32 v33, v95
    v_add_f32 v29, v29, v32
    v_add_f32 v29, v29, v33
    v_mfma_f32_32x32x16_bf16 v[56:71], v[180:183], a[172:175], v[56:71]
    v_cvt_pk_bf16_f32 v131, v32, v33
    v_exp_f32 v30, v96
    v_exp_f32 v31, v97
    s_waitcnt lgkmcnt(7)
    v_mfma_f32_32x32x16_bf16 v[40:55], v[184:187], a[144:147], v[40:55]
    ds_read_b64_tr_b16 v[176:177], v18 offset:40960
    ds_read_b64_tr_b16 v[178:179], v18 offset:43008
    v_add_f32 v29, v29, v30
    v_add_f32 v29, v29, v31
    v_cvt_pk_bf16_f32 v132, v30, v31
    v_mfma_f32_32x32x16_bf16 v[56:71], v[184:187], a[176:179], v[56:71]
    v_exp_f32 v32, v98
    v_exp_f32 v33, v99
    s_waitcnt lgkmcnt(8)
    v_mfma_f32_32x32x16_bf16 v[40:55], v[188:191], a[148:151], v[40:55]
    ds_read_b64_tr_b16 v[180:181], v19 offset:40960
    ds_read_b64_tr_b16 v[182:183], v19 offset:43008
    v_add_f32 v29, v29, v32
    v_add_f32 v29, v29, v33
    v_cvt_pk_bf16_f32 v133, v32, v33
    v_exp_f32 v30, v100
    v_mfma_f32_32x32x16_bf16 v[56:71], v[188:191], a[180:183], v[56:71]
    v_exp_f32 v31, v101
    v_add_f32 v29, v29, v30
    v_add_f32 v29, v29, v31
    s_waitcnt lgkmcnt(9)
    v_mfma_f32_32x32x16_bf16 v[40:55], v[192:195], a[152:155], v[40:55]
    ds_read_b64_tr_b16 v[184:185], v16 offset:45056
    ds_read_b64_tr_b16 v[186:187], v16 offset:47104
    v_cvt_pk_bf16_f32 v134, v30, v31
    v_exp_f32 v32, v102
    v_mfma_f32_32x32x16_bf16 v[56:71], v[192:195], a[184:187], v[56:71]
    v_exp_f32 v33, v103
    v_add_f32 v29, v29, v32
    v_add_f32 v29, v29, v33
    v_cvt_pk_bf16_f32 v135, v32, v33
    s_waitcnt lgkmcnt(10)
    v_mfma_f32_32x32x16_bf16 v[40:55], v[196:199], a[156:159], v[40:55]
    ds_read_b64_tr_b16 v[188:189], v17 offset:45056
    ds_read_b64_tr_b16 v[190:191], v17 offset:47104
    v_max_f32 v34, v28, v29
    v_cmp_lt_f32 vcc, s32, v34
    s_cbranch_vccnz attn_kernel_rare11
attn_kernel_ret12:
    v_add_f32 v26, v26, v28
    v_add_f32 v27, v27, v29
    v_mfma_f32_32x32x16_bf16 v[56:71], v[196:199], a[188:191], v[56:71]
    s_add_u32 m0, s30, 65536
    s_nop 0
    buffer_load_dwordx4 v24, s[12:15], s29 offen offset:0 lds
    s_waitcnt lgkmcnt(10)
    v_mfma_f32_32x32x16_bf16 a[0:15], v[168:171], v[120:123], a[0:15]
    ds_read_b64_tr_b16 v[192:193], v18 offset:45056
    ds_read_b64_tr_b16 v[194:195], v18 offset:47104
    buffer_load_dwordx4 v24, s[12:15], s29 offen offset:1024 lds
    v_mfma_f32_32x32x16_bf16 a[64:79], v[168:171], v[128:131], a[64:79]
    buffer_load_dwordx4 v24, s[12:15], s29 offen offset:2048 lds
    s_waitcnt lgkmcnt(10)
    v_mfma_f32_32x32x16_bf16 a[16:31], v[172:175], v[120:123], a[16:31]
    ds_read_b64_tr_b16 v[196:197], v19 offset:45056
    ds_read_b64_tr_b16 v[198:199], v19 offset:47104
    buffer_load_dwordx4 v24, s[12:15], s29 offen offset:3072 lds
    s_add_u32 s29, s29, 16384
    v_mfma_f32_32x32x16_bf16 a[80:95], v[172:175], v[128:131], a[80:95]
    v_exp_f32 v30, v40
    v_exp_f32 v31, v41
    s_waitcnt lgkmcnt(10)
    v_mfma_f32_32x32x16_bf16 a[32:47], v[176:179], v[120:123], a[32:47]
    ds_read_b128 v[168:171], v8 offset:57344
    s_nop 0
    v_add_f32 v28, v30, v31
    v_cvt_pk_bf16_f32 v104, v30, v31
    v_exp_f32 v32, v42
    v_mfma_f32_32x32x16_bf16 a[96:111], v[176:179], v[128:131], a[96:111]
    v_exp_f32 v33, v43
    v_add_f32 v28, v28, v32
    s_waitcnt lgkmcnt(9)
    v_mfma_f32_32x32x16_bf16 a[48:63], v[180:183], v[120:123], a[48:63]
    ds_read_b128 v[172:175], v9 offset:57344
    v_add_f32 v28, v28, v33
    v_cvt_pk_bf16_f32 v105, v32, v33
    v_exp_f32 v30, v44
    v_mfma_f32_32x32x16_bf16 a[112:127], v[180:183], v[128:131], a[112:127]
    v_exp_f32 v31, v45
    v_add_f32 v28, v28, v30
    v_add_f32 v28, v28, v31
    v_cvt_pk_bf16_f32 v106, v30, v31
    s_waitcnt lgkmcnt(8)
    v_mfma_f32_32x32x16_bf16 a[0:15], v[184:187], v[124:127], a[0:15]
    ds_read_b128 v[176:179], v10 offset:57344
    v_exp_f32 v32, v46
    v_exp_f32 v33, v47
    v_mfma_f32_32x32x16_bf16 a[64:79], v[184:187], v[132:135], a[64:79]
    v_add_f32 v28, v28, v32
    v_add_f32 v28, v28, v33
    v_cvt_pk_bf16_f32 v107, v32, v33
    v_exp_f32 v30, v48
    s_waitcnt lgkmcnt(7)
    v_mfma_f32_32x32x16_bf16 a[16:31], v[188:191], v[124:127], a[16:31]
    ds_read_b128 v[180:183], v11 offset:57344
    v_exp_f32 v31, v49
    v_add_f32 v28, v28, v30
    v_mfma_f32_32x32x16_bf16 a[80:95], v[188:191], v[132:135], a[80:95]
    v_add_f32 v28, v28, v31
    v_cvt_pk_bf16_f32 v108, v30, v31
    v_exp_f32 v32, v50
    s_waitcnt lgkmcnt(6)
    v_mfma_f32_32x32x16_bf16 a[32:47], v[192:195], v[124:127], a[32:47]
    ds_read_b128 v[184:187], v12 offset:57344
    v_exp_f32 v33, v51
    v_add_f32 v28, v28, v32
    v_add_f32 v28, v28, v33
    v_mfma_f32_32x32x16_bf16 a[96:111], v[192:195], v[132:135], a[96:111]
    v_cvt_pk_bf16_f32 v109, v32, v33
    v_exp_f32 v30, v52
    v_exp_f32 v31, v53
    s_waitcnt lgkmcnt(5)
    v_mfma_f32_32x32x16_bf16 a[48:63], v[196:199], v[124:127], a[48:63]
    ds_read_b128 v[188:191], v13 offset:57344
    v_add_f32 v28, v28, v30
    v_add_f32 v28, v28, v31
    v_cvt_pk_bf16_f32 v110, v30, v31
    v_mfma_f32_32x32x16_bf16 a[112:127], v[196:199], v[132:135], a[112:127]
    v_exp_f32 v32, v54
    v_exp_f32 v33, v55
    v_add_f32 v28, v28, v32
    s_waitcnt vmcnt(8)
    s_barrier
    s_waitcnt lgkmcnt(5)
    v_mfma_f32_32x32x16_bf16 v[72:87], v[168:171], a[128:131], v[136:151]
    ds_read_b128 v[192:195], v14 offset:57344
    v_add_f32 v28, v28, v33
    v_cvt_pk_bf16_f32 v111, v32, v33
    v_exp_f32 v30, v56
    v_mfma_f32_32x32x16_bf16 v[88:103], v[168:171], a[160:163], v[152:167]
    v_exp_f32 v31, v57
    s_nop 0
    v_add_f32 v29, v30, v31
    s_waitcnt lgkmcnt(5)
    v_mfma_f32_32x32x16_bf16 v[72:87], v[172:175], a[132:135], v[72:87]
    ds_read_b128 v[196:199], v15 offset:57344
    v_cvt_pk_bf16_f32 v112, v30, v31
    v_exp_f32 v32, v58
    v_exp_f32 v33, v59
    v_mfma_f32_32x32x16_bf16 v[88:103], v[172:175], a[164:167], v[88:103]
    v_add_f32 v29, v29, v32
    v_add_f32 v29, v29, v33
    v_cvt_pk_bf16_f32 v113, v32, v33
    s_waitcnt lgkmcnt(5)
    v_mfma_f32_32x32x16_bf16 v[72:87], v[176:179], a[136:139], v[72:87]
    ds_read_b64_tr_b16 v[168:169], v16 offset:49152
    ds_read_b64_tr_b16 v[170:171], v16 offset:51200
    v_exp_f32 v30, v60
    v_exp_f32 v31, v61
    v_add_f32 v29, v29, v30
    v_mfma_f32_32x32x16_bf16 v[88:103], v[176:179], a[168:171], v[88:103]
    v_add_f32 v29, v29, v31
    v_cvt_pk_bf16_f32 v114, v30, v31
    v_exp_f32 v32, v62
    s_waitcnt lgkmcnt(6)
    v_mfma_f32_32x32x16_bf16 v[72:87], v[180:183], a[140:143], v[72:87]
    ds_read_b64_tr_b16 v[172:173], v17 offset:49152
    ds_read_b64_tr_b16 v[174:175], v17 offset:51200
    v_exp_f32 v33, v63
    v_add_f32 v29, v29, v32
    v_add_f32 v29, v29, v33
    v_mfma_f32_32x32x16_bf16 v[88:103], v[180:183], a[172:175], v[88:103]
    v_cvt_pk_bf16_f32 v115, v32, v33
    v_exp_f32 v30, v64
    v_exp_f32 v31, v65
    s_waitcnt lgkmcnt(7)
    v_mfma_f32_32x32x16_bf16 v[72:87], v[184:187], a[144:147], v[72:87]
    ds_read_b64_tr_b16 v[176:177], v18 offset:49152
    ds_read_b64_tr_b16 v[178:179], v18 offset:51200
    v_add_f32 v29, v29, v30
    v_add_f32 v29, v29, v31
    v_cvt_pk_bf16_f32 v116, v30, v31
    v_mfma_f32_32x32x16_bf16 v[88:103], v[184:187], a[176:179], v[88:103]
    v_exp_f32 v32, v66
    v_exp_f32 v33, v67
    s_waitcnt lgkmcnt(8)
    v_mfma_f32_32x32x16_bf16 v[72:87], v[188:191], a[148:151], v[72:87]
    ds_read_b64_tr_b16 v[180:181], v19 offset:49152
    ds_read_b64_tr_b16 v[182:183], v19 offset:51200
    v_add_f32 v29, v29, v32
    v_add_f32 v29, v29, v33
    v_cvt_pk_bf16_f32 v117, v32, v33
    v_exp_f32 v30, v68
    v_mfma_f32_32x32x16_bf16 v[88:103], v[188:191], a[180:183], v[88:103]
    v_exp_f32 v31, v69
    v_add_f32 v29, v29, v30
    v_add_f32 v29, v29, v31
    s_waitcnt lgkmcnt(9)
    v_mfma_f32_32x32x16_bf16 v[72:87], v[192:195], a[152:155], v[72:87]
    ds_read_b64_tr_b16 v[184:185], v16 offset:53248
    ds_read_b64_tr_b16 v[186:187], v16 offset:55296
    v_cvt_pk_bf16_f32 v118, v30, v31
    v_exp_f32 v32, v70
    v_mfma_f32_32x32x16_bf16 v[88:103], v[192:195], a[184:187], v[88:103]
    v_exp_f32 v33, v71
    v_add_f32 v29, v29, v32
    v_add_f32 v29, v29, v33
    v_cvt_pk_bf16_f32 v119, v32, v33
    s_waitcnt lgkmcnt(10)
    v_mfma_f32_32x32x16_bf16 v[72:87], v[196:199], a[156:159], v[72:87]
    ds_read_b64_tr_b16 v[188:189], v17 offset:53248
    ds_read_b64_tr_b16 v[190:191], v17 offset:55296
    v_max_f32 v34, v28, v29
    v_cmp_lt_f32 vcc, s32, v34
    s_cbranch_vccnz attn_kernel_rare13
attn_kernel_ret14:
    v_add_f32 v26, v26, v28
    v_add_f32 v27, v27, v29
    v_mfma_f32_32x32x16_bf16 v[88:103], v[196:199], a[188:191], v[88:103]
    s_add_u32 m0, s30, 32768
    s_nop 0
    buffer_load_dwordx4 v20, s[8:11], s28 offen offset:0 lds
    s_waitcnt lgkmcnt(10)
    v_mfma_f32_32x32x16_bf16 a[0:15], v[168:171], v[104:107], a[0:15]
    ds_read_b64_tr_b16 v[192:193], v18 offset:53248
    ds_read_b64_tr_b16 v[194:195], v18 offset:55296
    buffer_load_dwordx4 v21, s[8:11], s28 offen offset:1024 lds
    v_mfma_f32_32x32x16_bf16 a[64:79], v[168:171], v[112:115], a[64:79]
    buffer_load_dwordx4 v22, s[8:11], s28 offen offset:2048 lds
    s_waitcnt lgkmcnt(10)
    v_mfma_f32_32x32x16_bf16 a[16:31], v[172:175], v[104:107], a[16:31]
    ds_read_b64_tr_b16 v[196:197], v19 offset:53248
    ds_read_b64_tr_b16 v[198:199], v19 offset:55296
    buffer_load_dwordx4 v23, s[8:11], s28 offen offset:3072 lds
    s_add_u32 s28, s28, 16384
    v_mfma_f32_32x32x16_bf16 a[80:95], v[172:175], v[112:115], a[80:95]
    v_exp_f32 v30, v72
    v_exp_f32 v31, v73
    s_waitcnt lgkmcnt(10)
    v_mfma_f32_32x32x16_bf16 a[32:47], v[176:179], v[104:107], a[32:47]
    ds_read_b128 v[168:171], v8 offset:0
    s_nop 0
    v_add_f32 v28, v30, v31
    v_cvt_pk_bf16_f32 v120, v30, v31
    v_exp_f32 v32, v74
    v_mfma_f32_32x32x16_bf16 a[96:111], v[176:179], v[112:115], a[96:111]
    v_exp_f32 v33, v75
    v_add_f32 v28, v28, v32
    s_waitcnt lgkmcnt(9)
    v_mfma_f32_32x32x16_bf16 a[48:63], v[180:183], v[104:107], a[48:63]
    ds_read_b128 v[172:175], v9 offset:0
    v_add_f32 v28, v28, v33
    v_cvt_pk_bf16_f32 v121, v32, v33
    v_exp_f32 v30, v76
    v_mfma_f32_32x32x16_bf16 a[112:127], v[180:183], v[112:115], a[112:127]
    v_exp_f32 v31, v77
    v_add_f32 v28, v28, v30
    v_add_f32 v28, v28, v31
    v_cvt_pk_bf16_f32 v122, v30, v31
    s_waitcnt lgkmcnt(8)
    v_mfma_f32_32x32x16_bf16 a[0:15], v[184:187], v[108:111], a[0:15]
    ds_read_b128 v[176:179], v10 offset:0
    v_exp_f32 v32, v78
    v_exp_f32 v33, v79
    v_mfma_f32_32x32x16_bf16 a[64:79], v[184:187], v[116:119], a[64:79]
    v_add_f32 v28, v28, v32
    v_add_f32 v28, v28, v33
    v_cvt_pk_bf16_f32 v123, v32, v33
    v_exp_f32 v30, v80
    s_waitcnt lgkmcnt(7)
    v_mfma_f32_32x32x16_bf16 a[16:31], v[188:191], v[108:111], a[16:31]
    ds_read_b128 v[180:183], v11 offset:0
    v_exp_f32 v31, v81
    v_add_f32 v28, v28, v30
    v_mfma_f32_32x32x16_bf16 a[80:95], v[188:191], v[116:119], a[80:95]
    v_add_f32 v28, v28, v31
    v_cvt_pk_bf16_f32 v124, v30, v31
    v_exp_f32 v32, v82
    s_waitcnt lgkmcnt(6)
    v_mfma_f32_32x32x16_bf16 a[32:47], v[192:195], v[108:111], a[32:47]
    ds_read_b128 v[184:187], v12 offset:0
    v_exp_f32 v33, v83
    v_add_f32 v28, v28, v32
    v_add_f32 v28, v28, v33
    v_mfma_f32_32x32x16_bf16 a[96:111], v[192:195], v[116:119], a[96:111]
    v_cvt_pk_bf16_f32 v125, v32, v33
    v_exp_f32 v30, v84
    v_exp_f32 v31, v85
    s_waitcnt lgkmcnt(5)
    v_mfma_f32_32x32x16_bf16 a[48:63], v[196:199], v[108:111], a[48:63]
    ds_read_b128 v[188:191], v13 offset:0
    v_add_f32 v28, v28, v30
    v_add_f32 v28, v28, v31
    v_cvt_pk_bf16_f32 v126, v30, v31
    v_mfma_f32_32x32x16_bf16 a[112:127], v[196:199], v[116:119], a[112:127]
    v_exp_f32 v32, v86
    v_exp_f32 v33, v87
    v_add_f32 v28, v28, v32
    s_waitcnt lgkmcnt(5)
    v_mfma_f32_32x32x16_bf16 v[40:55], v[168:171], a[128:131], v[136:151]
    ds_read_b128 v[192:195], v14 offset:0
    v_add_f32 v28, v28, v33
    v_cvt_pk_bf16_f32 v127, v32, v33
    v_exp_f32 v30, v88
    v_mfma_f32_32x32x16_bf16 v[56:71], v[168:171], a[160:163], v[152:167]
    v_exp_f32 v31, v89
    s_nop 0
    v_add_f32 v29, v30, v31
    s_waitcnt lgkmcnt(5)
    v_mfma_f32_32x32x16_bf16 v[40:55], v[172:175], a[132:135], v[40:55]
    ds_read_b128 v[196:199], v15 offset:0
    v_cvt_pk_bf16_f32 v128, v30, v31
    v_exp_f32 v32, v90
    v_exp_f32 v33, v91
    v_mfma_f32_32x32x16_bf16 v[56:71], v[172:175], a[164:167], v[56:71]
    v_add_f32 v29, v29, v32
    v_add_f32 v29, v29, v33
    v_cvt_pk_bf16_f32 v129, v32, v33
    s_waitcnt lgkmcnt(5)
    v_mfma_f32_32x32x16_bf16 v[40:55], v[176:179], a[136:139], v[40:55]
    ds_read_b64_tr_b16 v[168:169], v16 offset:57344
    ds_read_b64_tr_b16 v[170:171], v16 offset:59392
    v_exp_f32 v30, v92
    v_exp_f32 v31, v93
    v_add_f32 v29, v29, v30
    v_mfma_f32_32x32x16_bf16 v[56:71], v[176:179], a[168:171], v[56:71]
    v_add_f32 v29, v29, v31
    v_cvt_pk_bf16_f32 v130, v30, v31
    v_exp_f32 v32, v94
    s_waitcnt lgkmcnt(6)
    v_mfma_f32_32x32x16_bf16 v[40:55], v[180:183], a[140:143], v[40:55]
    ds_read_b64_tr_b16 v[172:173], v17 offset:57344
    ds_read_b64_tr_b16 v[174:175], v17 offset:59392
    v_exp_f32 v33, v95
    v_add_f32 v29, v29, v32
    v_add_f32 v29, v29, v33
    v_mfma_f32_32x32x16_bf16 v[56:71], v[180:183], a[172:175], v[56:71]
    v_cvt_pk_bf16_f32 v131, v32, v33
    v_exp_f32 v30, v96
    v_exp_f32 v31, v97
    s_waitcnt lgkmcnt(7)
    v_mfma_f32_32x32x16_bf16 v[40:55], v[184:187], a[144:147], v[40:55]
    ds_read_b64_tr_b16 v[176:177], v18 offset:57344
    ds_read_b64_tr_b16 v[178:179], v18 offset:59392
    v_add_f32 v29, v29, v30
    v_add_f32 v29, v29, v31
    v_cvt_pk_bf16_f32 v132, v30, v31
    v_mfma_f32_32x32x16_bf16 v[56:71], v[184:187], a[176:179], v[56:71]
    v_exp_f32 v32, v98
    v_exp_f32 v33, v99
    s_waitcnt lgkmcnt(8)
    v_mfma_f32_32x32x16_bf16 v[40:55], v[188:191], a[148:151], v[40:55]
    ds_read_b64_tr_b16 v[180:181], v19 offset:57344
    ds_read_b64_tr_b16 v[182:183], v19 offset:59392
    v_add_f32 v29, v29, v32
    v_add_f32 v29, v29, v33
    v_cvt_pk_bf16_f32 v133, v32, v33
    v_exp_f32 v30, v100
    v_mfma_f32_32x32x16_bf16 v[56:71], v[188:191], a[180:183], v[56:71]
    v_exp_f32 v31, v101
    v_add_f32 v29, v29, v30
    v_add_f32 v29, v29, v31
    s_waitcnt lgkmcnt(9)
    v_mfma_f32_32x32x16_bf16 v[40:55], v[192:195], a[152:155], v[40:55]
    ds_read_b64_tr_b16 v[184:185], v16 offset:61440
    ds_read_b64_tr_b16 v[186:187], v16 offset:63488
    v_cvt_pk_bf16_f32 v134, v30, v31
    v_exp_f32 v32, v102
    v_mfma_f32_32x32x16_bf16 v[56:71], v[192:195], a[184:187], v[56:71]
    v_exp_f32 v33, v103
    v_add_f32 v29, v29, v32
    v_add_f32 v29, v29, v33
    v_cvt_pk_bf16_f32 v135, v32, v33
    s_waitcnt lgkmcnt(10)
    v_mfma_f32_32x32x16_bf16 v[40:55], v[196:199], a[156:159], v[40:55]
    ds_read_b64_tr_b16 v[188:189], v17 offset:61440
    ds_read_b64_tr_b16 v[190:191], v17 offset:63488
    v_max_f32 v34, v28, v29
    v_cmp_lt_f32 vcc, s32, v34
    s_cbranch_vccnz attn_kernel_rare15
attn_kernel_ret16:
    v_add_f32 v26, v26, v28
    v_add_f32 v27, v27, v29
    v_mfma_f32_32x32x16_bf16 v[56:71], v[196:199], a[188:191], v[56:71]
    s_add_u32 m0, s30, 81920
    s_nop 0
    buffer_load_dwordx4 v24, s[12:15], s29 offen offset:0 lds
    s_waitcnt lgkmcnt(10)
    v_mfma_f32_32x32x16_bf16 a[0:15], v[168:171], v[120:123], a[0:15]
    ds_read_b64_tr_b16 v[192:193], v18 offset:61440
    ds_read_b64_tr_b16 v[194:195], v18 offset:63488
    buffer_load_dwordx4 v24, s[12:15], s29 offen offset:1024 lds
    v_mfma_f32_32x32x16_bf16 a[64:79], v[168:171], v[128:131], a[64:79]
    buffer_load_dwordx4 v24, s[12:15], s29 offen offset:2048 lds
    s_waitcnt lgkmcnt(10)
    v_mfma_f32_32x32x16_bf16 a[16:31], v[172:175], v[120:123], a[16:31]
    ds_read_b64_tr_b16 v[196:197], v19 offset:61440
    ds_read_b64_tr_b16 v[198:199], v19 offset:63488
    buffer_load_dwordx4 v24, s[12:15], s29 offen offset:3072 lds
    s_add_u32 s29, s29, 16384
    v_mfma_f32_32x32x16_bf16 a[80:95], v[172:175], v[128:131], a[80:95]
    v_exp_f32 v30, v40
    v_exp_f32 v31, v41
    s_waitcnt lgkmcnt(10)
    v_mfma_f32_32x32x16_bf16 a[32:47], v[176:179], v[120:123], a[32:47]
    ds_read_b128 v[168:171], v8 offset:8192
    s_nop 0
    v_add_f32 v28, v30, v31
    v_cvt_pk_bf16_f32 v104, v30, v31
    v_exp_f32 v32, v42
    v_mfma_f32_32x32x16_bf16 a[96:111], v[176:179], v[128:131], a[96:111]
    v_exp_f32 v33, v43
    v_add_f32 v28, v28, v32
    s_waitcnt lgkmcnt(9)
    v_mfma_f32_32x32x16_bf16 a[48:63], v[180:183], v[120:123], a[48:63]
    ds_read_b128 v[172:175], v9 offset:8192
    v_add_f32 v28, v28, v33
    v_cvt_pk_bf16_f32 v105, v32, v33
    v_exp_f32 v30, v44
    v_mfma_f32_32x32x16_bf16 a[112:127], v[180:183], v[128:131], a[112:127]
    v_exp_f32 v31, v45
    v_add_f32 v28, v28, v30
    v_add_f32 v28, v28, v31
    v_cvt_pk_bf16_f32 v106, v30, v31
    s_waitcnt lgkmcnt(8)
    v_mfma_f32_32x32x16_bf16 a[0:15], v[184:187], v[124:127], a[0:15]
    ds_read_b128 v[176:179], v10 offset:8192
    v_exp_f32 v32, v46
    v_exp_f32 v33, v47
    v_mfma_f32_32x32x16_bf16 a[64:79], v[184:187], v[132:135], a[64:79]
    v_add_f32 v28, v28, v32
    v_add_f32 v28, v28, v33
    v_cvt_pk_bf16_f32 v107, v32, v33
    v_exp_f32 v30, v48
    s_waitcnt lgkmcnt(7)
    v_mfma_f32_32x32x16_bf16 a[16:31], v[188:191], v[124:127], a[16:31]
    ds_read_b128 v[180:183], v11 offset:8192
    v_exp_f32 v31, v49
    v_add_f32 v28, v28, v30
    v_mfma_f32_32x32x16_bf16 a[80:95], v[188:191], v[132:135], a[80:95]
    v_add_f32 v28, v28, v31
    v_cvt_pk_bf16_f32 v108, v30, v31
    v_exp_f32 v32, v50
    s_waitcnt lgkmcnt(6)
    v_mfma_f32_32x32x16_bf16 a[32:47], v[192:195], v[124:127], a[32:47]
    ds_read_b128 v[184:187], v12 offset:8192
    v_exp_f32 v33, v51
    v_add_f32 v28, v28, v32
    v_add_f32 v28, v28, v33
    v_mfma_f32_32x32x16_bf16 a[96:111], v[192:195], v[132:135], a[96:111]
    v_cvt_pk_bf16_f32 v109, v32, v33
    v_exp_f32 v30, v52
    v_exp_f32 v31, v53
    s_waitcnt lgkmcnt(5)
    v_mfma_f32_32x32x16_bf16 a[48:63], v[196:199], v[124:127], a[48:63]
    ds_read_b128 v[188:191], v13 offset:8192
    v_add_f32 v28, v28, v30
    v_add_f32 v28, v28, v31
    v_cvt_pk_bf16_f32 v110, v30, v31
    v_mfma_f32_32x32x16_bf16 a[112:127], v[196:199], v[132:135], a[112:127]
    v_exp_f32 v32, v54
    v_exp_f32 v33, v55
    v_add_f32 v28, v28, v32
    s_sub_u32 s31, s31, 1
    s_cmp_lg_u32 s31, 0
    s_cbranch_scc1 attn_loop
    s_nop 15
    s_waitcnt vmcnt(0) lgkmcnt(0)
    v_mov_b32 v208, v26
    s_nop 1
    v_permlane32_swap_b32 v208, v26
    s_nop 1
    v_add_f32 v26, v26, v208
    v_rcp_f32 v26, v26
    s_nop 0
    v_mov_b32 v208, v27
    s_nop 1
    v_permlane32_swap_b32 v208, v27
    s_nop 1
    v_add_f32 v27, v27, v208
    v_rcp_f32 v27, v27
    s_nop 0
    s_barrier
    s_mul_i32 s6, s5, 17408
    v_mul_u32_u24 v4, 272, v2
    v_lshl_add_u32 v4, v3, 4, v4
    v_add_u32 v4, s6, v4
    v_lshrrev_b32 v5, 4, v1
    v_and_b32 v6, 15, v1
    v_lshlrev_b32 v6, 4, v6
    v_mul_u32_u24 v7, 272, v5
    v_add3_u32 v7, v7, v6, s6
    v_lshl_add_u32 v6, v5, 8, v6
    v_accvgpr_read_b32 v212, a0
    v_accvgpr_read_b32 v213, a1
    v_accvgpr_read_b32 v214, a2
    v_accvgpr_read_b32 v215, a3
    v_accvgpr_read_b32 v216, a4
    v_accvgpr_read_b32 v217, a5
    v_accvgpr_read_b32 v218, a6
    v_accvgpr_read_b32 v219, a7
    v_mul_f32 v212, v212, v26
    v_mul_f32 v213, v213, v26
    v_mul_f32 v214, v214, v26
    v_mul_f32 v215, v215, v26
    v_mul_f32 v216, v216, v26
    v_mul_f32 v217, v217, v26
    v_mul_f32 v218, v218, v26
    v_mul_f32 v219, v219, v26
    v_cvt_pk_bf16_f32 v208, v212, v213
    v_cvt_pk_bf16_f32 v209, v214, v215
    v_cvt_pk_bf16_f32 v210, v216, v217
    v_cvt_pk_bf16_f32 v211, v218, v219
    s_nop 1
    v_permlane32_swap_b32 v208, v210
    v_permlane32_swap_b32 v209, v211
    ds_write_b128 v4, v[208:211] offset:0
    v_accvgpr_read_b32 v224, a8
    v_accvgpr_read_b32 v225, a9
    v_accvgpr_read_b32 v226, a10
    v_accvgpr_read_b32 v227, a11
    v_accvgpr_read_b32 v228, a12
    v_accvgpr_read_b32 v229, a13
    v_accvgpr_read_b32 v230, a14
    v_accvgpr_read_b32 v231, a15
    v_mul_f32 v224, v224, v26
    v_mul_f32 v225, v225, v26
    v_mul_f32 v226, v226, v26
    v_mul_f32 v227, v227, v26
    v_mul_f32 v228, v228, v26
    v_mul_f32 v229, v229, v26
    v_mul_f32 v230, v230, v26
    v_mul_f32 v231, v231, v26
    v_cvt_pk_bf16_f32 v220, v224, v225
    v_cvt_pk_bf16_f32 v221, v226, v227
    v_cvt_pk_bf16_f32 v222, v228, v229
    v_cvt_pk_bf16_f32 v223, v230, v231
    s_nop 1
    v_permlane32_swap_b32 v220, v222
    v_permlane32_swap_b32 v221, v223
    ds_write_b128 v4, v[220:223] offset:32
    v_accvgpr_read_b32 v212, a16
    v_accvgpr_read_b32 v213, a17
    v_accvgpr_read_b32 v214, a18
    v_accvgpr_read_b32 v215, a19
    v_accvgpr_read_b32 v216, a20
    v_accvgpr_read_b32 v217, a21
    v_accvgpr_read_b32 v218, a22
    v_accvgpr_read_b32 v219, a23
    v_mul_f32 v212, v212, v26
    v_mul_f32 v213, v213, v26
    v_mul_f32 v214, v214, v26
    v_mul_f32 v215, v215, v26
    v_mul_f32 v216, v216, v26
    v_mul_f32 v217, v217, v26
    v_mul_f32 v218, v218, v26
    v_mul_f32 v219, v219, v26
    v_cvt_pk_bf16_f32 v208, v212, v213
    v_cvt_pk_bf16_f32 v209, v214, v215
    v_cvt_pk_bf16_f32 v210, v216, v217
    v_cvt_pk_bf16_f32 v211, v218, v219
    s_nop 1
    v_permlane32_swap_b32 v208, v210
    v_permlane32_swap_b32 v209, v211
    ds_write_b128 v4, v[208:211] offset:64
    v_accvgpr_read_b32 v224, a24
    v_accvgpr_read_b32 v225, a25
    v_accvgpr_read_b32 v226, a26
    v_accvgpr_read_b32 v227, a27
    v_accvgpr_read_b32 v228, a28
    v_accvgpr_read_b32 v229, a29
    v_accvgpr_read_b32 v230, a30
    v_accvgpr_read_b32 v231, a31
    v_mul_f32 v224, v224, v26
    v_mul_f32 v225, v225, v26
    v_mul_f32 v226, v226, v26
    v_mul_f32 v227, v227, v26
    v_mul_f32 v228, v228, v26
    v_mul_f32 v229, v229, v26
    v_mul_f32 v230, v230, v26
    v_mul_f32 v231, v231, v26
    v_cvt_pk_bf16_f32 v220, v224, v225
    v_cvt_pk_bf16_f32 v221, v226, v227
    v_cvt_pk_bf16_f32 v222, v228, v229
    v_cvt_pk_bf16_f32 v223, v230, v231
    s_nop 1
    v_permlane32_swap_b32 v220, v222
    v_permlane32_swap_b32 v221, v223
    ds_write_b128 v4, v[220:223] offset:96
    v_accvgpr_read_b32 v212, a32
    v_accvgpr_read_b32 v213, a33
    v_accvgpr_read_b32 v214, a34
    v_accvgpr_read_b32 v215, a35
    v_accvgpr_read_b32 v216, a36
    v_accvgpr_read_b32 v217, a37
    v_accvgpr_read_b32 v218, a38
    v_accvgpr_read_b32 v219, a39
    v_mul_f32 v212, v212, v26
    v_mul_f32 v213, v213, v26
    v_mul_f32 v214, v214, v26
    v_mul_f32 v215, v215, v26
    v_mul_f32 v216, v216, v26
    v_mul_f32 v217, v217, v26
    v_mul_f32 v218, v218, v26
    v_mul_f32 v219, v219, v26
    v_cvt_pk_bf16_f32 v208, v212, v213
    v_cvt_pk_bf16_f32 v209, v214, v215
    v_cvt_pk_bf16_f32 v210, v216, v217
    v_cvt_pk_bf16_f32 v211, v218, v219
    s_nop 1
    v_permlane32_swap_b32 v208, v210
    v_permlane32_swap_b32 v209, v211
    ds_write_b128 v4, v[208:211] offset:128
    v_accvgpr_read_b32 v224, a40
    v_accvgpr_read_b32 v225, a41
    v_accvgpr_read_b32 v226, a42
    v_accvgpr_read_b32 v227, a43
    v_accvgpr_read_b32 v228, a44
    v_accvgpr_read_b32 v229, a45
    v_accvgpr_read_b32 v230, a46
    v_accvgpr_read_b32 v231, a47
    v_mul_f32 v224, v224, v26
    v_mul_f32 v225, v225, v26
    v_mul_f32 v226, v226, v26
    v_mul_f32 v227, v227, v26
    v_mul_f32 v228, v228, v26
    v_mul_f32 v229, v229, v26
    v_mul_f32 v230, v230, v26
    v_mul_f32 v231, v231, v26
    v_cvt_pk_bf16_f32 v220, v224, v225
    v_cvt_pk_bf16_f32 v221, v226, v227
    v_cvt_pk_bf16_f32 v222, v228, v229
    v_cvt_pk_bf16_f32 v223, v230, v231
    s_nop 1
    v_permlane32_swap_b32 v220, v222
    v_permlane32_swap_b32 v221, v223
    ds_write_b128 v4, v[220:223] offset:160
    v_accvgpr_read_b32 v212, a48
    v_accvgpr_read_b32 v213, a49
    v_accvgpr_read_b32 v214, a50
    v_accvgpr_read_b32 v215, a51
    v_accvgpr_read_b32 v216, a52
    v_accvgpr_read_b32 v217, a53
    v_accvgpr_read_b32 v218, a54
    v_accvgpr_read_b32 v219, a55
    v_mul_f32 v212, v212, v26
    v_mul_f32 v213, v213, v26
    v_mul_f32 v214, v214, v26
    v_mul_f32 v215, v215, v26
    v_mul_f32 v216, v216, v26
    v_mul_f32 v217, v217, v26
    v_mul_f32 v218, v218, v26
    v_mul_f32 v219, v219, v26
    v_cvt_pk_bf16_f32 v208, v212, v213
    v_cvt_pk_bf16_f32 v209, v214, v215
    v_cvt_pk_bf16_f32 v210, v216, v217
    v_cvt_pk_bf16_f32 v211, v218, v219
    s_nop 1
    v_permlane32_swap_b32 v208, v210
    v_permlane32_swap_b32 v209, v211
    ds_write_b128 v4, v[208:211] offset:192
    v_accvgpr_read_b32 v224, a56
    v_accvgpr_read_b32 v225, a57
    v_accvgpr_read_b32 v226, a58
    v_accvgpr_read_b32 v227, a59
    v_accvgpr_read_b32 v228, a60
    v_accvgpr_read_b32 v229, a61
    v_accvgpr_read_b32 v230, a62
    v_accvgpr_read_b32 v231, a63
    v_mul_f32 v224, v224, v26
    v_mul_f32 v225, v225, v26
    v_mul_f32 v226, v226, v26
    v_mul_f32 v227, v227, v26
    v_mul_f32 v228, v228, v26
    v_mul_f32 v229, v229, v26
    v_mul_f32 v230, v230, v26
    v_mul_f32 v231, v231, v26
    v_cvt_pk_bf16_f32 v220, v224, v225
    v_cvt_pk_bf16_f32 v221, v226, v227
    v_cvt_pk_bf16_f32 v222, v228, v229
    v_cvt_pk_bf16_f32 v223, v230, v231
    s_nop 1
    v_permlane32_swap_b32 v220, v222
    v_permlane32_swap_b32 v221, v223
    ds_write_b128 v4, v[220:223] offset:224
    v_accvgpr_read_b32 v212, a64
    v_accvgpr_read_b32 v213, a65
    v_accvgpr_read_b32 v214, a66
    v_accvgpr_read_b32 v215, a67
    v_accvgpr_read_b32 v216, a68
    v_accvgpr_read_b32 v217, a69
    v_accvgpr_read_b32 v218, a70
    v_accvgpr_read_b32 v219, a71
    v_mul_f32 v212, v212, v27
    v_mul_f32 v213, v213, v27
    v_mul_f32 v214, v214, v27
    v_mul_f32 v215, v215, v27
    v_mul_f32 v216, v216, v27
    v_mul_f32 v217, v217, v27
    v_mul_f32 v218, v218, v27
    v_mul_f32 v219, v219, v27
    v_cvt_pk_bf16_f32 v208, v212, v213
    v_cvt_pk_bf16_f32 v209, v214, v215
    v_cvt_pk_bf16_f32 v210, v216, v217
    v_cvt_pk_bf16_f32 v211, v218, v219
    s_nop 1
    v_permlane32_swap_b32 v208, v210
    v_permlane32_swap_b32 v209, v211
    ds_write_b128 v4, v[208:211] offset:8704
    v_accvgpr_read_b32 v224, a72
    v_accvgpr_read_b32 v225, a73
    v_accvgpr_read_b32 v226, a74
    v_accvgpr_read_b32 v227, a75
    v_accvgpr_read_b32 v228, a76
    v_accvgpr_read_b32 v229, a77
    v_accvgpr_read_b32 v230, a78
    v_accvgpr_read_b32 v231, a79
    v_mul_f32 v224, v224, v27
    v_mul_f32 v225, v225, v27
    v_mul_f32 v226, v226, v27
    v_mul_f32 v227, v227, v27
    v_mul_f32 v228, v228, v27
    v_mul_f32 v229, v229, v27
    v_mul_f32 v230, v230, v27
    v_mul_f32 v231, v231, v27
    v_cvt_pk_bf16_f32 v220, v224, v225
    v_cvt_pk_bf16_f32 v221, v226, v227
    v_cvt_pk_bf16_f32 v222, v228, v229
    v_cvt_pk_bf16_f32 v223, v230, v231
    s_nop 1
    v_permlane32_swap_b32 v220, v222
    v_permlane32_swap_b32 v221, v223
    ds_write_b128 v4, v[220:223] offset:8736
    v_accvgpr_read_b32 v212, a80
    v_accvgpr_read_b32 v213, a81
    v_accvgpr_read_b32 v214, a82
    v_accvgpr_read_b32 v215, a83
    v_accvgpr_read_b32 v216, a84
    v_accvgpr_read_b32 v217, a85
    v_accvgpr_read_b32 v218, a86
    v_accvgpr_read_b32 v219, a87
    v_mul_f32 v212, v212, v27
    v_mul_f32 v213, v213, v27
    v_mul_f32 v214, v214, v27
    v_mul_f32 v215, v215, v27
    v_mul_f32 v216, v216, v27
    v_mul_f32 v217, v217, v27
    v_mul_f32 v218, v218, v27
    v_mul_f32 v219, v219, v27
    v_cvt_pk_bf16_f32 v208, v212, v213
    v_cvt_pk_bf16_f32 v209, v214, v215
    v_cvt_pk_bf16_f32 v210, v216, v217
    v_cvt_pk_bf16_f32 v211, v218, v219
    s_nop 1
    v_permlane32_swap_b32 v208, v210
    v_permlane32_swap_b32 v209, v211
    ds_write_b128 v4, v[208:211] offset:8768
    v_accvgpr_read_b32 v224, a88
    v_accvgpr_read_b32 v225, a89
    v_accvgpr_read_b32 v226, a90
    v_accvgpr_read_b32 v227, a91
    v_accvgpr_read_b32 v228, a92
    v_accvgpr_read_b32 v229, a93
    v_accvgpr_read_b32 v230, a94
    v_accvgpr_read_b32 v231, a95
    v_mul_f32 v224, v224, v27
    v_mul_f32 v225, v225, v27
    v_mul_f32 v226, v226, v27
    v_mul_f32 v227, v227, v27
    v_mul_f32 v228, v228, v27
    v_mul_f32 v229, v229, v27
    v_mul_f32 v230, v230, v27
    v_mul_f32 v231, v231, v27
    v_cvt_pk_bf16_f32 v220, v224, v225
    v_cvt_pk_bf16_f32 v221, v226, v227
    v_cvt_pk_bf16_f32 v222, v228, v229
    v_cvt_pk_bf16_f32 v223, v230, v231
    s_nop 1
    v_permlane32_swap_b32 v220, v222
    v_permlane32_swap_b32 v221, v223
    ds_write_b128 v4, v[220:223] offset:8800
    v_accvgpr_read_b32 v212, a96
    v_accvgpr_read_b32 v213, a97
    v_accvgpr_read_b32 v214, a98
    v_accvgpr_read_b32 v215, a99
    v_accvgpr_read_b32 v216, a100
    v_accvgpr_read_b32 v217, a101
    v_accvgpr_read_b32 v218, a102
    v_accvgpr_read_b32 v219, a103
    v_mul_f32 v212, v212, v27
    v_mul_f32 v213, v213, v27
    v_mul_f32 v214, v214, v27
    v_mul_f32 v215, v215, v27
    v_mul_f32 v216, v216, v27
    v_mul_f32 v217, v217, v27
    v_mul_f32 v218, v218, v27
    v_mul_f32 v219, v219, v27
    v_cvt_pk_bf16_f32 v208, v212, v213
    v_cvt_pk_bf16_f32 v209, v214, v215
    v_cvt_pk_bf16_f32 v210, v216, v217
    v_cvt_pk_bf16_f32 v211, v218, v219
    s_nop 1
    v_permlane32_swap_b32 v208, v210
    v_permlane32_swap_b32 v209, v211
    ds_write_b128 v4, v[208:211] offset:8832
    v_accvgpr_read_b32 v224, a104
    v_accvgpr_read_b32 v225, a105
    v_accvgpr_read_b32 v226, a106
    v_accvgpr_read_b32 v227, a107
    v_accvgpr_read_b32 v228, a108
    v_accvgpr_read_b32 v229, a109
    v_accvgpr_read_b32 v230, a110
    v_accvgpr_read_b32 v231, a111
    v_mul_f32 v224, v224, v27
    v_mul_f32 v225, v225, v27
    v_mul_f32 v226, v226, v27
    v_mul_f32 v227, v227, v27
    v_mul_f32 v228, v228, v27
    v_mul_f32 v229, v229, v27
    v_mul_f32 v230, v230, v27
    v_mul_f32 v231, v231, v27
    v_cvt_pk_bf16_f32 v220, v224, v225
    v_cvt_pk_bf16_f32 v221, v226, v227
    v_cvt_pk_bf16_f32 v222, v228, v229
    v_cvt_pk_bf16_f32 v223, v230, v231
    s_nop 1
    v_permlane32_swap_b32 v220, v222
    v_permlane32_swap_b32 v221, v223
    ds_write_b128 v4, v[220:223] offset:8864
    v_accvgpr_read_b32 v212, a112
    v_accvgpr_read_b32 v213, a113
    v_accvgpr_read_b32 v214, a114
    v_accvgpr_read_b32 v215, a115
    v_accvgpr_read_b32 v216, a116
    v_accvgpr_read_b32 v217, a117
    v_accvgpr_read_b32 v218, a118
    v_accvgpr_read_b32 v219, a119
    v_mul_f32 v212, v212, v27
    v_mul_f32 v213, v213, v27
    v_mul_f32 v214, v214, v27
    v_mul_f32 v215, v215, v27
    v_mul_f32 v216, v216, v27
    v_mul_f32 v217, v217, v27
    v_mul_f32 v218, v218, v27
    v_mul_f32 v219, v219, v27
    v_cvt_pk_bf16_f32 v208, v212, v213
    v_cvt_pk_bf16_f32 v209, v214, v215
    v_cvt_pk_bf16_f32 v210, v216, v217
    v_cvt_pk_bf16_f32 v211, v218, v219
    s_nop 1
    v_permlane32_swap_b32 v208, v210
    v_permlane32_swap_b32 v209, v211
    ds_write_b128 v4, v[208:211] offset:8896
    v_accvgpr_read_b32 v224, a120
    v_accvgpr_read_b32 v225, a121
    v_accvgpr_read_b32 v226, a122
    v_accvgpr_read_b32 v227, a123
    v_accvgpr_read_b32 v228, a124
    v_accvgpr_read_b32 v229, a125
    v_accvgpr_read_b32 v230, a126
    v_accvgpr_read_b32 v231, a127
    v_mul_f32 v224, v224, v27
    v_mul_f32 v225, v225, v27
    v_mul_f32 v226, v226, v27
    v_mul_f32 v227, v227, v27
    v_mul_f32 v228, v228, v27
    v_mul_f32 v229, v229, v27
    v_mul_f32 v230, v230, v27
    v_mul_f32 v231, v231, v27
    v_cvt_pk_bf16_f32 v220, v224, v225
    v_cvt_pk_bf16_f32 v221, v226, v227
    v_cvt_pk_bf16_f32 v222, v228, v229
    v_cvt_pk_bf16_f32 v223, v230, v231
    s_nop 1
    v_permlane32_swap_b32 v220, v222
    v_permlane32_swap_b32 v221, v223
    ds_write_b128 v4, v[220:223] offset:8928
    s_waitcnt lgkmcnt(0)
    ds_read_b128 v[40:43], v7 offset:0
    ds_read_b128 v[44:47], v7 offset:1088
    ds_read_b128 v[48:51], v7 offset:2176
    ds_read_b128 v[52:55], v7 offset:3264
    ds_read_b128 v[56:59], v7 offset:4352
    ds_read_b128 v[60:63], v7 offset:5440
    ds_read_b128 v[64:67], v7 offset:6528
    ds_read_b128 v[68:71], v7 offset:7616
    ds_read_b128 v[72:75], v7 offset:8704
    ds_read_b128 v[76:79], v7 offset:9792
    ds_read_b128 v[80:83], v7 offset:10880
    ds_read_b128 v[84:87], v7 offset:11968
    ds_read_b128 v[88:91], v7 offset:13056
    ds_read_b128 v[92:95], v7 offset:14144
    ds_read_b128 v[96:99], v7 offset:15232
    ds_read_b128 v[100:103], v7 offset:16320
    s_waitcnt lgkmcnt(15)
    buffer_store_dwordx4 v[40:43], v6, s[24:27], s35 offen offset:0 sc1
    s_waitcnt lgkmcnt(14)
    buffer_store_dwordx4 v[44:47], v6, s[24:27], s35 offen offset:1024 sc1
    s_waitcnt lgkmcnt(13)
    buffer_store_dwordx4 v[48:51], v6, s[24:27], s35 offen offset:2048 sc1
    s_waitcnt lgkmcnt(12)
    buffer_store_dwordx4 v[52:55], v6, s[24:27], s35 offen offset:3072 sc1
    s_add_u32 s35, s35, 4096
    s_waitcnt lgkmcnt(11)
    buffer_store_dwordx4 v[56:59], v6, s[24:27], s35 offen offset:0 sc1
    s_waitcnt lgkmcnt(10)
    buffer_store_dwordx4 v[60:63], v6, s[24:27], s35 offen offset:1024 sc1
    s_waitcnt lgkmcnt(9)
    buffer_store_dwordx4 v[64:67], v6, s[24:27], s35 offen offset:2048 sc1
    s_waitcnt lgkmcnt(8)
    buffer_store_dwordx4 v[68:71], v6, s[24:27], s35 offen offset:3072 sc1
    s_add_u32 s35, s35, 4096
    s_waitcnt lgkmcnt(7)
    buffer_store_dwordx4 v[72:75], v6, s[24:27], s35 offen offset:0 sc1
    s_waitcnt lgkmcnt(6)
    buffer_store_dwordx4 v[76:79], v6, s[24:27], s35 offen offset:1024 sc1
    s_waitcnt lgkmcnt(5)
    buffer_store_dwordx4 v[80:83], v6, s[24:27], s35 offen offset:2048 sc1
    s_waitcnt lgkmcnt(4)
    buffer_store_dwordx4 v[84:87], v6, s[24:27], s35 offen offset:3072 sc1
    s_add_u32 s35, s35, 4096
    s_waitcnt lgkmcnt(3)
    buffer_store_dwordx4 v[88:91], v6, s[24:27], s35 offen offset:0 sc1
    s_waitcnt lgkmcnt(2)
    buffer_store_dwordx4 v[92:95], v6, s[24:27], s35 offen offset:1024 sc1
    s_waitcnt lgkmcnt(1)
    buffer_store_dwordx4 v[96:99], v6, s[24:27], s35 offen offset:2048 sc1
    s_waitcnt lgkmcnt(0)
    buffer_store_dwordx4 v[100:103], v6, s[24:27], s35 offen offset:3072 sc1
    s_add_u32 s35, s35, 4096
attn_done:
    s_endpgm
attn_kernel_rare1:
    s_nop 15
    s_nop 15
    v_max3_f32 v208, v40, v41, v42
    v_max3_f32 v208, v208, v43, v44
    v_max3_f32 v208, v208, v45, v46
    v_max3_f32 v208, v208, v47, v48
    v_max3_f32 v208, v208, v49, v50
    v_max3_f32 v208, v208, v51, v52
    v_max3_f32 v208, v208, v53, v54
    v_max_f32 v208, v208, v55
    v_mov_b32 v209, v208
    s_nop 1
    v_permlane32_swap_b32 v209, v208
    s_nop 1
    v_max_f32 v208, v208, v209
    v_max_f32 v208, 0, v208
    v_sub_f32 v210, 0, v208
    v_exp_f32 v210, v210
    s_nop 0
    v_mul_f32 v26, v26, v210
    v_accvgpr_read_b32 v209, a0
    v_mul_f32 v209, v209, v210
    v_accvgpr_write_b32 a0, v209
    v_accvgpr_read_b32 v209, a1
    v_mul_f32 v209, v209, v210
    v_accvgpr_write_b32 a1, v209
    v_accvgpr_read_b32 v209, a2
    v_mul_f32 v209, v209, v210
    v_accvgpr_write_b32 a2, v209
    v_accvgpr_read_b32 v209, a3
    v_mul_f32 v209, v209, v210
    v_accvgpr_write_b32 a3, v209
    v_accvgpr_read_b32 v209, a4
    v_mul_f32 v209, v209, v210
    v_accvgpr_write_b32 a4, v209
    v_accvgpr_read_b32 v209, a5
    v_mul_f32 v209, v209, v210
    v_accvgpr_write_b32 a5, v209
    v_accvgpr_read_b32 v209, a6
    v_mul_f32 v209, v209, v210
    v_accvgpr_write_b32 a6, v209
    v_accvgpr_read_b32 v209, a7
    v_mul_f32 v209, v209, v210
    v_accvgpr_write_b32 a7, v209
    v_accvgpr_read_b32 v209, a8
    v_mul_f32 v209, v209, v210
    v_accvgpr_write_b32 a8, v209
    v_accvgpr_read_b32 v209, a9
    v_mul_f32 v209, v209, v210
    v_accvgpr_write_b32 a9, v209
    v_accvgpr_read_b32 v209, a10
    v_mul_f32 v209, v209, v210
    v_accvgpr_write_b32 a10, v209
    v_accvgpr_read_b32 v209, a11
    v_mul_f32 v209, v209, v210
    v_accvgpr_write_b32 a11, v209
    v_accvgpr_read_b32 v209, a12
    v_mul_f32 v209, v209, v210
    v_accvgpr_write_b32 a12, v209
    v_accvgpr_read_b32 v209, a13
    v_mul_f32 v209, v209, v210
    v_accvgpr_write_b32 a13, v209
    v_accvgpr_read_b32 v209, a14
    v_mul_f32 v209, v209, v210
    v_accvgpr_write_b32 a14, v209
    v_accvgpr_read_b32 v209, a15
    v_mul_f32 v209, v209, v210
    v_accvgpr_write_b32 a15, v209
    v_accvgpr_read_b32 v209, a16
    v_mul_f32 v209, v209, v210
    v_accvgpr_write_b32 a16, v209
    v_accvgpr_read_b32 v209, a17
    v_mul_f32 v209, v209, v210
    v_accvgpr_write_b32 a17, v209
    v_accvgpr_read_b32 v209, a18
    v_mul_f32 v209, v209, v210
    v_accvgpr_write_b32 a18, v209
    v_accvgpr_read_b32 v209, a19
    v_mul_f32 v209, v209, v210
    v_accvgpr_write_b32 a19, v209
    v_accvgpr_read_b32 v209, a20
    v_mul_f32 v209, v209, v210
    v_accvgpr_write_b32 a20, v209
    v_accvgpr_read_b32 v209, a21
    v_mul_f32 v209, v209, v210
    v_accvgpr_write_b32 a21, v209
    v_accvgpr_read_b32 v209, a22
    v_mul_f32 v209, v209, v210
    v_accvgpr_write_b32 a22, v209
    v_accvgpr_read_b32 v209, a23
    v_mul_f32 v209, v209, v210
    v_accvgpr_write_b32 a23, v209
    v_accvgpr_read_b32 v209, a24
    v_mul_f32 v209, v209, v210
    v_accvgpr_write_b32 a24, v209
    v_accvgpr_read_b32 v209, a25
    v_mul_f32 v209, v209, v210
    v_accvgpr_write_b32 a25, v209
    v_accvgpr_read_b32 v209, a26
    v_mul_f32 v209, v209, v210
    v_accvgpr_write_b32 a26, v209
    v_accvgpr_read_b32 v209, a27
    v_mul_f32 v209, v209, v210
    v_accvgpr_write_b32 a27, v209
    v_accvgpr_read_b32 v209, a28
    v_mul_f32 v209, v209, v210
    v_accvgpr_write_b32 a28, v209
    v_accvgpr_read_b32 v209, a29
    v_mul_f32 v209, v209, v210
    v_accvgpr_write_b32 a29, v209
    v_accvgpr_read_b32 v209, a30
    v_mul_f32 v209, v209, v210
    v_accvgpr_write_b32 a30, v209
    v_accvgpr_read_b32 v209, a31
    v_mul_f32 v209, v209, v210
    v_accvgpr_write_b32 a31, v209
    v_accvgpr_read_b32 v209, a32
    v_mul_f32 v209, v209, v210
    v_accvgpr_write_b32 a32, v209
    v_accvgpr_read_b32 v209, a33
    v_mul_f32 v209, v209, v210
    v_accvgpr_write_b32 a33, v209
    v_accvgpr_read_b32 v209, a34
    v_mul_f32 v209, v209, v210
    v_accvgpr_write_b32 a34, v209
    v_accvgpr_read_b32 v209, a35
    v_mul_f32 v209, v209, v210
    v_accvgpr_write_b32 a35, v209
    v_accvgpr_read_b32 v209, a36
    v_mul_f32 v209, v209, v210
    v_accvgpr_write_b32 a36, v209
    v_accvgpr_read_b32 v209, a37
    v_mul_f32 v209, v209, v210
    v_accvgpr_write_b32 a37, v209
    v_accvgpr_read_b32 v209, a38
    v_mul_f32 v209, v209, v210
    v_accvgpr_write_b32 a38, v209
    v_accvgpr_read_b32 v209, a39
    v_mul_f32 v209, v209, v210
    v_accvgpr_write_b32 a39, v209
    v_accvgpr_read_b32 v209, a40
    v_mul_f32 v209, v209, v210
    v_accvgpr_write_b32 a40, v209
    v_accvgpr_read_b32 v209, a41
    v_mul_f32 v209, v209, v210
    v_accvgpr_write_b32 a41, v209
    v_accvgpr_read_b32 v209, a42
    v_mul_f32 v209, v209, v210
    v_accvgpr_write_b32 a42, v209
    v_accvgpr_read_b32 v209, a43
    v_mul_f32 v209, v209, v210
    v_accvgpr_write_b32 a43, v209
    v_accvgpr_read_b32 v209, a44
    v_mul_f32 v209, v209, v210
    v_accvgpr_write_b32 a44, v209
    v_accvgpr_read_b32 v209, a45
    v_mul_f32 v209, v209, v210
    v_accvgpr_write_b32 a45, v209
    v_accvgpr_read_b32 v209, a46
    v_mul_f32 v209, v209, v210
    v_accvgpr_write_b32 a46, v209
    v_accvgpr_read_b32 v209, a47
    v_mul_f32 v209, v209, v210
    v_accvgpr_write_b32 a47, v209
    v_accvgpr_read_b32 v209, a48
    v_mul_f32 v209, v209, v210
    v_accvgpr_write_b32 a48, v209
    v_accvgpr_read_b32 v209, a49
    v_mul_f32 v209, v209, v210
    v_accvgpr_write_b32 a49, v209
    v_accvgpr_read_b32 v209, a50
    v_mul_f32 v209, v209, v210
    v_accvgpr_write_b32 a50, v209
    v_accvgpr_read_b32 v209, a51
    v_mul_f32 v209, v209, v210
    v_accvgpr_write_b32 a51, v209
    v_accvgpr_read_b32 v209, a52
    v_mul_f32 v209, v209, v210
    v_accvgpr_write_b32 a52, v209
    v_accvgpr_read_b32 v209, a53
    v_mul_f32 v209, v209, v210
    v_accvgpr_write_b32 a53, v209
    v_accvgpr_read_b32 v209, a54
    v_mul_f32 v209, v209, v210
    v_accvgpr_write_b32 a54, v209
    v_accvgpr_read_b32 v209, a55
    v_mul_f32 v209, v209, v210
    v_accvgpr_write_b32 a55, v209
    v_accvgpr_read_b32 v209, a56
    v_mul_f32 v209, v209, v210
    v_accvgpr_write_b32 a56, v209
    v_accvgpr_read_b32 v209, a57
    v_mul_f32 v209, v209, v210
    v_accvgpr_write_b32 a57, v209
    v_accvgpr_read_b32 v209, a58
    v_mul_f32 v209, v209, v210
    v_accvgpr_write_b32 a58, v209
    v_accvgpr_read_b32 v209, a59
    v_mul_f32 v209, v209, v210
    v_accvgpr_write_b32 a59, v209
    v_accvgpr_read_b32 v209, a60
    v_mul_f32 v209, v209, v210
    v_accvgpr_write_b32 a60, v209
    v_accvgpr_read_b32 v209, a61
    v_mul_f32 v209, v209, v210
    v_accvgpr_write_b32 a61, v209
    v_accvgpr_read_b32 v209, a62
    v_mul_f32 v209, v209, v210
    v_accvgpr_write_b32 a62, v209
    v_accvgpr_read_b32 v209, a63
    v_mul_f32 v209, v209, v210
    v_accvgpr_write_b32 a63, v209
    v_sub_f32 v136, v136, v208
    v_sub_f32 v40, v40, v208
    v_sub_f32 v72, v72, v208
    v_sub_f32 v137, v137, v208
    v_sub_f32 v41, v41, v208
    v_sub_f32 v73, v73, v208
    v_sub_f32 v138, v138, v208
    v_sub_f32 v42, v42, v208
    v_sub_f32 v74, v74, v208
    v_sub_f32 v139, v139, v208
    v_sub_f32 v43, v43, v208
    v_sub_f32 v75, v75, v208
    v_sub_f32 v140, v140, v208
    v_sub_f32 v44, v44, v208
    v_sub_f32 v76, v76, v208
    v_sub_f32 v141, v141, v208
    v_sub_f32 v45, v45, v208
    v_sub_f32 v77, v77, v208
    v_sub_f32 v142, v142, v208
    v_sub_f32 v46, v46, v208
    v_sub_f32 v78, v78, v208
    v_sub_f32 v143, v143, v208
    v_sub_f32 v47, v47, v208
    v_sub_f32 v79, v79, v208
    v_sub_f32 v144, v144, v208
    v_sub_f32 v48, v48, v208
    v_sub_f32 v80, v80, v208
    v_sub_f32 v145, v145, v208
    v_sub_f32 v49, v49, v208
    v_sub_f32 v81, v81, v208
    v_sub_f32 v146, v146, v208
    v_sub_f32 v50, v50, v208
    v_sub_f32 v82, v82, v208
    v_sub_f32 v147, v147, v208
    v_sub_f32 v51, v51, v208
    v_sub_f32 v83, v83, v208
    v_sub_f32 v148, v148, v208
    v_sub_f32 v52, v52, v208
    v_sub_f32 v84, v84, v208
    v_sub_f32 v149, v149, v208
    v_sub_f32 v53, v53, v208
    v_sub_f32 v85, v85, v208
    v_sub_f32 v150, v150, v208
    v_sub_f32 v54, v54, v208
    v_sub_f32 v86, v86, v208
    v_sub_f32 v151, v151, v208
    v_sub_f32 v55, v55, v208
    v_sub_f32 v87, v87, v208
    v_max3_f32 v208, v56, v57, v58
    v_max3_f32 v208, v208, v59, v60
    v_max3_f32 v208, v208, v61, v62
    v_max3_f32 v208, v208, v63, v64
    v_max3_f32 v208, v208, v65, v66
    v_max3_f32 v208, v208, v67, v68
    v_max3_f32 v208, v208, v69, v70
    v_max_f32 v208, v208, v71
    v_mov_b32 v209, v208
    s_nop 1
    v_permlane32_swap_b32 v209, v208
    s_nop 1
    v_max_f32 v208, v208, v209
    v_max_f32 v208, 0, v208
    v_sub_f32 v210, 0, v208
    v_exp_f32 v210, v210
    s_nop 0
    v_mul_f32 v27, v27, v210
    v_accvgpr_read_b32 v209, a64
    v_mul_f32 v209, v209, v210
    v_accvgpr_write_b32 a64, v209
    v_accvgpr_read_b32 v209, a65
    v_mul_f32 v209, v209, v210
    v_accvgpr_write_b32 a65, v209
    v_accvgpr_read_b32 v209, a66
    v_mul_f32 v209, v209, v210
    v_accvgpr_write_b32 a66, v209
    v_accvgpr_read_b32 v209, a67
    v_mul_f32 v209, v209, v210
    v_accvgpr_write_b32 a67, v209
    v_accvgpr_read_b32 v209, a68
    v_mul_f32 v209, v209, v210
    v_accvgpr_write_b32 a68, v209
    v_accvgpr_read_b32 v209, a69
    v_mul_f32 v209, v209, v210
    v_accvgpr_write_b32 a69, v209
    v_accvgpr_read_b32 v209, a70
    v_mul_f32 v209, v209, v210
    v_accvgpr_write_b32 a70, v209
    v_accvgpr_read_b32 v209, a71
    v_mul_f32 v209, v209, v210
    v_accvgpr_write_b32 a71, v209
    v_accvgpr_read_b32 v209, a72
    v_mul_f32 v209, v209, v210
    v_accvgpr_write_b32 a72, v209
    v_accvgpr_read_b32 v209, a73
    v_mul_f32 v209, v209, v210
    v_accvgpr_write_b32 a73, v209
    v_accvgpr_read_b32 v209, a74
    v_mul_f32 v209, v209, v210
    v_accvgpr_write_b32 a74, v209
    v_accvgpr_read_b32 v209, a75
    v_mul_f32 v209, v209, v210
    v_accvgpr_write_b32 a75, v209
    v_accvgpr_read_b32 v209, a76
    v_mul_f32 v209, v209, v210
    v_accvgpr_write_b32 a76, v209
    v_accvgpr_read_b32 v209, a77
    v_mul_f32 v209, v209, v210
    v_accvgpr_write_b32 a77, v209
    v_accvgpr_read_b32 v209, a78
    v_mul_f32 v209, v209, v210
    v_accvgpr_write_b32 a78, v209
    v_accvgpr_read_b32 v209, a79
    v_mul_f32 v209, v209, v210
    v_accvgpr_write_b32 a79, v209
    v_accvgpr_read_b32 v209, a80
    v_mul_f32 v209, v209, v210
    v_accvgpr_write_b32 a80, v209
    v_accvgpr_read_b32 v209, a81
    v_mul_f32 v209, v209, v210
    v_accvgpr_write_b32 a81, v209
    v_accvgpr_read_b32 v209, a82
    v_mul_f32 v209, v209, v210
    v_accvgpr_write_b32 a82, v209
    v_accvgpr_read_b32 v209, a83
    v_mul_f32 v209, v209, v210
    v_accvgpr_write_b32 a83, v209
    v_accvgpr_read_b32 v209, a84
    v_mul_f32 v209, v209, v210
    v_accvgpr_write_b32 a84, v209
    v_accvgpr_read_b32 v209, a85
    v_mul_f32 v209, v209, v210
    v_accvgpr_write_b32 a85, v209
    v_accvgpr_read_b32 v209, a86
    v_mul_f32 v209, v209, v210
    v_accvgpr_write_b32 a86, v209
    v_accvgpr_read_b32 v209, a87
    v_mul_f32 v209, v209, v210
    v_accvgpr_write_b32 a87, v209
    v_accvgpr_read_b32 v209, a88
    v_mul_f32 v209, v209, v210
    v_accvgpr_write_b32 a88, v209
    v_accvgpr_read_b32 v209, a89
    v_mul_f32 v209, v209, v210
    v_accvgpr_write_b32 a89, v209
    v_accvgpr_read_b32 v209, a90
    v_mul_f32 v209, v209, v210
    v_accvgpr_write_b32 a90, v209
    v_accvgpr_read_b32 v209, a91
    v_mul_f32 v209, v209, v210
    v_accvgpr_write_b32 a91, v209
    v_accvgpr_read_b32 v209, a92
    v_mul_f32 v209, v209, v210
    v_accvgpr_write_b32 a92, v209
    v_accvgpr_read_b32 v209, a93
    v_mul_f32 v209, v209, v210
    v_accvgpr_write_b32 a93, v209
    v_accvgpr_read_b32 v209, a94
    v_mul_f32 v209, v209, v210
    v_accvgpr_write_b32 a94, v209
    v_accvgpr_read_b32 v209, a95
    v_mul_f32 v209, v209, v210
    v_accvgpr_write_b32 a95, v209
    v_accvgpr_read_b32 v209, a96
    v_mul_f32 v209, v209, v210
    v_accvgpr_write_b32 a96, v209
    v_accvgpr_read_b32 v209, a97
    v_mul_f32 v209, v209, v210
    v_accvgpr_write_b32 a97, v209
    v_accvgpr_read_b32 v209, a98
    v_mul_f32 v209, v209, v210
    v_accvgpr_write_b32 a98, v209
    v_accvgpr_read_b32 v209, a99
    v_mul_f32 v209, v209, v210
    v_accvgpr_write_b32 a99, v209
    v_accvgpr_read_b32 v209, a100
    v_mul_f32 v209, v209, v210
    v_accvgpr_write_b32 a100, v209
    v_accvgpr_read_b32 v209, a101
    v_mul_f32 v209, v209, v210
    v_accvgpr_write_b32 a101, v209
    v_accvgpr_read_b32 v209, a102
    v_mul_f32 v209, v209, v210
    v_accvgpr_write_b32 a102, v209
    v_accvgpr_read_b32 v209, a103
    v_mul_f32 v209, v209, v210
    v_accvgpr_write_b32 a103, v209
    v_accvgpr_read_b32 v209, a104
    v_mul_f32 v209, v209, v210
    v_accvgpr_write_b32 a104, v209
    v_accvgpr_read_b32 v209, a105
    v_mul_f32 v209, v209, v210
    v_accvgpr_write_b32 a105, v209
    v_accvgpr_read_b32 v209, a106
    v_mul_f32 v209, v209, v210
    v_accvgpr_write_b32 a106, v209
    v_accvgpr_read_b32 v209, a107
    v_mul_f32 v209, v209, v210
    v_accvgpr_write_b32 a107, v209
    v_accvgpr_read_b32 v209, a108
    v_mul_f32 v209, v209, v210
    v_accvgpr_write_b32 a108, v209
    v_accvgpr_read_b32 v209, a109
    v_mul_f32 v209, v209, v210
    v_accvgpr_write_b32 a109, v209
    v_accvgpr_read_b32 v209, a110
    v_mul_f32 v209, v209, v210
    v_accvgpr_write_b32 a110, v209
    v_accvgpr_read_b32 v209, a111
    v_mul_f32 v209, v209, v210
    v_accvgpr_write_b32 a111, v209
    v_accvgpr_read_b32 v209, a112
    v_mul_f32 v209, v209, v210
    v_accvgpr_write_b32 a112, v209
    v_accvgpr_read_b32 v209, a113
    v_mul_f32 v209, v209, v210
    v_accvgpr_write_b32 a113, v209
    v_accvgpr_read_b32 v209, a114
    v_mul_f32 v209, v209, v210
    v_accvgpr_write_b32 a114, v209
    v_accvgpr_read_b32 v209, a115
    v_mul_f32 v209, v209, v210
    v_accvgpr_write_b32 a115, v209
    v_accvgpr_read_b32 v209, a116
    v_mul_f32 v209, v209, v210
    v_accvgpr_write_b32 a116, v209
    v_accvgpr_read_b32 v209, a117
    v_mul_f32 v209, v209, v210
    v_accvgpr_write_b32 a117, v209
    v_accvgpr_read_b32 v209, a118
    v_mul_f32 v209, v209, v210
    v_accvgpr_write_b32 a118, v209
    v_accvgpr_read_b32 v209, a119
    v_mul_f32 v209, v209, v210
    v_accvgpr_write_b32 a119, v209
    v_accvgpr_read_b32 v209, a120
    v_mul_f32 v209, v209, v210
    v_accvgpr_write_b32 a120, v209
    v_accvgpr_read_b32 v209, a121
    v_mul_f32 v209, v209, v210
    v_accvgpr_write_b32 a121, v209
    v_accvgpr_read_b32 v209, a122
    v_mul_f32 v209, v209, v210
    v_accvgpr_write_b32 a122, v209
    v_accvgpr_read_b32 v209, a123
    v_mul_f32 v209, v209, v210
    v_accvgpr_write_b32 a123, v209
    v_accvgpr_read_b32 v209, a124
    v_mul_f32 v209, v209, v210
    v_accvgpr_write_b32 a124, v209
    v_accvgpr_read_b32 v209, a125
    v_mul_f32 v209, v209, v210
    v_accvgpr_write_b32 a125, v209
    v_accvgpr_read_b32 v209, a126
    v_mul_f32 v209, v209, v210
    v_accvgpr_write_b32 a126, v209
    v_accvgpr_read_b32 v209, a127
    v_mul_f32 v209, v209, v210
    v_accvgpr_write_b32 a127, v209
    v_sub_f32 v152, v152, v208
    v_sub_f32 v56, v56, v208
    v_sub_f32 v88, v88, v208
    v_sub_f32 v153, v153, v208
    v_sub_f32 v57, v57, v208
    v_sub_f32 v89, v89, v208
    v_sub_f32 v154, v154, v208
    v_sub_f32 v58, v58, v208
    v_sub_f32 v90, v90, v208
    v_sub_f32 v155, v155, v208
    v_sub_f32 v59, v59, v208
    v_sub_f32 v91, v91, v208
    v_sub_f32 v156, v156, v208
    v_sub_f32 v60, v60, v208
    v_sub_f32 v92, v92, v208
    v_sub_f32 v157, v157, v208
    v_sub_f32 v61, v61, v208
    v_sub_f32 v93, v93, v208
    v_sub_f32 v158, v158, v208
    v_sub_f32 v62, v62, v208
    v_sub_f32 v94, v94, v208
    v_sub_f32 v159, v159, v208
    v_sub_f32 v63, v63, v208
    v_sub_f32 v95, v95, v208
    v_sub_f32 v160, v160, v208
    v_sub_f32 v64, v64, v208
    v_sub_f32 v96, v96, v208
    v_sub_f32 v161, v161, v208
    v_sub_f32 v65, v65, v208
    v_sub_f32 v97, v97, v208
    v_sub_f32 v162, v162, v208
    v_sub_f32 v66, v66, v208
    v_sub_f32 v98, v98, v208
    v_sub_f32 v163, v163, v208
    v_sub_f32 v67, v67, v208
    v_sub_f32 v99, v99, v208
    v_sub_f32 v164, v164, v208
    v_sub_f32 v68, v68, v208
    v_sub_f32 v100, v100, v208
    v_sub_f32 v165, v165, v208
    v_sub_f32 v69, v69, v208
    v_sub_f32 v101, v101, v208
    v_sub_f32 v166, v166, v208
    v_sub_f32 v70, v70, v208
    v_sub_f32 v102, v102, v208
    v_sub_f32 v167, v167, v208
    v_sub_f32 v71, v71, v208
    v_sub_f32 v103, v103, v208
    v_exp_f32 v30, v40
    v_exp_f32 v31, v41
    s_nop 0
    v_add_f32 v28, v30, v31
    v_cvt_pk_bf16_f32 v104, v30, v31
    v_exp_f32 v32, v42
    v_exp_f32 v33, v43
    v_add_f32 v28, v28, v32
    v_add_f32 v28, v28, v33
    v_cvt_pk_bf16_f32 v105, v32, v33
    v_exp_f32 v30, v44
    v_exp_f32 v31, v45
    v_add_f32 v28, v28, v30
    v_add_f32 v28, v28, v31
    v_cvt_pk_bf16_f32 v106, v30, v31
    v_exp_f32 v32, v46
    v_exp_f32 v33, v47
    v_add_f32 v28, v28, v32
    v_add_f32 v28, v28, v33
    v_cvt_pk_bf16_f32 v107, v32, v33
    v_exp_f32 v30, v48
    v_exp_f32 v31, v49
    v_add_f32 v28, v28, v30
    v_add_f32 v28, v28, v31
    v_cvt_pk_bf16_f32 v108, v30, v31
    v_exp_f32 v32, v50
    v_exp_f32 v33, v51
    v_add_f32 v28, v28, v32
    v_add_f32 v28, v28, v33
    v_cvt_pk_bf16_f32 v109, v32, v33
    v_exp_f32 v30, v52
    v_exp_f32 v31, v53
    v_add_f32 v28, v28, v30
    v_add_f32 v28, v28, v31
    v_cvt_pk_bf16_f32 v110, v30, v31
    v_exp_f32 v32, v54
    v_exp_f32 v33, v55
    v_add_f32 v28, v28, v32
    v_add_f32 v28, v28, v33
    v_cvt_pk_bf16_f32 v111, v32, v33
    v_exp_f32 v30, v56
    v_exp_f32 v31, v57
    s_nop 0
    v_add_f32 v29, v30, v31
    v_cvt_pk_bf16_f32 v112, v30, v31
    v_exp_f32 v32, v58
    v_exp_f32 v33, v59
    v_add_f32 v29, v29, v32
    v_add_f32 v29, v29, v33
    v_cvt_pk_bf16_f32 v113, v32, v33
    v_exp_f32 v30, v60
    v_exp_f32 v31, v61
    v_add_f32 v29, v29, v30
    v_add_f32 v29, v29, v31
    v_cvt_pk_bf16_f32 v114, v30, v31
    v_exp_f32 v32, v62
    v_exp_f32 v33, v63
    v_add_f32 v29, v29, v32
    v_add_f32 v29, v29, v33
    v_cvt_pk_bf16_f32 v115, v32, v33
    v_exp_f32 v30, v64
    v_exp_f32 v31, v65
    v_add_f32 v29, v29, v30
    v_add_f32 v29, v29, v31
    v_cvt_pk_bf16_f32 v116, v30, v31
    v_exp_f32 v32, v66
    v_exp_f32 v33, v67
    v_add_f32 v29, v29, v32
    v_add_f32 v29, v29, v33
    v_cvt_pk_bf16_f32 v117, v32, v33
    v_exp_f32 v30, v68
    v_exp_f32 v31, v69
    v_add_f32 v29, v29, v30
    v_add_f32 v29, v29, v31
    v_cvt_pk_bf16_f32 v118, v30, v31
    v_exp_f32 v32, v70
    v_exp_f32 v33, v71
    v_add_f32 v29, v29, v32
    v_add_f32 v29, v29, v33
    v_cvt_pk_bf16_f32 v119, v32, v33
    s_nop 1
    s_branch attn_kernel_ret2
attn_kernel_rare3:
    s_nop 15
    s_nop 15
    v_max3_f32 v208, v72, v73, v74
    v_max3_f32 v208, v208, v75, v76
    v_max3_f32 v208, v208, v77, v78
    v_max3_f32 v208, v208, v79, v80
    v_max3_f32 v208, v208, v81, v82
    v_max3_f32 v208, v208, v83, v84
    v_max3_f32 v208, v208, v85, v86
    v_max_f32 v208, v208, v87
    v_mov_b32 v209, v208
    s_nop 1
    v_permlane32_swap_b32 v209, v208
    s_nop 1
    v_max_f32 v208, v208, v209
    v_max_f32 v208, 0, v208
    v_sub_f32 v210, 0, v208
    v_exp_f32 v210, v210
    s_nop 0
    v_mul_f32 v26, v26, v210
    v_accvgpr_read_b32 v209, a0
    v_mul_f32 v209, v209, v210
    v_accvgpr_write_b32 a0, v209
    v_accvgpr_read_b32 v209, a1
    v_mul_f32 v209, v209, v210
    v_accvgpr_write_b32 a1, v209
    v_accvgpr_read_b32 v209, a2
    v_mul_f32 v209, v209, v210
    v_accvgpr_write_b32 a2, v209
    v_accvgpr_read_b32 v209, a3
    v_mul_f32 v209, v209, v210
    v_accvgpr_write_b32 a3, v209
    v_accvgpr_read_b32 v209, a4
    v_mul_f32 v209, v209, v210
    v_accvgpr_write_b32 a4, v209
    v_accvgpr_read_b32 v209, a5
    v_mul_f32 v209, v209, v210
    v_accvgpr_write_b32 a5, v209
    v_accvgpr_read_b32 v209, a6
    v_mul_f32 v209, v209, v210
    v_accvgpr_write_b32 a6, v209
    v_accvgpr_read_b32 v209, a7
    v_mul_f32 v209, v209, v210
    v_accvgpr_write_b32 a7, v209
    v_accvgpr_read_b32 v209, a8
    v_mul_f32 v209, v209, v210
    v_accvgpr_write_b32 a8, v209
    v_accvgpr_read_b32 v209, a9
    v_mul_f32 v209, v209, v210
    v_accvgpr_write_b32 a9, v209
    v_accvgpr_read_b32 v209, a10
    v_mul_f32 v209, v209, v210
    v_accvgpr_write_b32 a10, v209
    v_accvgpr_read_b32 v209, a11
    v_mul_f32 v209, v209, v210
    v_accvgpr_write_b32 a11, v209
    v_accvgpr_read_b32 v209, a12
    v_mul_f32 v209, v209, v210
    v_accvgpr_write_b32 a12, v209
    v_accvgpr_read_b32 v209, a13
    v_mul_f32 v209, v209, v210
    v_accvgpr_write_b32 a13, v209
    v_accvgpr_read_b32 v209, a14
    v_mul_f32 v209, v209, v210
    v_accvgpr_write_b32 a14, v209
    v_accvgpr_read_b32 v209, a15
    v_mul_f32 v209, v209, v210
    v_accvgpr_write_b32 a15, v209
    v_accvgpr_read_b32 v209, a16
    v_mul_f32 v209, v209, v210
    v_accvgpr_write_b32 a16, v209
    v_accvgpr_read_b32 v209, a17
    v_mul_f32 v209, v209, v210
    v_accvgpr_write_b32 a17, v209
    v_accvgpr_read_b32 v209, a18
    v_mul_f32 v209, v209, v210
    v_accvgpr_write_b32 a18, v209
    v_accvgpr_read_b32 v209, a19
    v_mul_f32 v209, v209, v210
    v_accvgpr_write_b32 a19, v209
    v_accvgpr_read_b32 v209, a20
    v_mul_f32 v209, v209, v210
    v_accvgpr_write_b32 a20, v209
    v_accvgpr_read_b32 v209, a21
    v_mul_f32 v209, v209, v210
    v_accvgpr_write_b32 a21, v209
    v_accvgpr_read_b32 v209, a22
    v_mul_f32 v209, v209, v210
    v_accvgpr_write_b32 a22, v209
    v_accvgpr_read_b32 v209, a23
    v_mul_f32 v209, v209, v210
    v_accvgpr_write_b32 a23, v209
    v_accvgpr_read_b32 v209, a24
    v_mul_f32 v209, v209, v210
    v_accvgpr_write_b32 a24, v209
    v_accvgpr_read_b32 v209, a25
    v_mul_f32 v209, v209, v210
    v_accvgpr_write_b32 a25, v209
    v_accvgpr_read_b32 v209, a26
    v_mul_f32 v209, v209, v210
    v_accvgpr_write_b32 a26, v209
    v_accvgpr_read_b32 v209, a27
    v_mul_f32 v209, v209, v210
    v_accvgpr_write_b32 a27, v209
    v_accvgpr_read_b32 v209, a28
    v_mul_f32 v209, v209, v210
    v_accvgpr_write_b32 a28, v209
    v_accvgpr_read_b32 v209, a29
    v_mul_f32 v209, v209, v210
    v_accvgpr_write_b32 a29, v209
    v_accvgpr_read_b32 v209, a30
    v_mul_f32 v209, v209, v210
    v_accvgpr_write_b32 a30, v209
    v_accvgpr_read_b32 v209, a31
    v_mul_f32 v209, v209, v210
    v_accvgpr_write_b32 a31, v209
    v_accvgpr_read_b32 v209, a32
    v_mul_f32 v209, v209, v210
    v_accvgpr_write_b32 a32, v209
    v_accvgpr_read_b32 v209, a33
    v_mul_f32 v209, v209, v210
    v_accvgpr_write_b32 a33, v209
    v_accvgpr_read_b32 v209, a34
    v_mul_f32 v209, v209, v210
    v_accvgpr_write_b32 a34, v209
    v_accvgpr_read_b32 v209, a35
    v_mul_f32 v209, v209, v210
    v_accvgpr_write_b32 a35, v209
    v_accvgpr_read_b32 v209, a36
    v_mul_f32 v209, v209, v210
    v_accvgpr_write_b32 a36, v209
    v_accvgpr_read_b32 v209, a37
    v_mul_f32 v209, v209, v210
    v_accvgpr_write_b32 a37, v209
    v_accvgpr_read_b32 v209, a38
    v_mul_f32 v209, v209, v210
    v_accvgpr_write_b32 a38, v209
    v_accvgpr_read_b32 v209, a39
    v_mul_f32 v209, v209, v210
    v_accvgpr_write_b32 a39, v209
    v_accvgpr_read_b32 v209, a40
    v_mul_f32 v209, v209, v210
    v_accvgpr_write_b32 a40, v209
    v_accvgpr_read_b32 v209, a41
    v_mul_f32 v209, v209, v210
    v_accvgpr_write_b32 a41, v209
    v_accvgpr_read_b32 v209, a42
    v_mul_f32 v209, v209, v210
    v_accvgpr_write_b32 a42, v209
    v_accvgpr_read_b32 v209, a43
    v_mul_f32 v209, v209, v210
    v_accvgpr_write_b32 a43, v209
    v_accvgpr_read_b32 v209, a44
    v_mul_f32 v209, v209, v210
    v_accvgpr_write_b32 a44, v209
    v_accvgpr_read_b32 v209, a45
    v_mul_f32 v209, v209, v210
    v_accvgpr_write_b32 a45, v209
    v_accvgpr_read_b32 v209, a46
    v_mul_f32 v209, v209, v210
    v_accvgpr_write_b32 a46, v209
    v_accvgpr_read_b32 v209, a47
    v_mul_f32 v209, v209, v210
    v_accvgpr_write_b32 a47, v209
    v_accvgpr_read_b32 v209, a48
    v_mul_f32 v209, v209, v210
    v_accvgpr_write_b32 a48, v209
    v_accvgpr_read_b32 v209, a49
    v_mul_f32 v209, v209, v210
    v_accvgpr_write_b32 a49, v209
    v_accvgpr_read_b32 v209, a50
    v_mul_f32 v209, v209, v210
    v_accvgpr_write_b32 a50, v209
    v_accvgpr_read_b32 v209, a51
    v_mul_f32 v209, v209, v210
    v_accvgpr_write_b32 a51, v209
    v_accvgpr_read_b32 v209, a52
    v_mul_f32 v209, v209, v210
    v_accvgpr_write_b32 a52, v209
    v_accvgpr_read_b32 v209, a53
    v_mul_f32 v209, v209, v210
    v_accvgpr_write_b32 a53, v209
    v_accvgpr_read_b32 v209, a54
    v_mul_f32 v209, v209, v210
    v_accvgpr_write_b32 a54, v209
    v_accvgpr_read_b32 v209, a55
    v_mul_f32 v209, v209, v210
    v_accvgpr_write_b32 a55, v209
    v_accvgpr_read_b32 v209, a56
    v_mul_f32 v209, v209, v210
    v_accvgpr_write_b32 a56, v209
    v_accvgpr_read_b32 v209, a57
    v_mul_f32 v209, v209, v210
    v_accvgpr_write_b32 a57, v209
    v_accvgpr_read_b32 v209, a58
    v_mul_f32 v209, v209, v210
    v_accvgpr_write_b32 a58, v209
    v_accvgpr_read_b32 v209, a59
    v_mul_f32 v209, v209, v210
    v_accvgpr_write_b32 a59, v209
    v_accvgpr_read_b32 v209, a60
    v_mul_f32 v209, v209, v210
    v_accvgpr_write_b32 a60, v209
    v_accvgpr_read_b32 v209, a61
    v_mul_f32 v209, v209, v210
    v_accvgpr_write_b32 a61, v209
    v_accvgpr_read_b32 v209, a62
    v_mul_f32 v209, v209, v210
    v_accvgpr_write_b32 a62, v209
    v_accvgpr_read_b32 v209, a63
    v_mul_f32 v209, v209, v210
    v_accvgpr_write_b32 a63, v209
    v_sub_f32 v136, v136, v208
    v_sub_f32 v72, v72, v208
    v_sub_f32 v40, v40, v208
    v_sub_f32 v137, v137, v208
    v_sub_f32 v73, v73, v208
    v_sub_f32 v41, v41, v208
    v_sub_f32 v138, v138, v208
    v_sub_f32 v74, v74, v208
    v_sub_f32 v42, v42, v208
    v_sub_f32 v139, v139, v208
    v_sub_f32 v75, v75, v208
    v_sub_f32 v43, v43, v208
    v_sub_f32 v140, v140, v208
    v_sub_f32 v76, v76, v208
    v_sub_f32 v44, v44, v208
    v_sub_f32 v141, v141, v208
    v_sub_f32 v77, v77, v208
    v_sub_f32 v45, v45, v208
    v_sub_f32 v142, v142, v208
    v_sub_f32 v78, v78, v208
    v_sub_f32 v46, v46, v208
    v_sub_f32 v143, v143, v208
    v_sub_f32 v79, v79, v208
    v_sub_f32 v47, v47, v208
    v_sub_f32 v144, v144, v208
    v_sub_f32 v80, v80, v208
    v_sub_f32 v48, v48, v208
    v_sub_f32 v145, v145, v208
    v_sub_f32 v81, v81, v208
    v_sub_f32 v49, v49, v208
    v_sub_f32 v146, v146, v208
    v_sub_f32 v82, v82, v208
    v_sub_f32 v50, v50, v208
    v_sub_f32 v147, v147, v208
    v_sub_f32 v83, v83, v208
    v_sub_f32 v51, v51, v208
    v_sub_f32 v148, v148, v208
    v_sub_f32 v84, v84, v208
    v_sub_f32 v52, v52, v208
    v_sub_f32 v149, v149, v208
    v_sub_f32 v85, v85, v208
    v_sub_f32 v53, v53, v208
    v_sub_f32 v150, v150, v208
    v_sub_f32 v86, v86, v208
    v_sub_f32 v54, v54, v208
    v_sub_f32 v151, v151, v208
    v_sub_f32 v87, v87, v208
    v_sub_f32 v55, v55, v208
    v_max3_f32 v208, v88, v89, v90
    v_max3_f32 v208, v208, v91, v92
    v_max3_f32 v208, v208, v93, v94
    v_max3_f32 v208, v208, v95, v96
    v_max3_f32 v208, v208, v97, v98
    v_max3_f32 v208, v208, v99, v100
    v_max3_f32 v208, v208, v101, v102
    v_max_f32 v208, v208, v103
    v_mov_b32 v209, v208
    s_nop 1
    v_permlane32_swap_b32 v209, v208
    s_nop 1
    v_max_f32 v208, v208, v209
    v_max_f32 v208, 0, v208
    v_sub_f32 v210, 0, v208
    v_exp_f32 v210, v210
    s_nop 0
    v_mul_f32 v27, v27, v210
    v_accvgpr_read_b32 v209, a64
    v_mul_f32 v209, v209, v210
    v_accvgpr_write_b32 a64, v209
    v_accvgpr_read_b32 v209, a65
    v_mul_f32 v209, v209, v210
    v_accvgpr_write_b32 a65, v209
    v_accvgpr_read_b32 v209, a66
    v_mul_f32 v209, v209, v210
    v_accvgpr_write_b32 a66, v209
    v_accvgpr_read_b32 v209, a67
    v_mul_f32 v209, v209, v210
    v_accvgpr_write_b32 a67, v209
    v_accvgpr_read_b32 v209, a68
    v_mul_f32 v209, v209, v210
    v_accvgpr_write_b32 a68, v209
    v_accvgpr_read_b32 v209, a69
    v_mul_f32 v209, v209, v210
    v_accvgpr_write_b32 a69, v209
    v_accvgpr_read_b32 v209, a70
    v_mul_f32 v209, v209, v210
    v_accvgpr_write_b32 a70, v209
    v_accvgpr_read_b32 v209, a71
    v_mul_f32 v209, v209, v210
    v_accvgpr_write_b32 a71, v209
    v_accvgpr_read_b32 v209, a72
    v_mul_f32 v209, v209, v210
    v_accvgpr_write_b32 a72, v209
    v_accvgpr_read_b32 v209, a73
    v_mul_f32 v209, v209, v210
    v_accvgpr_write_b32 a73, v209
    v_accvgpr_read_b32 v209, a74
    v_mul_f32 v209, v209, v210
    v_accvgpr_write_b32 a74, v209
    v_accvgpr_read_b32 v209, a75
    v_mul_f32 v209, v209, v210
    v_accvgpr_write_b32 a75, v209
    v_accvgpr_read_b32 v209, a76
    v_mul_f32 v209, v209, v210
    v_accvgpr_write_b32 a76, v209
    v_accvgpr_read_b32 v209, a77
    v_mul_f32 v209, v209, v210
    v_accvgpr_write_b32 a77, v209
    v_accvgpr_read_b32 v209, a78
    v_mul_f32 v209, v209, v210
    v_accvgpr_write_b32 a78, v209
    v_accvgpr_read_b32 v209, a79
    v_mul_f32 v209, v209, v210
    v_accvgpr_write_b32 a79, v209
    v_accvgpr_read_b32 v209, a80
    v_mul_f32 v209, v209, v210
    v_accvgpr_write_b32 a80, v209
    v_accvgpr_read_b32 v209, a81
    v_mul_f32 v209, v209, v210
    v_accvgpr_write_b32 a81, v209
    v_accvgpr_read_b32 v209, a82
    v_mul_f32 v209, v209, v210
    v_accvgpr_write_b32 a82, v209
    v_accvgpr_read_b32 v209, a83
    v_mul_f32 v209, v209, v210
    v_accvgpr_write_b32 a83, v209
    v_accvgpr_read_b32 v209, a84
    v_mul_f32 v209, v209, v210
    v_accvgpr_write_b32 a84, v209
    v_accvgpr_read_b32 v209, a85
    v_mul_f32 v209, v209, v210
    v_accvgpr_write_b32 a85, v209
    v_accvgpr_read_b32 v209, a86
    v_mul_f32 v209, v209, v210
    v_accvgpr_write_b32 a86, v209
    v_accvgpr_read_b32 v209, a87
    v_mul_f32 v209, v209, v210
    v_accvgpr_write_b32 a87, v209
    v_accvgpr_read_b32 v209, a88
    v_mul_f32 v209, v209, v210
    v_accvgpr_write_b32 a88, v209
    v_accvgpr_read_b32 v209, a89
    v_mul_f32 v209, v209, v210
    v_accvgpr_write_b32 a89, v209
    v_accvgpr_read_b32 v209, a90
    v_mul_f32 v209, v209, v210
    v_accvgpr_write_b32 a90, v209
    v_accvgpr_read_b32 v209, a91
    v_mul_f32 v209, v209, v210
    v_accvgpr_write_b32 a91, v209
    v_accvgpr_read_b32 v209, a92
    v_mul_f32 v209, v209, v210
    v_accvgpr_write_b32 a92, v209
    v_accvgpr_read_b32 v209, a93
    v_mul_f32 v209, v209, v210
    v_accvgpr_write_b32 a93, v209
    v_accvgpr_read_b32 v209, a94
    v_mul_f32 v209, v209, v210
    v_accvgpr_write_b32 a94, v209
    v_accvgpr_read_b32 v209, a95
    v_mul_f32 v209, v209, v210
    v_accvgpr_write_b32 a95, v209
    v_accvgpr_read_b32 v209, a96
    v_mul_f32 v209, v209, v210
    v_accvgpr_write_b32 a96, v209
    v_accvgpr_read_b32 v209, a97
    v_mul_f32 v209, v209, v210
    v_accvgpr_write_b32 a97, v209
    v_accvgpr_read_b32 v209, a98
    v_mul_f32 v209, v209, v210
    v_accvgpr_write_b32 a98, v209
    v_accvgpr_read_b32 v209, a99
    v_mul_f32 v209, v209, v210
    v_accvgpr_write_b32 a99, v209
    v_accvgpr_read_b32 v209, a100
    v_mul_f32 v209, v209, v210
    v_accvgpr_write_b32 a100, v209
    v_accvgpr_read_b32 v209, a101
    v_mul_f32 v209, v209, v210
    v_accvgpr_write_b32 a101, v209
    v_accvgpr_read_b32 v209, a102
    v_mul_f32 v209, v209, v210
    v_accvgpr_write_b32 a102, v209
    v_accvgpr_read_b32 v209, a103
    v_mul_f32 v209, v209, v210
    v_accvgpr_write_b32 a103, v209
    v_accvgpr_read_b32 v209, a104
    v_mul_f32 v209, v209, v210
    v_accvgpr_write_b32 a104, v209
    v_accvgpr_read_b32 v209, a105
    v_mul_f32 v209, v209, v210
    v_accvgpr_write_b32 a105, v209
    v_accvgpr_read_b32 v209, a106
    v_mul_f32 v209, v209, v210
    v_accvgpr_write_b32 a106, v209
    v_accvgpr_read_b32 v209, a107
    v_mul_f32 v209, v209, v210
    v_accvgpr_write_b32 a107, v209
    v_accvgpr_read_b32 v209, a108
    v_mul_f32 v209, v209, v210
    v_accvgpr_write_b32 a108, v209
    v_accvgpr_read_b32 v209, a109
    v_mul_f32 v209, v209, v210
    v_accvgpr_write_b32 a109, v209
    v_accvgpr_read_b32 v209, a110
    v_mul_f32 v209, v209, v210
    v_accvgpr_write_b32 a110, v209
    v_accvgpr_read_b32 v209, a111
    v_mul_f32 v209, v209, v210
    v_accvgpr_write_b32 a111, v209
    v_accvgpr_read_b32 v209, a112
    v_mul_f32 v209, v209, v210
    v_accvgpr_write_b32 a112, v209
    v_accvgpr_read_b32 v209, a113
    v_mul_f32 v209, v209, v210
    v_accvgpr_write_b32 a113, v209
    v_accvgpr_read_b32 v209, a114
    v_mul_f32 v209, v209, v210
    v_accvgpr_write_b32 a114, v209
    v_accvgpr_read_b32 v209, a115
    v_mul_f32 v209, v209, v210
    v_accvgpr_write_b32 a115, v209
    v_accvgpr_read_b32 v209, a116
    v_mul_f32 v209, v209, v210
    v_accvgpr_write_b32 a116, v209
    v_accvgpr_read_b32 v209, a117
    v_mul_f32 v209, v209, v210
    v_accvgpr_write_b32 a117, v209
    v_accvgpr_read_b32 v209, a118
    v_mul_f32 v209, v209, v210
    v_accvgpr_write_b32 a118, v209
    v_accvgpr_read_b32 v209, a119
    v_mul_f32 v209, v209, v210
    v_accvgpr_write_b32 a119, v209
    v_accvgpr_read_b32 v209, a120
    v_mul_f32 v209, v209, v210
    v_accvgpr_write_b32 a120, v209
    v_accvgpr_read_b32 v209, a121
    v_mul_f32 v209, v209, v210
    v_accvgpr_write_b32 a121, v209
    v_accvgpr_read_b32 v209, a122
    v_mul_f32 v209, v209, v210
    v_accvgpr_write_b32 a122, v209
    v_accvgpr_read_b32 v209, a123
    v_mul_f32 v209, v209, v210
    v_accvgpr_write_b32 a123, v209
    v_accvgpr_read_b32 v209, a124
    v_mul_f32 v209, v209, v210
    v_accvgpr_write_b32 a124, v209
    v_accvgpr_read_b32 v209, a125
    v_mul_f32 v209, v209, v210
    v_accvgpr_write_b32 a125, v209
    v_accvgpr_read_b32 v209, a126
    v_mul_f32 v209, v209, v210
    v_accvgpr_write_b32 a126, v209
    v_accvgpr_read_b32 v209, a127
    v_mul_f32 v209, v209, v210
    v_accvgpr_write_b32 a127, v209
    v_sub_f32 v152, v152, v208
    v_sub_f32 v88, v88, v208
    v_sub_f32 v56, v56, v208
    v_sub_f32 v153, v153, v208
    v_sub_f32 v89, v89, v208
    v_sub_f32 v57, v57, v208
    v_sub_f32 v154, v154, v208
    v_sub_f32 v90, v90, v208
    v_sub_f32 v58, v58, v208
    v_sub_f32 v155, v155, v208
    v_sub_f32 v91, v91, v208
    v_sub_f32 v59, v59, v208
    v_sub_f32 v156, v156, v208
    v_sub_f32 v92, v92, v208
    v_sub_f32 v60, v60, v208
    v_sub_f32 v157, v157, v208
    v_sub_f32 v93, v93, v208
    v_sub_f32 v61, v61, v208
    v_sub_f32 v158, v158, v208
    v_sub_f32 v94, v94, v208
    v_sub_f32 v62, v62, v208
    v_sub_f32 v159, v159, v208
    v_sub_f32 v95, v95, v208
    v_sub_f32 v63, v63, v208
    v_sub_f32 v160, v160, v208
    v_sub_f32 v96, v96, v208
    v_sub_f32 v64, v64, v208
    v_sub_f32 v161, v161, v208
    v_sub_f32 v97, v97, v208
    v_sub_f32 v65, v65, v208
    v_sub_f32 v162, v162, v208
    v_sub_f32 v98, v98, v208
    v_sub_f32 v66, v66, v208
    v_sub_f32 v163, v163, v208
    v_sub_f32 v99, v99, v208
    v_sub_f32 v67, v67, v208
    v_sub_f32 v164, v164, v208
    v_sub_f32 v100, v100, v208
    v_sub_f32 v68, v68, v208
    v_sub_f32 v165, v165, v208
    v_sub_f32 v101, v101, v208
    v_sub_f32 v69, v69, v208
    v_sub_f32 v166, v166, v208
    v_sub_f32 v102, v102, v208
    v_sub_f32 v70, v70, v208
    v_sub_f32 v167, v167, v208
    v_sub_f32 v103, v103, v208
    v_sub_f32 v71, v71, v208
    v_exp_f32 v30, v72
    v_exp_f32 v31, v73
    s_nop 0
    v_add_f32 v28, v30, v31
    v_cvt_pk_bf16_f32 v120, v30, v31
    v_exp_f32 v32, v74
    v_exp_f32 v33, v75
    v_add_f32 v28, v28, v32
    v_add_f32 v28, v28, v33
    v_cvt_pk_bf16_f32 v121, v32, v33
    v_exp_f32 v30, v76
    v_exp_f32 v31, v77
    v_add_f32 v28, v28, v30
    v_add_f32 v28, v28, v31
    v_cvt_pk_bf16_f32 v122, v30, v31
    v_exp_f32 v32, v78
    v_exp_f32 v33, v79
    v_add_f32 v28, v28, v32
    v_add_f32 v28, v28, v33
    v_cvt_pk_bf16_f32 v123, v32, v33
    v_exp_f32 v30, v80
    v_exp_f32 v31, v81
    v_add_f32 v28, v28, v30
    v_add_f32 v28, v28, v31
    v_cvt_pk_bf16_f32 v124, v30, v31
    v_exp_f32 v32, v82
    v_exp_f32 v33, v83
    v_add_f32 v28, v28, v32
    v_add_f32 v28, v28, v33
    v_cvt_pk_bf16_f32 v125, v32, v33
    v_exp_f32 v30, v84
    v_exp_f32 v31, v85
    v_add_f32 v28, v28, v30
    v_add_f32 v28, v28, v31
    v_cvt_pk_bf16_f32 v126, v30, v31
    v_exp_f32 v32, v86
    v_exp_f32 v33, v87
    v_add_f32 v28, v28, v32
    v_add_f32 v28, v28, v33
    v_cvt_pk_bf16_f32 v127, v32, v33
    v_exp_f32 v30, v88
    v_exp_f32 v31, v89
    s_nop 0
    v_add_f32 v29, v30, v31
    v_cvt_pk_bf16_f32 v128, v30, v31
    v_exp_f32 v32, v90
    v_exp_f32 v33, v91
    v_add_f32 v29, v29, v32
    v_add_f32 v29, v29, v33
    v_cvt_pk_bf16_f32 v129, v32, v33
    v_exp_f32 v30, v92
    v_exp_f32 v31, v93
    v_add_f32 v29, v29, v30
    v_add_f32 v29, v29, v31
    v_cvt_pk_bf16_f32 v130, v30, v31
    v_exp_f32 v32, v94
    v_exp_f32 v33, v95
    v_add_f32 v29, v29, v32
    v_add_f32 v29, v29, v33
    v_cvt_pk_bf16_f32 v131, v32, v33
    v_exp_f32 v30, v96
    v_exp_f32 v31, v97
    v_add_f32 v29, v29, v30
    v_add_f32 v29, v29, v31
    v_cvt_pk_bf16_f32 v132, v30, v31
    v_exp_f32 v32, v98
    v_exp_f32 v33, v99
    v_add_f32 v29, v29, v32
    v_add_f32 v29, v29, v33
    v_cvt_pk_bf16_f32 v133, v32, v33
    v_exp_f32 v30, v100
    v_exp_f32 v31, v101
    v_add_f32 v29, v29, v30
    v_add_f32 v29, v29, v31
    v_cvt_pk_bf16_f32 v134, v30, v31
    v_exp_f32 v32, v102
    v_exp_f32 v33, v103
    v_add_f32 v29, v29, v32
    v_add_f32 v29, v29, v33
    v_cvt_pk_bf16_f32 v135, v32, v33
    s_nop 1
    s_branch attn_kernel_ret4
attn_kernel_rare5:
    s_nop 15
    s_nop 15
    v_max3_f32 v208, v40, v41, v42
    v_max3_f32 v208, v208, v43, v44
    v_max3_f32 v208, v208, v45, v46
    v_max3_f32 v208, v208, v47, v48
    v_max3_f32 v208, v208, v49, v50
    v_max3_f32 v208, v208, v51, v52
    v_max3_f32 v208, v208, v53, v54
    v_max_f32 v208, v208, v55
    v_mov_b32 v209, v208
    s_nop 1
    v_permlane32_swap_b32 v209, v208
    s_nop 1
    v_max_f32 v208, v208, v209
    v_max_f32 v208, 0, v208
    v_sub_f32 v210, 0, v208
    v_exp_f32 v210, v210
    s_nop 0
    v_mul_f32 v26, v26, v210
    v_accvgpr_read_b32 v209, a0
    v_mul_f32 v209, v209, v210
    v_accvgpr_write_b32 a0, v209
    v_accvgpr_read_b32 v209, a1
    v_mul_f32 v209, v209, v210
    v_accvgpr_write_b32 a1, v209
    v_accvgpr_read_b32 v209, a2
    v_mul_f32 v209, v209, v210
    v_accvgpr_write_b32 a2, v209
    v_accvgpr_read_b32 v209, a3
    v_mul_f32 v209, v209, v210
    v_accvgpr_write_b32 a3, v209
    v_accvgpr_read_b32 v209, a4
    v_mul_f32 v209, v209, v210
    v_accvgpr_write_b32 a4, v209
    v_accvgpr_read_b32 v209, a5
    v_mul_f32 v209, v209, v210
    v_accvgpr_write_b32 a5, v209
    v_accvgpr_read_b32 v209, a6
    v_mul_f32 v209, v209, v210
    v_accvgpr_write_b32 a6, v209
    v_accvgpr_read_b32 v209, a7
    v_mul_f32 v209, v209, v210
    v_accvgpr_write_b32 a7, v209
    v_accvgpr_read_b32 v209, a8
    v_mul_f32 v209, v209, v210
    v_accvgpr_write_b32 a8, v209
    v_accvgpr_read_b32 v209, a9
    v_mul_f32 v209, v209, v210
    v_accvgpr_write_b32 a9, v209
    v_accvgpr_read_b32 v209, a10
    v_mul_f32 v209, v209, v210
    v_accvgpr_write_b32 a10, v209
    v_accvgpr_read_b32 v209, a11
    v_mul_f32 v209, v209, v210
    v_accvgpr_write_b32 a11, v209
    v_accvgpr_read_b32 v209, a12
    v_mul_f32 v209, v209, v210
    v_accvgpr_write_b32 a12, v209
    v_accvgpr_read_b32 v209, a13
    v_mul_f32 v209, v209, v210
    v_accvgpr_write_b32 a13, v209
    v_accvgpr_read_b32 v209, a14
    v_mul_f32 v209, v209, v210
    v_accvgpr_write_b32 a14, v209
    v_accvgpr_read_b32 v209, a15
    v_mul_f32 v209, v209, v210
    v_accvgpr_write_b32 a15, v209
    v_accvgpr_read_b32 v209, a16
    v_mul_f32 v209, v209, v210
    v_accvgpr_write_b32 a16, v209
    v_accvgpr_read_b32 v209, a17
    v_mul_f32 v209, v209, v210
    v_accvgpr_write_b32 a17, v209
    v_accvgpr_read_b32 v209, a18
    v_mul_f32 v209, v209, v210
    v_accvgpr_write_b32 a18, v209
    v_accvgpr_read_b32 v209, a19
    v_mul_f32 v209, v209, v210
    v_accvgpr_write_b32 a19, v209
    v_accvgpr_read_b32 v209, a20
    v_mul_f32 v209, v209, v210
    v_accvgpr_write_b32 a20, v209
    v_accvgpr_read_b32 v209, a21
    v_mul_f32 v209, v209, v210
    v_accvgpr_write_b32 a21, v209
    v_accvgpr_read_b32 v209, a22
    v_mul_f32 v209, v209, v210
    v_accvgpr_write_b32 a22, v209
    v_accvgpr_read_b32 v209, a23
    v_mul_f32 v209, v209, v210
    v_accvgpr_write_b32 a23, v209
    v_accvgpr_read_b32 v209, a24
    v_mul_f32 v209, v209, v210
    v_accvgpr_write_b32 a24, v209
    v_accvgpr_read_b32 v209, a25
    v_mul_f32 v209, v209, v210
    v_accvgpr_write_b32 a25, v209
    v_accvgpr_read_b32 v209, a26
    v_mul_f32 v209, v209, v210
    v_accvgpr_write_b32 a26, v209
    v_accvgpr_read_b32 v209, a27
    v_mul_f32 v209, v209, v210
    v_accvgpr_write_b32 a27, v209
    v_accvgpr_read_b32 v209, a28
    v_mul_f32 v209, v209, v210
    v_accvgpr_write_b32 a28, v209
    v_accvgpr_read_b32 v209, a29
    v_mul_f32 v209, v209, v210
    v_accvgpr_write_b32 a29, v209
    v_accvgpr_read_b32 v209, a30
    v_mul_f32 v209, v209, v210
    v_accvgpr_write_b32 a30, v209
    v_accvgpr_read_b32 v209, a31
    v_mul_f32 v209, v209, v210
    v_accvgpr_write_b32 a31, v209
    v_accvgpr_read_b32 v209, a32
    v_mul_f32 v209, v209, v210
    v_accvgpr_write_b32 a32, v209
    v_accvgpr_read_b32 v209, a33
    v_mul_f32 v209, v209, v210
    v_accvgpr_write_b32 a33, v209
    v_accvgpr_read_b32 v209, a34
    v_mul_f32 v209, v209, v210
    v_accvgpr_write_b32 a34, v209
    v_accvgpr_read_b32 v209, a35
    v_mul_f32 v209, v209, v210
    v_accvgpr_write_b32 a35, v209
    v_accvgpr_read_b32 v209, a36
    v_mul_f32 v209, v209, v210
    v_accvgpr_write_b32 a36, v209
    v_accvgpr_read_b32 v209, a37
    v_mul_f32 v209, v209, v210
    v_accvgpr_write_b32 a37, v209
    v_accvgpr_read_b32 v209, a38
    v_mul_f32 v209, v209, v210
    v_accvgpr_write_b32 a38, v209
    v_accvgpr_read_b32 v209, a39
    v_mul_f32 v209, v209, v210
    v_accvgpr_write_b32 a39, v209
    v_accvgpr_read_b32 v209, a40
    v_mul_f32 v209, v209, v210
    v_accvgpr_write_b32 a40, v209
    v_accvgpr_read_b32 v209, a41
    v_mul_f32 v209, v209, v210
    v_accvgpr_write_b32 a41, v209
    v_accvgpr_read_b32 v209, a42
    v_mul_f32 v209, v209, v210
    v_accvgpr_write_b32 a42, v209
    v_accvgpr_read_b32 v209, a43
    v_mul_f32 v209, v209, v210
    v_accvgpr_write_b32 a43, v209
    v_accvgpr_read_b32 v209, a44
    v_mul_f32 v209, v209, v210
    v_accvgpr_write_b32 a44, v209
    v_accvgpr_read_b32 v209, a45
    v_mul_f32 v209, v209, v210
    v_accvgpr_write_b32 a45, v209
    v_accvgpr_read_b32 v209, a46
    v_mul_f32 v209, v209, v210
    v_accvgpr_write_b32 a46, v209
    v_accvgpr_read_b32 v209, a47
    v_mul_f32 v209, v209, v210
    v_accvgpr_write_b32 a47, v209
    v_accvgpr_read_b32 v209, a48
    v_mul_f32 v209, v209, v210
    v_accvgpr_write_b32 a48, v209
    v_accvgpr_read_b32 v209, a49
    v_mul_f32 v209, v209, v210
    v_accvgpr_write_b32 a49, v209
    v_accvgpr_read_b32 v209, a50
    v_mul_f32 v209, v209, v210
    v_accvgpr_write_b32 a50, v209
    v_accvgpr_read_b32 v209, a51
    v_mul_f32 v209, v209, v210
    v_accvgpr_write_b32 a51, v209
    v_accvgpr_read_b32 v209, a52
    v_mul_f32 v209, v209, v210
    v_accvgpr_write_b32 a52, v209
    v_accvgpr_read_b32 v209, a53
    v_mul_f32 v209, v209, v210
    v_accvgpr_write_b32 a53, v209
    v_accvgpr_read_b32 v209, a54
    v_mul_f32 v209, v209, v210
    v_accvgpr_write_b32 a54, v209
    v_accvgpr_read_b32 v209, a55
    v_mul_f32 v209, v209, v210
    v_accvgpr_write_b32 a55, v209
    v_accvgpr_read_b32 v209, a56
    v_mul_f32 v209, v209, v210
    v_accvgpr_write_b32 a56, v209
    v_accvgpr_read_b32 v209, a57
    v_mul_f32 v209, v209, v210
    v_accvgpr_write_b32 a57, v209
    v_accvgpr_read_b32 v209, a58
    v_mul_f32 v209, v209, v210
    v_accvgpr_write_b32 a58, v209
    v_accvgpr_read_b32 v209, a59
    v_mul_f32 v209, v209, v210
    v_accvgpr_write_b32 a59, v209
    v_accvgpr_read_b32 v209, a60
    v_mul_f32 v209, v209, v210
    v_accvgpr_write_b32 a60, v209
    v_accvgpr_read_b32 v209, a61
    v_mul_f32 v209, v209, v210
    v_accvgpr_write_b32 a61, v209
    v_accvgpr_read_b32 v209, a62
    v_mul_f32 v209, v209, v210
    v_accvgpr_write_b32 a62, v209
    v_accvgpr_read_b32 v209, a63
    v_mul_f32 v209, v209, v210
    v_accvgpr_write_b32 a63, v209
    v_sub_f32 v136, v136, v208
    v_sub_f32 v40, v40, v208
    v_sub_f32 v72, v72, v208
    v_sub_f32 v137, v137, v208
    v_sub_f32 v41, v41, v208
    v_sub_f32 v73, v73, v208
    v_sub_f32 v138, v138, v208
    v_sub_f32 v42, v42, v208
    v_sub_f32 v74, v74, v208
    v_sub_f32 v139, v139, v208
    v_sub_f32 v43, v43, v208
    v_sub_f32 v75, v75, v208
    v_sub_f32 v140, v140, v208
    v_sub_f32 v44, v44, v208
    v_sub_f32 v76, v76, v208
    v_sub_f32 v141, v141, v208
    v_sub_f32 v45, v45, v208
    v_sub_f32 v77, v77, v208
    v_sub_f32 v142, v142, v208
    v_sub_f32 v46, v46, v208
    v_sub_f32 v78, v78, v208
    v_sub_f32 v143, v143, v208
    v_sub_f32 v47, v47, v208
    v_sub_f32 v79, v79, v208
    v_sub_f32 v144, v144, v208
    v_sub_f32 v48, v48, v208
    v_sub_f32 v80, v80, v208
    v_sub_f32 v145, v145, v208
    v_sub_f32 v49, v49, v208
    v_sub_f32 v81, v81, v208
    v_sub_f32 v146, v146, v208
    v_sub_f32 v50, v50, v208
    v_sub_f32 v82, v82, v208
    v_sub_f32 v147, v147, v208
    v_sub_f32 v51, v51, v208
    v_sub_f32 v83, v83, v208
    v_sub_f32 v148, v148, v208
    v_sub_f32 v52, v52, v208
    v_sub_f32 v84, v84, v208
    v_sub_f32 v149, v149, v208
    v_sub_f32 v53, v53, v208
    v_sub_f32 v85, v85, v208
    v_sub_f32 v150, v150, v208
    v_sub_f32 v54, v54, v208
    v_sub_f32 v86, v86, v208
    v_sub_f32 v151, v151, v208
    v_sub_f32 v55, v55, v208
    v_sub_f32 v87, v87, v208
    v_max3_f32 v208, v56, v57, v58
    v_max3_f32 v208, v208, v59, v60
    v_max3_f32 v208, v208, v61, v62
    v_max3_f32 v208, v208, v63, v64
    v_max3_f32 v208, v208, v65, v66
    v_max3_f32 v208, v208, v67, v68
    v_max3_f32 v208, v208, v69, v70
    v_max_f32 v208, v208, v71
    v_mov_b32 v209, v208
    s_nop 1
    v_permlane32_swap_b32 v209, v208
    s_nop 1
    v_max_f32 v208, v208, v209
    v_max_f32 v208, 0, v208
    v_sub_f32 v210, 0, v208
    v_exp_f32 v210, v210
    s_nop 0
    v_mul_f32 v27, v27, v210
    v_accvgpr_read_b32 v209, a64
    v_mul_f32 v209, v209, v210
    v_accvgpr_write_b32 a64, v209
    v_accvgpr_read_b32 v209, a65
    v_mul_f32 v209, v209, v210
    v_accvgpr_write_b32 a65, v209
    v_accvgpr_read_b32 v209, a66
    v_mul_f32 v209, v209, v210
    v_accvgpr_write_b32 a66, v209
    v_accvgpr_read_b32 v209, a67
    v_mul_f32 v209, v209, v210
    v_accvgpr_write_b32 a67, v209
    v_accvgpr_read_b32 v209, a68
    v_mul_f32 v209, v209, v210
    v_accvgpr_write_b32 a68, v209
    v_accvgpr_read_b32 v209, a69
    v_mul_f32 v209, v209, v210
    v_accvgpr_write_b32 a69, v209
    v_accvgpr_read_b32 v209, a70
    v_mul_f32 v209, v209, v210
    v_accvgpr_write_b32 a70, v209
    v_accvgpr_read_b32 v209, a71
    v_mul_f32 v209, v209, v210
    v_accvgpr_write_b32 a71, v209
    v_accvgpr_read_b32 v209, a72
    v_mul_f32 v209, v209, v210
    v_accvgpr_write_b32 a72, v209
    v_accvgpr_read_b32 v209, a73
    v_mul_f32 v209, v209, v210
    v_accvgpr_write_b32 a73, v209
    v_accvgpr_read_b32 v209, a74
    v_mul_f32 v209, v209, v210
    v_accvgpr_write_b32 a74, v209
    v_accvgpr_read_b32 v209, a75
    v_mul_f32 v209, v209, v210
    v_accvgpr_write_b32 a75, v209
    v_accvgpr_read_b32 v209, a76
    v_mul_f32 v209, v209, v210
    v_accvgpr_write_b32 a76, v209
    v_accvgpr_read_b32 v209, a77
    v_mul_f32 v209, v209, v210
    v_accvgpr_write_b32 a77, v209
    v_accvgpr_read_b32 v209, a78
    v_mul_f32 v209, v209, v210
    v_accvgpr_write_b32 a78, v209
    v_accvgpr_read_b32 v209, a79
    v_mul_f32 v209, v209, v210
    v_accvgpr_write_b32 a79, v209
    v_accvgpr_read_b32 v209, a80
    v_mul_f32 v209, v209, v210
    v_accvgpr_write_b32 a80, v209
    v_accvgpr_read_b32 v209, a81
    v_mul_f32 v209, v209, v210
    v_accvgpr_write_b32 a81, v209
    v_accvgpr_read_b32 v209, a82
    v_mul_f32 v209, v209, v210
    v_accvgpr_write_b32 a82, v209
    v_accvgpr_read_b32 v209, a83
    v_mul_f32 v209, v209, v210
    v_accvgpr_write_b32 a83, v209
    v_accvgpr_read_b32 v209, a84
    v_mul_f32 v209, v209, v210
    v_accvgpr_write_b32 a84, v209
    v_accvgpr_read_b32 v209, a85
    v_mul_f32 v209, v209, v210
    v_accvgpr_write_b32 a85, v209
    v_accvgpr_read_b32 v209, a86
    v_mul_f32 v209, v209, v210
    v_accvgpr_write_b32 a86, v209
    v_accvgpr_read_b32 v209, a87
    v_mul_f32 v209, v209, v210
    v_accvgpr_write_b32 a87, v209
    v_accvgpr_read_b32 v209, a88
    v_mul_f32 v209, v209, v210
    v_accvgpr_write_b32 a88, v209
    v_accvgpr_read_b32 v209, a89
    v_mul_f32 v209, v209, v210
    v_accvgpr_write_b32 a89, v209
    v_accvgpr_read_b32 v209, a90
    v_mul_f32 v209, v209, v210
    v_accvgpr_write_b32 a90, v209
    v_accvgpr_read_b32 v209, a91
    v_mul_f32 v209, v209, v210
    v_accvgpr_write_b32 a91, v209
    v_accvgpr_read_b32 v209, a92
    v_mul_f32 v209, v209, v210
    v_accvgpr_write_b32 a92, v209
    v_accvgpr_read_b32 v209, a93
    v_mul_f32 v209, v209, v210
    v_accvgpr_write_b32 a93, v209
    v_accvgpr_read_b32 v209, a94
    v_mul_f32 v209, v209, v210
    v_accvgpr_write_b32 a94, v209
    v_accvgpr_read_b32 v209, a95
    v_mul_f32 v209, v209, v210
    v_accvgpr_write_b32 a95, v209
    v_accvgpr_read_b32 v209, a96
    v_mul_f32 v209, v209, v210
    v_accvgpr_write_b32 a96, v209
    v_accvgpr_read_b32 v209, a97
    v_mul_f32 v209, v209, v210
    v_accvgpr_write_b32 a97, v209
    v_accvgpr_read_b32 v209, a98
    v_mul_f32 v209, v209, v210
    v_accvgpr_write_b32 a98, v209
    v_accvgpr_read_b32 v209, a99
    v_mul_f32 v209, v209, v210
    v_accvgpr_write_b32 a99, v209
    v_accvgpr_read_b32 v209, a100
    v_mul_f32 v209, v209, v210
    v_accvgpr_write_b32 a100, v209
    v_accvgpr_read_b32 v209, a101
    v_mul_f32 v209, v209, v210
    v_accvgpr_write_b32 a101, v209
    v_accvgpr_read_b32 v209, a102
    v_mul_f32 v209, v209, v210
    v_accvgpr_write_b32 a102, v209
    v_accvgpr_read_b32 v209, a103
    v_mul_f32 v209, v209, v210
    v_accvgpr_write_b32 a103, v209
    v_accvgpr_read_b32 v209, a104
    v_mul_f32 v209, v209, v210
    v_accvgpr_write_b32 a104, v209
    v_accvgpr_read_b32 v209, a105
    v_mul_f32 v209, v209, v210
    v_accvgpr_write_b32 a105, v209
    v_accvgpr_read_b32 v209, a106
    v_mul_f32 v209, v209, v210
    v_accvgpr_write_b32 a106, v209
    v_accvgpr_read_b32 v209, a107
    v_mul_f32 v209, v209, v210
    v_accvgpr_write_b32 a107, v209
    v_accvgpr_read_b32 v209, a108
    v_mul_f32 v209, v209, v210
    v_accvgpr_write_b32 a108, v209
    v_accvgpr_read_b32 v209, a109
    v_mul_f32 v209, v209, v210
    v_accvgpr_write_b32 a109, v209
    v_accvgpr_read_b32 v209, a110
    v_mul_f32 v209, v209, v210
    v_accvgpr_write_b32 a110, v209
    v_accvgpr_read_b32 v209, a111
    v_mul_f32 v209, v209, v210
    v_accvgpr_write_b32 a111, v209
    v_accvgpr_read_b32 v209, a112
    v_mul_f32 v209, v209, v210
    v_accvgpr_write_b32 a112, v209
    v_accvgpr_read_b32 v209, a113
    v_mul_f32 v209, v209, v210
    v_accvgpr_write_b32 a113, v209
    v_accvgpr_read_b32 v209, a114
    v_mul_f32 v209, v209, v210
    v_accvgpr_write_b32 a114, v209
    v_accvgpr_read_b32 v209, a115
    v_mul_f32 v209, v209, v210
    v_accvgpr_write_b32 a115, v209
    v_accvgpr_read_b32 v209, a116
    v_mul_f32 v209, v209, v210
    v_accvgpr_write_b32 a116, v209
    v_accvgpr_read_b32 v209, a117
    v_mul_f32 v209, v209, v210
    v_accvgpr_write_b32 a117, v209
    v_accvgpr_read_b32 v209, a118
    v_mul_f32 v209, v209, v210
    v_accvgpr_write_b32 a118, v209
    v_accvgpr_read_b32 v209, a119
    v_mul_f32 v209, v209, v210
    v_accvgpr_write_b32 a119, v209
    v_accvgpr_read_b32 v209, a120
    v_mul_f32 v209, v209, v210
    v_accvgpr_write_b32 a120, v209
    v_accvgpr_read_b32 v209, a121
    v_mul_f32 v209, v209, v210
    v_accvgpr_write_b32 a121, v209
    v_accvgpr_read_b32 v209, a122
    v_mul_f32 v209, v209, v210
    v_accvgpr_write_b32 a122, v209
    v_accvgpr_read_b32 v209, a123
    v_mul_f32 v209, v209, v210
    v_accvgpr_write_b32 a123, v209
    v_accvgpr_read_b32 v209, a124
    v_mul_f32 v209, v209, v210
    v_accvgpr_write_b32 a124, v209
    v_accvgpr_read_b32 v209, a125
    v_mul_f32 v209, v209, v210
    v_accvgpr_write_b32 a125, v209
    v_accvgpr_read_b32 v209, a126
    v_mul_f32 v209, v209, v210
    v_accvgpr_write_b32 a126, v209
    v_accvgpr_read_b32 v209, a127
    v_mul_f32 v209, v209, v210
    v_accvgpr_write_b32 a127, v209
    v_sub_f32 v152, v152, v208
    v_sub_f32 v56, v56, v208
    v_sub_f32 v88, v88, v208
    v_sub_f32 v153, v153, v208
    v_sub_f32 v57, v57, v208
    v_sub_f32 v89, v89, v208
    v_sub_f32 v154, v154, v208
    v_sub_f32 v58, v58, v208
    v_sub_f32 v90, v90, v208
    v_sub_f32 v155, v155, v208
    v_sub_f32 v59, v59, v208
    v_sub_f32 v91, v91, v208
    v_sub_f32 v156, v156, v208
    v_sub_f32 v60, v60, v208
    v_sub_f32 v92, v92, v208
    v_sub_f32 v157, v157, v208
    v_sub_f32 v61, v61, v208
    v_sub_f32 v93, v93, v208
    v_sub_f32 v158, v158, v208
    v_sub_f32 v62, v62, v208
    v_sub_f32 v94, v94, v208
    v_sub_f32 v159, v159, v208
    v_sub_f32 v63, v63, v208
    v_sub_f32 v95, v95, v208
    v_sub_f32 v160, v160, v208
    v_sub_f32 v64, v64, v208
    v_sub_f32 v96, v96, v208
    v_sub_f32 v161, v161, v208
    v_sub_f32 v65, v65, v208
    v_sub_f32 v97, v97, v208
    v_sub_f32 v162, v162, v208
    v_sub_f32 v66, v66, v208
    v_sub_f32 v98, v98, v208
    v_sub_f32 v163, v163, v208
    v_sub_f32 v67, v67, v208
    v_sub_f32 v99, v99, v208
    v_sub_f32 v164, v164, v208
    v_sub_f32 v68, v68, v208
    v_sub_f32 v100, v100, v208
    v_sub_f32 v165, v165, v208
    v_sub_f32 v69, v69, v208
    v_sub_f32 v101, v101, v208
    v_sub_f32 v166, v166, v208
    v_sub_f32 v70, v70, v208
    v_sub_f32 v102, v102, v208
    v_sub_f32 v167, v167, v208
    v_sub_f32 v71, v71, v208
    v_sub_f32 v103, v103, v208
    v_exp_f32 v30, v40
    v_exp_f32 v31, v41
    s_nop 0
    v_add_f32 v28, v30, v31
    v_cvt_pk_bf16_f32 v104, v30, v31
    v_exp_f32 v32, v42
    v_exp_f32 v33, v43
    v_add_f32 v28, v28, v32
    v_add_f32 v28, v28, v33
    v_cvt_pk_bf16_f32 v105, v32, v33
    v_exp_f32 v30, v44
    v_exp_f32 v31, v45
    v_add_f32 v28, v28, v30
    v_add_f32 v28, v28, v31
    v_cvt_pk_bf16_f32 v106, v30, v31
    v_exp_f32 v32, v46
    v_exp_f32 v33, v47
    v_add_f32 v28, v28, v32
    v_add_f32 v28, v28, v33
    v_cvt_pk_bf16_f32 v107, v32, v33
    v_exp_f32 v30, v48
    v_exp_f32 v31, v49
    v_add_f32 v28, v28, v30
    v_add_f32 v28, v28, v31
    v_cvt_pk_bf16_f32 v108, v30, v31
    v_exp_f32 v32, v50
    v_exp_f32 v33, v51
    v_add_f32 v28, v28, v32
    v_add_f32 v28, v28, v33
    v_cvt_pk_bf16_f32 v109, v32, v33
    v_exp_f32 v30, v52
    v_exp_f32 v31, v53
    v_add_f32 v28, v28, v30
    v_add_f32 v28, v28, v31
    v_cvt_pk_bf16_f32 v110, v30, v31
    v_exp_f32 v32, v54
    v_exp_f32 v33, v55
    v_add_f32 v28, v28, v32
    v_add_f32 v28, v28, v33
    v_cvt_pk_bf16_f32 v111, v32, v33
    v_exp_f32 v30, v56
    v_exp_f32 v31, v57
    s_nop 0
    v_add_f32 v29, v30, v31
    v_cvt_pk_bf16_f32 v112, v30, v31
    v_exp_f32 v32, v58
    v_exp_f32 v33, v59
    v_add_f32 v29, v29, v32
    v_add_f32 v29, v29, v33
    v_cvt_pk_bf16_f32 v113, v32, v33
    v_exp_f32 v30, v60
    v_exp_f32 v31, v61
    v_add_f32 v29, v29, v30
    v_add_f32 v29, v29, v31
    v_cvt_pk_bf16_f32 v114, v30, v31
    v_exp_f32 v32, v62
    v_exp_f32 v33, v63
    v_add_f32 v29, v29, v32
    v_add_f32 v29, v29, v33
    v_cvt_pk_bf16_f32 v115, v32, v33
    v_exp_f32 v30, v64
    v_exp_f32 v31, v65
    v_add_f32 v29, v29, v30
    v_add_f32 v29, v29, v31
    v_cvt_pk_bf16_f32 v116, v30, v31
    v_exp_f32 v32, v66
    v_exp_f32 v33, v67
    v_add_f32 v29, v29, v32
    v_add_f32 v29, v29, v33
    v_cvt_pk_bf16_f32 v117, v32, v33
    v_exp_f32 v30, v68
    v_exp_f32 v31, v69
    v_add_f32 v29, v29, v30
    v_add_f32 v29, v29, v31
    v_cvt_pk_bf16_f32 v118, v30, v31
    v_exp_f32 v32, v70
    v_exp_f32 v33, v71
    v_add_f32 v29, v29, v32
    v_add_f32 v29, v29, v33
    v_cvt_pk_bf16_f32 v119, v32, v33
    s_nop 1
    s_branch attn_kernel_ret6
attn_kernel_rare7:
    s_nop 15
    s_nop 15
    v_max3_f32 v208, v72, v73, v74
    v_max3_f32 v208, v208, v75, v76
    v_max3_f32 v208, v208, v77, v78
    v_max3_f32 v208, v208, v79, v80
    v_max3_f32 v208, v208, v81, v82
    v_max3_f32 v208, v208, v83, v84
    v_max3_f32 v208, v208, v85, v86
    v_max_f32 v208, v208, v87
    v_mov_b32 v209, v208
    s_nop 1
    v_permlane32_swap_b32 v209, v208
    s_nop 1
    v_max_f32 v208, v208, v209
    v_max_f32 v208, 0, v208
    v_sub_f32 v210, 0, v208
    v_exp_f32 v210, v210
    s_nop 0
    v_mul_f32 v26, v26, v210
    v_accvgpr_read_b32 v209, a0
    v_mul_f32 v209, v209, v210
    v_accvgpr_write_b32 a0, v209
    v_accvgpr_read_b32 v209, a1
    v_mul_f32 v209, v209, v210
    v_accvgpr_write_b32 a1, v209
    v_accvgpr_read_b32 v209, a2
    v_mul_f32 v209, v209, v210
    v_accvgpr_write_b32 a2, v209
    v_accvgpr_read_b32 v209, a3
    v_mul_f32 v209, v209, v210
    v_accvgpr_write_b32 a3, v209
    v_accvgpr_read_b32 v209, a4
    v_mul_f32 v209, v209, v210
    v_accvgpr_write_b32 a4, v209
    v_accvgpr_read_b32 v209, a5
    v_mul_f32 v209, v209, v210
    v_accvgpr_write_b32 a5, v209
    v_accvgpr_read_b32 v209, a6
    v_mul_f32 v209, v209, v210
    v_accvgpr_write_b32 a6, v209
    v_accvgpr_read_b32 v209, a7
    v_mul_f32 v209, v209, v210
    v_accvgpr_write_b32 a7, v209
    v_accvgpr_read_b32 v209, a8
    v_mul_f32 v209, v209, v210
    v_accvgpr_write_b32 a8, v209
    v_accvgpr_read_b32 v209, a9
    v_mul_f32 v209, v209, v210
    v_accvgpr_write_b32 a9, v209
    v_accvgpr_read_b32 v209, a10
    v_mul_f32 v209, v209, v210
    v_accvgpr_write_b32 a10, v209
    v_accvgpr_read_b32 v209, a11
    v_mul_f32 v209, v209, v210
    v_accvgpr_write_b32 a11, v209
    v_accvgpr_read_b32 v209, a12
    v_mul_f32 v209, v209, v210
    v_accvgpr_write_b32 a12, v209
    v_accvgpr_read_b32 v209, a13
    v_mul_f32 v209, v209, v210
    v_accvgpr_write_b32 a13, v209
    v_accvgpr_read_b32 v209, a14
    v_mul_f32 v209, v209, v210
    v_accvgpr_write_b32 a14, v209
    v_accvgpr_read_b32 v209, a15
    v_mul_f32 v209, v209, v210
    v_accvgpr_write_b32 a15, v209
    v_accvgpr_read_b32 v209, a16
    v_mul_f32 v209, v209, v210
    v_accvgpr_write_b32 a16, v209
    v_accvgpr_read_b32 v209, a17
    v_mul_f32 v209, v209, v210
    v_accvgpr_write_b32 a17, v209
    v_accvgpr_read_b32 v209, a18
    v_mul_f32 v209, v209, v210
    v_accvgpr_write_b32 a18, v209
    v_accvgpr_read_b32 v209, a19
    v_mul_f32 v209, v209, v210
    v_accvgpr_write_b32 a19, v209
    v_accvgpr_read_b32 v209, a20
    v_mul_f32 v209, v209, v210
    v_accvgpr_write_b32 a20, v209
    v_accvgpr_read_b32 v209, a21
    v_mul_f32 v209, v209, v210
    v_accvgpr_write_b32 a21, v209
    v_accvgpr_read_b32 v209, a22
    v_mul_f32 v209, v209, v210
    v_accvgpr_write_b32 a22, v209
    v_accvgpr_read_b32 v209, a23
    v_mul_f32 v209, v209, v210
    v_accvgpr_write_b32 a23, v209
    v_accvgpr_read_b32 v209, a24
    v_mul_f32 v209, v209, v210
    v_accvgpr_write_b32 a24, v209
    v_accvgpr_read_b32 v209, a25
    v_mul_f32 v209, v209, v210
    v_accvgpr_write_b32 a25, v209
    v_accvgpr_read_b32 v209, a26
    v_mul_f32 v209, v209, v210
    v_accvgpr_write_b32 a26, v209
    v_accvgpr_read_b32 v209, a27
    v_mul_f32 v209, v209, v210
    v_accvgpr_write_b32 a27, v209
    v_accvgpr_read_b32 v209, a28
    v_mul_f32 v209, v209, v210
    v_accvgpr_write_b32 a28, v209
    v_accvgpr_read_b32 v209, a29
    v_mul_f32 v209, v209, v210
    v_accvgpr_write_b32 a29, v209
    v_accvgpr_read_b32 v209, a30
    v_mul_f32 v209, v209, v210
    v_accvgpr_write_b32 a30, v209
    v_accvgpr_read_b32 v209, a31
    v_mul_f32 v209, v209, v210
    v_accvgpr_write_b32 a31, v209
    v_accvgpr_read_b32 v209, a32
    v_mul_f32 v209, v209, v210
    v_accvgpr_write_b32 a32, v209
    v_accvgpr_read_b32 v209, a33
    v_mul_f32 v209, v209, v210
    v_accvgpr_write_b32 a33, v209
    v_accvgpr_read_b32 v209, a34
    v_mul_f32 v209, v209, v210
    v_accvgpr_write_b32 a34, v209
    v_accvgpr_read_b32 v209, a35
    v_mul_f32 v209, v209, v210
    v_accvgpr_write_b32 a35, v209
    v_accvgpr_read_b32 v209, a36
    v_mul_f32 v209, v209, v210
    v_accvgpr_write_b32 a36, v209
    v_accvgpr_read_b32 v209, a37
    v_mul_f32 v209, v209, v210
    v_accvgpr_write_b32 a37, v209
    v_accvgpr_read_b32 v209, a38
    v_mul_f32 v209, v209, v210
    v_accvgpr_write_b32 a38, v209
    v_accvgpr_read_b32 v209, a39
    v_mul_f32 v209, v209, v210
    v_accvgpr_write_b32 a39, v209
    v_accvgpr_read_b32 v209, a40
    v_mul_f32 v209, v209, v210
    v_accvgpr_write_b32 a40, v209
    v_accvgpr_read_b32 v209, a41
    v_mul_f32 v209, v209, v210
    v_accvgpr_write_b32 a41, v209
    v_accvgpr_read_b32 v209, a42
    v_mul_f32 v209, v209, v210
    v_accvgpr_write_b32 a42, v209
    v_accvgpr_read_b32 v209, a43
    v_mul_f32 v209, v209, v210
    v_accvgpr_write_b32 a43, v209
    v_accvgpr_read_b32 v209, a44
    v_mul_f32 v209, v209, v210
    v_accvgpr_write_b32 a44, v209
    v_accvgpr_read_b32 v209, a45
    v_mul_f32 v209, v209, v210
    v_accvgpr_write_b32 a45, v209
    v_accvgpr_read_b32 v209, a46
    v_mul_f32 v209, v209, v210
    v_accvgpr_write_b32 a46, v209
    v_accvgpr_read_b32 v209, a47
    v_mul_f32 v209, v209, v210
    v_accvgpr_write_b32 a47, v209
    v_accvgpr_read_b32 v209, a48
    v_mul_f32 v209, v209, v210
    v_accvgpr_write_b32 a48, v209
    v_accvgpr_read_b32 v209, a49
    v_mul_f32 v209, v209, v210
    v_accvgpr_write_b32 a49, v209
    v_accvgpr_read_b32 v209, a50
    v_mul_f32 v209, v209, v210
    v_accvgpr_write_b32 a50, v209
    v_accvgpr_read_b32 v209, a51
    v_mul_f32 v209, v209, v210
    v_accvgpr_write_b32 a51, v209
    v_accvgpr_read_b32 v209, a52
    v_mul_f32 v209, v209, v210
    v_accvgpr_write_b32 a52, v209
    v_accvgpr_read_b32 v209, a53
    v_mul_f32 v209, v209, v210
    v_accvgpr_write_b32 a53, v209
    v_accvgpr_read_b32 v209, a54
    v_mul_f32 v209, v209, v210
    v_accvgpr_write_b32 a54, v209
    v_accvgpr_read_b32 v209, a55
    v_mul_f32 v209, v209, v210
    v_accvgpr_write_b32 a55, v209
    v_accvgpr_read_b32 v209, a56
    v_mul_f32 v209, v209, v210
    v_accvgpr_write_b32 a56, v209
    v_accvgpr_read_b32 v209, a57
    v_mul_f32 v209, v209, v210
    v_accvgpr_write_b32 a57, v209
    v_accvgpr_read_b32 v209, a58
    v_mul_f32 v209, v209, v210
    v_accvgpr_write_b32 a58, v209
    v_accvgpr_read_b32 v209, a59
    v_mul_f32 v209, v209, v210
    v_accvgpr_write_b32 a59, v209
    v_accvgpr_read_b32 v209, a60
    v_mul_f32 v209, v209, v210
    v_accvgpr_write_b32 a60, v209
    v_accvgpr_read_b32 v209, a61
    v_mul_f32 v209, v209, v210
    v_accvgpr_write_b32 a61, v209
    v_accvgpr_read_b32 v209, a62
    v_mul_f32 v209, v209, v210
    v_accvgpr_write_b32 a62, v209
    v_accvgpr_read_b32 v209, a63
    v_mul_f32 v209, v209, v210
    v_accvgpr_write_b32 a63, v209
    v_sub_f32 v136, v136, v208
    v_sub_f32 v72, v72, v208
    v_sub_f32 v40, v40, v208
    v_sub_f32 v137, v137, v208
    v_sub_f32 v73, v73, v208
    v_sub_f32 v41, v41, v208
    v_sub_f32 v138, v138, v208
    v_sub_f32 v74, v74, v208
    v_sub_f32 v42, v42, v208
    v_sub_f32 v139, v139, v208
    v_sub_f32 v75, v75, v208
    v_sub_f32 v43, v43, v208
    v_sub_f32 v140, v140, v208
    v_sub_f32 v76, v76, v208
    v_sub_f32 v44, v44, v208
    v_sub_f32 v141, v141, v208
    v_sub_f32 v77, v77, v208
    v_sub_f32 v45, v45, v208
    v_sub_f32 v142, v142, v208
    v_sub_f32 v78, v78, v208
    v_sub_f32 v46, v46, v208
    v_sub_f32 v143, v143, v208
    v_sub_f32 v79, v79, v208
    v_sub_f32 v47, v47, v208
    v_sub_f32 v144, v144, v208
    v_sub_f32 v80, v80, v208
    v_sub_f32 v48, v48, v208
    v_sub_f32 v145, v145, v208
    v_sub_f32 v81, v81, v208
    v_sub_f32 v49, v49, v208
    v_sub_f32 v146, v146, v208
    v_sub_f32 v82, v82, v208
    v_sub_f32 v50, v50, v208
    v_sub_f32 v147, v147, v208
    v_sub_f32 v83, v83, v208
    v_sub_f32 v51, v51, v208
    v_sub_f32 v148, v148, v208
    v_sub_f32 v84, v84, v208
    v_sub_f32 v52, v52, v208
    v_sub_f32 v149, v149, v208
    v_sub_f32 v85, v85, v208
    v_sub_f32 v53, v53, v208
    v_sub_f32 v150, v150, v208
    v_sub_f32 v86, v86, v208
    v_sub_f32 v54, v54, v208
    v_sub_f32 v151, v151, v208
    v_sub_f32 v87, v87, v208
    v_sub_f32 v55, v55, v208
    v_max3_f32 v208, v88, v89, v90
    v_max3_f32 v208, v208, v91, v92
    v_max3_f32 v208, v208, v93, v94
    v_max3_f32 v208, v208, v95, v96
    v_max3_f32 v208, v208, v97, v98
    v_max3_f32 v208, v208, v99, v100
    v_max3_f32 v208, v208, v101, v102
    v_max_f32 v208, v208, v103
    v_mov_b32 v209, v208
    s_nop 1
    v_permlane32_swap_b32 v209, v208
    s_nop 1
    v_max_f32 v208, v208, v209
    v_max_f32 v208, 0, v208
    v_sub_f32 v210, 0, v208
    v_exp_f32 v210, v210
    s_nop 0
    v_mul_f32 v27, v27, v210
    v_accvgpr_read_b32 v209, a64
    v_mul_f32 v209, v209, v210
    v_accvgpr_write_b32 a64, v209
    v_accvgpr_read_b32 v209, a65
    v_mul_f32 v209, v209, v210
    v_accvgpr_write_b32 a65, v209
    v_accvgpr_read_b32 v209, a66
    v_mul_f32 v209, v209, v210
    v_accvgpr_write_b32 a66, v209
    v_accvgpr_read_b32 v209, a67
    v_mul_f32 v209, v209, v210
    v_accvgpr_write_b32 a67, v209
    v_accvgpr_read_b32 v209, a68
    v_mul_f32 v209, v209, v210
    v_accvgpr_write_b32 a68, v209
    v_accvgpr_read_b32 v209, a69
    v_mul_f32 v209, v209, v210
    v_accvgpr_write_b32 a69, v209
    v_accvgpr_read_b32 v209, a70
    v_mul_f32 v209, v209, v210
    v_accvgpr_write_b32 a70, v209
    v_accvgpr_read_b32 v209, a71
    v_mul_f32 v209, v209, v210
    v_accvgpr_write_b32 a71, v209
    v_accvgpr_read_b32 v209, a72
    v_mul_f32 v209, v209, v210
    v_accvgpr_write_b32 a72, v209
    v_accvgpr_read_b32 v209, a73
    v_mul_f32 v209, v209, v210
    v_accvgpr_write_b32 a73, v209
    v_accvgpr_read_b32 v209, a74
    v_mul_f32 v209, v209, v210
    v_accvgpr_write_b32 a74, v209
    v_accvgpr_read_b32 v209, a75
    v_mul_f32 v209, v209, v210
    v_accvgpr_write_b32 a75, v209
    v_accvgpr_read_b32 v209, a76
    v_mul_f32 v209, v209, v210
    v_accvgpr_write_b32 a76, v209
    v_accvgpr_read_b32 v209, a77
    v_mul_f32 v209, v209, v210
    v_accvgpr_write_b32 a77, v209
    v_accvgpr_read_b32 v209, a78
    v_mul_f32 v209, v209, v210
    v_accvgpr_write_b32 a78, v209
    v_accvgpr_read_b32 v209, a79
    v_mul_f32 v209, v209, v210
    v_accvgpr_write_b32 a79, v209
    v_accvgpr_read_b32 v209, a80
    v_mul_f32 v209, v209, v210
    v_accvgpr_write_b32 a80, v209
    v_accvgpr_read_b32 v209, a81
    v_mul_f32 v209, v209, v210
    v_accvgpr_write_b32 a81, v209
    v_accvgpr_read_b32 v209, a82
    v_mul_f32 v209, v209, v210
    v_accvgpr_write_b32 a82, v209
    v_accvgpr_read_b32 v209, a83
    v_mul_f32 v209, v209, v210
    v_accvgpr_write_b32 a83, v209
    v_accvgpr_read_b32 v209, a84
    v_mul_f32 v209, v209, v210
    v_accvgpr_write_b32 a84, v209
    v_accvgpr_read_b32 v209, a85
    v_mul_f32 v209, v209, v210
    v_accvgpr_write_b32 a85, v209
    v_accvgpr_read_b32 v209, a86
    v_mul_f32 v209, v209, v210
    v_accvgpr_write_b32 a86, v209
    v_accvgpr_read_b32 v209, a87
    v_mul_f32 v209, v209, v210
    v_accvgpr_write_b32 a87, v209
    v_accvgpr_read_b32 v209, a88
    v_mul_f32 v209, v209, v210
    v_accvgpr_write_b32 a88, v209
    v_accvgpr_read_b32 v209, a89
    v_mul_f32 v209, v209, v210
    v_accvgpr_write_b32 a89, v209
    v_accvgpr_read_b32 v209, a90
    v_mul_f32 v209, v209, v210
    v_accvgpr_write_b32 a90, v209
    v_accvgpr_read_b32 v209, a91
    v_mul_f32 v209, v209, v210
    v_accvgpr_write_b32 a91, v209
    v_accvgpr_read_b32 v209, a92
    v_mul_f32 v209, v209, v210
    v_accvgpr_write_b32 a92, v209
    v_accvgpr_read_b32 v209, a93
    v_mul_f32 v209, v209, v210
    v_accvgpr_write_b32 a93, v209
    v_accvgpr_read_b32 v209, a94
    v_mul_f32 v209, v209, v210
    v_accvgpr_write_b32 a94, v209
    v_accvgpr_read_b32 v209, a95
    v_mul_f32 v209, v209, v210
    v_accvgpr_write_b32 a95, v209
    v_accvgpr_read_b32 v209, a96
    v_mul_f32 v209, v209, v210
    v_accvgpr_write_b32 a96, v209
    v_accvgpr_read_b32 v209, a97
    v_mul_f32 v209, v209, v210
    v_accvgpr_write_b32 a97, v209
    v_accvgpr_read_b32 v209, a98
    v_mul_f32 v209, v209, v210
    v_accvgpr_write_b32 a98, v209
    v_accvgpr_read_b32 v209, a99
    v_mul_f32 v209, v209, v210
    v_accvgpr_write_b32 a99, v209
    v_accvgpr_read_b32 v209, a100
    v_mul_f32 v209, v209, v210
    v_accvgpr_write_b32 a100, v209
    v_accvgpr_read_b32 v209, a101
    v_mul_f32 v209, v209, v210
    v_accvgpr_write_b32 a101, v209
    v_accvgpr_read_b32 v209, a102
    v_mul_f32 v209, v209, v210
    v_accvgpr_write_b32 a102, v209
    v_accvgpr_read_b32 v209, a103
    v_mul_f32 v209, v209, v210
    v_accvgpr_write_b32 a103, v209
    v_accvgpr_read_b32 v209, a104
    v_mul_f32 v209, v209, v210
    v_accvgpr_write_b32 a104, v209
    v_accvgpr_read_b32 v209, a105
    v_mul_f32 v209, v209, v210
    v_accvgpr_write_b32 a105, v209
    v_accvgpr_read_b32 v209, a106
    v_mul_f32 v209, v209, v210
    v_accvgpr_write_b32 a106, v209
    v_accvgpr_read_b32 v209, a107
    v_mul_f32 v209, v209, v210
    v_accvgpr_write_b32 a107, v209
    v_accvgpr_read_b32 v209, a108
    v_mul_f32 v209, v209, v210
    v_accvgpr_write_b32 a108, v209
    v_accvgpr_read_b32 v209, a109
    v_mul_f32 v209, v209, v210
    v_accvgpr_write_b32 a109, v209
    v_accvgpr_read_b32 v209, a110
    v_mul_f32 v209, v209, v210
    v_accvgpr_write_b32 a110, v209
    v_accvgpr_read_b32 v209, a111
    v_mul_f32 v209, v209, v210
    v_accvgpr_write_b32 a111, v209
    v_accvgpr_read_b32 v209, a112
    v_mul_f32 v209, v209, v210
    v_accvgpr_write_b32 a112, v209
    v_accvgpr_read_b32 v209, a113
    v_mul_f32 v209, v209, v210
    v_accvgpr_write_b32 a113, v209
    v_accvgpr_read_b32 v209, a114
    v_mul_f32 v209, v209, v210
    v_accvgpr_write_b32 a114, v209
    v_accvgpr_read_b32 v209, a115
    v_mul_f32 v209, v209, v210
    v_accvgpr_write_b32 a115, v209
    v_accvgpr_read_b32 v209, a116
    v_mul_f32 v209, v209, v210
    v_accvgpr_write_b32 a116, v209
    v_accvgpr_read_b32 v209, a117
    v_mul_f32 v209, v209, v210
    v_accvgpr_write_b32 a117, v209
    v_accvgpr_read_b32 v209, a118
    v_mul_f32 v209, v209, v210
    v_accvgpr_write_b32 a118, v209
    v_accvgpr_read_b32 v209, a119
    v_mul_f32 v209, v209, v210
    v_accvgpr_write_b32 a119, v209
    v_accvgpr_read_b32 v209, a120
    v_mul_f32 v209, v209, v210
    v_accvgpr_write_b32 a120, v209
    v_accvgpr_read_b32 v209, a121
    v_mul_f32 v209, v209, v210
    v_accvgpr_write_b32 a121, v209
    v_accvgpr_read_b32 v209, a122
    v_mul_f32 v209, v209, v210
    v_accvgpr_write_b32 a122, v209
    v_accvgpr_read_b32 v209, a123
    v_mul_f32 v209, v209, v210
    v_accvgpr_write_b32 a123, v209
    v_accvgpr_read_b32 v209, a124
    v_mul_f32 v209, v209, v210
    v_accvgpr_write_b32 a124, v209
    v_accvgpr_read_b32 v209, a125
    v_mul_f32 v209, v209, v210
    v_accvgpr_write_b32 a125, v209
    v_accvgpr_read_b32 v209, a126
    v_mul_f32 v209, v209, v210
    v_accvgpr_write_b32 a126, v209
    v_accvgpr_read_b32 v209, a127
    v_mul_f32 v209, v209, v210
    v_accvgpr_write_b32 a127, v209
    v_sub_f32 v152, v152, v208
    v_sub_f32 v88, v88, v208
    v_sub_f32 v56, v56, v208
    v_sub_f32 v153, v153, v208
    v_sub_f32 v89, v89, v208
    v_sub_f32 v57, v57, v208
    v_sub_f32 v154, v154, v208
    v_sub_f32 v90, v90, v208
    v_sub_f32 v58, v58, v208
    v_sub_f32 v155, v155, v208
    v_sub_f32 v91, v91, v208
    v_sub_f32 v59, v59, v208
    v_sub_f32 v156, v156, v208
    v_sub_f32 v92, v92, v208
    v_sub_f32 v60, v60, v208
    v_sub_f32 v157, v157, v208
    v_sub_f32 v93, v93, v208
    v_sub_f32 v61, v61, v208
    v_sub_f32 v158, v158, v208
    v_sub_f32 v94, v94, v208
    v_sub_f32 v62, v62, v208
    v_sub_f32 v159, v159, v208
    v_sub_f32 v95, v95, v208
    v_sub_f32 v63, v63, v208
    v_sub_f32 v160, v160, v208
    v_sub_f32 v96, v96, v208
    v_sub_f32 v64, v64, v208
    v_sub_f32 v161, v161, v208
    v_sub_f32 v97, v97, v208
    v_sub_f32 v65, v65, v208
    v_sub_f32 v162, v162, v208
    v_sub_f32 v98, v98, v208
    v_sub_f32 v66, v66, v208
    v_sub_f32 v163, v163, v208
    v_sub_f32 v99, v99, v208
    v_sub_f32 v67, v67, v208
    v_sub_f32 v164, v164, v208
    v_sub_f32 v100, v100, v208
    v_sub_f32 v68, v68, v208
    v_sub_f32 v165, v165, v208
    v_sub_f32 v101, v101, v208
    v_sub_f32 v69, v69, v208
    v_sub_f32 v166, v166, v208
    v_sub_f32 v102, v102, v208
    v_sub_f32 v70, v70, v208
    v_sub_f32 v167, v167, v208
    v_sub_f32 v103, v103, v208
    v_sub_f32 v71, v71, v208
    v_exp_f32 v30, v72
    v_exp_f32 v31, v73
    s_nop 0
    v_add_f32 v28, v30, v31
    v_cvt_pk_bf16_f32 v120, v30, v31
    v_exp_f32 v32, v74
    v_exp_f32 v33, v75
    v_add_f32 v28, v28, v32
    v_add_f32 v28, v28, v33
    v_cvt_pk_bf16_f32 v121, v32, v33
    v_exp_f32 v30, v76
    v_exp_f32 v31, v77
    v_add_f32 v28, v28, v30
    v_add_f32 v28, v28, v31
    v_cvt_pk_bf16_f32 v122, v30, v31
    v_exp_f32 v32, v78
    v_exp_f32 v33, v79
    v_add_f32 v28, v28, v32
    v_add_f32 v28, v28, v33
    v_cvt_pk_bf16_f32 v123, v32, v33
    v_exp_f32 v30, v80
    v_exp_f32 v31, v81
    v_add_f32 v28, v28, v30
    v_add_f32 v28, v28, v31
    v_cvt_pk_bf16_f32 v124, v30, v31
    v_exp_f32 v32, v82
    v_exp_f32 v33, v83
    v_add_f32 v28, v28, v32
    v_add_f32 v28, v28, v33
    v_cvt_pk_bf16_f32 v125, v32, v33
    v_exp_f32 v30, v84
    v_exp_f32 v31, v85
    v_add_f32 v28, v28, v30
    v_add_f32 v28, v28, v31
    v_cvt_pk_bf16_f32 v126, v30, v31
    v_exp_f32 v32, v86
    v_exp_f32 v33, v87
    v_add_f32 v28, v28, v32
    v_add_f32 v28, v28, v33
    v_cvt_pk_bf16_f32 v127, v32, v33
    v_exp_f32 v30, v88
    v_exp_f32 v31, v89
    s_nop 0
    v_add_f32 v29, v30, v31
    v_cvt_pk_bf16_f32 v128, v30, v31
    v_exp_f32 v32, v90
    v_exp_f32 v33, v91
    v_add_f32 v29, v29, v32
    v_add_f32 v29, v29, v33
    v_cvt_pk_bf16_f32 v129, v32, v33
    v_exp_f32 v30, v92
    v_exp_f32 v31, v93
    v_add_f32 v29, v29, v30
    v_add_f32 v29, v29, v31
    v_cvt_pk_bf16_f32 v130, v30, v31
    v_exp_f32 v32, v94
    v_exp_f32 v33, v95
    v_add_f32 v29, v29, v32
    v_add_f32 v29, v29, v33
    v_cvt_pk_bf16_f32 v131, v32, v33
    v_exp_f32 v30, v96
    v_exp_f32 v31, v97
    v_add_f32 v29, v29, v30
    v_add_f32 v29, v29, v31
    v_cvt_pk_bf16_f32 v132, v30, v31
    v_exp_f32 v32, v98
    v_exp_f32 v33, v99
    v_add_f32 v29, v29, v32
    v_add_f32 v29, v29, v33
    v_cvt_pk_bf16_f32 v133, v32, v33
    v_exp_f32 v30, v100
    v_exp_f32 v31, v101
    v_add_f32 v29, v29, v30
    v_add_f32 v29, v29, v31
    v_cvt_pk_bf16_f32 v134, v30, v31
    v_exp_f32 v32, v102
    v_exp_f32 v33, v103
    v_add_f32 v29, v29, v32
    v_add_f32 v29, v29, v33
    v_cvt_pk_bf16_f32 v135, v32, v33
    s_nop 1
    s_branch attn_kernel_ret8
attn_kernel_rare9:
    s_nop 15
    s_nop 15
    v_max3_f32 v208, v40, v41, v42
    v_max3_f32 v208, v208, v43, v44
    v_max3_f32 v208, v208, v45, v46
    v_max3_f32 v208, v208, v47, v48
    v_max3_f32 v208, v208, v49, v50
    v_max3_f32 v208, v208, v51, v52
    v_max3_f32 v208, v208, v53, v54
    v_max_f32 v208, v208, v55
    v_mov_b32 v209, v208
    s_nop 1
    v_permlane32_swap_b32 v209, v208
    s_nop 1
    v_max_f32 v208, v208, v209
    v_max_f32 v208, 0, v208
    v_sub_f32 v210, 0, v208
    v_exp_f32 v210, v210
    s_nop 0
    v_mul_f32 v26, v26, v210
    v_accvgpr_read_b32 v209, a0
    v_mul_f32 v209, v209, v210
    v_accvgpr_write_b32 a0, v209
    v_accvgpr_read_b32 v209, a1
    v_mul_f32 v209, v209, v210
    v_accvgpr_write_b32 a1, v209
    v_accvgpr_read_b32 v209, a2
    v_mul_f32 v209, v209, v210
    v_accvgpr_write_b32 a2, v209
    v_accvgpr_read_b32 v209, a3
    v_mul_f32 v209, v209, v210
    v_accvgpr_write_b32 a3, v209
    v_accvgpr_read_b32 v209, a4
    v_mul_f32 v209, v209, v210
    v_accvgpr_write_b32 a4, v209
    v_accvgpr_read_b32 v209, a5
    v_mul_f32 v209, v209, v210
    v_accvgpr_write_b32 a5, v209
    v_accvgpr_read_b32 v209, a6
    v_mul_f32 v209, v209, v210
    v_accvgpr_write_b32 a6, v209
    v_accvgpr_read_b32 v209, a7
    v_mul_f32 v209, v209, v210
    v_accvgpr_write_b32 a7, v209
    v_accvgpr_read_b32 v209, a8
    v_mul_f32 v209, v209, v210
    v_accvgpr_write_b32 a8, v209
    v_accvgpr_read_b32 v209, a9
    v_mul_f32 v209, v209, v210
    v_accvgpr_write_b32 a9, v209
    v_accvgpr_read_b32 v209, a10
    v_mul_f32 v209, v209, v210
    v_accvgpr_write_b32 a10, v209
    v_accvgpr_read_b32 v209, a11
    v_mul_f32 v209, v209, v210
    v_accvgpr_write_b32 a11, v209
    v_accvgpr_read_b32 v209, a12
    v_mul_f32 v209, v209, v210
    v_accvgpr_write_b32 a12, v209
    v_accvgpr_read_b32 v209, a13
    v_mul_f32 v209, v209, v210
    v_accvgpr_write_b32 a13, v209
    v_accvgpr_read_b32 v209, a14
    v_mul_f32 v209, v209, v210
    v_accvgpr_write_b32 a14, v209
    v_accvgpr_read_b32 v209, a15
    v_mul_f32 v209, v209, v210
    v_accvgpr_write_b32 a15, v209
    v_accvgpr_read_b32 v209, a16
    v_mul_f32 v209, v209, v210
    v_accvgpr_write_b32 a16, v209
    v_accvgpr_read_b32 v209, a17
    v_mul_f32 v209, v209, v210
    v_accvgpr_write_b32 a17, v209
    v_accvgpr_read_b32 v209, a18
    v_mul_f32 v209, v209, v210
    v_accvgpr_write_b32 a18, v209
    v_accvgpr_read_b32 v209, a19
    v_mul_f32 v209, v209, v210
    v_accvgpr_write_b32 a19, v209
    v_accvgpr_read_b32 v209, a20
    v_mul_f32 v209, v209, v210
    v_accvgpr_write_b32 a20, v209
    v_accvgpr_read_b32 v209, a21
    v_mul_f32 v209, v209, v210
    v_accvgpr_write_b32 a21, v209
    v_accvgpr_read_b32 v209, a22
    v_mul_f32 v209, v209, v210
    v_accvgpr_write_b32 a22, v209
    v_accvgpr_read_b32 v209, a23
    v_mul_f32 v209, v209, v210
    v_accvgpr_write_b32 a23, v209
    v_accvgpr_read_b32 v209, a24
    v_mul_f32 v209, v209, v210
    v_accvgpr_write_b32 a24, v209
    v_accvgpr_read_b32 v209, a25
    v_mul_f32 v209, v209, v210
    v_accvgpr_write_b32 a25, v209
    v_accvgpr_read_b32 v209, a26
    v_mul_f32 v209, v209, v210
    v_accvgpr_write_b32 a26, v209
    v_accvgpr_read_b32 v209, a27
    v_mul_f32 v209, v209, v210
    v_accvgpr_write_b32 a27, v209
    v_accvgpr_read_b32 v209, a28
    v_mul_f32 v209, v209, v210
    v_accvgpr_write_b32 a28, v209
    v_accvgpr_read_b32 v209, a29
    v_mul_f32 v209, v209, v210
    v_accvgpr_write_b32 a29, v209
    v_accvgpr_read_b32 v209, a30
    v_mul_f32 v209, v209, v210
    v_accvgpr_write_b32 a30, v209
    v_accvgpr_read_b32 v209, a31
    v_mul_f32 v209, v209, v210
    v_accvgpr_write_b32 a31, v209
    v_accvgpr_read_b32 v209, a32
    v_mul_f32 v209, v209, v210
    v_accvgpr_write_b32 a32, v209
    v_accvgpr_read_b32 v209, a33
    v_mul_f32 v209, v209, v210
    v_accvgpr_write_b32 a33, v209
    v_accvgpr_read_b32 v209, a34
    v_mul_f32 v209, v209, v210
    v_accvgpr_write_b32 a34, v209
    v_accvgpr_read_b32 v209, a35
    v_mul_f32 v209, v209, v210
    v_accvgpr_write_b32 a35, v209
    v_accvgpr_read_b32 v209, a36
    v_mul_f32 v209, v209, v210
    v_accvgpr_write_b32 a36, v209
    v_accvgpr_read_b32 v209, a37
    v_mul_f32 v209, v209, v210
    v_accvgpr_write_b32 a37, v209
    v_accvgpr_read_b32 v209, a38
    v_mul_f32 v209, v209, v210
    v_accvgpr_write_b32 a38, v209
    v_accvgpr_read_b32 v209, a39
    v_mul_f32 v209, v209, v210
    v_accvgpr_write_b32 a39, v209
    v_accvgpr_read_b32 v209, a40
    v_mul_f32 v209, v209, v210
    v_accvgpr_write_b32 a40, v209
    v_accvgpr_read_b32 v209, a41
    v_mul_f32 v209, v209, v210
    v_accvgpr_write_b32 a41, v209
    v_accvgpr_read_b32 v209, a42
    v_mul_f32 v209, v209, v210
    v_accvgpr_write_b32 a42, v209
    v_accvgpr_read_b32 v209, a43
    v_mul_f32 v209, v209, v210
    v_accvgpr_write_b32 a43, v209
    v_accvgpr_read_b32 v209, a44
    v_mul_f32 v209, v209, v210
    v_accvgpr_write_b32 a44, v209
    v_accvgpr_read_b32 v209, a45
    v_mul_f32 v209, v209, v210
    v_accvgpr_write_b32 a45, v209
    v_accvgpr_read_b32 v209, a46
    v_mul_f32 v209, v209, v210
    v_accvgpr_write_b32 a46, v209
    v_accvgpr_read_b32 v209, a47
    v_mul_f32 v209, v209, v210
    v_accvgpr_write_b32 a47, v209
    v_accvgpr_read_b32 v209, a48
    v_mul_f32 v209, v209, v210
    v_accvgpr_write_b32 a48, v209
    v_accvgpr_read_b32 v209, a49
    v_mul_f32 v209, v209, v210
    v_accvgpr_write_b32 a49, v209
    v_accvgpr_read_b32 v209, a50
    v_mul_f32 v209, v209, v210
    v_accvgpr_write_b32 a50, v209
    v_accvgpr_read_b32 v209, a51
    v_mul_f32 v209, v209, v210
    v_accvgpr_write_b32 a51, v209
    v_accvgpr_read_b32 v209, a52
    v_mul_f32 v209, v209, v210
    v_accvgpr_write_b32 a52, v209
    v_accvgpr_read_b32 v209, a53
    v_mul_f32 v209, v209, v210
    v_accvgpr_write_b32 a53, v209
    v_accvgpr_read_b32 v209, a54
    v_mul_f32 v209, v209, v210
    v_accvgpr_write_b32 a54, v209
    v_accvgpr_read_b32 v209, a55
    v_mul_f32 v209, v209, v210
    v_accvgpr_write_b32 a55, v209
    v_accvgpr_read_b32 v209, a56
    v_mul_f32 v209, v209, v210
    v_accvgpr_write_b32 a56, v209
    v_accvgpr_read_b32 v209, a57
    v_mul_f32 v209, v209, v210
    v_accvgpr_write_b32 a57, v209
    v_accvgpr_read_b32 v209, a58
    v_mul_f32 v209, v209, v210
    v_accvgpr_write_b32 a58, v209
    v_accvgpr_read_b32 v209, a59
    v_mul_f32 v209, v209, v210
    v_accvgpr_write_b32 a59, v209
    v_accvgpr_read_b32 v209, a60
    v_mul_f32 v209, v209, v210
    v_accvgpr_write_b32 a60, v209
    v_accvgpr_read_b32 v209, a61
    v_mul_f32 v209, v209, v210
    v_accvgpr_write_b32 a61, v209
    v_accvgpr_read_b32 v209, a62
    v_mul_f32 v209, v209, v210
    v_accvgpr_write_b32 a62, v209
    v_accvgpr_read_b32 v209, a63
    v_mul_f32 v209, v209, v210
    v_accvgpr_write_b32 a63, v209
    v_sub_f32 v136, v136, v208
    v_sub_f32 v40, v40, v208
    v_sub_f32 v72, v72, v208
    v_sub_f32 v137, v137, v208
    v_sub_f32 v41, v41, v208
    v_sub_f32 v73, v73, v208
    v_sub_f32 v138, v138, v208
    v_sub_f32 v42, v42, v208
    v_sub_f32 v74, v74, v208
    v_sub_f32 v139, v139, v208
    v_sub_f32 v43, v43, v208
    v_sub_f32 v75, v75, v208
    v_sub_f32 v140, v140, v208
    v_sub_f32 v44, v44, v208
    v_sub_f32 v76, v76, v208
    v_sub_f32 v141, v141, v208
    v_sub_f32 v45, v45, v208
    v_sub_f32 v77, v77, v208
    v_sub_f32 v142, v142, v208
    v_sub_f32 v46, v46, v208
    v_sub_f32 v78, v78, v208
    v_sub_f32 v143, v143, v208
    v_sub_f32 v47, v47, v208
    v_sub_f32 v79, v79, v208
    v_sub_f32 v144, v144, v208
    v_sub_f32 v48, v48, v208
    v_sub_f32 v80, v80, v208
    v_sub_f32 v145, v145, v208
    v_sub_f32 v49, v49, v208
    v_sub_f32 v81, v81, v208
    v_sub_f32 v146, v146, v208
    v_sub_f32 v50, v50, v208
    v_sub_f32 v82, v82, v208
    v_sub_f32 v147, v147, v208
    v_sub_f32 v51, v51, v208
    v_sub_f32 v83, v83, v208
    v_sub_f32 v148, v148, v208
    v_sub_f32 v52, v52, v208
    v_sub_f32 v84, v84, v208
    v_sub_f32 v149, v149, v208
    v_sub_f32 v53, v53, v208
    v_sub_f32 v85, v85, v208
    v_sub_f32 v150, v150, v208
    v_sub_f32 v54, v54, v208
    v_sub_f32 v86, v86, v208
    v_sub_f32 v151, v151, v208
    v_sub_f32 v55, v55, v208
    v_sub_f32 v87, v87, v208
    v_max3_f32 v208, v56, v57, v58
    v_max3_f32 v208, v208, v59, v60
    v_max3_f32 v208, v208, v61, v62
    v_max3_f32 v208, v208, v63, v64
    v_max3_f32 v208, v208, v65, v66
    v_max3_f32 v208, v208, v67, v68
    v_max3_f32 v208, v208, v69, v70
    v_max_f32 v208, v208, v71
    v_mov_b32 v209, v208
    s_nop 1
    v_permlane32_swap_b32 v209, v208
    s_nop 1
    v_max_f32 v208, v208, v209
    v_max_f32 v208, 0, v208
    v_sub_f32 v210, 0, v208
    v_exp_f32 v210, v210
    s_nop 0
    v_mul_f32 v27, v27, v210
    v_accvgpr_read_b32 v209, a64
    v_mul_f32 v209, v209, v210
    v_accvgpr_write_b32 a64, v209
    v_accvgpr_read_b32 v209, a65
    v_mul_f32 v209, v209, v210
    v_accvgpr_write_b32 a65, v209
    v_accvgpr_read_b32 v209, a66
    v_mul_f32 v209, v209, v210
    v_accvgpr_write_b32 a66, v209
    v_accvgpr_read_b32 v209, a67
    v_mul_f32 v209, v209, v210
    v_accvgpr_write_b32 a67, v209
    v_accvgpr_read_b32 v209, a68
    v_mul_f32 v209, v209, v210
    v_accvgpr_write_b32 a68, v209
    v_accvgpr_read_b32 v209, a69
    v_mul_f32 v209, v209, v210
    v_accvgpr_write_b32 a69, v209
    v_accvgpr_read_b32 v209, a70
    v_mul_f32 v209, v209, v210
    v_accvgpr_write_b32 a70, v209
    v_accvgpr_read_b32 v209, a71
    v_mul_f32 v209, v209, v210
    v_accvgpr_write_b32 a71, v209
    v_accvgpr_read_b32 v209, a72
    v_mul_f32 v209, v209, v210
    v_accvgpr_write_b32 a72, v209
    v_accvgpr_read_b32 v209, a73
    v_mul_f32 v209, v209, v210
    v_accvgpr_write_b32 a73, v209
    v_accvgpr_read_b32 v209, a74
    v_mul_f32 v209, v209, v210
    v_accvgpr_write_b32 a74, v209
    v_accvgpr_read_b32 v209, a75
    v_mul_f32 v209, v209, v210
    v_accvgpr_write_b32 a75, v209
    v_accvgpr_read_b32 v209, a76
    v_mul_f32 v209, v209, v210
    v_accvgpr_write_b32 a76, v209
    v_accvgpr_read_b32 v209, a77
    v_mul_f32 v209, v209, v210
    v_accvgpr_write_b32 a77, v209
    v_accvgpr_read_b32 v209, a78
    v_mul_f32 v209, v209, v210
    v_accvgpr_write_b32 a78, v209
    v_accvgpr_read_b32 v209, a79
    v_mul_f32 v209, v209, v210
    v_accvgpr_write_b32 a79, v209
    v_accvgpr_read_b32 v209, a80
    v_mul_f32 v209, v209, v210
    v_accvgpr_write_b32 a80, v209
    v_accvgpr_read_b32 v209, a81
    v_mul_f32 v209, v209, v210
    v_accvgpr_write_b32 a81, v209
    v_accvgpr_read_b32 v209, a82
    v_mul_f32 v209, v209, v210
    v_accvgpr_write_b32 a82, v209
    v_accvgpr_read_b32 v209, a83
    v_mul_f32 v209, v209, v210
    v_accvgpr_write_b32 a83, v209
    v_accvgpr_read_b32 v209, a84
    v_mul_f32 v209, v209, v210
    v_accvgpr_write_b32 a84, v209
    v_accvgpr_read_b32 v209, a85
    v_mul_f32 v209, v209, v210
    v_accvgpr_write_b32 a85, v209
    v_accvgpr_read_b32 v209, a86
    v_mul_f32 v209, v209, v210
    v_accvgpr_write_b32 a86, v209
    v_accvgpr_read_b32 v209, a87
    v_mul_f32 v209, v209, v210
    v_accvgpr_write_b32 a87, v209
    v_accvgpr_read_b32 v209, a88
    v_mul_f32 v209, v209, v210
    v_accvgpr_write_b32 a88, v209
    v_accvgpr_read_b32 v209, a89
    v_mul_f32 v209, v209, v210
    v_accvgpr_write_b32 a89, v209
    v_accvgpr_read_b32 v209, a90
    v_mul_f32 v209, v209, v210
    v_accvgpr_write_b32 a90, v209
    v_accvgpr_read_b32 v209, a91
    v_mul_f32 v209, v209, v210
    v_accvgpr_write_b32 a91, v209
    v_accvgpr_read_b32 v209, a92
    v_mul_f32 v209, v209, v210
    v_accvgpr_write_b32 a92, v209
    v_accvgpr_read_b32 v209, a93
    v_mul_f32 v209, v209, v210
    v_accvgpr_write_b32 a93, v209
    v_accvgpr_read_b32 v209, a94
    v_mul_f32 v209, v209, v210
    v_accvgpr_write_b32 a94, v209
    v_accvgpr_read_b32 v209, a95
    v_mul_f32 v209, v209, v210
    v_accvgpr_write_b32 a95, v209
    v_accvgpr_read_b32 v209, a96
    v_mul_f32 v209, v209, v210
    v_accvgpr_write_b32 a96, v209
    v_accvgpr_read_b32 v209, a97
    v_mul_f32 v209, v209, v210
    v_accvgpr_write_b32 a97, v209
    v_accvgpr_read_b32 v209, a98
    v_mul_f32 v209, v209, v210
    v_accvgpr_write_b32 a98, v209
    v_accvgpr_read_b32 v209, a99
    v_mul_f32 v209, v209, v210
    v_accvgpr_write_b32 a99, v209
    v_accvgpr_read_b32 v209, a100
    v_mul_f32 v209, v209, v210
    v_accvgpr_write_b32 a100, v209
    v_accvgpr_read_b32 v209, a101
    v_mul_f32 v209, v209, v210
    v_accvgpr_write_b32 a101, v209
    v_accvgpr_read_b32 v209, a102
    v_mul_f32 v209, v209, v210
    v_accvgpr_write_b32 a102, v209
    v_accvgpr_read_b32 v209, a103
    v_mul_f32 v209, v209, v210
    v_accvgpr_write_b32 a103, v209
    v_accvgpr_read_b32 v209, a104
    v_mul_f32 v209, v209, v210
    v_accvgpr_write_b32 a104, v209
    v_accvgpr_read_b32 v209, a105
    v_mul_f32 v209, v209, v210
    v_accvgpr_write_b32 a105, v209
    v_accvgpr_read_b32 v209, a106
    v_mul_f32 v209, v209, v210
    v_accvgpr_write_b32 a106, v209
    v_accvgpr_read_b32 v209, a107
    v_mul_f32 v209, v209, v210
    v_accvgpr_write_b32 a107, v209
    v_accvgpr_read_b32 v209, a108
    v_mul_f32 v209, v209, v210
    v_accvgpr_write_b32 a108, v209
    v_accvgpr_read_b32 v209, a109
    v_mul_f32 v209, v209, v210
    v_accvgpr_write_b32 a109, v209
    v_accvgpr_read_b32 v209, a110
    v_mul_f32 v209, v209, v210
    v_accvgpr_write_b32 a110, v209
    v_accvgpr_read_b32 v209, a111
    v_mul_f32 v209, v209, v210
    v_accvgpr_write_b32 a111, v209
    v_accvgpr_read_b32 v209, a112
    v_mul_f32 v209, v209, v210
    v_accvgpr_write_b32 a112, v209
    v_accvgpr_read_b32 v209, a113
    v_mul_f32 v209, v209, v210
    v_accvgpr_write_b32 a113, v209
    v_accvgpr_read_b32 v209, a114
    v_mul_f32 v209, v209, v210
    v_accvgpr_write_b32 a114, v209
    v_accvgpr_read_b32 v209, a115
    v_mul_f32 v209, v209, v210
    v_accvgpr_write_b32 a115, v209
    v_accvgpr_read_b32 v209, a116
    v_mul_f32 v209, v209, v210
    v_accvgpr_write_b32 a116, v209
    v_accvgpr_read_b32 v209, a117
    v_mul_f32 v209, v209, v210
    v_accvgpr_write_b32 a117, v209
    v_accvgpr_read_b32 v209, a118
    v_mul_f32 v209, v209, v210
    v_accvgpr_write_b32 a118, v209
    v_accvgpr_read_b32 v209, a119
    v_mul_f32 v209, v209, v210
    v_accvgpr_write_b32 a119, v209
    v_accvgpr_read_b32 v209, a120
    v_mul_f32 v209, v209, v210
    v_accvgpr_write_b32 a120, v209
    v_accvgpr_read_b32 v209, a121
    v_mul_f32 v209, v209, v210
    v_accvgpr_write_b32 a121, v209
    v_accvgpr_read_b32 v209, a122
    v_mul_f32 v209, v209, v210
    v_accvgpr_write_b32 a122, v209
    v_accvgpr_read_b32 v209, a123
    v_mul_f32 v209, v209, v210
    v_accvgpr_write_b32 a123, v209
    v_accvgpr_read_b32 v209, a124
    v_mul_f32 v209, v209, v210
    v_accvgpr_write_b32 a124, v209
    v_accvgpr_read_b32 v209, a125
    v_mul_f32 v209, v209, v210
    v_accvgpr_write_b32 a125, v209
    v_accvgpr_read_b32 v209, a126
    v_mul_f32 v209, v209, v210
    v_accvgpr_write_b32 a126, v209
    v_accvgpr_read_b32 v209, a127
    v_mul_f32 v209, v209, v210
    v_accvgpr_write_b32 a127, v209
    v_sub_f32 v152, v152, v208
    v_sub_f32 v56, v56, v208
    v_sub_f32 v88, v88, v208
    v_sub_f32 v153, v153, v208
    v_sub_f32 v57, v57, v208
    v_sub_f32 v89, v89, v208
    v_sub_f32 v154, v154, v208
    v_sub_f32 v58, v58, v208
    v_sub_f32 v90, v90, v208
    v_sub_f32 v155, v155, v208
    v_sub_f32 v59, v59, v208
    v_sub_f32 v91, v91, v208
    v_sub_f32 v156, v156, v208
    v_sub_f32 v60, v60, v208
    v_sub_f32 v92, v92, v208
    v_sub_f32 v157, v157, v208
    v_sub_f32 v61, v61, v208
    v_sub_f32 v93, v93, v208
    v_sub_f32 v158, v158, v208
    v_sub_f32 v62, v62, v208
    v_sub_f32 v94, v94, v208
    v_sub_f32 v159, v159, v208
    v_sub_f32 v63, v63, v208
    v_sub_f32 v95, v95, v208
    v_sub_f32 v160, v160, v208
    v_sub_f32 v64, v64, v208
    v_sub_f32 v96, v96, v208
    v_sub_f32 v161, v161, v208
    v_sub_f32 v65, v65, v208
    v_sub_f32 v97, v97, v208
    v_sub_f32 v162, v162, v208
    v_sub_f32 v66, v66, v208
    v_sub_f32 v98, v98, v208
    v_sub_f32 v163, v163, v208
    v_sub_f32 v67, v67, v208
    v_sub_f32 v99, v99, v208
    v_sub_f32 v164, v164, v208
    v_sub_f32 v68, v68, v208
    v_sub_f32 v100, v100, v208
    v_sub_f32 v165, v165, v208
    v_sub_f32 v69, v69, v208
    v_sub_f32 v101, v101, v208
    v_sub_f32 v166, v166, v208
    v_sub_f32 v70, v70, v208
    v_sub_f32 v102, v102, v208
    v_sub_f32 v167, v167, v208
    v_sub_f32 v71, v71, v208
    v_sub_f32 v103, v103, v208
    v_exp_f32 v30, v40
    v_exp_f32 v31, v41
    s_nop 0
    v_add_f32 v28, v30, v31
    v_cvt_pk_bf16_f32 v104, v30, v31
    v_exp_f32 v32, v42
    v_exp_f32 v33, v43
    v_add_f32 v28, v28, v32
    v_add_f32 v28, v28, v33
    v_cvt_pk_bf16_f32 v105, v32, v33
    v_exp_f32 v30, v44
    v_exp_f32 v31, v45
    v_add_f32 v28, v28, v30
    v_add_f32 v28, v28, v31
    v_cvt_pk_bf16_f32 v106, v30, v31
    v_exp_f32 v32, v46
    v_exp_f32 v33, v47
    v_add_f32 v28, v28, v32
    v_add_f32 v28, v28, v33
    v_cvt_pk_bf16_f32 v107, v32, v33
    v_exp_f32 v30, v48
    v_exp_f32 v31, v49
    v_add_f32 v28, v28, v30
    v_add_f32 v28, v28, v31
    v_cvt_pk_bf16_f32 v108, v30, v31
    v_exp_f32 v32, v50
    v_exp_f32 v33, v51
    v_add_f32 v28, v28, v32
    v_add_f32 v28, v28, v33
    v_cvt_pk_bf16_f32 v109, v32, v33
    v_exp_f32 v30, v52
    v_exp_f32 v31, v53
    v_add_f32 v28, v28, v30
    v_add_f32 v28, v28, v31
    v_cvt_pk_bf16_f32 v110, v30, v31
    v_exp_f32 v32, v54
    v_exp_f32 v33, v55
    v_add_f32 v28, v28, v32
    v_add_f32 v28, v28, v33
    v_cvt_pk_bf16_f32 v111, v32, v33
    v_exp_f32 v30, v56
    v_exp_f32 v31, v57
    s_nop 0
    v_add_f32 v29, v30, v31
    v_cvt_pk_bf16_f32 v112, v30, v31
    v_exp_f32 v32, v58
    v_exp_f32 v33, v59
    v_add_f32 v29, v29, v32
    v_add_f32 v29, v29, v33
    v_cvt_pk_bf16_f32 v113, v32, v33
    v_exp_f32 v30, v60
    v_exp_f32 v31, v61
    v_add_f32 v29, v29, v30
    v_add_f32 v29, v29, v31
    v_cvt_pk_bf16_f32 v114, v30, v31
    v_exp_f32 v32, v62
    v_exp_f32 v33, v63
    v_add_f32 v29, v29, v32
    v_add_f32 v29, v29, v33
    v_cvt_pk_bf16_f32 v115, v32, v33
    v_exp_f32 v30, v64
    v_exp_f32 v31, v65
    v_add_f32 v29, v29, v30
    v_add_f32 v29, v29, v31
    v_cvt_pk_bf16_f32 v116, v30, v31
    v_exp_f32 v32, v66
    v_exp_f32 v33, v67
    v_add_f32 v29, v29, v32
    v_add_f32 v29, v29, v33
    v_cvt_pk_bf16_f32 v117, v32, v33
    v_exp_f32 v30, v68
    v_exp_f32 v31, v69
    v_add_f32 v29, v29, v30
    v_add_f32 v29, v29, v31
    v_cvt_pk_bf16_f32 v118, v30, v31
    v_exp_f32 v32, v70
    v_exp_f32 v33, v71
    v_add_f32 v29, v29, v32
    v_add_f32 v29, v29, v33
    v_cvt_pk_bf16_f32 v119, v32, v33
    s_nop 1
    s_branch attn_kernel_ret10
attn_kernel_rare11:
    s_nop 15
    s_nop 15
    v_max3_f32 v208, v72, v73, v74
    v_max3_f32 v208, v208, v75, v76
    v_max3_f32 v208, v208, v77, v78
    v_max3_f32 v208, v208, v79, v80
    v_max3_f32 v208, v208, v81, v82
    v_max3_f32 v208, v208, v83, v84
    v_max3_f32 v208, v208, v85, v86
    v_max_f32 v208, v208, v87
    v_mov_b32 v209, v208
    s_nop 1
    v_permlane32_swap_b32 v209, v208
    s_nop 1
    v_max_f32 v208, v208, v209
    v_max_f32 v208, 0, v208
    v_sub_f32 v210, 0, v208
    v_exp_f32 v210, v210
    s_nop 0
    v_mul_f32 v26, v26, v210
    v_accvgpr_read_b32 v209, a0
    v_mul_f32 v209, v209, v210
    v_accvgpr_write_b32 a0, v209
    v_accvgpr_read_b32 v209, a1
    v_mul_f32 v209, v209, v210
    v_accvgpr_write_b32 a1, v209
    v_accvgpr_read_b32 v209, a2
    v_mul_f32 v209, v209, v210
    v_accvgpr_write_b32 a2, v209
    v_accvgpr_read_b32 v209, a3
    v_mul_f32 v209, v209, v210
    v_accvgpr_write_b32 a3, v209
    v_accvgpr_read_b32 v209, a4
    v_mul_f32 v209, v209, v210
    v_accvgpr_write_b32 a4, v209
    v_accvgpr_read_b32 v209, a5
    v_mul_f32 v209, v209, v210
    v_accvgpr_write_b32 a5, v209
    v_accvgpr_read_b32 v209, a6
    v_mul_f32 v209, v209, v210
    v_accvgpr_write_b32 a6, v209
    v_accvgpr_read_b32 v209, a7
    v_mul_f32 v209, v209, v210
    v_accvgpr_write_b32 a7, v209
    v_accvgpr_read_b32 v209, a8
    v_mul_f32 v209, v209, v210
    v_accvgpr_write_b32 a8, v209
    v_accvgpr_read_b32 v209, a9
    v_mul_f32 v209, v209, v210
    v_accvgpr_write_b32 a9, v209
    v_accvgpr_read_b32 v209, a10
    v_mul_f32 v209, v209, v210
    v_accvgpr_write_b32 a10, v209
    v_accvgpr_read_b32 v209, a11
    v_mul_f32 v209, v209, v210
    v_accvgpr_write_b32 a11, v209
    v_accvgpr_read_b32 v209, a12
    v_mul_f32 v209, v209, v210
    v_accvgpr_write_b32 a12, v209
    v_accvgpr_read_b32 v209, a13
    v_mul_f32 v209, v209, v210
    v_accvgpr_write_b32 a13, v209
    v_accvgpr_read_b32 v209, a14
    v_mul_f32 v209, v209, v210
    v_accvgpr_write_b32 a14, v209
    v_accvgpr_read_b32 v209, a15
    v_mul_f32 v209, v209, v210
    v_accvgpr_write_b32 a15, v209
    v_accvgpr_read_b32 v209, a16
    v_mul_f32 v209, v209, v210
    v_accvgpr_write_b32 a16, v209
    v_accvgpr_read_b32 v209, a17
    v_mul_f32 v209, v209, v210
    v_accvgpr_write_b32 a17, v209
    v_accvgpr_read_b32 v209, a18
    v_mul_f32 v209, v209, v210
    v_accvgpr_write_b32 a18, v209
    v_accvgpr_read_b32 v209, a19
    v_mul_f32 v209, v209, v210
    v_accvgpr_write_b32 a19, v209
    v_accvgpr_read_b32 v209, a20
    v_mul_f32 v209, v209, v210
    v_accvgpr_write_b32 a20, v209
    v_accvgpr_read_b32 v209, a21
    v_mul_f32 v209, v209, v210
    v_accvgpr_write_b32 a21, v209
    v_accvgpr_read_b32 v209, a22
    v_mul_f32 v209, v209, v210
    v_accvgpr_write_b32 a22, v209
    v_accvgpr_read_b32 v209, a23
    v_mul_f32 v209, v209, v210
    v_accvgpr_write_b32 a23, v209
    v_accvgpr_read_b32 v209, a24
    v_mul_f32 v209, v209, v210
    v_accvgpr_write_b32 a24, v209
    v_accvgpr_read_b32 v209, a25
    v_mul_f32 v209, v209, v210
    v_accvgpr_write_b32 a25, v209
    v_accvgpr_read_b32 v209, a26
    v_mul_f32 v209, v209, v210
    v_accvgpr_write_b32 a26, v209
    v_accvgpr_read_b32 v209, a27
    v_mul_f32 v209, v209, v210
    v_accvgpr_write_b32 a27, v209
    v_accvgpr_read_b32 v209, a28
    v_mul_f32 v209, v209, v210
    v_accvgpr_write_b32 a28, v209
    v_accvgpr_read_b32 v209, a29
    v_mul_f32 v209, v209, v210
    v_accvgpr_write_b32 a29, v209
    v_accvgpr_read_b32 v209, a30
    v_mul_f32 v209, v209, v210
    v_accvgpr_write_b32 a30, v209
    v_accvgpr_read_b32 v209, a31
    v_mul_f32 v209, v209, v210
    v_accvgpr_write_b32 a31, v209
    v_accvgpr_read_b32 v209, a32
    v_mul_f32 v209, v209, v210
    v_accvgpr_write_b32 a32, v209
    v_accvgpr_read_b32 v209, a33
    v_mul_f32 v209, v209, v210
    v_accvgpr_write_b32 a33, v209
    v_accvgpr_read_b32 v209, a34
    v_mul_f32 v209, v209, v210
    v_accvgpr_write_b32 a34, v209
    v_accvgpr_read_b32 v209, a35
    v_mul_f32 v209, v209, v210
    v_accvgpr_write_b32 a35, v209
    v_accvgpr_read_b32 v209, a36
    v_mul_f32 v209, v209, v210
    v_accvgpr_write_b32 a36, v209
    v_accvgpr_read_b32 v209, a37
    v_mul_f32 v209, v209, v210
    v_accvgpr_write_b32 a37, v209
    v_accvgpr_read_b32 v209, a38
    v_mul_f32 v209, v209, v210
    v_accvgpr_write_b32 a38, v209
    v_accvgpr_read_b32 v209, a39
    v_mul_f32 v209, v209, v210
    v_accvgpr_write_b32 a39, v209
    v_accvgpr_read_b32 v209, a40
    v_mul_f32 v209, v209, v210
    v_accvgpr_write_b32 a40, v209
    v_accvgpr_read_b32 v209, a41
    v_mul_f32 v209, v209, v210
    v_accvgpr_write_b32 a41, v209
    v_accvgpr_read_b32 v209, a42
    v_mul_f32 v209, v209, v210
    v_accvgpr_write_b32 a42, v209
    v_accvgpr_read_b32 v209, a43
    v_mul_f32 v209, v209, v210
    v_accvgpr_write_b32 a43, v209
    v_accvgpr_read_b32 v209, a44
    v_mul_f32 v209, v209, v210
    v_accvgpr_write_b32 a44, v209
    v_accvgpr_read_b32 v209, a45
    v_mul_f32 v209, v209, v210
    v_accvgpr_write_b32 a45, v209
    v_accvgpr_read_b32 v209, a46
    v_mul_f32 v209, v209, v210
    v_accvgpr_write_b32 a46, v209
    v_accvgpr_read_b32 v209, a47
    v_mul_f32 v209, v209, v210
    v_accvgpr_write_b32 a47, v209
    v_accvgpr_read_b32 v209, a48
    v_mul_f32 v209, v209, v210
    v_accvgpr_write_b32 a48, v209
    v_accvgpr_read_b32 v209, a49
    v_mul_f32 v209, v209, v210
    v_accvgpr_write_b32 a49, v209
    v_accvgpr_read_b32 v209, a50
    v_mul_f32 v209, v209, v210
    v_accvgpr_write_b32 a50, v209
    v_accvgpr_read_b32 v209, a51
    v_mul_f32 v209, v209, v210
    v_accvgpr_write_b32 a51, v209
    v_accvgpr_read_b32 v209, a52
    v_mul_f32 v209, v209, v210
    v_accvgpr_write_b32 a52, v209
    v_accvgpr_read_b32 v209, a53
    v_mul_f32 v209, v209, v210
    v_accvgpr_write_b32 a53, v209
    v_accvgpr_read_b32 v209, a54
    v_mul_f32 v209, v209, v210
    v_accvgpr_write_b32 a54, v209
    v_accvgpr_read_b32 v209, a55
    v_mul_f32 v209, v209, v210
    v_accvgpr_write_b32 a55, v209
    v_accvgpr_read_b32 v209, a56
    v_mul_f32 v209, v209, v210
    v_accvgpr_write_b32 a56, v209
    v_accvgpr_read_b32 v209, a57
    v_mul_f32 v209, v209, v210
    v_accvgpr_write_b32 a57, v209
    v_accvgpr_read_b32 v209, a58
    v_mul_f32 v209, v209, v210
    v_accvgpr_write_b32 a58, v209
    v_accvgpr_read_b32 v209, a59
    v_mul_f32 v209, v209, v210
    v_accvgpr_write_b32 a59, v209
    v_accvgpr_read_b32 v209, a60
    v_mul_f32 v209, v209, v210
    v_accvgpr_write_b32 a60, v209
    v_accvgpr_read_b32 v209, a61
    v_mul_f32 v209, v209, v210
    v_accvgpr_write_b32 a61, v209
    v_accvgpr_read_b32 v209, a62
    v_mul_f32 v209, v209, v210
    v_accvgpr_write_b32 a62, v209
    v_accvgpr_read_b32 v209, a63
    v_mul_f32 v209, v209, v210
    v_accvgpr_write_b32 a63, v209
    v_sub_f32 v136, v136, v208
    v_sub_f32 v72, v72, v208
    v_sub_f32 v40, v40, v208
    v_sub_f32 v137, v137, v208
    v_sub_f32 v73, v73, v208
    v_sub_f32 v41, v41, v208
    v_sub_f32 v138, v138, v208
    v_sub_f32 v74, v74, v208
    v_sub_f32 v42, v42, v208
    v_sub_f32 v139, v139, v208
    v_sub_f32 v75, v75, v208
    v_sub_f32 v43, v43, v208
    v_sub_f32 v140, v140, v208
    v_sub_f32 v76, v76, v208
    v_sub_f32 v44, v44, v208
    v_sub_f32 v141, v141, v208
    v_sub_f32 v77, v77, v208
    v_sub_f32 v45, v45, v208
    v_sub_f32 v142, v142, v208
    v_sub_f32 v78, v78, v208
    v_sub_f32 v46, v46, v208
    v_sub_f32 v143, v143, v208
    v_sub_f32 v79, v79, v208
    v_sub_f32 v47, v47, v208
    v_sub_f32 v144, v144, v208
    v_sub_f32 v80, v80, v208
    v_sub_f32 v48, v48, v208
    v_sub_f32 v145, v145, v208
    v_sub_f32 v81, v81, v208
    v_sub_f32 v49, v49, v208
    v_sub_f32 v146, v146, v208
    v_sub_f32 v82, v82, v208
    v_sub_f32 v50, v50, v208
    v_sub_f32 v147, v147, v208
    v_sub_f32 v83, v83, v208
    v_sub_f32 v51, v51, v208
    v_sub_f32 v148, v148, v208
    v_sub_f32 v84, v84, v208
    v_sub_f32 v52, v52, v208
    v_sub_f32 v149, v149, v208
    v_sub_f32 v85, v85, v208
    v_sub_f32 v53, v53, v208
    v_sub_f32 v150, v150, v208
    v_sub_f32 v86, v86, v208
    v_sub_f32 v54, v54, v208
    v_sub_f32 v151, v151, v208
    v_sub_f32 v87, v87, v208
    v_sub_f32 v55, v55, v208
    v_max3_f32 v208, v88, v89, v90
    v_max3_f32 v208, v208, v91, v92
    v_max3_f32 v208, v208, v93, v94
    v_max3_f32 v208, v208, v95, v96
    v_max3_f32 v208, v208, v97, v98
    v_max3_f32 v208, v208, v99, v100
    v_max3_f32 v208, v208, v101, v102
    v_max_f32 v208, v208, v103
    v_mov_b32 v209, v208
    s_nop 1
    v_permlane32_swap_b32 v209, v208
    s_nop 1
    v_max_f32 v208, v208, v209
    v_max_f32 v208, 0, v208
    v_sub_f32 v210, 0, v208
    v_exp_f32 v210, v210
    s_nop 0
    v_mul_f32 v27, v27, v210
    v_accvgpr_read_b32 v209, a64
    v_mul_f32 v209, v209, v210
    v_accvgpr_write_b32 a64, v209
    v_accvgpr_read_b32 v209, a65
    v_mul_f32 v209, v209, v210
    v_accvgpr_write_b32 a65, v209
    v_accvgpr_read_b32 v209, a66
    v_mul_f32 v209, v209, v210
    v_accvgpr_write_b32 a66, v209
    v_accvgpr_read_b32 v209, a67
    v_mul_f32 v209, v209, v210
    v_accvgpr_write_b32 a67, v209
    v_accvgpr_read_b32 v209, a68
    v_mul_f32 v209, v209, v210
    v_accvgpr_write_b32 a68, v209
    v_accvgpr_read_b32 v209, a69
    v_mul_f32 v209, v209, v210
    v_accvgpr_write_b32 a69, v209
    v_accvgpr_read_b32 v209, a70
    v_mul_f32 v209, v209, v210
    v_accvgpr_write_b32 a70, v209
    v_accvgpr_read_b32 v209, a71
    v_mul_f32 v209, v209, v210
    v_accvgpr_write_b32 a71, v209
    v_accvgpr_read_b32 v209, a72
    v_mul_f32 v209, v209, v210
    v_accvgpr_write_b32 a72, v209
    v_accvgpr_read_b32 v209, a73
    v_mul_f32 v209, v209, v210
    v_accvgpr_write_b32 a73, v209
    v_accvgpr_read_b32 v209, a74
    v_mul_f32 v209, v209, v210
    v_accvgpr_write_b32 a74, v209
    v_accvgpr_read_b32 v209, a75
    v_mul_f32 v209, v209, v210
    v_accvgpr_write_b32 a75, v209
    v_accvgpr_read_b32 v209, a76
    v_mul_f32 v209, v209, v210
    v_accvgpr_write_b32 a76, v209
    v_accvgpr_read_b32 v209, a77
    v_mul_f32 v209, v209, v210
    v_accvgpr_write_b32 a77, v209
    v_accvgpr_read_b32 v209, a78
    v_mul_f32 v209, v209, v210
    v_accvgpr_write_b32 a78, v209
    v_accvgpr_read_b32 v209, a79
    v_mul_f32 v209, v209, v210
    v_accvgpr_write_b32 a79, v209
    v_accvgpr_read_b32 v209, a80
    v_mul_f32 v209, v209, v210
    v_accvgpr_write_b32 a80, v209
    v_accvgpr_read_b32 v209, a81
    v_mul_f32 v209, v209, v210
    v_accvgpr_write_b32 a81, v209
    v_accvgpr_read_b32 v209, a82
    v_mul_f32 v209, v209, v210
    v_accvgpr_write_b32 a82, v209
    v_accvgpr_read_b32 v209, a83
    v_mul_f32 v209, v209, v210
    v_accvgpr_write_b32 a83, v209
    v_accvgpr_read_b32 v209, a84
    v_mul_f32 v209, v209, v210
    v_accvgpr_write_b32 a84, v209
    v_accvgpr_read_b32 v209, a85
    v_mul_f32 v209, v209, v210
    v_accvgpr_write_b32 a85, v209
    v_accvgpr_read_b32 v209, a86
    v_mul_f32 v209, v209, v210
    v_accvgpr_write_b32 a86, v209
    v_accvgpr_read_b32 v209, a87
    v_mul_f32 v209, v209, v210
    v_accvgpr_write_b32 a87, v209
    v_accvgpr_read_b32 v209, a88
    v_mul_f32 v209, v209, v210
    v_accvgpr_write_b32 a88, v209
    v_accvgpr_read_b32 v209, a89
    v_mul_f32 v209, v209, v210
    v_accvgpr_write_b32 a89, v209
    v_accvgpr_read_b32 v209, a90
    v_mul_f32 v209, v209, v210
    v_accvgpr_write_b32 a90, v209
    v_accvgpr_read_b32 v209, a91
    v_mul_f32 v209, v209, v210
    v_accvgpr_write_b32 a91, v209
    v_accvgpr_read_b32 v209, a92
    v_mul_f32 v209, v209, v210
    v_accvgpr_write_b32 a92, v209
    v_accvgpr_read_b32 v209, a93
    v_mul_f32 v209, v209, v210
    v_accvgpr_write_b32 a93, v209
    v_accvgpr_read_b32 v209, a94
    v_mul_f32 v209, v209, v210
    v_accvgpr_write_b32 a94, v209
    v_accvgpr_read_b32 v209, a95
    v_mul_f32 v209, v209, v210
    v_accvgpr_write_b32 a95, v209
    v_accvgpr_read_b32 v209, a96
    v_mul_f32 v209, v209, v210
    v_accvgpr_write_b32 a96, v209
    v_accvgpr_read_b32 v209, a97
    v_mul_f32 v209, v209, v210
    v_accvgpr_write_b32 a97, v209
    v_accvgpr_read_b32 v209, a98
    v_mul_f32 v209, v209, v210
    v_accvgpr_write_b32 a98, v209
    v_accvgpr_read_b32 v209, a99
    v_mul_f32 v209, v209, v210
    v_accvgpr_write_b32 a99, v209
    v_accvgpr_read_b32 v209, a100
    v_mul_f32 v209, v209, v210
    v_accvgpr_write_b32 a100, v209
    v_accvgpr_read_b32 v209, a101
    v_mul_f32 v209, v209, v210
    v_accvgpr_write_b32 a101, v209
    v_accvgpr_read_b32 v209, a102
    v_mul_f32 v209, v209, v210
    v_accvgpr_write_b32 a102, v209
    v_accvgpr_read_b32 v209, a103
    v_mul_f32 v209, v209, v210
    v_accvgpr_write_b32 a103, v209
    v_accvgpr_read_b32 v209, a104
    v_mul_f32 v209, v209, v210
    v_accvgpr_write_b32 a104, v209
    v_accvgpr_read_b32 v209, a105
    v_mul_f32 v209, v209, v210
    v_accvgpr_write_b32 a105, v209
    v_accvgpr_read_b32 v209, a106
    v_mul_f32 v209, v209, v210
    v_accvgpr_write_b32 a106, v209
    v_accvgpr_read_b32 v209, a107
    v_mul_f32 v209, v209, v210
    v_accvgpr_write_b32 a107, v209
    v_accvgpr_read_b32 v209, a108
    v_mul_f32 v209, v209, v210
    v_accvgpr_write_b32 a108, v209
    v_accvgpr_read_b32 v209, a109
    v_mul_f32 v209, v209, v210
    v_accvgpr_write_b32 a109, v209
    v_accvgpr_read_b32 v209, a110
    v_mul_f32 v209, v209, v210
    v_accvgpr_write_b32 a110, v209
    v_accvgpr_read_b32 v209, a111
    v_mul_f32 v209, v209, v210
    v_accvgpr_write_b32 a111, v209
    v_accvgpr_read_b32 v209, a112
    v_mul_f32 v209, v209, v210
    v_accvgpr_write_b32 a112, v209
    v_accvgpr_read_b32 v209, a113
    v_mul_f32 v209, v209, v210
    v_accvgpr_write_b32 a113, v209
    v_accvgpr_read_b32 v209, a114
    v_mul_f32 v209, v209, v210
    v_accvgpr_write_b32 a114, v209
    v_accvgpr_read_b32 v209, a115
    v_mul_f32 v209, v209, v210
    v_accvgpr_write_b32 a115, v209
    v_accvgpr_read_b32 v209, a116
    v_mul_f32 v209, v209, v210
    v_accvgpr_write_b32 a116, v209
    v_accvgpr_read_b32 v209, a117
    v_mul_f32 v209, v209, v210
    v_accvgpr_write_b32 a117, v209
    v_accvgpr_read_b32 v209, a118
    v_mul_f32 v209, v209, v210
    v_accvgpr_write_b32 a118, v209
    v_accvgpr_read_b32 v209, a119
    v_mul_f32 v209, v209, v210
    v_accvgpr_write_b32 a119, v209
    v_accvgpr_read_b32 v209, a120
    v_mul_f32 v209, v209, v210
    v_accvgpr_write_b32 a120, v209
    v_accvgpr_read_b32 v209, a121
    v_mul_f32 v209, v209, v210
    v_accvgpr_write_b32 a121, v209
    v_accvgpr_read_b32 v209, a122
    v_mul_f32 v209, v209, v210
    v_accvgpr_write_b32 a122, v209
    v_accvgpr_read_b32 v209, a123
    v_mul_f32 v209, v209, v210
    v_accvgpr_write_b32 a123, v209
    v_accvgpr_read_b32 v209, a124
    v_mul_f32 v209, v209, v210
    v_accvgpr_write_b32 a124, v209
    v_accvgpr_read_b32 v209, a125
    v_mul_f32 v209, v209, v210
    v_accvgpr_write_b32 a125, v209
    v_accvgpr_read_b32 v209, a126
    v_mul_f32 v209, v209, v210
    v_accvgpr_write_b32 a126, v209
    v_accvgpr_read_b32 v209, a127
    v_mul_f32 v209, v209, v210
    v_accvgpr_write_b32 a127, v209
    v_sub_f32 v152, v152, v208
    v_sub_f32 v88, v88, v208
    v_sub_f32 v56, v56, v208
    v_sub_f32 v153, v153, v208
    v_sub_f32 v89, v89, v208
    v_sub_f32 v57, v57, v208
    v_sub_f32 v154, v154, v208
    v_sub_f32 v90, v90, v208
    v_sub_f32 v58, v58, v208
    v_sub_f32 v155, v155, v208
    v_sub_f32 v91, v91, v208
    v_sub_f32 v59, v59, v208
    v_sub_f32 v156, v156, v208
    v_sub_f32 v92, v92, v208
    v_sub_f32 v60, v60, v208
    v_sub_f32 v157, v157, v208
    v_sub_f32 v93, v93, v208
    v_sub_f32 v61, v61, v208
    v_sub_f32 v158, v158, v208
    v_sub_f32 v94, v94, v208
    v_sub_f32 v62, v62, v208
    v_sub_f32 v159, v159, v208
    v_sub_f32 v95, v95, v208
    v_sub_f32 v63, v63, v208
    v_sub_f32 v160, v160, v208
    v_sub_f32 v96, v96, v208
    v_sub_f32 v64, v64, v208
    v_sub_f32 v161, v161, v208
    v_sub_f32 v97, v97, v208
    v_sub_f32 v65, v65, v208
    v_sub_f32 v162, v162, v208
    v_sub_f32 v98, v98, v208
    v_sub_f32 v66, v66, v208
    v_sub_f32 v163, v163, v208
    v_sub_f32 v99, v99, v208
    v_sub_f32 v67, v67, v208
    v_sub_f32 v164, v164, v208
    v_sub_f32 v100, v100, v208
    v_sub_f32 v68, v68, v208
    v_sub_f32 v165, v165, v208
    v_sub_f32 v101, v101, v208
    v_sub_f32 v69, v69, v208
    v_sub_f32 v166, v166, v208
    v_sub_f32 v102, v102, v208
    v_sub_f32 v70, v70, v208
    v_sub_f32 v167, v167, v208
    v_sub_f32 v103, v103, v208
    v_sub_f32 v71, v71, v208
    v_exp_f32 v30, v72
    v_exp_f32 v31, v73
    s_nop 0
    v_add_f32 v28, v30, v31
    v_cvt_pk_bf16_f32 v120, v30, v31
    v_exp_f32 v32, v74
    v_exp_f32 v33, v75
    v_add_f32 v28, v28, v32
    v_add_f32 v28, v28, v33
    v_cvt_pk_bf16_f32 v121, v32, v33
    v_exp_f32 v30, v76
    v_exp_f32 v31, v77
    v_add_f32 v28, v28, v30
    v_add_f32 v28, v28, v31
    v_cvt_pk_bf16_f32 v122, v30, v31
    v_exp_f32 v32, v78
    v_exp_f32 v33, v79
    v_add_f32 v28, v28, v32
    v_add_f32 v28, v28, v33
    v_cvt_pk_bf16_f32 v123, v32, v33
    v_exp_f32 v30, v80
    v_exp_f32 v31, v81
    v_add_f32 v28, v28, v30
    v_add_f32 v28, v28, v31
    v_cvt_pk_bf16_f32 v124, v30, v31
    v_exp_f32 v32, v82
    v_exp_f32 v33, v83
    v_add_f32 v28, v28, v32
    v_add_f32 v28, v28, v33
    v_cvt_pk_bf16_f32 v125, v32, v33
    v_exp_f32 v30, v84
    v_exp_f32 v31, v85
    v_add_f32 v28, v28, v30
    v_add_f32 v28, v28, v31
    v_cvt_pk_bf16_f32 v126, v30, v31
    v_exp_f32 v32, v86
    v_exp_f32 v33, v87
    v_add_f32 v28, v28, v32
    v_add_f32 v28, v28, v33
    v_cvt_pk_bf16_f32 v127, v32, v33
    v_exp_f32 v30, v88
    v_exp_f32 v31, v89
    s_nop 0
    v_add_f32 v29, v30, v31
    v_cvt_pk_bf16_f32 v128, v30, v31
    v_exp_f32 v32, v90
    v_exp_f32 v33, v91
    v_add_f32 v29, v29, v32
    v_add_f32 v29, v29, v33
    v_cvt_pk_bf16_f32 v129, v32, v33
    v_exp_f32 v30, v92
    v_exp_f32 v31, v93
    v_add_f32 v29, v29, v30
    v_add_f32 v29, v29, v31
    v_cvt_pk_bf16_f32 v130, v30, v31
    v_exp_f32 v32, v94
    v_exp_f32 v33, v95
    v_add_f32 v29, v29, v32
    v_add_f32 v29, v29, v33
    v_cvt_pk_bf16_f32 v131, v32, v33
    v_exp_f32 v30, v96
    v_exp_f32 v31, v97
    v_add_f32 v29, v29, v30
    v_add_f32 v29, v29, v31
    v_cvt_pk_bf16_f32 v132, v30, v31
    v_exp_f32 v32, v98
    v_exp_f32 v33, v99
    v_add_f32 v29, v29, v32
    v_add_f32 v29, v29, v33
    v_cvt_pk_bf16_f32 v133, v32, v33
    v_exp_f32 v30, v100
    v_exp_f32 v31, v101
    v_add_f32 v29, v29, v30
    v_add_f32 v29, v29, v31
    v_cvt_pk_bf16_f32 v134, v30, v31
    v_exp_f32 v32, v102
    v_exp_f32 v33, v103
    v_add_f32 v29, v29, v32
    v_add_f32 v29, v29, v33
    v_cvt_pk_bf16_f32 v135, v32, v33
    s_nop 1
    s_branch attn_kernel_ret12
attn_kernel_rare13:
    s_nop 15
    s_nop 15
    v_max3_f32 v208, v40, v41, v42
    v_max3_f32 v208, v208, v43, v44
    v_max3_f32 v208, v208, v45, v46
    v_max3_f32 v208, v208, v47, v48
    v_max3_f32 v208, v208, v49, v50
    v_max3_f32 v208, v208, v51, v52
    v_max3_f32 v208, v208, v53, v54
    v_max_f32 v208, v208, v55
    v_mov_b32 v209, v208
    s_nop 1
    v_permlane32_swap_b32 v209, v208
    s_nop 1
    v_max_f32 v208, v208, v209
    v_max_f32 v208, 0, v208
    v_sub_f32 v210, 0, v208
    v_exp_f32 v210, v210
    s_nop 0
    v_mul_f32 v26, v26, v210
    v_accvgpr_read_b32 v209, a0
    v_mul_f32 v209, v209, v210
    v_accvgpr_write_b32 a0, v209
    v_accvgpr_read_b32 v209, a1
    v_mul_f32 v209, v209, v210
    v_accvgpr_write_b32 a1, v209
    v_accvgpr_read_b32 v209, a2
    v_mul_f32 v209, v209, v210
    v_accvgpr_write_b32 a2, v209
    v_accvgpr_read_b32 v209, a3
    v_mul_f32 v209, v209, v210
    v_accvgpr_write_b32 a3, v209
    v_accvgpr_read_b32 v209, a4
    v_mul_f32 v209, v209, v210
    v_accvgpr_write_b32 a4, v209
    v_accvgpr_read_b32 v209, a5
    v_mul_f32 v209, v209, v210
    v_accvgpr_write_b32 a5, v209
    v_accvgpr_read_b32 v209, a6
    v_mul_f32 v209, v209, v210
    v_accvgpr_write_b32 a6, v209
    v_accvgpr_read_b32 v209, a7
    v_mul_f32 v209, v209, v210
    v_accvgpr_write_b32 a7, v209
    v_accvgpr_read_b32 v209, a8
    v_mul_f32 v209, v209, v210
    v_accvgpr_write_b32 a8, v209
    v_accvgpr_read_b32 v209, a9
    v_mul_f32 v209, v209, v210
    v_accvgpr_write_b32 a9, v209
    v_accvgpr_read_b32 v209, a10
    v_mul_f32 v209, v209, v210
    v_accvgpr_write_b32 a10, v209
    v_accvgpr_read_b32 v209, a11
    v_mul_f32 v209, v209, v210
    v_accvgpr_write_b32 a11, v209
    v_accvgpr_read_b32 v209, a12
    v_mul_f32 v209, v209, v210
    v_accvgpr_write_b32 a12, v209
    v_accvgpr_read_b32 v209, a13
    v_mul_f32 v209, v209, v210
    v_accvgpr_write_b32 a13, v209
    v_accvgpr_read_b32 v209, a14
    v_mul_f32 v209, v209, v210
    v_accvgpr_write_b32 a14, v209
    v_accvgpr_read_b32 v209, a15
    v_mul_f32 v209, v209, v210
    v_accvgpr_write_b32 a15, v209
    v_accvgpr_read_b32 v209, a16
    v_mul_f32 v209, v209, v210
    v_accvgpr_write_b32 a16, v209
    v_accvgpr_read_b32 v209, a17
    v_mul_f32 v209, v209, v210
    v_accvgpr_write_b32 a17, v209
    v_accvgpr_read_b32 v209, a18
    v_mul_f32 v209, v209, v210
    v_accvgpr_write_b32 a18, v209
    v_accvgpr_read_b32 v209, a19
    v_mul_f32 v209, v209, v210
    v_accvgpr_write_b32 a19, v209
    v_accvgpr_read_b32 v209, a20
    v_mul_f32 v209, v209, v210
    v_accvgpr_write_b32 a20, v209
    v_accvgpr_read_b32 v209, a21
    v_mul_f32 v209, v209, v210
    v_accvgpr_write_b32 a21, v209
    v_accvgpr_read_b32 v209, a22
    v_mul_f32 v209, v209, v210
    v_accvgpr_write_b32 a22, v209
    v_accvgpr_read_b32 v209, a23
    v_mul_f32 v209, v209, v210
    v_accvgpr_write_b32 a23, v209
    v_accvgpr_read_b32 v209, a24
    v_mul_f32 v209, v209, v210
    v_accvgpr_write_b32 a24, v209
    v_accvgpr_read_b32 v209, a25
    v_mul_f32 v209, v209, v210
    v_accvgpr_write_b32 a25, v209
    v_accvgpr_read_b32 v209, a26
    v_mul_f32 v209, v209, v210
    v_accvgpr_write_b32 a26, v209
    v_accvgpr_read_b32 v209, a27
    v_mul_f32 v209, v209, v210
    v_accvgpr_write_b32 a27, v209
    v_accvgpr_read_b32 v209, a28
    v_mul_f32 v209, v209, v210
    v_accvgpr_write_b32 a28, v209
    v_accvgpr_read_b32 v209, a29
    v_mul_f32 v209, v209, v210
    v_accvgpr_write_b32 a29, v209
    v_accvgpr_read_b32 v209, a30
    v_mul_f32 v209, v209, v210
    v_accvgpr_write_b32 a30, v209
    v_accvgpr_read_b32 v209, a31
    v_mul_f32 v209, v209, v210
    v_accvgpr_write_b32 a31, v209
    v_accvgpr_read_b32 v209, a32
    v_mul_f32 v209, v209, v210
    v_accvgpr_write_b32 a32, v209
    v_accvgpr_read_b32 v209, a33
    v_mul_f32 v209, v209, v210
    v_accvgpr_write_b32 a33, v209
    v_accvgpr_read_b32 v209, a34
    v_mul_f32 v209, v209, v210
    v_accvgpr_write_b32 a34, v209
    v_accvgpr_read_b32 v209, a35
    v_mul_f32 v209, v209, v210
    v_accvgpr_write_b32 a35, v209
    v_accvgpr_read_b32 v209, a36
    v_mul_f32 v209, v209, v210
    v_accvgpr_write_b32 a36, v209
    v_accvgpr_read_b32 v209, a37
    v_mul_f32 v209, v209, v210
    v_accvgpr_write_b32 a37, v209
    v_accvgpr_read_b32 v209, a38
    v_mul_f32 v209, v209, v210
    v_accvgpr_write_b32 a38, v209
    v_accvgpr_read_b32 v209, a39
    v_mul_f32 v209, v209, v210
    v_accvgpr_write_b32 a39, v209
    v_accvgpr_read_b32 v209, a40
    v_mul_f32 v209, v209, v210
    v_accvgpr_write_b32 a40, v209
    v_accvgpr_read_b32 v209, a41
    v_mul_f32 v209, v209, v210
    v_accvgpr_write_b32 a41, v209
    v_accvgpr_read_b32 v209, a42
    v_mul_f32 v209, v209, v210
    v_accvgpr_write_b32 a42, v209
    v_accvgpr_read_b32 v209, a43
    v_mul_f32 v209, v209, v210
    v_accvgpr_write_b32 a43, v209
    v_accvgpr_read_b32 v209, a44
    v_mul_f32 v209, v209, v210
    v_accvgpr_write_b32 a44, v209
    v_accvgpr_read_b32 v209, a45
    v_mul_f32 v209, v209, v210
    v_accvgpr_write_b32 a45, v209
    v_accvgpr_read_b32 v209, a46
    v_mul_f32 v209, v209, v210
    v_accvgpr_write_b32 a46, v209
    v_accvgpr_read_b32 v209, a47
    v_mul_f32 v209, v209, v210
    v_accvgpr_write_b32 a47, v209
    v_accvgpr_read_b32 v209, a48
    v_mul_f32 v209, v209, v210
    v_accvgpr_write_b32 a48, v209
    v_accvgpr_read_b32 v209, a49
    v_mul_f32 v209, v209, v210
    v_accvgpr_write_b32 a49, v209
    v_accvgpr_read_b32 v209, a50
    v_mul_f32 v209, v209, v210
    v_accvgpr_write_b32 a50, v209
    v_accvgpr_read_b32 v209, a51
    v_mul_f32 v209, v209, v210
    v_accvgpr_write_b32 a51, v209
    v_accvgpr_read_b32 v209, a52
    v_mul_f32 v209, v209, v210
    v_accvgpr_write_b32 a52, v209
    v_accvgpr_read_b32 v209, a53
    v_mul_f32 v209, v209, v210
    v_accvgpr_write_b32 a53, v209
    v_accvgpr_read_b32 v209, a54
    v_mul_f32 v209, v209, v210
    v_accvgpr_write_b32 a54, v209
    v_accvgpr_read_b32 v209, a55
    v_mul_f32 v209, v209, v210
    v_accvgpr_write_b32 a55, v209
    v_accvgpr_read_b32 v209, a56
    v_mul_f32 v209, v209, v210
    v_accvgpr_write_b32 a56, v209
    v_accvgpr_read_b32 v209, a57
    v_mul_f32 v209, v209, v210
    v_accvgpr_write_b32 a57, v209
    v_accvgpr_read_b32 v209, a58
    v_mul_f32 v209, v209, v210
    v_accvgpr_write_b32 a58, v209
    v_accvgpr_read_b32 v209, a59
    v_mul_f32 v209, v209, v210
    v_accvgpr_write_b32 a59, v209
    v_accvgpr_read_b32 v209, a60
    v_mul_f32 v209, v209, v210
    v_accvgpr_write_b32 a60, v209
    v_accvgpr_read_b32 v209, a61
    v_mul_f32 v209, v209, v210
    v_accvgpr_write_b32 a61, v209
    v_accvgpr_read_b32 v209, a62
    v_mul_f32 v209, v209, v210
    v_accvgpr_write_b32 a62, v209
    v_accvgpr_read_b32 v209, a63
    v_mul_f32 v209, v209, v210
    v_accvgpr_write_b32 a63, v209
    v_sub_f32 v136, v136, v208
    v_sub_f32 v40, v40, v208
    v_sub_f32 v72, v72, v208
    v_sub_f32 v137, v137, v208
    v_sub_f32 v41, v41, v208
    v_sub_f32 v73, v73, v208
    v_sub_f32 v138, v138, v208
    v_sub_f32 v42, v42, v208
    v_sub_f32 v74, v74, v208
    v_sub_f32 v139, v139, v208
    v_sub_f32 v43, v43, v208
    v_sub_f32 v75, v75, v208
    v_sub_f32 v140, v140, v208
    v_sub_f32 v44, v44, v208
    v_sub_f32 v76, v76, v208
    v_sub_f32 v141, v141, v208
    v_sub_f32 v45, v45, v208
    v_sub_f32 v77, v77, v208
    v_sub_f32 v142, v142, v208
    v_sub_f32 v46, v46, v208
    v_sub_f32 v78, v78, v208
    v_sub_f32 v143, v143, v208
    v_sub_f32 v47, v47, v208
    v_sub_f32 v79, v79, v208
    v_sub_f32 v144, v144, v208
    v_sub_f32 v48, v48, v208
    v_sub_f32 v80, v80, v208
    v_sub_f32 v145, v145, v208
    v_sub_f32 v49, v49, v208
    v_sub_f32 v81, v81, v208
    v_sub_f32 v146, v146, v208
    v_sub_f32 v50, v50, v208
    v_sub_f32 v82, v82, v208
    v_sub_f32 v147, v147, v208
    v_sub_f32 v51, v51, v208
    v_sub_f32 v83, v83, v208
    v_sub_f32 v148, v148, v208
    v_sub_f32 v52, v52, v208
    v_sub_f32 v84, v84, v208
    v_sub_f32 v149, v149, v208
    v_sub_f32 v53, v53, v208
    v_sub_f32 v85, v85, v208
    v_sub_f32 v150, v150, v208
    v_sub_f32 v54, v54, v208
    v_sub_f32 v86, v86, v208
    v_sub_f32 v151, v151, v208
    v_sub_f32 v55, v55, v208
    v_sub_f32 v87, v87, v208
    v_max3_f32 v208, v56, v57, v58
    v_max3_f32 v208, v208, v59, v60
    v_max3_f32 v208, v208, v61, v62
    v_max3_f32 v208, v208, v63, v64
    v_max3_f32 v208, v208, v65, v66
    v_max3_f32 v208, v208, v67, v68
    v_max3_f32 v208, v208, v69, v70
    v_max_f32 v208, v208, v71
    v_mov_b32 v209, v208
    s_nop 1
    v_permlane32_swap_b32 v209, v208
    s_nop 1
    v_max_f32 v208, v208, v209
    v_max_f32 v208, 0, v208
    v_sub_f32 v210, 0, v208
    v_exp_f32 v210, v210
    s_nop 0
    v_mul_f32 v27, v27, v210
    v_accvgpr_read_b32 v209, a64
    v_mul_f32 v209, v209, v210
    v_accvgpr_write_b32 a64, v209
    v_accvgpr_read_b32 v209, a65
    v_mul_f32 v209, v209, v210
    v_accvgpr_write_b32 a65, v209
    v_accvgpr_read_b32 v209, a66
    v_mul_f32 v209, v209, v210
    v_accvgpr_write_b32 a66, v209
    v_accvgpr_read_b32 v209, a67
    v_mul_f32 v209, v209, v210
    v_accvgpr_write_b32 a67, v209
    v_accvgpr_read_b32 v209, a68
    v_mul_f32 v209, v209, v210
    v_accvgpr_write_b32 a68, v209
    v_accvgpr_read_b32 v209, a69
    v_mul_f32 v209, v209, v210
    v_accvgpr_write_b32 a69, v209
    v_accvgpr_read_b32 v209, a70
    v_mul_f32 v209, v209, v210
    v_accvgpr_write_b32 a70, v209
    v_accvgpr_read_b32 v209, a71
    v_mul_f32 v209, v209, v210
    v_accvgpr_write_b32 a71, v209
    v_accvgpr_read_b32 v209, a72
    v_mul_f32 v209, v209, v210
    v_accvgpr_write_b32 a72, v209
    v_accvgpr_read_b32 v209, a73
    v_mul_f32 v209, v209, v210
    v_accvgpr_write_b32 a73, v209
    v_accvgpr_read_b32 v209, a74
    v_mul_f32 v209, v209, v210
    v_accvgpr_write_b32 a74, v209
    v_accvgpr_read_b32 v209, a75
    v_mul_f32 v209, v209, v210
    v_accvgpr_write_b32 a75, v209
    v_accvgpr_read_b32 v209, a76
    v_mul_f32 v209, v209, v210
    v_accvgpr_write_b32 a76, v209
    v_accvgpr_read_b32 v209, a77
    v_mul_f32 v209, v209, v210
    v_accvgpr_write_b32 a77, v209
    v_accvgpr_read_b32 v209, a78
    v_mul_f32 v209, v209, v210
    v_accvgpr_write_b32 a78, v209
    v_accvgpr_read_b32 v209, a79
    v_mul_f32 v209, v209, v210
    v_accvgpr_write_b32 a79, v209
    v_accvgpr_read_b32 v209, a80
    v_mul_f32 v209, v209, v210
    v_accvgpr_write_b32 a80, v209
    v_accvgpr_read_b32 v209, a81
    v_mul_f32 v209, v209, v210
    v_accvgpr_write_b32 a81, v209
    v_accvgpr_read_b32 v209, a82
    v_mul_f32 v209, v209, v210
    v_accvgpr_write_b32 a82, v209
    v_accvgpr_read_b32 v209, a83
    v_mul_f32 v209, v209, v210
    v_accvgpr_write_b32 a83, v209
    v_accvgpr_read_b32 v209, a84
    v_mul_f32 v209, v209, v210
    v_accvgpr_write_b32 a84, v209
    v_accvgpr_read_b32 v209, a85
    v_mul_f32 v209, v209, v210
    v_accvgpr_write_b32 a85, v209
    v_accvgpr_read_b32 v209, a86
    v_mul_f32 v209, v209, v210
    v_accvgpr_write_b32 a86, v209
    v_accvgpr_read_b32 v209, a87
    v_mul_f32 v209, v209, v210
    v_accvgpr_write_b32 a87, v209
    v_accvgpr_read_b32 v209, a88
    v_mul_f32 v209, v209, v210
    v_accvgpr_write_b32 a88, v209
    v_accvgpr_read_b32 v209, a89
    v_mul_f32 v209, v209, v210
    v_accvgpr_write_b32 a89, v209
    v_accvgpr_read_b32 v209, a90
    v_mul_f32 v209, v209, v210
    v_accvgpr_write_b32 a90, v209
    v_accvgpr_read_b32 v209, a91
    v_mul_f32 v209, v209, v210
    v_accvgpr_write_b32 a91, v209
    v_accvgpr_read_b32 v209, a92
    v_mul_f32 v209, v209, v210
    v_accvgpr_write_b32 a92, v209
    v_accvgpr_read_b32 v209, a93
    v_mul_f32 v209, v209, v210
    v_accvgpr_write_b32 a93, v209
    v_accvgpr_read_b32 v209, a94
    v_mul_f32 v209, v209, v210
    v_accvgpr_write_b32 a94, v209
    v_accvgpr_read_b32 v209, a95
    v_mul_f32 v209, v209, v210
    v_accvgpr_write_b32 a95, v209
    v_accvgpr_read_b32 v209, a96
    v_mul_f32 v209, v209, v210
    v_accvgpr_write_b32 a96, v209
    v_accvgpr_read_b32 v209, a97
    v_mul_f32 v209, v209, v210
    v_accvgpr_write_b32 a97, v209
    v_accvgpr_read_b32 v209, a98
    v_mul_f32 v209, v209, v210
    v_accvgpr_write_b32 a98, v209
    v_accvgpr_read_b32 v209, a99
    v_mul_f32 v209, v209, v210
    v_accvgpr_write_b32 a99, v209
    v_accvgpr_read_b32 v209, a100
    v_mul_f32 v209, v209, v210
    v_accvgpr_write_b32 a100, v209
    v_accvgpr_read_b32 v209, a101
    v_mul_f32 v209, v209, v210
    v_accvgpr_write_b32 a101, v209
    v_accvgpr_read_b32 v209, a102
    v_mul_f32 v209, v209, v210
    v_accvgpr_write_b32 a102, v209
    v_accvgpr_read_b32 v209, a103
    v_mul_f32 v209, v209, v210
    v_accvgpr_write_b32 a103, v209
    v_accvgpr_read_b32 v209, a104
    v_mul_f32 v209, v209, v210
    v_accvgpr_write_b32 a104, v209
    v_accvgpr_read_b32 v209, a105
    v_mul_f32 v209, v209, v210
    v_accvgpr_write_b32 a105, v209
    v_accvgpr_read_b32 v209, a106
    v_mul_f32 v209, v209, v210
    v_accvgpr_write_b32 a106, v209
    v_accvgpr_read_b32 v209, a107
    v_mul_f32 v209, v209, v210
    v_accvgpr_write_b32 a107, v209
    v_accvgpr_read_b32 v209, a108
    v_mul_f32 v209, v209, v210
    v_accvgpr_write_b32 a108, v209
    v_accvgpr_read_b32 v209, a109
    v_mul_f32 v209, v209, v210
    v_accvgpr_write_b32 a109, v209
    v_accvgpr_read_b32 v209, a110
    v_mul_f32 v209, v209, v210
    v_accvgpr_write_b32 a110, v209
    v_accvgpr_read_b32 v209, a111
    v_mul_f32 v209, v209, v210
    v_accvgpr_write_b32 a111, v209
    v_accvgpr_read_b32 v209, a112
    v_mul_f32 v209, v209, v210
    v_accvgpr_write_b32 a112, v209
    v_accvgpr_read_b32 v209, a113
    v_mul_f32 v209, v209, v210
    v_accvgpr_write_b32 a113, v209
    v_accvgpr_read_b32 v209, a114
    v_mul_f32 v209, v209, v210
    v_accvgpr_write_b32 a114, v209
    v_accvgpr_read_b32 v209, a115
    v_mul_f32 v209, v209, v210
    v_accvgpr_write_b32 a115, v209
    v_accvgpr_read_b32 v209, a116
    v_mul_f32 v209, v209, v210
    v_accvgpr_write_b32 a116, v209
    v_accvgpr_read_b32 v209, a117
    v_mul_f32 v209, v209, v210
    v_accvgpr_write_b32 a117, v209
    v_accvgpr_read_b32 v209, a118
    v_mul_f32 v209, v209, v210
    v_accvgpr_write_b32 a118, v209
    v_accvgpr_read_b32 v209, a119
    v_mul_f32 v209, v209, v210
    v_accvgpr_write_b32 a119, v209
    v_accvgpr_read_b32 v209, a120
    v_mul_f32 v209, v209, v210
    v_accvgpr_write_b32 a120, v209
    v_accvgpr_read_b32 v209, a121
    v_mul_f32 v209, v209, v210
    v_accvgpr_write_b32 a121, v209
    v_accvgpr_read_b32 v209, a122
    v_mul_f32 v209, v209, v210
    v_accvgpr_write_b32 a122, v209
    v_accvgpr_read_b32 v209, a123
    v_mul_f32 v209, v209, v210
    v_accvgpr_write_b32 a123, v209
    v_accvgpr_read_b32 v209, a124
    v_mul_f32 v209, v209, v210
    v_accvgpr_write_b32 a124, v209
    v_accvgpr_read_b32 v209, a125
    v_mul_f32 v209, v209, v210
    v_accvgpr_write_b32 a125, v209
    v_accvgpr_read_b32 v209, a126
    v_mul_f32 v209, v209, v210
    v_accvgpr_write_b32 a126, v209
    v_accvgpr_read_b32 v209, a127
    v_mul_f32 v209, v209, v210
    v_accvgpr_write_b32 a127, v209
    v_sub_f32 v152, v152, v208
    v_sub_f32 v56, v56, v208
    v_sub_f32 v88, v88, v208
    v_sub_f32 v153, v153, v208
    v_sub_f32 v57, v57, v208
    v_sub_f32 v89, v89, v208
    v_sub_f32 v154, v154, v208
    v_sub_f32 v58, v58, v208
    v_sub_f32 v90, v90, v208
    v_sub_f32 v155, v155, v208
    v_sub_f32 v59, v59, v208
    v_sub_f32 v91, v91, v208
    v_sub_f32 v156, v156, v208
    v_sub_f32 v60, v60, v208
    v_sub_f32 v92, v92, v208
    v_sub_f32 v157, v157, v208
    v_sub_f32 v61, v61, v208
    v_sub_f32 v93, v93, v208
    v_sub_f32 v158, v158, v208
    v_sub_f32 v62, v62, v208
    v_sub_f32 v94, v94, v208
    v_sub_f32 v159, v159, v208
    v_sub_f32 v63, v63, v208
    v_sub_f32 v95, v95, v208
    v_sub_f32 v160, v160, v208
    v_sub_f32 v64, v64, v208
    v_sub_f32 v96, v96, v208
    v_sub_f32 v161, v161, v208
    v_sub_f32 v65, v65, v208
    v_sub_f32 v97, v97, v208
    v_sub_f32 v162, v162, v208
    v_sub_f32 v66, v66, v208
    v_sub_f32 v98, v98, v208
    v_sub_f32 v163, v163, v208
    v_sub_f32 v67, v67, v208
    v_sub_f32 v99, v99, v208
    v_sub_f32 v164, v164, v208
    v_sub_f32 v68, v68, v208
    v_sub_f32 v100, v100, v208
    v_sub_f32 v165, v165, v208
    v_sub_f32 v69, v69, v208
    v_sub_f32 v101, v101, v208
    v_sub_f32 v166, v166, v208
    v_sub_f32 v70, v70, v208
    v_sub_f32 v102, v102, v208
    v_sub_f32 v167, v167, v208
    v_sub_f32 v71, v71, v208
    v_sub_f32 v103, v103, v208
    v_exp_f32 v30, v40
    v_exp_f32 v31, v41
    s_nop 0
    v_add_f32 v28, v30, v31
    v_cvt_pk_bf16_f32 v104, v30, v31
    v_exp_f32 v32, v42
    v_exp_f32 v33, v43
    v_add_f32 v28, v28, v32
    v_add_f32 v28, v28, v33
    v_cvt_pk_bf16_f32 v105, v32, v33
    v_exp_f32 v30, v44
    v_exp_f32 v31, v45
    v_add_f32 v28, v28, v30
    v_add_f32 v28, v28, v31
    v_cvt_pk_bf16_f32 v106, v30, v31
    v_exp_f32 v32, v46
    v_exp_f32 v33, v47
    v_add_f32 v28, v28, v32
    v_add_f32 v28, v28, v33
    v_cvt_pk_bf16_f32 v107, v32, v33
    v_exp_f32 v30, v48
    v_exp_f32 v31, v49
    v_add_f32 v28, v28, v30
    v_add_f32 v28, v28, v31
    v_cvt_pk_bf16_f32 v108, v30, v31
    v_exp_f32 v32, v50
    v_exp_f32 v33, v51
    v_add_f32 v28, v28, v32
    v_add_f32 v28, v28, v33
    v_cvt_pk_bf16_f32 v109, v32, v33
    v_exp_f32 v30, v52
    v_exp_f32 v31, v53
    v_add_f32 v28, v28, v30
    v_add_f32 v28, v28, v31
    v_cvt_pk_bf16_f32 v110, v30, v31
    v_exp_f32 v32, v54
    v_exp_f32 v33, v55
    v_add_f32 v28, v28, v32
    v_add_f32 v28, v28, v33
    v_cvt_pk_bf16_f32 v111, v32, v33
    v_exp_f32 v30, v56
    v_exp_f32 v31, v57
    s_nop 0
    v_add_f32 v29, v30, v31
    v_cvt_pk_bf16_f32 v112, v30, v31
    v_exp_f32 v32, v58
    v_exp_f32 v33, v59
    v_add_f32 v29, v29, v32
    v_add_f32 v29, v29, v33
    v_cvt_pk_bf16_f32 v113, v32, v33
    v_exp_f32 v30, v60
    v_exp_f32 v31, v61
    v_add_f32 v29, v29, v30
    v_add_f32 v29, v29, v31
    v_cvt_pk_bf16_f32 v114, v30, v31
    v_exp_f32 v32, v62
    v_exp_f32 v33, v63
    v_add_f32 v29, v29, v32
    v_add_f32 v29, v29, v33
    v_cvt_pk_bf16_f32 v115, v32, v33
    v_exp_f32 v30, v64
    v_exp_f32 v31, v65
    v_add_f32 v29, v29, v30
    v_add_f32 v29, v29, v31
    v_cvt_pk_bf16_f32 v116, v30, v31
    v_exp_f32 v32, v66
    v_exp_f32 v33, v67
    v_add_f32 v29, v29, v32
    v_add_f32 v29, v29, v33
    v_cvt_pk_bf16_f32 v117, v32, v33
    v_exp_f32 v30, v68
    v_exp_f32 v31, v69
    v_add_f32 v29, v29, v30
    v_add_f32 v29, v29, v31
    v_cvt_pk_bf16_f32 v118, v30, v31
    v_exp_f32 v32, v70
    v_exp_f32 v33, v71
    v_add_f32 v29, v29, v32
    v_add_f32 v29, v29, v33
    v_cvt_pk_bf16_f32 v119, v32, v33
    s_nop 1
    s_branch attn_kernel_ret14
attn_kernel_rare15:
    s_nop 15
    s_nop 15
    v_max3_f32 v208, v72, v73, v74
    v_max3_f32 v208, v208, v75, v76
    v_max3_f32 v208, v208, v77, v78
    v_max3_f32 v208, v208, v79, v80
    v_max3_f32 v208, v208, v81, v82
    v_max3_f32 v208, v208, v83, v84
    v_max3_f32 v208, v208, v85, v86
    v_max_f32 v208, v208, v87
    v_mov_b32 v209, v208
    s_nop 1
    v_permlane32_swap_b32 v209, v208
    s_nop 1
    v_max_f32 v208, v208, v209
    v_max_f32 v208, 0, v208
    v_sub_f32 v210, 0, v208
    v_exp_f32 v210, v210
    s_nop 0
    v_mul_f32 v26, v26, v210
    v_accvgpr_read_b32 v209, a0
    v_mul_f32 v209, v209, v210
    v_accvgpr_write_b32 a0, v209
    v_accvgpr_read_b32 v209, a1
    v_mul_f32 v209, v209, v210
    v_accvgpr_write_b32 a1, v209
    v_accvgpr_read_b32 v209, a2
    v_mul_f32 v209, v209, v210
    v_accvgpr_write_b32 a2, v209
    v_accvgpr_read_b32 v209, a3
    v_mul_f32 v209, v209, v210
    v_accvgpr_write_b32 a3, v209
    v_accvgpr_read_b32 v209, a4
    v_mul_f32 v209, v209, v210
    v_accvgpr_write_b32 a4, v209
    v_accvgpr_read_b32 v209, a5
    v_mul_f32 v209, v209, v210
    v_accvgpr_write_b32 a5, v209
    v_accvgpr_read_b32 v209, a6
    v_mul_f32 v209, v209, v210
    v_accvgpr_write_b32 a6, v209
    v_accvgpr_read_b32 v209, a7
    v_mul_f32 v209, v209, v210
    v_accvgpr_write_b32 a7, v209
    v_accvgpr_read_b32 v209, a8
    v_mul_f32 v209, v209, v210
    v_accvgpr_write_b32 a8, v209
    v_accvgpr_read_b32 v209, a9
    v_mul_f32 v209, v209, v210
    v_accvgpr_write_b32 a9, v209
    v_accvgpr_read_b32 v209, a10
    v_mul_f32 v209, v209, v210
    v_accvgpr_write_b32 a10, v209
    v_accvgpr_read_b32 v209, a11
    v_mul_f32 v209, v209, v210
    v_accvgpr_write_b32 a11, v209
    v_accvgpr_read_b32 v209, a12
    v_mul_f32 v209, v209, v210
    v_accvgpr_write_b32 a12, v209
    v_accvgpr_read_b32 v209, a13
    v_mul_f32 v209, v209, v210
    v_accvgpr_write_b32 a13, v209
    v_accvgpr_read_b32 v209, a14
    v_mul_f32 v209, v209, v210
    v_accvgpr_write_b32 a14, v209
    v_accvgpr_read_b32 v209, a15
    v_mul_f32 v209, v209, v210
    v_accvgpr_write_b32 a15, v209
    v_accvgpr_read_b32 v209, a16
    v_mul_f32 v209, v209, v210
    v_accvgpr_write_b32 a16, v209
    v_accvgpr_read_b32 v209, a17
    v_mul_f32 v209, v209, v210
    v_accvgpr_write_b32 a17, v209
    v_accvgpr_read_b32 v209, a18
    v_mul_f32 v209, v209, v210
    v_accvgpr_write_b32 a18, v209
    v_accvgpr_read_b32 v209, a19
    v_mul_f32 v209, v209, v210
    v_accvgpr_write_b32 a19, v209
    v_accvgpr_read_b32 v209, a20
    v_mul_f32 v209, v209, v210
    v_accvgpr_write_b32 a20, v209
    v_accvgpr_read_b32 v209, a21
    v_mul_f32 v209, v209, v210
    v_accvgpr_write_b32 a21, v209
    v_accvgpr_read_b32 v209, a22
    v_mul_f32 v209, v209, v210
    v_accvgpr_write_b32 a22, v209
    v_accvgpr_read_b32 v209, a23
    v_mul_f32 v209, v209, v210
    v_accvgpr_write_b32 a23, v209
    v_accvgpr_read_b32 v209, a24
    v_mul_f32 v209, v209, v210
    v_accvgpr_write_b32 a24, v209
    v_accvgpr_read_b32 v209, a25
    v_mul_f32 v209, v209, v210
    v_accvgpr_write_b32 a25, v209
    v_accvgpr_read_b32 v209, a26
    v_mul_f32 v209, v209, v210
    v_accvgpr_write_b32 a26, v209
    v_accvgpr_read_b32 v209, a27
    v_mul_f32 v209, v209, v210
    v_accvgpr_write_b32 a27, v209
    v_accvgpr_read_b32 v209, a28
    v_mul_f32 v209, v209, v210
    v_accvgpr_write_b32 a28, v209
    v_accvgpr_read_b32 v209, a29
    v_mul_f32 v209, v209, v210
    v_accvgpr_write_b32 a29, v209
    v_accvgpr_read_b32 v209, a30
    v_mul_f32 v209, v209, v210
    v_accvgpr_write_b32 a30, v209
    v_accvgpr_read_b32 v209, a31
    v_mul_f32 v209, v209, v210
    v_accvgpr_write_b32 a31, v209
    v_accvgpr_read_b32 v209, a32
    v_mul_f32 v209, v209, v210
    v_accvgpr_write_b32 a32, v209
    v_accvgpr_read_b32 v209, a33
    v_mul_f32 v209, v209, v210
    v_accvgpr_write_b32 a33, v209
    v_accvgpr_read_b32 v209, a34
    v_mul_f32 v209, v209, v210
    v_accvgpr_write_b32 a34, v209
    v_accvgpr_read_b32 v209, a35
    v_mul_f32 v209, v209, v210
    v_accvgpr_write_b32 a35, v209
    v_accvgpr_read_b32 v209, a36
    v_mul_f32 v209, v209, v210
    v_accvgpr_write_b32 a36, v209
    v_accvgpr_read_b32 v209, a37
    v_mul_f32 v209, v209, v210
    v_accvgpr_write_b32 a37, v209
    v_accvgpr_read_b32 v209, a38
    v_mul_f32 v209, v209, v210
    v_accvgpr_write_b32 a38, v209
    v_accvgpr_read_b32 v209, a39
    v_mul_f32 v209, v209, v210
    v_accvgpr_write_b32 a39, v209
    v_accvgpr_read_b32 v209, a40
    v_mul_f32 v209, v209, v210
    v_accvgpr_write_b32 a40, v209
    v_accvgpr_read_b32 v209, a41
    v_mul_f32 v209, v209, v210
    v_accvgpr_write_b32 a41, v209
    v_accvgpr_read_b32 v209, a42
    v_mul_f32 v209, v209, v210
    v_accvgpr_write_b32 a42, v209
    v_accvgpr_read_b32 v209, a43
    v_mul_f32 v209, v209, v210
    v_accvgpr_write_b32 a43, v209
    v_accvgpr_read_b32 v209, a44
    v_mul_f32 v209, v209, v210
    v_accvgpr_write_b32 a44, v209
    v_accvgpr_read_b32 v209, a45
    v_mul_f32 v209, v209, v210
    v_accvgpr_write_b32 a45, v209
    v_accvgpr_read_b32 v209, a46
    v_mul_f32 v209, v209, v210
    v_accvgpr_write_b32 a46, v209
    v_accvgpr_read_b32 v209, a47
    v_mul_f32 v209, v209, v210
    v_accvgpr_write_b32 a47, v209
    v_accvgpr_read_b32 v209, a48
    v_mul_f32 v209, v209, v210
    v_accvgpr_write_b32 a48, v209
    v_accvgpr_read_b32 v209, a49
    v_mul_f32 v209, v209, v210
    v_accvgpr_write_b32 a49, v209
    v_accvgpr_read_b32 v209, a50
    v_mul_f32 v209, v209, v210
    v_accvgpr_write_b32 a50, v209
    v_accvgpr_read_b32 v209, a51
    v_mul_f32 v209, v209, v210
    v_accvgpr_write_b32 a51, v209
    v_accvgpr_read_b32 v209, a52
    v_mul_f32 v209, v209, v210
    v_accvgpr_write_b32 a52, v209
    v_accvgpr_read_b32 v209, a53
    v_mul_f32 v209, v209, v210
    v_accvgpr_write_b32 a53, v209
    v_accvgpr_read_b32 v209, a54
    v_mul_f32 v209, v209, v210
    v_accvgpr_write_b32 a54, v209
    v_accvgpr_read_b32 v209, a55
    v_mul_f32 v209, v209, v210
    v_accvgpr_write_b32 a55, v209
    v_accvgpr_read_b32 v209, a56
    v_mul_f32 v209, v209, v210
    v_accvgpr_write_b32 a56, v209
    v_accvgpr_read_b32 v209, a57
    v_mul_f32 v209, v209, v210
    v_accvgpr_write_b32 a57, v209
    v_accvgpr_read_b32 v209, a58
    v_mul_f32 v209, v209, v210
    v_accvgpr_write_b32 a58, v209
    v_accvgpr_read_b32 v209, a59
    v_mul_f32 v209, v209, v210
    v_accvgpr_write_b32 a59, v209
    v_accvgpr_read_b32 v209, a60
    v_mul_f32 v209, v209, v210
    v_accvgpr_write_b32 a60, v209
    v_accvgpr_read_b32 v209, a61
    v_mul_f32 v209, v209, v210
    v_accvgpr_write_b32 a61, v209
    v_accvgpr_read_b32 v209, a62
    v_mul_f32 v209, v209, v210
    v_accvgpr_write_b32 a62, v209
    v_accvgpr_read_b32 v209, a63
    v_mul_f32 v209, v209, v210
    v_accvgpr_write_b32 a63, v209
    v_sub_f32 v136, v136, v208
    v_sub_f32 v72, v72, v208
    v_sub_f32 v40, v40, v208
    v_sub_f32 v137, v137, v208
    v_sub_f32 v73, v73, v208
    v_sub_f32 v41, v41, v208
    v_sub_f32 v138, v138, v208
    v_sub_f32 v74, v74, v208
    v_sub_f32 v42, v42, v208
    v_sub_f32 v139, v139, v208
    v_sub_f32 v75, v75, v208
    v_sub_f32 v43, v43, v208
    v_sub_f32 v140, v140, v208
    v_sub_f32 v76, v76, v208
    v_sub_f32 v44, v44, v208
    v_sub_f32 v141, v141, v208
    v_sub_f32 v77, v77, v208
    v_sub_f32 v45, v45, v208
    v_sub_f32 v142, v142, v208
    v_sub_f32 v78, v78, v208
    v_sub_f32 v46, v46, v208
    v_sub_f32 v143, v143, v208
    v_sub_f32 v79, v79, v208
    v_sub_f32 v47, v47, v208
    v_sub_f32 v144, v144, v208
    v_sub_f32 v80, v80, v208
    v_sub_f32 v48, v48, v208
    v_sub_f32 v145, v145, v208
    v_sub_f32 v81, v81, v208
    v_sub_f32 v49, v49, v208
    v_sub_f32 v146, v146, v208
    v_sub_f32 v82, v82, v208
    v_sub_f32 v50, v50, v208
    v_sub_f32 v147, v147, v208
    v_sub_f32 v83, v83, v208
    v_sub_f32 v51, v51, v208
    v_sub_f32 v148, v148, v208
    v_sub_f32 v84, v84, v208
    v_sub_f32 v52, v52, v208
    v_sub_f32 v149, v149, v208
    v_sub_f32 v85, v85, v208
    v_sub_f32 v53, v53, v208
    v_sub_f32 v150, v150, v208
    v_sub_f32 v86, v86, v208
    v_sub_f32 v54, v54, v208
    v_sub_f32 v151, v151, v208
    v_sub_f32 v87, v87, v208
    v_sub_f32 v55, v55, v208
    v_max3_f32 v208, v88, v89, v90
    v_max3_f32 v208, v208, v91, v92
    v_max3_f32 v208, v208, v93, v94
    v_max3_f32 v208, v208, v95, v96
    v_max3_f32 v208, v208, v97, v98
    v_max3_f32 v208, v208, v99, v100
    v_max3_f32 v208, v208, v101, v102
    v_max_f32 v208, v208, v103
    v_mov_b32 v209, v208
    s_nop 1
    v_permlane32_swap_b32 v209, v208
    s_nop 1
    v_max_f32 v208, v208, v209
    v_max_f32 v208, 0, v208
    v_sub_f32 v210, 0, v208
    v_exp_f32 v210, v210
    s_nop 0
    v_mul_f32 v27, v27, v210
    v_accvgpr_read_b32 v209, a64
    v_mul_f32 v209, v209, v210
    v_accvgpr_write_b32 a64, v209
    v_accvgpr_read_b32 v209, a65
    v_mul_f32 v209, v209, v210
    v_accvgpr_write_b32 a65, v209
    v_accvgpr_read_b32 v209, a66
    v_mul_f32 v209, v209, v210
    v_accvgpr_write_b32 a66, v209
    v_accvgpr_read_b32 v209, a67
    v_mul_f32 v209, v209, v210
    v_accvgpr_write_b32 a67, v209
    v_accvgpr_read_b32 v209, a68
    v_mul_f32 v209, v209, v210
    v_accvgpr_write_b32 a68, v209
    v_accvgpr_read_b32 v209, a69
    v_mul_f32 v209, v209, v210
    v_accvgpr_write_b32 a69, v209
    v_accvgpr_read_b32 v209, a70
    v_mul_f32 v209, v209, v210
    v_accvgpr_write_b32 a70, v209
    v_accvgpr_read_b32 v209, a71
    v_mul_f32 v209, v209, v210
    v_accvgpr_write_b32 a71, v209
    v_accvgpr_read_b32 v209, a72
    v_mul_f32 v209, v209, v210
    v_accvgpr_write_b32 a72, v209
    v_accvgpr_read_b32 v209, a73
    v_mul_f32 v209, v209, v210
    v_accvgpr_write_b32 a73, v209
    v_accvgpr_read_b32 v209, a74
    v_mul_f32 v209, v209, v210
    v_accvgpr_write_b32 a74, v209
    v_accvgpr_read_b32 v209, a75
    v_mul_f32 v209, v209, v210
    v_accvgpr_write_b32 a75, v209
    v_accvgpr_read_b32 v209, a76
    v_mul_f32 v209, v209, v210
    v_accvgpr_write_b32 a76, v209
    v_accvgpr_read_b32 v209, a77
    v_mul_f32 v209, v209, v210
    v_accvgpr_write_b32 a77, v209
    v_accvgpr_read_b32 v209, a78
    v_mul_f32 v209, v209, v210
    v_accvgpr_write_b32 a78, v209
    v_accvgpr_read_b32 v209, a79
    v_mul_f32 v209, v209, v210
    v_accvgpr_write_b32 a79, v209
    v_accvgpr_read_b32 v209, a80
    v_mul_f32 v209, v209, v210
    v_accvgpr_write_b32 a80, v209
    v_accvgpr_read_b32 v209, a81
    v_mul_f32 v209, v209, v210
    v_accvgpr_write_b32 a81, v209
    v_accvgpr_read_b32 v209, a82
    v_mul_f32 v209, v209, v210
    v_accvgpr_write_b32 a82, v209
    v_accvgpr_read_b32 v209, a83
    v_mul_f32 v209, v209, v210
    v_accvgpr_write_b32 a83, v209
    v_accvgpr_read_b32 v209, a84
    v_mul_f32 v209, v209, v210
    v_accvgpr_write_b32 a84, v209
    v_accvgpr_read_b32 v209, a85
    v_mul_f32 v209, v209, v210
    v_accvgpr_write_b32 a85, v209
    v_accvgpr_read_b32 v209, a86
    v_mul_f32 v209, v209, v210
    v_accvgpr_write_b32 a86, v209
    v_accvgpr_read_b32 v209, a87
    v_mul_f32 v209, v209, v210
    v_accvgpr_write_b32 a87, v209
    v_accvgpr_read_b32 v209, a88
    v_mul_f32 v209, v209, v210
    v_accvgpr_write_b32 a88, v209
    v_accvgpr_read_b32 v209, a89
    v_mul_f32 v209, v209, v210
    v_accvgpr_write_b32 a89, v209
    v_accvgpr_read_b32 v209, a90
    v_mul_f32 v209, v209, v210
    v_accvgpr_write_b32 a90, v209
    v_accvgpr_read_b32 v209, a91
    v_mul_f32 v209, v209, v210
    v_accvgpr_write_b32 a91, v209
    v_accvgpr_read_b32 v209, a92
    v_mul_f32 v209, v209, v210
    v_accvgpr_write_b32 a92, v209
    v_accvgpr_read_b32 v209, a93
    v_mul_f32 v209, v209, v210
    v_accvgpr_write_b32 a93, v209
    v_accvgpr_read_b32 v209, a94
    v_mul_f32 v209, v209, v210
    v_accvgpr_write_b32 a94, v209
    v_accvgpr_read_b32 v209, a95
    v_mul_f32 v209, v209, v210
    v_accvgpr_write_b32 a95, v209
    v_accvgpr_read_b32 v209, a96
    v_mul_f32 v209, v209, v210
    v_accvgpr_write_b32 a96, v209
    v_accvgpr_read_b32 v209, a97
    v_mul_f32 v209, v209, v210
    v_accvgpr_write_b32 a97, v209
    v_accvgpr_read_b32 v209, a98
    v_mul_f32 v209, v209, v210
    v_accvgpr_write_b32 a98, v209
    v_accvgpr_read_b32 v209, a99
    v_mul_f32 v209, v209, v210
    v_accvgpr_write_b32 a99, v209
    v_accvgpr_read_b32 v209, a100
    v_mul_f32 v209, v209, v210
    v_accvgpr_write_b32 a100, v209
    v_accvgpr_read_b32 v209, a101
    v_mul_f32 v209, v209, v210
    v_accvgpr_write_b32 a101, v209
    v_accvgpr_read_b32 v209, a102
    v_mul_f32 v209, v209, v210
    v_accvgpr_write_b32 a102, v209
    v_accvgpr_read_b32 v209, a103
    v_mul_f32 v209, v209, v210
    v_accvgpr_write_b32 a103, v209
    v_accvgpr_read_b32 v209, a104
    v_mul_f32 v209, v209, v210
    v_accvgpr_write_b32 a104, v209
    v_accvgpr_read_b32 v209, a105
    v_mul_f32 v209, v209, v210
    v_accvgpr_write_b32 a105, v209
    v_accvgpr_read_b32 v209, a106
    v_mul_f32 v209, v209, v210
    v_accvgpr_write_b32 a106, v209
    v_accvgpr_read_b32 v209, a107
    v_mul_f32 v209, v209, v210
    v_accvgpr_write_b32 a107, v209
    v_accvgpr_read_b32 v209, a108
    v_mul_f32 v209, v209, v210
    v_accvgpr_write_b32 a108, v209
    v_accvgpr_read_b32 v209, a109
    v_mul_f32 v209, v209, v210
    v_accvgpr_write_b32 a109, v209
    v_accvgpr_read_b32 v209, a110
    v_mul_f32 v209, v209, v210
    v_accvgpr_write_b32 a110, v209
    v_accvgpr_read_b32 v209, a111
    v_mul_f32 v209, v209, v210
    v_accvgpr_write_b32 a111, v209
    v_accvgpr_read_b32 v209, a112
    v_mul_f32 v209, v209, v210
    v_accvgpr_write_b32 a112, v209
    v_accvgpr_read_b32 v209, a113
    v_mul_f32 v209, v209, v210
    v_accvgpr_write_b32 a113, v209
    v_accvgpr_read_b32 v209, a114
    v_mul_f32 v209, v209, v210
    v_accvgpr_write_b32 a114, v209
    v_accvgpr_read_b32 v209, a115
    v_mul_f32 v209, v209, v210
    v_accvgpr_write_b32 a115, v209
    v_accvgpr_read_b32 v209, a116
    v_mul_f32 v209, v209, v210
    v_accvgpr_write_b32 a116, v209
    v_accvgpr_read_b32 v209, a117
    v_mul_f32 v209, v209, v210
    v_accvgpr_write_b32 a117, v209
    v_accvgpr_read_b32 v209, a118
    v_mul_f32 v209, v209, v210
    v_accvgpr_write_b32 a118, v209
    v_accvgpr_read_b32 v209, a119
    v_mul_f32 v209, v209, v210
    v_accvgpr_write_b32 a119, v209
    v_accvgpr_read_b32 v209, a120
    v_mul_f32 v209, v209, v210
    v_accvgpr_write_b32 a120, v209
    v_accvgpr_read_b32 v209, a121
    v_mul_f32 v209, v209, v210
    v_accvgpr_write_b32 a121, v209
    v_accvgpr_read_b32 v209, a122
    v_mul_f32 v209, v209, v210
    v_accvgpr_write_b32 a122, v209
    v_accvgpr_read_b32 v209, a123
    v_mul_f32 v209, v209, v210
    v_accvgpr_write_b32 a123, v209
    v_accvgpr_read_b32 v209, a124
    v_mul_f32 v209, v209, v210
    v_accvgpr_write_b32 a124, v209
    v_accvgpr_read_b32 v209, a125
    v_mul_f32 v209, v209, v210
    v_accvgpr_write_b32 a125, v209
    v_accvgpr_read_b32 v209, a126
    v_mul_f32 v209, v209, v210
    v_accvgpr_write_b32 a126, v209
    v_accvgpr_read_b32 v209, a127
    v_mul_f32 v209, v209, v210
    v_accvgpr_write_b32 a127, v209
    v_sub_f32 v152, v152, v208
    v_sub_f32 v88, v88, v208
    v_sub_f32 v56, v56, v208
    v_sub_f32 v153, v153, v208
    v_sub_f32 v89, v89, v208
    v_sub_f32 v57, v57, v208
    v_sub_f32 v154, v154, v208
    v_sub_f32 v90, v90, v208
    v_sub_f32 v58, v58, v208
    v_sub_f32 v155, v155, v208
    v_sub_f32 v91, v91, v208
    v_sub_f32 v59, v59, v208
    v_sub_f32 v156, v156, v208
    v_sub_f32 v92, v92, v208
    v_sub_f32 v60, v60, v208
    v_sub_f32 v157, v157, v208
    v_sub_f32 v93, v93, v208
    v_sub_f32 v61, v61, v208
    v_sub_f32 v158, v158, v208
    v_sub_f32 v94, v94, v208
    v_sub_f32 v62, v62, v208
    v_sub_f32 v159, v159, v208
    v_sub_f32 v95, v95, v208
    v_sub_f32 v63, v63, v208
    v_sub_f32 v160, v160, v208
    v_sub_f32 v96, v96, v208
    v_sub_f32 v64, v64, v208
    v_sub_f32 v161, v161, v208
    v_sub_f32 v97, v97, v208
    v_sub_f32 v65, v65, v208
    v_sub_f32 v162, v162, v208
    v_sub_f32 v98, v98, v208
    v_sub_f32 v66, v66, v208
    v_sub_f32 v163, v163, v208
    v_sub_f32 v99, v99, v208
    v_sub_f32 v67, v67, v208
    v_sub_f32 v164, v164, v208
    v_sub_f32 v100, v100, v208
    v_sub_f32 v68, v68, v208
    v_sub_f32 v165, v165, v208
    v_sub_f32 v101, v101, v208
    v_sub_f32 v69, v69, v208
    v_sub_f32 v166, v166, v208
    v_sub_f32 v102, v102, v208
    v_sub_f32 v70, v70, v208
    v_sub_f32 v167, v167, v208
    v_sub_f32 v103, v103, v208
    v_sub_f32 v71, v71, v208
    v_exp_f32 v30, v72
    v_exp_f32 v31, v73
    s_nop 0
    v_add_f32 v28, v30, v31
    v_cvt_pk_bf16_f32 v120, v30, v31
    v_exp_f32 v32, v74
    v_exp_f32 v33, v75
    v_add_f32 v28, v28, v32
    v_add_f32 v28, v28, v33
    v_cvt_pk_bf16_f32 v121, v32, v33
    v_exp_f32 v30, v76
    v_exp_f32 v31, v77
    v_add_f32 v28, v28, v30
    v_add_f32 v28, v28, v31
    v_cvt_pk_bf16_f32 v122, v30, v31
    v_exp_f32 v32, v78
    v_exp_f32 v33, v79
    v_add_f32 v28, v28, v32
    v_add_f32 v28, v28, v33
    v_cvt_pk_bf16_f32 v123, v32, v33
    v_exp_f32 v30, v80
    v_exp_f32 v31, v81
    v_add_f32 v28, v28, v30
    v_add_f32 v28, v28, v31
    v_cvt_pk_bf16_f32 v124, v30, v31
    v_exp_f32 v32, v82
    v_exp_f32 v33, v83
    v_add_f32 v28, v28, v32
    v_add_f32 v28, v28, v33
    v_cvt_pk_bf16_f32 v125, v32, v33
    v_exp_f32 v30, v84
    v_exp_f32 v31, v85
    v_add_f32 v28, v28, v30
    v_add_f32 v28, v28, v31
    v_cvt_pk_bf16_f32 v126, v30, v31
    v_exp_f32 v32, v86
    v_exp_f32 v33, v87
    v_add_f32 v28, v28, v32
    v_add_f32 v28, v28, v33
    v_cvt_pk_bf16_f32 v127, v32, v33
    v_exp_f32 v30, v88
    v_exp_f32 v31, v89
    s_nop 0
    v_add_f32 v29, v30, v31
    v_cvt_pk_bf16_f32 v128, v30, v31
    v_exp_f32 v32, v90
    v_exp_f32 v33, v91
    v_add_f32 v29, v29, v32
    v_add_f32 v29, v29, v33
    v_cvt_pk_bf16_f32 v129, v32, v33
    v_exp_f32 v30, v92
    v_exp_f32 v31, v93
    v_add_f32 v29, v29, v30
    v_add_f32 v29, v29, v31
    v_cvt_pk_bf16_f32 v130, v30, v31
    v_exp_f32 v32, v94
    v_exp_f32 v33, v95
    v_add_f32 v29, v29, v32
    v_add_f32 v29, v29, v33
    v_cvt_pk_bf16_f32 v131, v32, v33
    v_exp_f32 v30, v96
    v_exp_f32 v31, v97
    v_add_f32 v29, v29, v30
    v_add_f32 v29, v29, v31
    v_cvt_pk_bf16_f32 v132, v30, v31
    v_exp_f32 v32, v98
    v_exp_f32 v33, v99
    v_add_f32 v29, v29, v32
    v_add_f32 v29, v29, v33
    v_cvt_pk_bf16_f32 v133, v32, v33
    v_exp_f32 v30, v100
    v_exp_f32 v31, v101
    v_add_f32 v29, v29, v30
    v_add_f32 v29, v29, v31
    v_cvt_pk_bf16_f32 v134, v30, v31
    v_exp_f32 v32, v102
    v_exp_f32 v33, v103
    v_add_f32 v29, v29, v32
    v_add_f32 v29, v29, v33
    v_cvt_pk_bf16_f32 v135, v32, v33
    s_nop 1
    s_branch attn_kernel_ret16

.globl oproj_kernel
.p2align 8
.type oproj_kernel,@function
oproj_kernel:
    s_cmp_ge_u32 s2, 256
    s_cbranch_scc1 oproj_kernel_done
    s_load_dwordx2 s[8:9], s[0:1], 96
    s_load_dwordx2 s[12:13], s[0:1], 32
    s_load_dwordx2 s[16:17], s[0:1], 96
    v_lshrrev_b32 v4, 6, v0
    v_and_b32 v1, 63, v0
    v_readfirstlane_b32 s5, v4
    v_and_b32 v2, 31, v0
    v_lshrrev_b32 v3, 5, v1
    s_and_b32 s6, s2, 7
    s_lshr_b32 s7, s2, 3
    s_and_b32 s3, s6, 1
    s_lshl_b32 s3, s3, 4
    s_and_b32 s24, s7, 15
    s_add_u32 s3, s3, s24
    s_lshr_b32 s4, s7, 4
    s_lshr_b32 s6, s6, 1
    s_mul_i32 s23, s6, 1024
    s_mul_i32 s24, s3, 64
    s_mul_i32 s22, s24, 1152
    s_mul_i32 s25, s6, 2359296
    s_add_u32 s22, s22, s25
    s_mul_i32 s25, s4, 576
    s_add_u32 s22, s22, s25
    s_waitcnt lgkmcnt(0)
    s_add_u32 s8, s8, 0x1000000
    s_addc_u32 s9, s9, 0
    s_and_b32 s9, s9, 0xffff
    s_mov_b32 s10, 0x1000000
    s_mov_b32 s11, 0x00020000
    s_and_b32 s13, s13, 0xffff
    s_mov_b32 s14, 0x480000
    s_mov_b32 s15, 0x00020000
    s_add_u32 s16, s16, 0x4000000
    s_addc_u32 s17, s17, 0
    s_and_b32 s17, s17, 0xffff
    s_mov_b32 s18, 0x900000
    s_mov_b32 s19, 0x00020000
    s_cmp_ge_u32 s5, 4
    s_cbranch_scc1 oproj_kernel_loader
    s_and_b32 s26, s5, 1
    s_lshr_b32 s27, s5, 1
    s_lshl_b32 s26, s26, 12
    s_lshl_b32 s28, s27, 2
    s_mul_i32 s27, s27, 18432
    v_bfe_u32 v28, v2, 1, 3
    v_lshlrev_b32 v29, 7, v2
    v_add_u32 v29, s26, v29
    v_add_u32 v31, s28, v3
    v_add_u32 v30, 0, v31
    v_xor_b32 v30, v30, v28
    v_lshl_add_u32 v4, v30, 4, v29
    v_add_u32 v30, 2, v31
    v_xor_b32 v30, v30, v28
    v_lshl_add_u32 v5, v30, 4, v29
    v_bfe_u32 v28, v1, 2, 2
    v_lshl_add_u32 v28, v3, 3, v28
    v_mul_u32_u24 v28, 576, v28
    v_bfe_u32 v29, v1, 4, 1
    v_lshl_add_u32 v28, v29, 5, v28
    v_and_b32 v29, 3, v1
    v_lshl_add_u32 v28, v29, 3, v28
    v_add_u32 v8, s27, v28
    s_barrier
    ds_read_b128 v[80:83], v4
    ds_read_b64_tr_b16 v[32:33], v8 offset:8192
    ds_read_b64_tr_b16 v[34:35], v8 offset:10496
    ds_read_b64_tr_b16 v[36:37], v8 offset:8256
    ds_read_b64_tr_b16 v[38:39], v8 offset:10560
    ds_read_b64_tr_b16 v[40:41], v8 offset:8320
    ds_read_b64_tr_b16 v[42:43], v8 offset:10624
    ds_read_b64_tr_b16 v[44:45], v8 offset:8384
    ds_read_b64_tr_b16 v[46:47], v8 offset:10688
    ds_read_b64_tr_b16 v[48:49], v8 offset:8448
    ds_read_b64_tr_b16 v[50:51], v8 offset:10752
    ds_read_b64_tr_b16 v[52:53], v8 offset:8512
    ds_read_b64_tr_b16 v[54:55], v8 offset:10816
    ds_read_b64_tr_b16 v[56:57], v8 offset:8576
    ds_read_b64_tr_b16 v[58:59], v8 offset:10880
    ds_read_b64_tr_b16 v[60:61], v8 offset:8640
    ds_read_b64_tr_b16 v[62:63], v8 offset:10944
    s_waitcnt lgkmcnt(14)
    v_mfma_f32_32x32x16_bf16 v[100:115], v[32:35], v[80:83], 0
    ds_read_b128 v[84:87], v5
    ds_read_b64_tr_b16 v[64:65], v8 offset:8704
    ds_read_b64_tr_b16 v[66:67], v8 offset:11008
    s_waitcnt lgkmcnt(15)
    v_mfma_f32_32x32x16_bf16 v[116:131], v[36:39], v[80:83], 0
    ds_read_b64_tr_b16 v[68:69], v8 offset:17408
    ds_read_b64_tr_b16 v[70:71], v8 offset:19712
    s_waitcnt lgkmcnt(15)
    v_mfma_f32_32x32x16_bf16 v[132:147], v[40:43], v[80:83], 0
    ds_read_b64_tr_b16 v[32:33], v8 offset:17472
    ds_read_b64_tr_b16 v[34:35], v8 offset:19776
    s_waitcnt lgkmcnt(15)
    v_mfma_f32_32x32x16_bf16 v[148:163], v[44:47], v[80:83], 0
    ds_read_b64_tr_b16 v[36:37], v8 offset:17536
    ds_read_b64_tr_b16 v[38:39], v8 offset:19840
    s_waitcnt lgkmcnt(15)
    v_mfma_f32_32x32x16_bf16 v[164:179], v[48:51], v[80:83], 0
    ds_read_b64_tr_b16 v[40:41], v8 offset:17600
    ds_read_b64_tr_b16 v[42:43], v8 offset:19904
    s_waitcnt lgkmcnt(15)
    v_mfma_f32_32x32x16_bf16 v[180:195], v[52:55], v[80:83], 0
    ds_read_b64_tr_b16 v[44:45], v8 offset:17664
    ds_read_b64_tr_b16 v[46:47], v8 offset:19968
    s_waitcnt lgkmcnt(15)
    v_mfma_f32_32x32x16_bf16 v[196:211], v[56:59], v[80:83], 0
    ds_read_b64_tr_b16 v[48:49], v8 offset:17728
    ds_read_b64_tr_b16 v[50:51], v8 offset:20032
    s_waitcnt lgkmcnt(15)
    v_mfma_f32_32x32x16_bf16 v[212:227], v[60:63], v[80:83], 0
    ds_read_b64_tr_b16 v[52:53], v8 offset:17792
    ds_read_b64_tr_b16 v[54:55], v8 offset:20096
    s_waitcnt lgkmcnt(14)
    v_mfma_f32_32x32x16_bf16 v[228:243], v[64:67], v[80:83], 0
    ds_read_b64_tr_b16 v[56:57], v8 offset:17856
    ds_read_b64_tr_b16 v[58:59], v8 offset:20160
    s_waitcnt lgkmcnt(14)
    v_mfma_f32_32x32x16_bf16 v[100:115], v[68:71], v[84:87], v[100:115]
    ds_read_b64_tr_b16 v[60:61], v8 offset:17920
    ds_read_b64_tr_b16 v[62:63], v8 offset:20224
    s_waitcnt lgkmcnt(14)
    v_mfma_f32_32x32x16_bf16 v[116:131], v[32:35], v[84:87], v[116:131]
    s_waitcnt lgkmcnt(12)
    v_mfma_f32_32x32x16_bf16 v[132:147], v[36:39], v[84:87], v[132:147]
    s_waitcnt lgkmcnt(10)
    v_mfma_f32_32x32x16_bf16 v[148:163], v[40:43], v[84:87], v[148:163]
    s_waitcnt lgkmcnt(0)
    s_barrier
    v_add_u32 v4, 45056, v4
    v_add_u32 v5, 45056, v5
    v_add_u32 v8, 45056, v8
    ds_read_b128 v[88:91], v4
    ds_read_b64_tr_b16 v[64:65], v8 offset:8192
    ds_read_b64_tr_b16 v[66:67], v8 offset:10496
    ds_read_b64_tr_b16 v[68:69], v8 offset:8256
    ds_read_b64_tr_b16 v[70:71], v8 offset:10560
    ds_read_b64_tr_b16 v[32:33], v8 offset:8320
    ds_read_b64_tr_b16 v[34:35], v8 offset:10624
    s_waitcnt lgkmcnt(15)
    v_mfma_f32_32x32x16_bf16 v[164:179], v[44:47], v[84:87], v[164:179]
    ds_read_b64_tr_b16 v[36:37], v8 offset:8384
    ds_read_b64_tr_b16 v[38:39], v8 offset:10688
    s_waitcnt lgkmcnt(15)
    v_mfma_f32_32x32x16_bf16 v[180:195], v[48:51], v[84:87], v[180:195]
    ds_read_b64_tr_b16 v[40:41], v8 offset:8448
    ds_read_b64_tr_b16 v[42:43], v8 offset:10752
    s_waitcnt lgkmcnt(15)
    v_mfma_f32_32x32x16_bf16 v[196:211], v[52:55], v[84:87], v[196:211]
    ds_read_b64_tr_b16 v[44:45], v8 offset:8512
    ds_read_b64_tr_b16 v[46:47], v8 offset:10816
    s_waitcnt lgkmcnt(15)
    v_mfma_f32_32x32x16_bf16 v[212:227], v[56:59], v[84:87], v[212:227]
    ds_read_b64_tr_b16 v[48:49], v8 offset:8576
    ds_read_b64_tr_b16 v[50:51], v8 offset:10880
    s_waitcnt lgkmcnt(15)
    v_mfma_f32_32x32x16_bf16 v[228:243], v[60:63], v[84:87], v[228:243]
    ds_read_b64_tr_b16 v[52:53], v8 offset:8640
    ds_read_b64_tr_b16 v[54:55], v8 offset:10944
    s_waitcnt lgkmcnt(14)
    v_mfma_f32_32x32x16_bf16 v[100:115], v[64:67], v[88:91], v[100:115]
    ds_read_b128 v[92:95], v5
    ds_read_b64_tr_b16 v[56:57], v8 offset:8704
    ds_read_b64_tr_b16 v[58:59], v8 offset:11008
    s_waitcnt lgkmcnt(15)
    v_mfma_f32_32x32x16_bf16 v[116:131], v[68:71], v[88:91], v[116:131]
    ds_read_b64_tr_b16 v[60:61], v8 offset:17408
    ds_read_b64_tr_b16 v[62:63], v8 offset:19712
    s_waitcnt lgkmcnt(15)
    v_mfma_f32_32x32x16_bf16 v[132:147], v[32:35], v[88:91], v[132:147]
    ds_read_b64_tr_b16 v[64:65], v8 offset:17472
    ds_read_b64_tr_b16 v[66:67], v8 offset:19776
    s_waitcnt lgkmcnt(15)
    v_mfma_f32_32x32x16_bf16 v[148:163], v[36:39], v[88:91], v[148:163]
    ds_read_b64_tr_b16 v[68:69], v8 offset:17536
    ds_read_b64_tr_b16 v[70:71], v8 offset:19840
    s_waitcnt lgkmcnt(15)
    v_mfma_f32_32x32x16_bf16 v[164:179], v[40:43], v[88:91], v[164:179]
    ds_read_b64_tr_b16 v[32:33], v8 offset:17600
    ds_read_b64_tr_b16 v[34:35], v8 offset:19904
    s_waitcnt lgkmcnt(15)
    v_mfma_f32_32x32x16_bf16 v[180:195], v[44:47], v[88:91], v[180:195]
    ds_read_b64_tr_b16 v[36:37], v8 offset:17664
    ds_read_b64_tr_b16 v[38:39], v8 offset:19968
    s_waitcnt lgkmcnt(15)
    v_mfma_f32_32x32x16_bf16 v[196:211], v[48:51], v[88:91], v[196:211]
    ds_read_b64_tr_b16 v[40:41], v8 offset:17728
    ds_read_b64_tr_b16 v[42:43], v8 offset:20032
    s_waitcnt lgkmcnt(15)
    v_mfma_f32_32x32x16_bf16 v[212:227], v[52:55], v[88:91], v[212:227]
    ds_read_b64_tr_b16 v[44:45], v8 offset:17792
    ds_read_b64_tr_b16 v[46:47], v8 offset:20096
    s_waitcnt lgkmcnt(14)
    v_mfma_f32_32x32x16_bf16 v[228:243], v[56:59], v[88:91], v[228:243]
    ds_read_b64_tr_b16 v[48:49], v8 offset:17856
    ds_read_b64_tr_b16 v[50:51], v8 offset:20160
    s_waitcnt lgkmcnt(14)
    v_mfma_f32_32x32x16_bf16 v[100:115], v[60:63], v[92:95], v[100:115]
    ds_read_b64_tr_b16 v[52:53], v8 offset:17920
    ds_read_b64_tr_b16 v[54:55], v8 offset:20224
    s_waitcnt lgkmcnt(14)
    v_mfma_f32_32x32x16_bf16 v[116:131], v[64:67], v[92:95], v[116:131]
    s_waitcnt lgkmcnt(12)
    v_mfma_f32_32x32x16_bf16 v[132:147], v[68:71], v[92:95], v[132:147]
    s_waitcnt lgkmcnt(10)
    v_mfma_f32_32x32x16_bf16 v[148:163], v[32:35], v[92:95], v[148:163]
    s_waitcnt lgkmcnt(0)
    s_barrier
    v_add_u32 v4, 45056, v4
    v_add_u32 v5, 45056, v5
    v_add_u32 v8, 45056, v8
    ds_read_b128 v[80:83], v4
    ds_read_b64_tr_b16 v[56:57], v8 offset:8192
    ds_read_b64_tr_b16 v[58:59], v8 offset:10496
    ds_read_b64_tr_b16 v[60:61], v8 offset:8256
    ds_read_b64_tr_b16 v[62:63], v8 offset:10560
    ds_read_b64_tr_b16 v[64:65], v8 offset:8320
    ds_read_b64_tr_b16 v[66:67], v8 offset:10624
    s_waitcnt lgkmcnt(15)
    v_mfma_f32_32x32x16_bf16 v[164:179], v[36:39], v[92:95], v[164:179]
    ds_read_b64_tr_b16 v[68:69], v8 offset:8384
    ds_read_b64_tr_b16 v[70:71], v8 offset:10688
    s_waitcnt lgkmcnt(15)
    v_mfma_f32_32x32x16_bf16 v[180:195], v[40:43], v[92:95], v[180:195]
    ds_read_b64_tr_b16 v[32:33], v8 offset:8448
    ds_read_b64_tr_b16 v[34:35], v8 offset:10752
    s_waitcnt lgkmcnt(15)
    v_mfma_f32_32x32x16_bf16 v[196:211], v[44:47], v[92:95], v[196:211]
    ds_read_b64_tr_b16 v[36:37], v8 offset:8512
    ds_read_b64_tr_b16 v[38:39], v8 offset:10816
    s_waitcnt lgkmcnt(15)
    v_mfma_f32_32x32x16_bf16 v[212:227], v[48:51], v[92:95], v[212:227]
    ds_read_b64_tr_b16 v[40:41], v8 offset:8576
    ds_read_b64_tr_b16 v[42:43], v8 offset:10880
    s_waitcnt lgkmcnt(15)
    v_mfma_f32_32x32x16_bf16 v[228:243], v[52:55], v[92:95], v[228:243]
    ds_read_b64_tr_b16 v[44:45], v8 offset:8640
    ds_read_b64_tr_b16 v[46:47], v8 offset:10944
    s_waitcnt lgkmcnt(14)
    v_mfma_f32_32x32x16_bf16 v[100:115], v[56:59], v[80:83], v[100:115]
    ds_read_b128 v[84:87], v5
    ds_read_b64_tr_b16 v[48:49], v8 offset:8704
    ds_read_b64_tr_b16 v[50:51], v8 offset:11008
    s_waitcnt lgkmcnt(15)
    v_mfma_f32_32x32x16_bf16 v[116:131], v[60:63], v[80:83], v[116:131]
    ds_read_b64_tr_b16 v[52:53], v8 offset:17408
    ds_read_b64_tr_b16 v[54:55], v8 offset:19712
    s_waitcnt lgkmcnt(15)
    v_mfma_f32_32x32x16_bf16 v[132:147], v[64:67], v[80:83], v[132:147]
    ds_read_b64_tr_b16 v[56:57], v8 offset:17472
    ds_read_b64_tr_b16 v[58:59], v8 offset:19776
    s_waitcnt lgkmcnt(15)
    v_mfma_f32_32x32x16_bf16 v[148:163], v[68:71], v[80:83], v[148:163]
    ds_read_b64_tr_b16 v[60:61], v8 offset:17536
    ds_read_b64_tr_b16 v[62:63], v8 offset:19840
    s_waitcnt lgkmcnt(15)
    v_mfma_f32_32x32x16_bf16 v[164:179], v[32:35], v[80:83], v[164:179]
    ds_read_b64_tr_b16 v[64:65], v8 offset:17600
    ds_read_b64_tr_b16 v[66:67], v8 offset:19904
    s_waitcnt lgkmcnt(15)
    v_mfma_f32_32x32x16_bf16 v[180:195], v[36:39], v[80:83], v[180:195]
    ds_read_b64_tr_b16 v[68:69], v8 offset:17664
    ds_read_b64_tr_b16 v[70:71], v8 offset:19968
    s_waitcnt lgkmcnt(15)
    v_mfma_f32_32x32x16_bf16 v[196:211], v[40:43], v[80:83], v[196:211]
    ds_read_b64_tr_b16 v[32:33], v8 offset:17728
    ds_read_b64_tr_b16 v[34:35], v8 offset:20032
    s_waitcnt lgkmcnt(15)
    v_mfma_f32_32x32x16_bf16 v[212:227], v[44:47], v[80:83], v[212:227]
    ds_read_b64_tr_b16 v[36:37], v8 offset:17792
    ds_read_b64_tr_b16 v[38:39], v8 offset:20096
    s_waitcnt lgkmcnt(14)
    v_mfma_f32_32x32x16_bf16 v[228:243], v[48:51], v[80:83], v[228:243]
    ds_read_b64_tr_b16 v[40:41], v8 offset:17856
    ds_read_b64_tr_b16 v[42:43], v8 offset:20160
    s_waitcnt lgkmcnt(14)
    v_mfma_f32_32x32x16_bf16 v[100:115], v[52:55], v[84:87], v[100:115]
    ds_read_b64_tr_b16 v[44:45], v8 offset:17920
    ds_read_b64_tr_b16 v[46:47], v8 offset:20224
    s_waitcnt lgkmcnt(14)
    v_mfma_f32_32x32x16_bf16 v[116:131], v[56:59], v[84:87], v[116:131]
    s_waitcnt lgkmcnt(12)
    v_mfma_f32_32x32x16_bf16 v[132:147], v[60:63], v[84:87], v[132:147]
    s_waitcnt lgkmcnt(10)
    v_mfma_f32_32x32x16_bf16 v[148:163], v[64:67], v[84:87], v[148:163]
    s_waitcnt lgkmcnt(0)
    s_barrier
    v_subrev_u32 v4, 90112, v4
    v_subrev_u32 v5, 90112, v5
    v_subrev_u32 v8, 90112, v8
    ds_read_b128 v[88:91], v4
    ds_read_b64_tr_b16 v[48:49], v8 offset:8192
    ds_read_b64_tr_b16 v[50:51], v8 offset:10496
    ds_read_b64_tr_b16 v[52:53], v8 offset:8256
    ds_read_b64_tr_b16 v[54:55], v8 offset:10560
    ds_read_b64_tr_b16 v[56:57], v8 offset:8320
    ds_read_b64_tr_b16 v[58:59], v8 offset:10624
    s_waitcnt lgkmcnt(15)
    v_mfma_f32_32x32x16_bf16 v[164:179], v[68:71], v[84:87], v[164:179]
    ds_read_b64_tr_b16 v[60:61], v8 offset:8384
    ds_read_b64_tr_b16 v[62:63], v8 offset:10688
    s_waitcnt lgkmcnt(15)
    v_mfma_f32_32x32x16_bf16 v[180:195], v[32:35], v[84:87], v[180:195]
    ds_read_b64_tr_b16 v[64:65], v8 offset:8448
    ds_read_b64_tr_b16 v[66:67], v8 offset:10752
    s_waitcnt lgkmcnt(15)
    v_mfma_f32_32x32x16_bf16 v[196:211], v[36:39], v[84:87], v[196:211]
    ds_read_b64_tr_b16 v[68:69], v8 offset:8512
    ds_read_b64_tr_b16 v[70:71], v8 offset:10816
    s_waitcnt lgkmcnt(15)
    v_mfma_f32_32x32x16_bf16 v[212:227], v[40:43], v[84:87], v[212:227]
    ds_read_b64_tr_b16 v[32:33], v8 offset:8576
    ds_read_b64_tr_b16 v[34:35], v8 offset:10880
    s_waitcnt lgkmcnt(15)
    v_mfma_f32_32x32x16_bf16 v[228:243], v[44:47], v[84:87], v[228:243]
    ds_read_b64_tr_b16 v[36:37], v8 offset:8640
    ds_read_b64_tr_b16 v[38:39], v8 offset:10944
    s_waitcnt lgkmcnt(14)
    v_mfma_f32_32x32x16_bf16 v[100:115], v[48:51], v[88:91], v[100:115]
    ds_read_b128 v[92:95], v5
    ds_read_b64_tr_b16 v[40:41], v8 offset:8704
    ds_read_b64_tr_b16 v[42:43], v8 offset:11008
    s_waitcnt lgkmcnt(15)
    v_mfma_f32_32x32x16_bf16 v[116:131], v[52:55], v[88:91], v[116:131]
    ds_read_b64_tr_b16 v[44:45], v8 offset:17408
    ds_read_b64_tr_b16 v[46:47], v8 offset:19712
    s_waitcnt lgkmcnt(15)
    v_mfma_f32_32x32x16_bf16 v[132:147], v[56:59], v[88:91], v[132:147]
    ds_read_b64_tr_b16 v[48:49], v8 offset:17472
    ds_read_b64_tr_b16 v[50:51], v8 offset:19776
    s_waitcnt lgkmcnt(15)
    v_mfma_f32_32x32x16_bf16 v[148:163], v[60:63], v[88:91], v[148:163]
    ds_read_b64_tr_b16 v[52:53], v8 offset:17536
    ds_read_b64_tr_b16 v[54:55], v8 offset:19840
    s_waitcnt lgkmcnt(15)
    v_mfma_f32_32x32x16_bf16 v[164:179], v[64:67], v[88:91], v[164:179]
    ds_read_b64_tr_b16 v[56:57], v8 offset:17600
    ds_read_b64_tr_b16 v[58:59], v8 offset:19904
    s_waitcnt lgkmcnt(15)
    v_mfma_f32_32x32x16_bf16 v[180:195], v[68:71], v[88:91], v[180:195]
    ds_read_b64_tr_b16 v[60:61], v8 offset:17664
    ds_read_b64_tr_b16 v[62:63], v8 offset:19968
    s_waitcnt lgkmcnt(15)
    v_mfma_f32_32x32x16_bf16 v[196:211], v[32:35], v[88:91], v[196:211]
    ds_read_b64_tr_b16 v[64:65], v8 offset:17728
    ds_read_b64_tr_b16 v[66:67], v8 offset:20032
    s_waitcnt lgkmcnt(15)
    v_mfma_f32_32x32x16_bf16 v[212:227], v[36:39], v[88:91], v[212:227]
    ds_read_b64_tr_b16 v[68:69], v8 offset:17792
    ds_read_b64_tr_b16 v[70:71], v8 offset:20096
    s_waitcnt lgkmcnt(14)
    v_mfma_f32_32x32x16_bf16 v[228:243], v[40:43], v[88:91], v[228:243]
    ds_read_b64_tr_b16 v[32:33], v8 offset:17856
    ds_read_b64_tr_b16 v[34:35], v8 offset:20160
    s_waitcnt lgkmcnt(14)
    v_mfma_f32_32x32x16_bf16 v[100:115], v[44:47], v[92:95], v[100:115]
    ds_read_b64_tr_b16 v[36:37], v8 offset:17920
    ds_read_b64_tr_b16 v[38:39], v8 offset:20224
    s_waitcnt lgkmcnt(14)
    v_mfma_f32_32x32x16_bf16 v[116:131], v[48:51], v[92:95], v[116:131]
    s_waitcnt lgkmcnt(12)
    v_mfma_f32_32x32x16_bf16 v[132:147], v[52:55], v[92:95], v[132:147]
    s_waitcnt lgkmcnt(10)
    v_mfma_f32_32x32x16_bf16 v[148:163], v[56:59], v[92:95], v[148:163]
    s_waitcnt lgkmcnt(0)
    s_barrier
    v_add_u32 v4, 45056, v4
    v_add_u32 v5, 45056, v5
    v_add_u32 v8, 45056, v8
    ds_read_b128 v[80:83], v4
    ds_read_b64_tr_b16 v[40:41], v8 offset:8192
    ds_read_b64_tr_b16 v[42:43], v8 offset:10496
    ds_read_b64_tr_b16 v[44:45], v8 offset:8256
    ds_read_b64_tr_b16 v[46:47], v8 offset:10560
    ds_read_b64_tr_b16 v[48:49], v8 offset:8320
    ds_read_b64_tr_b16 v[50:51], v8 offset:10624
    s_waitcnt lgkmcnt(15)
    v_mfma_f32_32x32x16_bf16 v[164:179], v[60:63], v[92:95], v[164:179]
    ds_read_b64_tr_b16 v[52:53], v8 offset:8384
    ds_read_b64_tr_b16 v[54:55], v8 offset:10688
    s_waitcnt lgkmcnt(15)
    v_mfma_f32_32x32x16_bf16 v[180:195], v[64:67], v[92:95], v[180:195]
    ds_read_b64_tr_b16 v[56:57], v8 offset:8448
    ds_read_b64_tr_b16 v[58:59], v8 offset:10752
    s_waitcnt lgkmcnt(15)
    v_mfma_f32_32x32x16_bf16 v[196:211], v[68:71], v[92:95], v[196:211]
    ds_read_b64_tr_b16 v[60:61], v8 offset:8512
    ds_read_b64_tr_b16 v[62:63], v8 offset:10816
    s_waitcnt lgkmcnt(15)
    v_mfma_f32_32x32x16_bf16 v[212:227], v[32:35], v[92:95], v[212:227]
    ds_read_b64_tr_b16 v[64:65], v8 offset:8576
    ds_read_b64_tr_b16 v[66:67], v8 offset:10880
    s_waitcnt lgkmcnt(15)
    v_mfma_f32_32x32x16_bf16 v[228:243], v[36:39], v[92:95], v[228:243]
    ds_read_b64_tr_b16 v[68:69], v8 offset:8640
    ds_read_b64_tr_b16 v[70:71], v8 offset:10944
    s_waitcnt lgkmcnt(14)
    v_mfma_f32_32x32x16_bf16 v[100:115], v[40:43], v[80:83], v[100:115]
    ds_read_b128 v[84:87], v5
    ds_read_b64_tr_b16 v[32:33], v8 offset:8704
    ds_read_b64_tr_b16 v[34:35], v8 offset:11008
    s_waitcnt lgkmcnt(15)
    v_mfma_f32_32x32x16_bf16 v[116:131], v[44:47], v[80:83], v[116:131]
    ds_read_b64_tr_b16 v[36:37], v8 offset:17408
    ds_read_b64_tr_b16 v[38:39], v8 offset:19712
    s_waitcnt lgkmcnt(15)
    v_mfma_f32_32x32x16_bf16 v[132:147], v[48:51], v[80:83], v[132:147]
    ds_read_b64_tr_b16 v[40:41], v8 offset:17472
    ds_read_b64_tr_b16 v[42:43], v8 offset:19776
    s_waitcnt lgkmcnt(15)
    v_mfma_f32_32x32x16_bf16 v[148:163], v[52:55], v[80:83], v[148:163]
    ds_read_b64_tr_b16 v[44:45], v8 offset:17536
    ds_read_b64_tr_b16 v[46:47], v8 offset:19840
    s_waitcnt lgkmcnt(15)
    v_mfma_f32_32x32x16_bf16 v[164:179], v[56:59], v[80:83], v[164:179]
    ds_read_b64_tr_b16 v[48:49], v8 offset:17600
    ds_read_b64_tr_b16 v[50:51], v8 offset:19904
    s_waitcnt lgkmcnt(15)
    v_mfma_f32_32x32x16_bf16 v[180:195], v[60:63], v[80:83], v[180:195]
    ds_read_b64_tr_b16 v[52:53], v8 offset:17664
    ds_read_b64_tr_b16 v[54:55], v8 offset:19968
    s_waitcnt lgkmcnt(15)
    v_mfma_f32_32x32x16_bf16 v[196:211], v[64:67], v[80:83], v[196:211]
    ds_read_b64_tr_b16 v[56:57], v8 offset:17728
    ds_read_b64_tr_b16 v[58:59], v8 offset:20032
    s_waitcnt lgkmcnt(15)
    v_mfma_f32_32x32x16_bf16 v[212:227], v[68:71], v[80:83], v[212:227]
    ds_read_b64_tr_b16 v[60:61], v8 offset:17792
    ds_read_b64_tr_b16 v[62:63], v8 offset:20096
    s_waitcnt lgkmcnt(14)
    v_mfma_f32_32x32x16_bf16 v[228:243], v[32:35], v[80:83], v[228:243]
    ds_read_b64_tr_b16 v[64:65], v8 offset:17856
    ds_read_b64_tr_b16 v[66:67], v8 offset:20160
    s_waitcnt lgkmcnt(14)
    v_mfma_f32_32x32x16_bf16 v[100:115], v[36:39], v[84:87], v[100:115]
    ds_read_b64_tr_b16 v[68:69], v8 offset:17920
    ds_read_b64_tr_b16 v[70:71], v8 offset:20224
    s_waitcnt lgkmcnt(14)
    v_mfma_f32_32x32x16_bf16 v[116:131], v[40:43], v[84:87], v[116:131]
    s_waitcnt lgkmcnt(12)
    v_mfma_f32_32x32x16_bf16 v[132:147], v[44:47], v[84:87], v[132:147]
    s_waitcnt lgkmcnt(10)
    v_mfma_f32_32x32x16_bf16 v[148:163], v[48:51], v[84:87], v[148:163]
    s_waitcnt lgkmcnt(0)
    s_barrier
    v_add_u32 v4, 45056, v4
    v_add_u32 v5, 45056, v5
    v_add_u32 v8, 45056, v8
    ds_read_b128 v[88:91], v4
    ds_read_b64_tr_b16 v[32:33], v8 offset:8192
    ds_read_b64_tr_b16 v[34:35], v8 offset:10496
    ds_read_b64_tr_b16 v[36:37], v8 offset:8256
    ds_read_b64_tr_b16 v[38:39], v8 offset:10560
    ds_read_b64_tr_b16 v[40:41], v8 offset:8320
    ds_read_b64_tr_b16 v[42:43], v8 offset:10624
    s_waitcnt lgkmcnt(15)
    v_mfma_f32_32x32x16_bf16 v[164:179], v[52:55], v[84:87], v[164:179]
    ds_read_b64_tr_b16 v[44:45], v8 offset:8384
    ds_read_b64_tr_b16 v[46:47], v8 offset:10688
    s_waitcnt lgkmcnt(15)
    v_mfma_f32_32x32x16_bf16 v[180:195], v[56:59], v[84:87], v[180:195]
    ds_read_b64_tr_b16 v[48:49], v8 offset:8448
    ds_read_b64_tr_b16 v[50:51], v8 offset:10752
    s_waitcnt lgkmcnt(15)
    v_mfma_f32_32x32x16_bf16 v[196:211], v[60:63], v[84:87], v[196:211]
    ds_read_b64_tr_b16 v[52:53], v8 offset:8512
    ds_read_b64_tr_b16 v[54:55], v8 offset:10816
    s_waitcnt lgkmcnt(15)
    v_mfma_f32_32x32x16_bf16 v[212:227], v[64:67], v[84:87], v[212:227]
    ds_read_b64_tr_b16 v[56:57], v8 offset:8576
    ds_read_b64_tr_b16 v[58:59], v8 offset:10880
    s_waitcnt lgkmcnt(15)
    v_mfma_f32_32x32x16_bf16 v[228:243], v[68:71], v[84:87], v[228:243]
    ds_read_b64_tr_b16 v[60:61], v8 offset:8640
    ds_read_b64_tr_b16 v[62:63], v8 offset:10944
    s_waitcnt lgkmcnt(14)
    v_mfma_f32_32x32x16_bf16 v[100:115], v[32:35], v[88:91], v[100:115]
    ds_read_b128 v[92:95], v5
    ds_read_b64_tr_b16 v[64:65], v8 offset:8704
    ds_read_b64_tr_b16 v[66:67], v8 offset:11008
    s_waitcnt lgkmcnt(15)
    v_mfma_f32_32x32x16_bf16 v[116:131], v[36:39], v[88:91], v[116:131]
    ds_read_b64_tr_b16 v[68:69], v8 offset:17408
    ds_read_b64_tr_b16 v[70:71], v8 offset:19712
    s_waitcnt lgkmcnt(15)
    v_mfma_f32_32x32x16_bf16 v[132:147], v[40:43], v[88:91], v[132:147]
    ds_read_b64_tr_b16 v[32:33], v8 offset:17472
    ds_read_b64_tr_b16 v[34:35], v8 offset:19776
    s_waitcnt lgkmcnt(15)
    v_mfma_f32_32x32x16_bf16 v[148:163], v[44:47], v[88:91], v[148:163]
    ds_read_b64_tr_b16 v[36:37], v8 offset:17536
    ds_read_b64_tr_b16 v[38:39], v8 offset:19840
    s_waitcnt lgkmcnt(15)
    v_mfma_f32_32x32x16_bf16 v[164:179], v[48:51], v[88:91], v[164:179]
    ds_read_b64_tr_b16 v[40:41], v8 offset:17600
    ds_read_b64_tr_b16 v[42:43], v8 offset:19904
    s_waitcnt lgkmcnt(15)
    v_mfma_f32_32x32x16_bf16 v[180:195], v[52:55], v[88:91], v[180:195]
    ds_read_b64_tr_b16 v[44:45], v8 offset:17664
    ds_read_b64_tr_b16 v[46:47], v8 offset:19968
    s_waitcnt lgkmcnt(15)
    v_mfma_f32_32x32x16_bf16 v[196:211], v[56:59], v[88:91], v[196:211]
    ds_read_b64_tr_b16 v[48:49], v8 offset:17728
    ds_read_b64_tr_b16 v[50:51], v8 offset:20032
    s_waitcnt lgkmcnt(15)
    v_mfma_f32_32x32x16_bf16 v[212:227], v[60:63], v[88:91], v[212:227]
    ds_read_b64_tr_b16 v[52:53], v8 offset:17792
    ds_read_b64_tr_b16 v[54:55], v8 offset:20096
    s_waitcnt lgkmcnt(14)
    v_mfma_f32_32x32x16_bf16 v[228:243], v[64:67], v[88:91], v[228:243]
    ds_read_b64_tr_b16 v[56:57], v8 offset:17856
    ds_read_b64_tr_b16 v[58:59], v8 offset:20160
    s_waitcnt lgkmcnt(14)
    v_mfma_f32_32x32x16_bf16 v[100:115], v[68:71], v[92:95], v[100:115]
    ds_read_b64_tr_b16 v[60:61], v8 offset:17920
    ds_read_b64_tr_b16 v[62:63], v8 offset:20224
    s_waitcnt lgkmcnt(14)
    v_mfma_f32_32x32x16_bf16 v[116:131], v[32:35], v[92:95], v[116:131]
    s_waitcnt lgkmcnt(12)
    v_mfma_f32_32x32x16_bf16 v[132:147], v[36:39], v[92:95], v[132:147]
    s_waitcnt lgkmcnt(10)
    v_mfma_f32_32x32x16_bf16 v[148:163], v[40:43], v[92:95], v[148:163]
    s_waitcnt lgkmcnt(0)
    s_barrier
    v_subrev_u32 v4, 90112, v4
    v_subrev_u32 v5, 90112, v5
    v_subrev_u32 v8, 90112, v8
    ds_read_b128 v[80:83], v4
    ds_read_b64_tr_b16 v[64:65], v8 offset:8192
    ds_read_b64_tr_b16 v[66:67], v8 offset:10496
    ds_read_b64_tr_b16 v[68:69], v8 offset:8256
    ds_read_b64_tr_b16 v[70:71], v8 offset:10560
    ds_read_b64_tr_b16 v[32:33], v8 offset:8320
    ds_read_b64_tr_b16 v[34:35], v8 offset:10624
    s_waitcnt lgkmcnt(15)
    v_mfma_f32_32x32x16_bf16 v[164:179], v[44:47], v[92:95], v[164:179]
    ds_read_b64_tr_b16 v[36:37], v8 offset:8384
    ds_read_b64_tr_b16 v[38:39], v8 offset:10688
    s_waitcnt lgkmcnt(15)
    v_mfma_f32_32x32x16_bf16 v[180:195], v[48:51], v[92:95], v[180:195]
    ds_read_b64_tr_b16 v[40:41], v8 offset:8448
    ds_read_b64_tr_b16 v[42:43], v8 offset:10752
    s_waitcnt lgkmcnt(15)
    v_mfma_f32_32x32x16_bf16 v[196:211], v[52:55], v[92:95], v[196:211]
    ds_read_b64_tr_b16 v[44:45], v8 offset:8512
    ds_read_b64_tr_b16 v[46:47], v8 offset:10816
    s_waitcnt lgkmcnt(15)
    v_mfma_f32_32x32x16_bf16 v[212:227], v[56:59], v[92:95], v[212:227]
    ds_read_b64_tr_b16 v[48:49], v8 offset:8576
    ds_read_b64_tr_b16 v[50:51], v8 offset:10880
    s_waitcnt lgkmcnt(15)
    v_mfma_f32_32x32x16_bf16 v[228:243], v[60:63], v[92:95], v[228:243]
    ds_read_b64_tr_b16 v[52:53], v8 offset:8640
    ds_read_b64_tr_b16 v[54:55], v8 offset:10944
    s_waitcnt lgkmcnt(14)
    v_mfma_f32_32x32x16_bf16 v[100:115], v[64:67], v[80:83], v[100:115]
    ds_read_b128 v[84:87], v5
    ds_read_b64_tr_b16 v[56:57], v8 offset:8704
    ds_read_b64_tr_b16 v[58:59], v8 offset:11008
    s_waitcnt lgkmcnt(15)
    v_mfma_f32_32x32x16_bf16 v[116:131], v[68:71], v[80:83], v[116:131]
    ds_read_b64_tr_b16 v[60:61], v8 offset:17408
    ds_read_b64_tr_b16 v[62:63], v8 offset:19712
    s_waitcnt lgkmcnt(15)
    v_mfma_f32_32x32x16_bf16 v[132:147], v[32:35], v[80:83], v[132:147]
    ds_read_b64_tr_b16 v[64:65], v8 offset:17472
    ds_read_b64_tr_b16 v[66:67], v8 offset:19776
    s_waitcnt lgkmcnt(15)
    v_mfma_f32_32x32x16_bf16 v[148:163], v[36:39], v[80:83], v[148:163]
    ds_read_b64_tr_b16 v[68:69], v8 offset:17536
    ds_read_b64_tr_b16 v[70:71], v8 offset:19840
    s_waitcnt lgkmcnt(15)
    v_mfma_f32_32x32x16_bf16 v[164:179], v[40:43], v[80:83], v[164:179]
    ds_read_b64_tr_b16 v[32:33], v8 offset:17600
    ds_read_b64_tr_b16 v[34:35], v8 offset:19904
    s_waitcnt lgkmcnt(15)
    v_mfma_f32_32x32x16_bf16 v[180:195], v[44:47], v[80:83], v[180:195]
    ds_read_b64_tr_b16 v[36:37], v8 offset:17664
    ds_read_b64_tr_b16 v[38:39], v8 offset:19968
    s_waitcnt lgkmcnt(15)
    v_mfma_f32_32x32x16_bf16 v[196:211], v[48:51], v[80:83], v[196:211]
    ds_read_b64_tr_b16 v[40:41], v8 offset:17728
    ds_read_b64_tr_b16 v[42:43], v8 offset:20032
    s_waitcnt lgkmcnt(15)
    v_mfma_f32_32x32x16_bf16 v[212:227], v[52:55], v[80:83], v[212:227]
    ds_read_b64_tr_b16 v[44:45], v8 offset:17792
    ds_read_b64_tr_b16 v[46:47], v8 offset:20096
    s_waitcnt lgkmcnt(14)
    v_mfma_f32_32x32x16_bf16 v[228:243], v[56:59], v[80:83], v[228:243]
    ds_read_b64_tr_b16 v[48:49], v8 offset:17856
    ds_read_b64_tr_b16 v[50:51], v8 offset:20160
    s_waitcnt lgkmcnt(14)
    v_mfma_f32_32x32x16_bf16 v[100:115], v[60:63], v[84:87], v[100:115]
    ds_read_b64_tr_b16 v[52:53], v8 offset:17920
    ds_read_b64_tr_b16 v[54:55], v8 offset:20224
    s_waitcnt lgkmcnt(14)
    v_mfma_f32_32x32x16_bf16 v[116:131], v[64:67], v[84:87], v[116:131]
    s_waitcnt lgkmcnt(12)
    v_mfma_f32_32x32x16_bf16 v[132:147], v[68:71], v[84:87], v[132:147]
    s_waitcnt lgkmcnt(10)
    v_mfma_f32_32x32x16_bf16 v[148:163], v[32:35], v[84:87], v[148:163]
    s_waitcnt lgkmcnt(0)
    s_barrier
    v_add_u32 v4, 45056, v4
    v_add_u32 v5, 45056, v5
    v_add_u32 v8, 45056, v8
    ds_read_b128 v[88:91], v4
    ds_read_b64_tr_b16 v[56:57], v8 offset:8192
    ds_read_b64_tr_b16 v[58:59], v8 offset:10496
    ds_read_b64_tr_b16 v[60:61], v8 offset:8256
    ds_read_b64_tr_b16 v[62:63], v8 offset:10560
    ds_read_b64_tr_b16 v[64:65], v8 offset:8320
    ds_read_b64_tr_b16 v[66:67], v8 offset:10624
    s_waitcnt lgkmcnt(15)
    v_mfma_f32_32x32x16_bf16 v[164:179], v[36:39], v[84:87], v[164:179]
    ds_read_b64_tr_b16 v[68:69], v8 offset:8384
    ds_read_b64_tr_b16 v[70:71], v8 offset:10688
    s_waitcnt lgkmcnt(15)
    v_mfma_f32_32x32x16_bf16 v[180:195], v[40:43], v[84:87], v[180:195]
    ds_read_b64_tr_b16 v[32:33], v8 offset:8448
    ds_read_b64_tr_b16 v[34:35], v8 offset:10752
    s_waitcnt lgkmcnt(15)
    v_mfma_f32_32x32x16_bf16 v[196:211], v[44:47], v[84:87], v[196:211]
    ds_read_b64_tr_b16 v[36:37], v8 offset:8512
    ds_read_b64_tr_b16 v[38:39], v8 offset:10816
    s_waitcnt lgkmcnt(15)
    v_mfma_f32_32x32x16_bf16 v[212:227], v[48:51], v[84:87], v[212:227]
    ds_read_b64_tr_b16 v[40:41], v8 offset:8576
    ds_read_b64_tr_b16 v[42:43], v8 offset:10880
    s_waitcnt lgkmcnt(15)
    v_mfma_f32_32x32x16_bf16 v[228:243], v[52:55], v[84:87], v[228:243]
    ds_read_b64_tr_b16 v[44:45], v8 offset:8640
    ds_read_b64_tr_b16 v[46:47], v8 offset:10944
    s_waitcnt lgkmcnt(14)
    v_mfma_f32_32x32x16_bf16 v[100:115], v[56:59], v[88:91], v[100:115]
    ds_read_b128 v[92:95], v5
    ds_read_b64_tr_b16 v[48:49], v8 offset:8704
    ds_read_b64_tr_b16 v[50:51], v8 offset:11008
    s_waitcnt lgkmcnt(15)
    v_mfma_f32_32x32x16_bf16 v[116:131], v[60:63], v[88:91], v[116:131]
    ds_read_b64_tr_b16 v[52:53], v8 offset:17408
    ds_read_b64_tr_b16 v[54:55], v8 offset:19712
    s_waitcnt lgkmcnt(15)
    v_mfma_f32_32x32x16_bf16 v[132:147], v[64:67], v[88:91], v[132:147]
    ds_read_b64_tr_b16 v[56:57], v8 offset:17472
    ds_read_b64_tr_b16 v[58:59], v8 offset:19776
    s_waitcnt lgkmcnt(15)
    v_mfma_f32_32x32x16_bf16 v[148:163], v[68:71], v[88:91], v[148:163]
    ds_read_b64_tr_b16 v[60:61], v8 offset:17536
    ds_read_b64_tr_b16 v[62:63], v8 offset:19840
    s_waitcnt lgkmcnt(15)
    v_mfma_f32_32x32x16_bf16 v[164:179], v[32:35], v[88:91], v[164:179]
    ds_read_b64_tr_b16 v[64:65], v8 offset:17600
    ds_read_b64_tr_b16 v[66:67], v8 offset:19904
    s_waitcnt lgkmcnt(15)
    v_mfma_f32_32x32x16_bf16 v[180:195], v[36:39], v[88:91], v[180:195]
    ds_read_b64_tr_b16 v[68:69], v8 offset:17664
    ds_read_b64_tr_b16 v[70:71], v8 offset:19968
    s_waitcnt lgkmcnt(15)
    v_mfma_f32_32x32x16_bf16 v[196:211], v[40:43], v[88:91], v[196:211]
    ds_read_b64_tr_b16 v[32:33], v8 offset:17728
    ds_read_b64_tr_b16 v[34:35], v8 offset:20032
    s_waitcnt lgkmcnt(15)
    v_mfma_f32_32x32x16_bf16 v[212:227], v[44:47], v[88:91], v[212:227]
    ds_read_b64_tr_b16 v[36:37], v8 offset:17792
    ds_read_b64_tr_b16 v[38:39], v8 offset:20096
    s_waitcnt lgkmcnt(14)
    v_mfma_f32_32x32x16_bf16 v[228:243], v[48:51], v[88:91], v[228:243]
    ds_read_b64_tr_b16 v[40:41], v8 offset:17856
    ds_read_b64_tr_b16 v[42:43], v8 offset:20160
    s_waitcnt lgkmcnt(14)
    v_mfma_f32_32x32x16_bf16 v[100:115], v[52:55], v[92:95], v[100:115]
    ds_read_b64_tr_b16 v[44:45], v8 offset:17920
    ds_read_b64_tr_b16 v[46:47], v8 offset:20224
    s_waitcnt lgkmcnt(14)
    v_mfma_f32_32x32x16_bf16 v[116:131], v[56:59], v[92:95], v[116:131]
    s_waitcnt lgkmcnt(12)
    v_mfma_f32_32x32x16_bf16 v[132:147], v[60:63], v[92:95], v[132:147]
    s_waitcnt lgkmcnt(10)
    v_mfma_f32_32x32x16_bf16 v[148:163], v[64:67], v[92:95], v[148:163]
    s_waitcnt lgkmcnt(0)
    s_barrier
    v_add_u32 v4, 45056, v4
    v_add_u32 v5, 45056, v5
    v_add_u32 v8, 45056, v8
    ds_read_b128 v[80:83], v4
    ds_read_b64_tr_b16 v[48:49], v8 offset:8192
    ds_read_b64_tr_b16 v[50:51], v8 offset:10496
    ds_read_b64_tr_b16 v[52:53], v8 offset:8256
    ds_read_b64_tr_b16 v[54:55], v8 offset:10560
    ds_read_b64_tr_b16 v[56:57], v8 offset:8320
    ds_read_b64_tr_b16 v[58:59], v8 offset:10624
    s_waitcnt lgkmcnt(15)
    v_mfma_f32_32x32x16_bf16 v[164:179], v[68:71], v[92:95], v[164:179]
    ds_read_b64_tr_b16 v[60:61], v8 offset:8384
    ds_read_b64_tr_b16 v[62:63], v8 offset:10688
    s_waitcnt lgkmcnt(15)
    v_mfma_f32_32x32x16_bf16 v[180:195], v[32:35], v[92:95], v[180:195]
    ds_read_b64_tr_b16 v[64:65], v8 offset:8448
    ds_read_b64_tr_b16 v[66:67], v8 offset:10752
    s_waitcnt lgkmcnt(15)
    v_mfma_f32_32x32x16_bf16 v[196:211], v[36:39], v[92:95], v[196:211]
    ds_read_b64_tr_b16 v[68:69], v8 offset:8512
    ds_read_b64_tr_b16 v[70:71], v8 offset:10816
    s_waitcnt lgkmcnt(15)
    v_mfma_f32_32x32x16_bf16 v[212:227], v[40:43], v[92:95], v[212:227]
    ds_read_b64_tr_b16 v[32:33], v8 offset:8576
    ds_read_b64_tr_b16 v[34:35], v8 offset:10880
    s_waitcnt lgkmcnt(15)
    v_mfma_f32_32x32x16_bf16 v[228:243], v[44:47], v[92:95], v[228:243]
    ds_read_b64_tr_b16 v[36:37], v8 offset:8640
    ds_read_b64_tr_b16 v[38:39], v8 offset:10944
    s_waitcnt lgkmcnt(14)
    v_mfma_f32_32x32x16_bf16 v[100:115], v[48:51], v[80:83], v[100:115]
    ds_read_b128 v[84:87], v5
    ds_read_b64_tr_b16 v[40:41], v8 offset:8704
    ds_read_b64_tr_b16 v[42:43], v8 offset:11008
    s_waitcnt lgkmcnt(15)
    v_mfma_f32_32x32x16_bf16 v[116:131], v[52:55], v[80:83], v[116:131]
    ds_read_b64_tr_b16 v[44:45], v8 offset:17408
    ds_read_b64_tr_b16 v[46:47], v8 offset:19712
    s_waitcnt lgkmcnt(15)
    v_mfma_f32_32x32x16_bf16 v[132:147], v[56:59], v[80:83], v[132:147]
    ds_read_b64_tr_b16 v[48:49], v8 offset:17472
    ds_read_b64_tr_b16 v[50:51], v8 offset:19776
    s_waitcnt lgkmcnt(15)
    v_mfma_f32_32x32x16_bf16 v[148:163], v[60:63], v[80:83], v[148:163]
    ds_read_b64_tr_b16 v[52:53], v8 offset:17536
    ds_read_b64_tr_b16 v[54:55], v8 offset:19840
    s_waitcnt lgkmcnt(15)
    v_mfma_f32_32x32x16_bf16 v[164:179], v[64:67], v[80:83], v[164:179]
    ds_read_b64_tr_b16 v[56:57], v8 offset:17600
    ds_read_b64_tr_b16 v[58:59], v8 offset:19904
    s_waitcnt lgkmcnt(15)
    v_mfma_f32_32x32x16_bf16 v[180:195], v[68:71], v[80:83], v[180:195]
    ds_read_b64_tr_b16 v[60:61], v8 offset:17664
    ds_read_b64_tr_b16 v[62:63], v8 offset:19968
    s_waitcnt lgkmcnt(15)
    v_mfma_f32_32x32x16_bf16 v[196:211], v[32:35], v[80:83], v[196:211]
    ds_read_b64_tr_b16 v[64:65], v8 offset:17728
    ds_read_b64_tr_b16 v[66:67], v8 offset:20032
    s_waitcnt lgkmcnt(15)
    v_mfma_f32_32x32x16_bf16 v[212:227], v[36:39], v[80:83], v[212:227]
    ds_read_b64_tr_b16 v[68:69], v8 offset:17792
    ds_read_b64_tr_b16 v[70:71], v8 offset:20096
    s_waitcnt lgkmcnt(14)
    v_mfma_f32_32x32x16_bf16 v[228:243], v[40:43], v[80:83], v[228:243]
    ds_read_b64_tr_b16 v[32:33], v8 offset:17856
    ds_read_b64_tr_b16 v[34:35], v8 offset:20160
    s_waitcnt lgkmcnt(14)
    v_mfma_f32_32x32x16_bf16 v[100:115], v[44:47], v[84:87], v[100:115]
    ds_read_b64_tr_b16 v[36:37], v8 offset:17920
    ds_read_b64_tr_b16 v[38:39], v8 offset:20224
    s_waitcnt lgkmcnt(14)
    v_mfma_f32_32x32x16_bf16 v[116:131], v[48:51], v[84:87], v[116:131]
    s_waitcnt lgkmcnt(12)
    v_mfma_f32_32x32x16_bf16 v[132:147], v[52:55], v[84:87], v[132:147]
    s_waitcnt lgkmcnt(10)
    v_mfma_f32_32x32x16_bf16 v[148:163], v[56:59], v[84:87], v[148:163]
    s_waitcnt lgkmcnt(0)
    s_barrier
    v_subrev_u32 v4, 90112, v4
    v_subrev_u32 v5, 90112, v5
    v_subrev_u32 v8, 90112, v8
    ds_read_b128 v[88:91], v4
    ds_read_b64_tr_b16 v[40:41], v8 offset:8192
    ds_read_b64_tr_b16 v[42:43], v8 offset:10496
    ds_read_b64_tr_b16 v[44:45], v8 offset:8256
    ds_read_b64_tr_b16 v[46:47], v8 offset:10560
    ds_read_b64_tr_b16 v[48:49], v8 offset:8320
    ds_read_b64_tr_b16 v[50:51], v8 offset:10624
    s_waitcnt lgkmcnt(15)
    v_mfma_f32_32x32x16_bf16 v[164:179], v[60:63], v[84:87], v[164:179]
    ds_read_b64_tr_b16 v[52:53], v8 offset:8384
    ds_read_b64_tr_b16 v[54:55], v8 offset:10688
    s_waitcnt lgkmcnt(15)
    v_mfma_f32_32x32x16_bf16 v[180:195], v[64:67], v[84:87], v[180:195]
    ds_read_b64_tr_b16 v[56:57], v8 offset:8448
    ds_read_b64_tr_b16 v[58:59], v8 offset:10752
    s_waitcnt lgkmcnt(15)
    v_mfma_f32_32x32x16_bf16 v[196:211], v[68:71], v[84:87], v[196:211]
    ds_read_b64_tr_b16 v[60:61], v8 offset:8512
    ds_read_b64_tr_b16 v[62:63], v8 offset:10816
    s_waitcnt lgkmcnt(15)
    v_mfma_f32_32x32x16_bf16 v[212:227], v[32:35], v[84:87], v[212:227]
    ds_read_b64_tr_b16 v[64:65], v8 offset:8576
    ds_read_b64_tr_b16 v[66:67], v8 offset:10880
    s_waitcnt lgkmcnt(15)
    v_mfma_f32_32x32x16_bf16 v[228:243], v[36:39], v[84:87], v[228:243]
    ds_read_b64_tr_b16 v[68:69], v8 offset:8640
    ds_read_b64_tr_b16 v[70:71], v8 offset:10944
    s_waitcnt lgkmcnt(14)
    v_mfma_f32_32x32x16_bf16 v[100:115], v[40:43], v[88:91], v[100:115]
    ds_read_b128 v[92:95], v5
    ds_read_b64_tr_b16 v[32:33], v8 offset:8704
    ds_read_b64_tr_b16 v[34:35], v8 offset:11008
    s_waitcnt lgkmcnt(15)
    v_mfma_f32_32x32x16_bf16 v[116:131], v[44:47], v[88:91], v[116:131]
    ds_read_b64_tr_b16 v[36:37], v8 offset:17408
    ds_read_b64_tr_b16 v[38:39], v8 offset:19712
    s_waitcnt lgkmcnt(15)
    v_mfma_f32_32x32x16_bf16 v[132:147], v[48:51], v[88:91], v[132:147]
    ds_read_b64_tr_b16 v[40:41], v8 offset:17472
    ds_read_b64_tr_b16 v[42:43], v8 offset:19776
    s_waitcnt lgkmcnt(15)
    v_mfma_f32_32x32x16_bf16 v[148:163], v[52:55], v[88:91], v[148:163]
    ds_read_b64_tr_b16 v[44:45], v8 offset:17536
    ds_read_b64_tr_b16 v[46:47], v8 offset:19840
    s_waitcnt lgkmcnt(15)
    v_mfma_f32_32x32x16_bf16 v[164:179], v[56:59], v[88:91], v[164:179]
    ds_read_b64_tr_b16 v[48:49], v8 offset:17600
    ds_read_b64_tr_b16 v[50:51], v8 offset:19904
    s_waitcnt lgkmcnt(15)
    v_mfma_f32_32x32x16_bf16 v[180:195], v[60:63], v[88:91], v[180:195]
    ds_read_b64_tr_b16 v[52:53], v8 offset:17664
    ds_read_b64_tr_b16 v[54:55], v8 offset:19968
    s_waitcnt lgkmcnt(15)
    v_mfma_f32_32x32x16_bf16 v[196:211], v[64:67], v[88:91], v[196:211]
    ds_read_b64_tr_b16 v[56:57], v8 offset:17728
    ds_read_b64_tr_b16 v[58:59], v8 offset:20032
    s_waitcnt lgkmcnt(15)
    v_mfma_f32_32x32x16_bf16 v[212:227], v[68:71], v[88:91], v[212:227]
    ds_read_b64_tr_b16 v[60:61], v8 offset:17792
    ds_read_b64_tr_b16 v[62:63], v8 offset:20096
    s_waitcnt lgkmcnt(14)
    v_mfma_f32_32x32x16_bf16 v[228:243], v[32:35], v[88:91], v[228:243]
    ds_read_b64_tr_b16 v[64:65], v8 offset:17856
    ds_read_b64_tr_b16 v[66:67], v8 offset:20160
    s_waitcnt lgkmcnt(14)
    v_mfma_f32_32x32x16_bf16 v[100:115], v[36:39], v[92:95], v[100:115]
    ds_read_b64_tr_b16 v[68:69], v8 offset:17920
    ds_read_b64_tr_b16 v[70:71], v8 offset:20224
    s_waitcnt lgkmcnt(14)
    v_mfma_f32_32x32x16_bf16 v[116:131], v[40:43], v[92:95], v[116:131]
    s_waitcnt lgkmcnt(12)
    v_mfma_f32_32x32x16_bf16 v[132:147], v[44:47], v[92:95], v[132:147]
    s_waitcnt lgkmcnt(10)
    v_mfma_f32_32x32x16_bf16 v[148:163], v[48:51], v[92:95], v[148:163]
    s_waitcnt lgkmcnt(0)
    s_barrier
    v_add_u32 v4, 45056, v4
    v_add_u32 v5, 45056, v5
    v_add_u32 v8, 45056, v8
    ds_read_b128 v[80:83], v4
    ds_read_b64_tr_b16 v[32:33], v8 offset:8192
    ds_read_b64_tr_b16 v[34:35], v8 offset:10496
    ds_read_b64_tr_b16 v[36:37], v8 offset:8256
    ds_read_b64_tr_b16 v[38:39], v8 offset:10560
    ds_read_b64_tr_b16 v[40:41], v8 offset:8320
    ds_read_b64_tr_b16 v[42:43], v8 offset:10624
    s_waitcnt lgkmcnt(15)
    v_mfma_f32_32x32x16_bf16 v[164:179], v[52:55], v[92:95], v[164:179]
    ds_read_b64_tr_b16 v[44:45], v8 offset:8384
    ds_read_b64_tr_b16 v[46:47], v8 offset:10688
    s_waitcnt lgkmcnt(15)
    v_mfma_f32_32x32x16_bf16 v[180:195], v[56:59], v[92:95], v[180:195]
    ds_read_b64_tr_b16 v[48:49], v8 offset:8448
    ds_read_b64_tr_b16 v[50:51], v8 offset:10752
    s_waitcnt lgkmcnt(15)
    v_mfma_f32_32x32x16_bf16 v[196:211], v[60:63], v[92:95], v[196:211]
    ds_read_b64_tr_b16 v[52:53], v8 offset:8512
    ds_read_b64_tr_b16 v[54:55], v8 offset:10816
    s_waitcnt lgkmcnt(15)
    v_mfma_f32_32x32x16_bf16 v[212:227], v[64:67], v[92:95], v[212:227]
    ds_read_b64_tr_b16 v[56:57], v8 offset:8576
    ds_read_b64_tr_b16 v[58:59], v8 offset:10880
    s_waitcnt lgkmcnt(15)
    v_mfma_f32_32x32x16_bf16 v[228:243], v[68:71], v[92:95], v[228:243]
    ds_read_b64_tr_b16 v[60:61], v8 offset:8640
    ds_read_b64_tr_b16 v[62:63], v8 offset:10944
    s_waitcnt lgkmcnt(14)
    v_mfma_f32_32x32x16_bf16 v[100:115], v[32:35], v[80:83], v[100:115]
    ds_read_b128 v[84:87], v5
    ds_read_b64_tr_b16 v[64:65], v8 offset:8704
    ds_read_b64_tr_b16 v[66:67], v8 offset:11008
    s_waitcnt lgkmcnt(15)
    v_mfma_f32_32x32x16_bf16 v[116:131], v[36:39], v[80:83], v[116:131]
    ds_read_b64_tr_b16 v[68:69], v8 offset:17408
    ds_read_b64_tr_b16 v[70:71], v8 offset:19712
    s_waitcnt lgkmcnt(15)
    v_mfma_f32_32x32x16_bf16 v[132:147], v[40:43], v[80:83], v[132:147]
    ds_read_b64_tr_b16 v[32:33], v8 offset:17472
    ds_read_b64_tr_b16 v[34:35], v8 offset:19776
    s_waitcnt lgkmcnt(15)
    v_mfma_f32_32x32x16_bf16 v[148:163], v[44:47], v[80:83], v[148:163]
    ds_read_b64_tr_b16 v[36:37], v8 offset:17536
    ds_read_b64_tr_b16 v[38:39], v8 offset:19840
    s_waitcnt lgkmcnt(15)
    v_mfma_f32_32x32x16_bf16 v[164:179], v[48:51], v[80:83], v[164:179]
    ds_read_b64_tr_b16 v[40:41], v8 offset:17600
    ds_read_b64_tr_b16 v[42:43], v8 offset:19904
    s_waitcnt lgkmcnt(15)
    v_mfma_f32_32x32x16_bf16 v[180:195], v[52:55], v[80:83], v[180:195]
    ds_read_b64_tr_b16 v[44:45], v8 offset:17664
    ds_read_b64_tr_b16 v[46:47], v8 offset:19968
    s_waitcnt lgkmcnt(15)
    v_mfma_f32_32x32x16_bf16 v[196:211], v[56:59], v[80:83], v[196:211]
    ds_read_b64_tr_b16 v[48:49], v8 offset:17728
    ds_read_b64_tr_b16 v[50:51], v8 offset:20032
    s_waitcnt lgkmcnt(15)
    v_mfma_f32_32x32x16_bf16 v[212:227], v[60:63], v[80:83], v[212:227]
    ds_read_b64_tr_b16 v[52:53], v8 offset:17792
    ds_read_b64_tr_b16 v[54:55], v8 offset:20096
    s_waitcnt lgkmcnt(14)
    v_mfma_f32_32x32x16_bf16 v[228:243], v[64:67], v[80:83], v[228:243]
    ds_read_b64_tr_b16 v[56:57], v8 offset:17856
    ds_read_b64_tr_b16 v[58:59], v8 offset:20160
    s_waitcnt lgkmcnt(14)
    v_mfma_f32_32x32x16_bf16 v[100:115], v[68:71], v[84:87], v[100:115]
    ds_read_b64_tr_b16 v[60:61], v8 offset:17920
    ds_read_b64_tr_b16 v[62:63], v8 offset:20224
    s_waitcnt lgkmcnt(14)
    v_mfma_f32_32x32x16_bf16 v[116:131], v[32:35], v[84:87], v[116:131]
    s_waitcnt lgkmcnt(12)
    v_mfma_f32_32x32x16_bf16 v[132:147], v[36:39], v[84:87], v[132:147]
    s_waitcnt lgkmcnt(10)
    v_mfma_f32_32x32x16_bf16 v[148:163], v[40:43], v[84:87], v[148:163]
    s_waitcnt lgkmcnt(0)
    s_barrier
    v_add_u32 v4, 45056, v4
    v_add_u32 v5, 45056, v5
    v_add_u32 v8, 45056, v8
    ds_read_b128 v[88:91], v4
    ds_read_b64_tr_b16 v[64:65], v8 offset:8192
    ds_read_b64_tr_b16 v[66:67], v8 offset:10496
    ds_read_b64_tr_b16 v[68:69], v8 offset:8256
    ds_read_b64_tr_b16 v[70:71], v8 offset:10560
    ds_read_b64_tr_b16 v[32:33], v8 offset:8320
    ds_read_b64_tr_b16 v[34:35], v8 offset:10624
    s_waitcnt lgkmcnt(15)
    v_mfma_f32_32x32x16_bf16 v[164:179], v[44:47], v[84:87], v[164:179]
    ds_read_b64_tr_b16 v[36:37], v8 offset:8384
    ds_read_b64_tr_b16 v[38:39], v8 offset:10688
    s_waitcnt lgkmcnt(15)
    v_mfma_f32_32x32x16_bf16 v[180:195], v[48:51], v[84:87], v[180:195]
    ds_read_b64_tr_b16 v[40:41], v8 offset:8448
    ds_read_b64_tr_b16 v[42:43], v8 offset:10752
    s_waitcnt lgkmcnt(15)
    v_mfma_f32_32x32x16_bf16 v[196:211], v[52:55], v[84:87], v[196:211]
    ds_read_b64_tr_b16 v[44:45], v8 offset:8512
    ds_read_b64_tr_b16 v[46:47], v8 offset:10816
    s_waitcnt lgkmcnt(15)
    v_mfma_f32_32x32x16_bf16 v[212:227], v[56:59], v[84:87], v[212:227]
    ds_read_b64_tr_b16 v[48:49], v8 offset:8576
    ds_read_b64_tr_b16 v[50:51], v8 offset:10880
    s_waitcnt lgkmcnt(15)
    v_mfma_f32_32x32x16_bf16 v[228:243], v[60:63], v[84:87], v[228:243]
    ds_read_b64_tr_b16 v[52:53], v8 offset:8640
    ds_read_b64_tr_b16 v[54:55], v8 offset:10944
    s_waitcnt lgkmcnt(14)
    v_mfma_f32_32x32x16_bf16 v[100:115], v[64:67], v[88:91], v[100:115]
    ds_read_b128 v[92:95], v5
    ds_read_b64_tr_b16 v[56:57], v8 offset:8704
    ds_read_b64_tr_b16 v[58:59], v8 offset:11008
    s_waitcnt lgkmcnt(15)
    v_mfma_f32_32x32x16_bf16 v[116:131], v[68:71], v[88:91], v[116:131]
    ds_read_b64_tr_b16 v[60:61], v8 offset:17408
    ds_read_b64_tr_b16 v[62:63], v8 offset:19712
    s_waitcnt lgkmcnt(15)
    v_mfma_f32_32x32x16_bf16 v[132:147], v[32:35], v[88:91], v[132:147]
    ds_read_b64_tr_b16 v[64:65], v8 offset:17472
    ds_read_b64_tr_b16 v[66:67], v8 offset:19776
    s_waitcnt lgkmcnt(15)
    v_mfma_f32_32x32x16_bf16 v[148:163], v[36:39], v[88:91], v[148:163]
    ds_read_b64_tr_b16 v[68:69], v8 offset:17536
    ds_read_b64_tr_b16 v[70:71], v8 offset:19840
    s_waitcnt lgkmcnt(15)
    v_mfma_f32_32x32x16_bf16 v[164:179], v[40:43], v[88:91], v[164:179]
    ds_read_b64_tr_b16 v[32:33], v8 offset:17600
    ds_read_b64_tr_b16 v[34:35], v8 offset:19904
    s_waitcnt lgkmcnt(15)
    v_mfma_f32_32x32x16_bf16 v[180:195], v[44:47], v[88:91], v[180:195]
    ds_read_b64_tr_b16 v[36:37], v8 offset:17664
    ds_read_b64_tr_b16 v[38:39], v8 offset:19968
    s_waitcnt lgkmcnt(15)
    v_mfma_f32_32x32x16_bf16 v[196:211], v[48:51], v[88:91], v[196:211]
    ds_read_b64_tr_b16 v[40:41], v8 offset:17728
    ds_read_b64_tr_b16 v[42:43], v8 offset:20032
    s_waitcnt lgkmcnt(15)
    v_mfma_f32_32x32x16_bf16 v[212:227], v[52:55], v[88:91], v[212:227]
    ds_read_b64_tr_b16 v[44:45], v8 offset:17792
    ds_read_b64_tr_b16 v[46:47], v8 offset:20096
    s_waitcnt lgkmcnt(14)
    v_mfma_f32_32x32x16_bf16 v[228:243], v[56:59], v[88:91], v[228:243]
    ds_read_b64_tr_b16 v[48:49], v8 offset:17856
    ds_read_b64_tr_b16 v[50:51], v8 offset:20160
    s_waitcnt lgkmcnt(14)
    v_mfma_f32_32x32x16_bf16 v[100:115], v[60:63], v[92:95], v[100:115]
    ds_read_b64_tr_b16 v[52:53], v8 offset:17920
    ds_read_b64_tr_b16 v[54:55], v8 offset:20224
    s_waitcnt lgkmcnt(14)
    v_mfma_f32_32x32x16_bf16 v[116:131], v[64:67], v[92:95], v[116:131]
    s_waitcnt lgkmcnt(12)
    v_mfma_f32_32x32x16_bf16 v[132:147], v[68:71], v[92:95], v[132:147]
    s_waitcnt lgkmcnt(10)
    v_mfma_f32_32x32x16_bf16 v[148:163], v[32:35], v[92:95], v[148:163]
    s_waitcnt lgkmcnt(0)
    s_barrier
    v_subrev_u32 v4, 90112, v4
    v_subrev_u32 v5, 90112, v5
    v_subrev_u32 v8, 90112, v8
    ds_read_b128 v[80:83], v4
    ds_read_b64_tr_b16 v[56:57], v8 offset:8192
    ds_read_b64_tr_b16 v[58:59], v8 offset:10496
    ds_read_b64_tr_b16 v[60:61], v8 offset:8256
    ds_read_b64_tr_b16 v[62:63], v8 offset:10560
    ds_read_b64_tr_b16 v[64:65], v8 offset:8320
    ds_read_b64_tr_b16 v[66:67], v8 offset:10624
    s_waitcnt lgkmcnt(15)
    v_mfma_f32_32x32x16_bf16 v[164:179], v[36:39], v[92:95], v[164:179]
    ds_read_b64_tr_b16 v[68:69], v8 offset:8384
    ds_read_b64_tr_b16 v[70:71], v8 offset:10688
    s_waitcnt lgkmcnt(15)
    v_mfma_f32_32x32x16_bf16 v[180:195], v[40:43], v[92:95], v[180:195]
    ds_read_b64_tr_b16 v[32:33], v8 offset:8448
    ds_read_b64_tr_b16 v[34:35], v8 offset:10752
    s_waitcnt lgkmcnt(15)
    v_mfma_f32_32x32x16_bf16 v[196:211], v[44:47], v[92:95], v[196:211]
    ds_read_b64_tr_b16 v[36:37], v8 offset:8512
    ds_read_b64_tr_b16 v[38:39], v8 offset:10816
    s_waitcnt lgkmcnt(15)
    v_mfma_f32_32x32x16_bf16 v[212:227], v[48:51], v[92:95], v[212:227]
    ds_read_b64_tr_b16 v[40:41], v8 offset:8576
    ds_read_b64_tr_b16 v[42:43], v8 offset:10880
    s_waitcnt lgkmcnt(15)
    v_mfma_f32_32x32x16_bf16 v[228:243], v[52:55], v[92:95], v[228:243]
    ds_read_b64_tr_b16 v[44:45], v8 offset:8640
    ds_read_b64_tr_b16 v[46:47], v8 offset:10944
    s_waitcnt lgkmcnt(14)
    v_mfma_f32_32x32x16_bf16 v[100:115], v[56:59], v[80:83], v[100:115]
    ds_read_b128 v[84:87], v5
    ds_read_b64_tr_b16 v[48:49], v8 offset:8704
    ds_read_b64_tr_b16 v[50:51], v8 offset:11008
    s_waitcnt lgkmcnt(15)
    v_mfma_f32_32x32x16_bf16 v[116:131], v[60:63], v[80:83], v[116:131]
    ds_read_b64_tr_b16 v[52:53], v8 offset:17408
    ds_read_b64_tr_b16 v[54:55], v8 offset:19712
    s_waitcnt lgkmcnt(15)
    v_mfma_f32_32x32x16_bf16 v[132:147], v[64:67], v[80:83], v[132:147]
    ds_read_b64_tr_b16 v[56:57], v8 offset:17472
    ds_read_b64_tr_b16 v[58:59], v8 offset:19776
    s_waitcnt lgkmcnt(15)
    v_mfma_f32_32x32x16_bf16 v[148:163], v[68:71], v[80:83], v[148:163]
    ds_read_b64_tr_b16 v[60:61], v8 offset:17536
    ds_read_b64_tr_b16 v[62:63], v8 offset:19840
    s_waitcnt lgkmcnt(15)
    v_mfma_f32_32x32x16_bf16 v[164:179], v[32:35], v[80:83], v[164:179]
    ds_read_b64_tr_b16 v[64:65], v8 offset:17600
    ds_read_b64_tr_b16 v[66:67], v8 offset:19904
    s_waitcnt lgkmcnt(15)
    v_mfma_f32_32x32x16_bf16 v[180:195], v[36:39], v[80:83], v[180:195]
    ds_read_b64_tr_b16 v[68:69], v8 offset:17664
    ds_read_b64_tr_b16 v[70:71], v8 offset:19968
    s_waitcnt lgkmcnt(15)
    v_mfma_f32_32x32x16_bf16 v[196:211], v[40:43], v[80:83], v[196:211]
    ds_read_b64_tr_b16 v[32:33], v8 offset:17728
    ds_read_b64_tr_b16 v[34:35], v8 offset:20032
    s_waitcnt lgkmcnt(15)
    v_mfma_f32_32x32x16_bf16 v[212:227], v[44:47], v[80:83], v[212:227]
    ds_read_b64_tr_b16 v[36:37], v8 offset:17792
    ds_read_b64_tr_b16 v[38:39], v8 offset:20096
    s_waitcnt lgkmcnt(14)
    v_mfma_f32_32x32x16_bf16 v[228:243], v[48:51], v[80:83], v[228:243]
    ds_read_b64_tr_b16 v[40:41], v8 offset:17856
    ds_read_b64_tr_b16 v[42:43], v8 offset:20160
    s_waitcnt lgkmcnt(14)
    v_mfma_f32_32x32x16_bf16 v[100:115], v[52:55], v[84:87], v[100:115]
    ds_read_b64_tr_b16 v[44:45], v8 offset:17920
    ds_read_b64_tr_b16 v[46:47], v8 offset:20224
    s_waitcnt lgkmcnt(14)
    v_mfma_f32_32x32x16_bf16 v[116:131], v[56:59], v[84:87], v[116:131]
    s_waitcnt lgkmcnt(12)
    v_mfma_f32_32x32x16_bf16 v[132:147], v[60:63], v[84:87], v[132:147]
    s_waitcnt lgkmcnt(10)
    v_mfma_f32_32x32x16_bf16 v[148:163], v[64:67], v[84:87], v[148:163]
    s_waitcnt lgkmcnt(0)
    s_barrier
    v_add_u32 v4, 45056, v4
    v_add_u32 v5, 45056, v5
    v_add_u32 v8, 45056, v8
    ds_read_b128 v[88:91], v4
    ds_read_b64_tr_b16 v[48:49], v8 offset:8192
    ds_read_b64_tr_b16 v[50:51], v8 offset:10496
    ds_read_b64_tr_b16 v[52:53], v8 offset:8256
    ds_read_b64_tr_b16 v[54:55], v8 offset:10560
    ds_read_b64_tr_b16 v[56:57], v8 offset:8320
    ds_read_b64_tr_b16 v[58:59], v8 offset:10624
    s_waitcnt lgkmcnt(15)
    v_mfma_f32_32x32x16_bf16 v[164:179], v[68:71], v[84:87], v[164:179]
    ds_read_b64_tr_b16 v[60:61], v8 offset:8384
    ds_read_b64_tr_b16 v[62:63], v8 offset:10688
    s_waitcnt lgkmcnt(15)
    v_mfma_f32_32x32x16_bf16 v[180:195], v[32:35], v[84:87], v[180:195]
    ds_read_b64_tr_b16 v[64:65], v8 offset:8448
    ds_read_b64_tr_b16 v[66:67], v8 offset:10752
    s_waitcnt lgkmcnt(15)
    v_mfma_f32_32x32x16_bf16 v[196:211], v[36:39], v[84:87], v[196:211]
    ds_read_b64_tr_b16 v[68:69], v8 offset:8512
    ds_read_b64_tr_b16 v[70:71], v8 offset:10816
    s_waitcnt lgkmcnt(15)
    v_mfma_f32_32x32x16_bf16 v[212:227], v[40:43], v[84:87], v[212:227]
    ds_read_b64_tr_b16 v[32:33], v8 offset:8576
    ds_read_b64_tr_b16 v[34:35], v8 offset:10880
    s_waitcnt lgkmcnt(15)
    v_mfma_f32_32x32x16_bf16 v[228:243], v[44:47], v[84:87], v[228:243]
    ds_read_b64_tr_b16 v[36:37], v8 offset:8640
    ds_read_b64_tr_b16 v[38:39], v8 offset:10944
    s_waitcnt lgkmcnt(14)
    v_mfma_f32_32x32x16_bf16 v[100:115], v[48:51], v[88:91], v[100:115]
    ds_read_b128 v[92:95], v5
    ds_read_b64_tr_b16 v[40:41], v8 offset:8704
    ds_read_b64_tr_b16 v[42:43], v8 offset:11008
    s_waitcnt lgkmcnt(15)
    v_mfma_f32_32x32x16_bf16 v[116:131], v[52:55], v[88:91], v[116:131]
    ds_read_b64_tr_b16 v[44:45], v8 offset:17408
    ds_read_b64_tr_b16 v[46:47], v8 offset:19712
    s_waitcnt lgkmcnt(15)
    v_mfma_f32_32x32x16_bf16 v[132:147], v[56:59], v[88:91], v[132:147]
    ds_read_b64_tr_b16 v[48:49], v8 offset:17472
    ds_read_b64_tr_b16 v[50:51], v8 offset:19776
    s_waitcnt lgkmcnt(15)
    v_mfma_f32_32x32x16_bf16 v[148:163], v[60:63], v[88:91], v[148:163]
    ds_read_b64_tr_b16 v[52:53], v8 offset:17536
    ds_read_b64_tr_b16 v[54:55], v8 offset:19840
    s_waitcnt lgkmcnt(15)
    v_mfma_f32_32x32x16_bf16 v[164:179], v[64:67], v[88:91], v[164:179]
    ds_read_b64_tr_b16 v[56:57], v8 offset:17600
    ds_read_b64_tr_b16 v[58:59], v8 offset:19904
    s_waitcnt lgkmcnt(15)
    v_mfma_f32_32x32x16_bf16 v[180:195], v[68:71], v[88:91], v[180:195]
    ds_read_b64_tr_b16 v[60:61], v8 offset:17664
    ds_read_b64_tr_b16 v[62:63], v8 offset:19968
    s_waitcnt lgkmcnt(15)
    v_mfma_f32_32x32x16_bf16 v[196:211], v[32:35], v[88:91], v[196:211]
    ds_read_b64_tr_b16 v[64:65], v8 offset:17728
    ds_read_b64_tr_b16 v[66:67], v8 offset:20032
    s_waitcnt lgkmcnt(15)
    v_mfma_f32_32x32x16_bf16 v[212:227], v[36:39], v[88:91], v[212:227]
    ds_read_b64_tr_b16 v[68:69], v8 offset:17792
    ds_read_b64_tr_b16 v[70:71], v8 offset:20096
    s_waitcnt lgkmcnt(14)
    v_mfma_f32_32x32x16_bf16 v[228:243], v[40:43], v[88:91], v[228:243]
    ds_read_b64_tr_b16 v[32:33], v8 offset:17856
    ds_read_b64_tr_b16 v[34:35], v8 offset:20160
    s_waitcnt lgkmcnt(14)
    v_mfma_f32_32x32x16_bf16 v[100:115], v[44:47], v[92:95], v[100:115]
    ds_read_b64_tr_b16 v[36:37], v8 offset:17920
    ds_read_b64_tr_b16 v[38:39], v8 offset:20224
    s_waitcnt lgkmcnt(14)
    v_mfma_f32_32x32x16_bf16 v[116:131], v[48:51], v[92:95], v[116:131]
    s_waitcnt lgkmcnt(12)
    v_mfma_f32_32x32x16_bf16 v[132:147], v[52:55], v[92:95], v[132:147]
    s_waitcnt lgkmcnt(10)
    v_mfma_f32_32x32x16_bf16 v[148:163], v[56:59], v[92:95], v[148:163]
    s_waitcnt lgkmcnt(0)
    s_barrier
    v_add_u32 v4, 45056, v4
    v_add_u32 v5, 45056, v5
    v_add_u32 v8, 45056, v8
    ds_read_b128 v[80:83], v4
    ds_read_b64_tr_b16 v[40:41], v8 offset:8192
    ds_read_b64_tr_b16 v[42:43], v8 offset:10496
    ds_read_b64_tr_b16 v[44:45], v8 offset:8256
    ds_read_b64_tr_b16 v[46:47], v8 offset:10560
    ds_read_b64_tr_b16 v[48:49], v8 offset:8320
    ds_read_b64_tr_b16 v[50:51], v8 offset:10624
    s_waitcnt lgkmcnt(15)
    v_mfma_f32_32x32x16_bf16 v[164:179], v[60:63], v[92:95], v[164:179]
    ds_read_b64_tr_b16 v[52:53], v8 offset:8384
    ds_read_b64_tr_b16 v[54:55], v8 offset:10688
    s_waitcnt lgkmcnt(15)
    v_mfma_f32_32x32x16_bf16 v[180:195], v[64:67], v[92:95], v[180:195]
    ds_read_b64_tr_b16 v[56:57], v8 offset:8448
    ds_read_b64_tr_b16 v[58:59], v8 offset:10752
    s_waitcnt lgkmcnt(15)
    v_mfma_f32_32x32x16_bf16 v[196:211], v[68:71], v[92:95], v[196:211]
    ds_read_b64_tr_b16 v[60:61], v8 offset:8512
    ds_read_b64_tr_b16 v[62:63], v8 offset:10816
    s_waitcnt lgkmcnt(15)
    v_mfma_f32_32x32x16_bf16 v[212:227], v[32:35], v[92:95], v[212:227]
    ds_read_b64_tr_b16 v[64:65], v8 offset:8576
    ds_read_b64_tr_b16 v[66:67], v8 offset:10880
    s_waitcnt lgkmcnt(15)
    v_mfma_f32_32x32x16_bf16 v[228:243], v[36:39], v[92:95], v[228:243]
    ds_read_b64_tr_b16 v[68:69], v8 offset:8640
    ds_read_b64_tr_b16 v[70:71], v8 offset:10944
    s_waitcnt lgkmcnt(14)
    v_mfma_f32_32x32x16_bf16 v[100:115], v[40:43], v[80:83], v[100:115]
    ds_read_b128 v[84:87], v5
    ds_read_b64_tr_b16 v[32:33], v8 offset:8704
    ds_read_b64_tr_b16 v[34:35], v8 offset:11008
    s_waitcnt lgkmcnt(15)
    v_mfma_f32_32x32x16_bf16 v[116:131], v[44:47], v[80:83], v[116:131]
    ds_read_b64_tr_b16 v[36:37], v8 offset:17408
    ds_read_b64_tr_b16 v[38:39], v8 offset:19712
    s_waitcnt lgkmcnt(15)
    v_mfma_f32_32x32x16_bf16 v[132:147], v[48:51], v[80:83], v[132:147]
    ds_read_b64_tr_b16 v[40:41], v8 offset:17472
    ds_read_b64_tr_b16 v[42:43], v8 offset:19776
    s_waitcnt lgkmcnt(15)
    v_mfma_f32_32x32x16_bf16 v[148:163], v[52:55], v[80:83], v[148:163]
    ds_read_b64_tr_b16 v[44:45], v8 offset:17536
    ds_read_b64_tr_b16 v[46:47], v8 offset:19840
    s_waitcnt lgkmcnt(15)
    v_mfma_f32_32x32x16_bf16 v[164:179], v[56:59], v[80:83], v[164:179]
    ds_read_b64_tr_b16 v[48:49], v8 offset:17600
    ds_read_b64_tr_b16 v[50:51], v8 offset:19904
    s_waitcnt lgkmcnt(15)
    v_mfma_f32_32x32x16_bf16 v[180:195], v[60:63], v[80:83], v[180:195]
    ds_read_b64_tr_b16 v[52:53], v8 offset:17664
    ds_read_b64_tr_b16 v[54:55], v8 offset:19968
    s_waitcnt lgkmcnt(15)
    v_mfma_f32_32x32x16_bf16 v[196:211], v[64:67], v[80:83], v[196:211]
    ds_read_b64_tr_b16 v[56:57], v8 offset:17728
    ds_read_b64_tr_b16 v[58:59], v8 offset:20032
    s_waitcnt lgkmcnt(15)
    v_mfma_f32_32x32x16_bf16 v[212:227], v[68:71], v[80:83], v[212:227]
    ds_read_b64_tr_b16 v[60:61], v8 offset:17792
    ds_read_b64_tr_b16 v[62:63], v8 offset:20096
    s_waitcnt lgkmcnt(14)
    v_mfma_f32_32x32x16_bf16 v[228:243], v[32:35], v[80:83], v[228:243]
    ds_read_b64_tr_b16 v[64:65], v8 offset:17856
    ds_read_b64_tr_b16 v[66:67], v8 offset:20160
    s_waitcnt lgkmcnt(14)
    v_mfma_f32_32x32x16_bf16 v[100:115], v[36:39], v[84:87], v[100:115]
    ds_read_b64_tr_b16 v[68:69], v8 offset:17920
    ds_read_b64_tr_b16 v[70:71], v8 offset:20224
    s_waitcnt lgkmcnt(14)
    v_mfma_f32_32x32x16_bf16 v[116:131], v[40:43], v[84:87], v[116:131]
    s_waitcnt lgkmcnt(12)
    v_mfma_f32_32x32x16_bf16 v[132:147], v[44:47], v[84:87], v[132:147]
    s_waitcnt lgkmcnt(10)
    v_mfma_f32_32x32x16_bf16 v[148:163], v[48:51], v[84:87], v[148:163]
    s_waitcnt lgkmcnt(0)
    s_barrier
    v_subrev_u32 v4, 90112, v4
    v_subrev_u32 v5, 90112, v5
    v_subrev_u32 v8, 90112, v8
    ds_read_b128 v[88:91], v4
    ds_read_b64_tr_b16 v[32:33], v8 offset:8192
    ds_read_b64_tr_b16 v[34:35], v8 offset:10496
    ds_read_b64_tr_b16 v[36:37], v8 offset:8256
    ds_read_b64_tr_b16 v[38:39], v8 offset:10560
    ds_read_b64_tr_b16 v[40:41], v8 offset:8320
    ds_read_b64_tr_b16 v[42:43], v8 offset:10624
    s_waitcnt lgkmcnt(15)
    v_mfma_f32_32x32x16_bf16 v[164:179], v[52:55], v[84:87], v[164:179]
    ds_read_b64_tr_b16 v[44:45], v8 offset:8384
    ds_read_b64_tr_b16 v[46:47], v8 offset:10688
    s_waitcnt lgkmcnt(15)
    v_mfma_f32_32x32x16_bf16 v[180:195], v[56:59], v[84:87], v[180:195]
    ds_read_b64_tr_b16 v[48:49], v8 offset:8448
    ds_read_b64_tr_b16 v[50:51], v8 offset:10752
    s_waitcnt lgkmcnt(15)
    v_mfma_f32_32x32x16_bf16 v[196:211], v[60:63], v[84:87], v[196:211]
    ds_read_b64_tr_b16 v[52:53], v8 offset:8512
    ds_read_b64_tr_b16 v[54:55], v8 offset:10816
    s_waitcnt lgkmcnt(15)
    v_mfma_f32_32x32x16_bf16 v[212:227], v[64:67], v[84:87], v[212:227]
    ds_read_b64_tr_b16 v[56:57], v8 offset:8576
    ds_read_b64_tr_b16 v[58:59], v8 offset:10880
    s_waitcnt lgkmcnt(15)
    v_mfma_f32_32x32x16_bf16 v[228:243], v[68:71], v[84:87], v[228:243]
    ds_read_b64_tr_b16 v[60:61], v8 offset:8640
    ds_read_b64_tr_b16 v[62:63], v8 offset:10944
    s_waitcnt lgkmcnt(14)
    v_mfma_f32_32x32x16_bf16 v[100:115], v[32:35], v[88:91], v[100:115]
    ds_read_b128 v[92:95], v5
    ds_read_b64_tr_b16 v[64:65], v8 offset:8704
    ds_read_b64_tr_b16 v[66:67], v8 offset:11008
    s_waitcnt lgkmcnt(15)
    v_mfma_f32_32x32x16_bf16 v[116:131], v[36:39], v[88:91], v[116:131]
    ds_read_b64_tr_b16 v[68:69], v8 offset:17408
    ds_read_b64_tr_b16 v[70:71], v8 offset:19712
    s_waitcnt lgkmcnt(15)
    v_mfma_f32_32x32x16_bf16 v[132:147], v[40:43], v[88:91], v[132:147]
    ds_read_b64_tr_b16 v[32:33], v8 offset:17472
    ds_read_b64_tr_b16 v[34:35], v8 offset:19776
    s_waitcnt lgkmcnt(15)
    v_mfma_f32_32x32x16_bf16 v[148:163], v[44:47], v[88:91], v[148:163]
    ds_read_b64_tr_b16 v[36:37], v8 offset:17536
    ds_read_b64_tr_b16 v[38:39], v8 offset:19840
    s_waitcnt lgkmcnt(15)
    v_mfma_f32_32x32x16_bf16 v[164:179], v[48:51], v[88:91], v[164:179]
    ds_read_b64_tr_b16 v[40:41], v8 offset:17600
    ds_read_b64_tr_b16 v[42:43], v8 offset:19904
    s_waitcnt lgkmcnt(15)
    v_mfma_f32_32x32x16_bf16 v[180:195], v[52:55], v[88:91], v[180:195]
    ds_read_b64_tr_b16 v[44:45], v8 offset:17664
    ds_read_b64_tr_b16 v[46:47], v8 offset:19968
    s_waitcnt lgkmcnt(15)
    v_mfma_f32_32x32x16_bf16 v[196:211], v[56:59], v[88:91], v[196:211]
    ds_read_b64_tr_b16 v[48:49], v8 offset:17728
    ds_read_b64_tr_b16 v[50:51], v8 offset:20032
    s_waitcnt lgkmcnt(15)
    v_mfma_f32_32x32x16_bf16 v[212:227], v[60:63], v[88:91], v[212:227]
    ds_read_b64_tr_b16 v[52:53], v8 offset:17792
    ds_read_b64_tr_b16 v[54:55], v8 offset:20096
    s_waitcnt lgkmcnt(14)
    v_mfma_f32_32x32x16_bf16 v[228:243], v[64:67], v[88:91], v[228:243]
    ds_read_b64_tr_b16 v[56:57], v8 offset:17856
    ds_read_b64_tr_b16 v[58:59], v8 offset:20160
    s_waitcnt lgkmcnt(14)
    v_mfma_f32_32x32x16_bf16 v[100:115], v[68:71], v[92:95], v[100:115]
    ds_read_b64_tr_b16 v[60:61], v8 offset:17920
    ds_read_b64_tr_b16 v[62:63], v8 offset:20224
    s_waitcnt lgkmcnt(14)
    v_mfma_f32_32x32x16_bf16 v[116:131], v[32:35], v[92:95], v[116:131]
    s_waitcnt lgkmcnt(12)
    v_mfma_f32_32x32x16_bf16 v[132:147], v[36:39], v[92:95], v[132:147]
    s_waitcnt lgkmcnt(10)
    v_mfma_f32_32x32x16_bf16 v[148:163], v[40:43], v[92:95], v[148:163]
    s_waitcnt lgkmcnt(8)
    v_mfma_f32_32x32x16_bf16 v[164:179], v[44:47], v[92:95], v[164:179]
    s_waitcnt lgkmcnt(6)
    v_mfma_f32_32x32x16_bf16 v[180:195], v[48:51], v[92:95], v[180:195]
    s_waitcnt lgkmcnt(4)
    v_mfma_f32_32x32x16_bf16 v[196:211], v[52:55], v[92:95], v[196:211]
    s_waitcnt lgkmcnt(2)
    v_mfma_f32_32x32x16_bf16 v[212:227], v[56:59], v[92:95], v[212:227]
    s_waitcnt lgkmcnt(0)
    v_mfma_f32_32x32x16_bf16 v[228:243], v[60:63], v[92:95], v[228:243]
    s_nop 15
    s_barrier
    s_lshr_b32 s26, s26, 7
    v_add_u32 v4, s26, v2
    v_mul_u32_u24 v4, 1168, v4
    v_lshl_add_u32 v4, v3, 4, v4
    s_cmp_lg_u32 s28, 0
    s_cbranch_scc1 oproj_kernel_wk11
    s_barrier
    v_add_u32 v5, s26, v2
    v_mul_u32_u24 v5, 592, v5
    v_lshl_add_u32 v5, v3, 4, v5
    v_add_u32 v5, 81920, v5
    ds_read_b128 v[32:35], v4 offset:0
    ds_read_b128 v[36:39], v4 offset:32
    ds_read_b128 v[40:43], v4 offset:64
    ds_read_b128 v[44:47], v4 offset:96
    ds_read_b128 v[48:51], v4 offset:128
    ds_read_b128 v[52:55], v4 offset:160
    ds_read_b128 v[56:59], v4 offset:192
    ds_read_b128 v[60:63], v4 offset:224
    ds_read_b128 v[64:67], v4 offset:256
    ds_read_b128 v[68:71], v4 offset:288
    ds_read_b128 v[72:75], v4 offset:320
    ds_read_b128 v[76:79], v4 offset:352
    s_waitcnt lgkmcnt(0)
    v_add_f32 v100, v100, v32
    v_add_f32 v101, v101, v33
    v_add_f32 v102, v102, v34
    v_add_f32 v103, v103, v35
    v_add_f32 v104, v104, v36
    v_add_f32 v105, v105, v37
    v_add_f32 v106, v106, v38
    v_add_f32 v107, v107, v39
    v_cvt_pk_bf16_f32 v80, v100, v101
    v_cvt_pk_bf16_f32 v81, v102, v103
    v_cvt_pk_bf16_f32 v82, v104, v105
    v_cvt_pk_bf16_f32 v83, v106, v107
    s_nop 1
    v_permlane32_swap_b32 v80, v82
    v_permlane32_swap_b32 v81, v83
    ds_write_b128 v5, v[80:83] offset:0
    v_add_f32 v108, v108, v40
    v_add_f32 v109, v109, v41
    v_add_f32 v110, v110, v42
    v_add_f32 v111, v111, v43
    v_add_f32 v112, v112, v44
    v_add_f32 v113, v113, v45
    v_add_f32 v114, v114, v46
    v_add_f32 v115, v115, v47
    v_cvt_pk_bf16_f32 v84, v108, v109
    v_cvt_pk_bf16_f32 v85, v110, v111
    v_cvt_pk_bf16_f32 v86, v112, v113
    v_cvt_pk_bf16_f32 v87, v114, v115
    s_nop 1
    v_permlane32_swap_b32 v84, v86
    v_permlane32_swap_b32 v85, v87
    ds_write_b128 v5, v[84:87] offset:32
    v_add_f32 v116, v116, v48
    v_add_f32 v117, v117, v49
    v_add_f32 v118, v118, v50
    v_add_f32 v119, v119, v51
    v_add_f32 v120, v120, v52
    v_add_f32 v121, v121, v53
    v_add_f32 v122, v122, v54
    v_add_f32 v123, v123, v55
    v_cvt_pk_bf16_f32 v80, v116, v117
    v_cvt_pk_bf16_f32 v81, v118, v119
    v_cvt_pk_bf16_f32 v82, v120, v121
    v_cvt_pk_bf16_f32 v83, v122, v123
    s_nop 1
    v_permlane32_swap_b32 v80, v82
    v_permlane32_swap_b32 v81, v83
    ds_write_b128 v5, v[80:83] offset:64
    v_add_f32 v124, v124, v56
    v_add_f32 v125, v125, v57
    v_add_f32 v126, v126, v58
    v_add_f32 v127, v127, v59
    v_add_f32 v128, v128, v60
    v_add_f32 v129, v129, v61
    v_add_f32 v130, v130, v62
    v_add_f32 v131, v131, v63
    v_cvt_pk_bf16_f32 v84, v124, v125
    v_cvt_pk_bf16_f32 v85, v126, v127
    v_cvt_pk_bf16_f32 v86, v128, v129
    v_cvt_pk_bf16_f32 v87, v130, v131
    s_nop 1
    v_permlane32_swap_b32 v84, v86
    v_permlane32_swap_b32 v85, v87
    ds_write_b128 v5, v[84:87] offset:96
    v_add_f32 v132, v132, v64
    v_add_f32 v133, v133, v65
    v_add_f32 v134, v134, v66
    v_add_f32 v135, v135, v67
    v_add_f32 v136, v136, v68
    v_add_f32 v137, v137, v69
    v_add_f32 v138, v138, v70
    v_add_f32 v139, v139, v71
    v_cvt_pk_bf16_f32 v80, v132, v133
    v_cvt_pk_bf16_f32 v81, v134, v135
    v_cvt_pk_bf16_f32 v82, v136, v137
    v_cvt_pk_bf16_f32 v83, v138, v139
    s_nop 1
    v_permlane32_swap_b32 v80, v82
    v_permlane32_swap_b32 v81, v83
    ds_write_b128 v5, v[80:83] offset:128
    v_add_f32 v140, v140, v72
    v_add_f32 v141, v141, v73
    v_add_f32 v142, v142, v74
    v_add_f32 v143, v143, v75
    v_add_f32 v144, v144, v76
    v_add_f32 v145, v145, v77
    v_add_f32 v146, v146, v78
    v_add_f32 v147, v147, v79
    v_cvt_pk_bf16_f32 v84, v140, v141
    v_cvt_pk_bf16_f32 v85, v142, v143
    v_cvt_pk_bf16_f32 v86, v144, v145
    v_cvt_pk_bf16_f32 v87, v146, v147
    s_nop 1
    v_permlane32_swap_b32 v84, v86
    v_permlane32_swap_b32 v85, v87
    ds_write_b128 v5, v[84:87] offset:160
    ds_read_b128 v[32:35], v4 offset:384
    ds_read_b128 v[36:39], v4 offset:416
    ds_read_b128 v[40:43], v4 offset:448
    ds_read_b128 v[44:47], v4 offset:480
    ds_read_b128 v[48:51], v4 offset:512
    ds_read_b128 v[52:55], v4 offset:544
    ds_read_b128 v[56:59], v4 offset:576
    ds_read_b128 v[60:63], v4 offset:608
    ds_read_b128 v[64:67], v4 offset:640
    ds_read_b128 v[68:71], v4 offset:672
    ds_read_b128 v[72:75], v4 offset:704
    ds_read_b128 v[76:79], v4 offset:736
    s_waitcnt lgkmcnt(0)
    v_add_f32 v148, v148, v32
    v_add_f32 v149, v149, v33
    v_add_f32 v150, v150, v34
    v_add_f32 v151, v151, v35
    v_add_f32 v152, v152, v36
    v_add_f32 v153, v153, v37
    v_add_f32 v154, v154, v38
    v_add_f32 v155, v155, v39
    v_cvt_pk_bf16_f32 v80, v148, v149
    v_cvt_pk_bf16_f32 v81, v150, v151
    v_cvt_pk_bf16_f32 v82, v152, v153
    v_cvt_pk_bf16_f32 v83, v154, v155
    s_nop 1
    v_permlane32_swap_b32 v80, v82
    v_permlane32_swap_b32 v81, v83
    ds_write_b128 v5, v[80:83] offset:192
    v_add_f32 v156, v156, v40
    v_add_f32 v157, v157, v41
    v_add_f32 v158, v158, v42
    v_add_f32 v159, v159, v43
    v_add_f32 v160, v160, v44
    v_add_f32 v161, v161, v45
    v_add_f32 v162, v162, v46
    v_add_f32 v163, v163, v47
    v_cvt_pk_bf16_f32 v84, v156, v157
    v_cvt_pk_bf16_f32 v85, v158, v159
    v_cvt_pk_bf16_f32 v86, v160, v161
    v_cvt_pk_bf16_f32 v87, v162, v163
    s_nop 1
    v_permlane32_swap_b32 v84, v86
    v_permlane32_swap_b32 v85, v87
    ds_write_b128 v5, v[84:87] offset:224
    v_add_f32 v164, v164, v48
    v_add_f32 v165, v165, v49
    v_add_f32 v166, v166, v50
    v_add_f32 v167, v167, v51
    v_add_f32 v168, v168, v52
    v_add_f32 v169, v169, v53
    v_add_f32 v170, v170, v54
    v_add_f32 v171, v171, v55
    v_cvt_pk_bf16_f32 v80, v164, v165
    v_cvt_pk_bf16_f32 v81, v166, v167
    v_cvt_pk_bf16_f32 v82, v168, v169
    v_cvt_pk_bf16_f32 v83, v170, v171
    s_nop 1
    v_permlane32_swap_b32 v80, v82
    v_permlane32_swap_b32 v81, v83
    ds_write_b128 v5, v[80:83] offset:256
    v_add_f32 v172, v172, v56
    v_add_f32 v173, v173, v57
    v_add_f32 v174, v174, v58
    v_add_f32 v175, v175, v59
    v_add_f32 v176, v176, v60
    v_add_f32 v177, v177, v61
    v_add_f32 v178, v178, v62
    v_add_f32 v179, v179, v63
    v_cvt_pk_bf16_f32 v84, v172, v173
    v_cvt_pk_bf16_f32 v85, v174, v175
    v_cvt_pk_bf16_f32 v86, v176, v177
    v_cvt_pk_bf16_f32 v87, v178, v179
    s_nop 1
    v_permlane32_swap_b32 v84, v86
    v_permlane32_swap_b32 v85, v87
    ds_write_b128 v5, v[84:87] offset:288
    v_add_f32 v180, v180, v64
    v_add_f32 v181, v181, v65
    v_add_f32 v182, v182, v66
    v_add_f32 v183, v183, v67
    v_add_f32 v184, v184, v68
    v_add_f32 v185, v185, v69
    v_add_f32 v186, v186, v70
    v_add_f32 v187, v187, v71
    v_cvt_pk_bf16_f32 v80, v180, v181
    v_cvt_pk_bf16_f32 v81, v182, v183
    v_cvt_pk_bf16_f32 v82, v184, v185
    v_cvt_pk_bf16_f32 v83, v186, v187
    s_nop 1
    v_permlane32_swap_b32 v80, v82
    v_permlane32_swap_b32 v81, v83
    ds_write_b128 v5, v[80:83] offset:320
    v_add_f32 v188, v188, v72
    v_add_f32 v189, v189, v73
    v_add_f32 v190, v190, v74
    v_add_f32 v191, v191, v75
    v_add_f32 v192, v192, v76
    v_add_f32 v193, v193, v77
    v_add_f32 v194, v194, v78
    v_add_f32 v195, v195, v79
    v_cvt_pk_bf16_f32 v84, v188, v189
    v_cvt_pk_bf16_f32 v85, v190, v191
    v_cvt_pk_bf16_f32 v86, v192, v193
    v_cvt_pk_bf16_f32 v87, v194, v195
    s_nop 1
    v_permlane32_swap_b32 v84, v86
    v_permlane32_swap_b32 v85, v87
    ds_write_b128 v5, v[84:87] offset:352
    ds_read_b128 v[32:35], v4 offset:768
    ds_read_b128 v[36:39], v4 offset:800
    ds_read_b128 v[40:43], v4 offset:832
    ds_read_b128 v[44:47], v4 offset:864
    ds_read_b128 v[48:51], v4 offset:896
    ds_read_b128 v[52:55], v4 offset:928
    ds_read_b128 v[56:59], v4 offset:960
    ds_read_b128 v[60:63], v4 offset:992
    ds_read_b128 v[64:67], v4 offset:1024
    ds_read_b128 v[68:71], v4 offset:1056
    ds_read_b128 v[72:75], v4 offset:1088
    ds_read_b128 v[76:79], v4 offset:1120
    s_waitcnt lgkmcnt(0)
    v_add_f32 v196, v196, v32
    v_add_f32 v197, v197, v33
    v_add_f32 v198, v198, v34
    v_add_f32 v199, v199, v35
    v_add_f32 v200, v200, v36
    v_add_f32 v201, v201, v37
    v_add_f32 v202, v202, v38
    v_add_f32 v203, v203, v39
    v_cvt_pk_bf16_f32 v80, v196, v197
    v_cvt_pk_bf16_f32 v81, v198, v199
    v_cvt_pk_bf16_f32 v82, v200, v201
    v_cvt_pk_bf16_f32 v83, v202, v203
    s_nop 1
    v_permlane32_swap_b32 v80, v82
    v_permlane32_swap_b32 v81, v83
    ds_write_b128 v5, v[80:83] offset:384
    v_add_f32 v204, v204, v40
    v_add_f32 v205, v205, v41
    v_add_f32 v206, v206, v42
    v_add_f32 v207, v207, v43
    v_add_f32 v208, v208, v44
    v_add_f32 v209, v209, v45
    v_add_f32 v210, v210, v46
    v_add_f32 v211, v211, v47
    v_cvt_pk_bf16_f32 v84, v204, v205
    v_cvt_pk_bf16_f32 v85, v206, v207
    v_cvt_pk_bf16_f32 v86, v208, v209
    v_cvt_pk_bf16_f32 v87, v210, v211
    s_nop 1
    v_permlane32_swap_b32 v84, v86
    v_permlane32_swap_b32 v85, v87
    ds_write_b128 v5, v[84:87] offset:416
    v_add_f32 v212, v212, v48
    v_add_f32 v213, v213, v49
    v_add_f32 v214, v214, v50
    v_add_f32 v215, v215, v51
    v_add_f32 v216, v216, v52
    v_add_f32 v217, v217, v53
    v_add_f32 v218, v218, v54
    v_add_f32 v219, v219, v55
    v_cvt_pk_bf16_f32 v80, v212, v213
    v_cvt_pk_bf16_f32 v81, v214, v215
    v_cvt_pk_bf16_f32 v82, v216, v217
    v_cvt_pk_bf16_f32 v83, v218, v219
    s_nop 1
    v_permlane32_swap_b32 v80, v82
    v_permlane32_swap_b32 v81, v83
    ds_write_b128 v5, v[80:83] offset:448
    v_add_f32 v220, v220, v56
    v_add_f32 v221, v221, v57
    v_add_f32 v222, v222, v58
    v_add_f32 v223, v223, v59
    v_add_f32 v224, v224, v60
    v_add_f32 v225, v225, v61
    v_add_f32 v226, v226, v62
    v_add_f32 v227, v227, v63
    v_cvt_pk_bf16_f32 v84, v220, v221
    v_cvt_pk_bf16_f32 v85, v222, v223
    v_cvt_pk_bf16_f32 v86, v224, v225
    v_cvt_pk_bf16_f32 v87, v226, v227
    s_nop 1
    v_permlane32_swap_b32 v84, v86
    v_permlane32_swap_b32 v85, v87
    ds_write_b128 v5, v[84:87] offset:480
    v_add_f32 v228, v228, v64
    v_add_f32 v229, v229, v65
    v_add_f32 v230, v230, v66
    v_add_f32 v231, v231, v67
    v_add_f32 v232, v232, v68
    v_add_f32 v233, v233, v69
    v_add_f32 v234, v234, v70
    v_add_f32 v235, v235, v71
    v_cvt_pk_bf16_f32 v80, v228, v229
    v_cvt_pk_bf16_f32 v81, v230, v231
    v_cvt_pk_bf16_f32 v82, v232, v233
    v_cvt_pk_bf16_f32 v83, v234, v235
    s_nop 1
    v_permlane32_swap_b32 v80, v82
    v_permlane32_swap_b32 v81, v83
    ds_write_b128 v5, v[80:83] offset:512
    v_add_f32 v236, v236, v72
    v_add_f32 v237, v237, v73
    v_add_f32 v238, v238, v74
    v_add_f32 v239, v239, v75
    v_add_f32 v240, v240, v76
    v_add_f32 v241, v241, v77
    v_add_f32 v242, v242, v78
    v_add_f32 v243, v243, v79
    v_cvt_pk_bf16_f32 v84, v236, v237
    v_cvt_pk_bf16_f32 v85, v238, v239
    v_cvt_pk_bf16_f32 v86, v240, v241
    v_cvt_pk_bf16_f32 v87, v242, v243
    s_nop 1
    v_permlane32_swap_b32 v84, v86
    v_permlane32_swap_b32 v85, v87
    ds_write_b128 v5, v[84:87] offset:544
    s_waitcnt lgkmcnt(0)
    s_branch oproj_kernel_wkj2
oproj_kernel_wk11:
    ds_write_b128 v4, v[100:103] offset:0
    ds_write_b128 v4, v[104:107] offset:32
    ds_write_b128 v4, v[108:111] offset:64
    ds_write_b128 v4, v[112:115] offset:96
    ds_write_b128 v4, v[116:119] offset:128
    ds_write_b128 v4, v[120:123] offset:160
    ds_write_b128 v4, v[124:127] offset:192
    ds_write_b128 v4, v[128:131] offset:224
    ds_write_b128 v4, v[132:135] offset:256
    ds_write_b128 v4, v[136:139] offset:288
    ds_write_b128 v4, v[140:143] offset:320
    ds_write_b128 v4, v[144:147] offset:352
    ds_write_b128 v4, v[148:151] offset:384
    ds_write_b128 v4, v[152:155] offset:416
    ds_write_b128 v4, v[156:159] offset:448
    ds_write_b128 v4, v[160:163] offset:480
    ds_write_b128 v4, v[164:167] offset:512
    ds_write_b128 v4, v[168:171] offset:544
    ds_write_b128 v4, v[172:175] offset:576
    ds_write_b128 v4, v[176:179] offset:608
    ds_write_b128 v4, v[180:183] offset:640
    ds_write_b128 v4, v[184:187] offset:672
    ds_write_b128 v4, v[188:191] offset:704
    ds_write_b128 v4, v[192:195] offset:736
    ds_write_b128 v4, v[196:199] offset:768
    ds_write_b128 v4, v[200:203] offset:800
    ds_write_b128 v4, v[204:207] offset:832
    ds_write_b128 v4, v[208:211] offset:864
    ds_write_b128 v4, v[212:215] offset:896
    ds_write_b128 v4, v[216:219] offset:928
    ds_write_b128 v4, v[220:223] offset:960
    ds_write_b128 v4, v[224:227] offset:992
    ds_write_b128 v4, v[228:231] offset:1024
    ds_write_b128 v4, v[232:235] offset:1056
    ds_write_b128 v4, v[236:239] offset:1088
    ds_write_b128 v4, v[240:243] offset:1120
    s_waitcnt lgkmcnt(0)
    s_barrier
oproj_kernel_wkj2:
    s_branch oproj_kernel_store
oproj_kernel_loader:
    s_sub_u32 s5, s5, 4
    s_mul_i32 s25, s5, 16
    s_add_u32 s25, s25, s24
    s_mul_i32 s20, s25, 256
    s_lshr_b32 s25, s23, 7
    s_mul_i32 s25, s25, 524288
    s_add_u32 s20, s20, s25
    s_lshl_b32 s25, s5, 4
    s_add_u32 s25, s25, s23
    s_mul_i32 s21, s25, 1152
    s_mul_i32 s25, s4, 576
    s_add_u32 s21, s21, s25
    s_mul_i32 s26, s5, 2048
    s_mul_i32 s27, s5, 9216
    s_add_u32 s27, s27, 8192
    v_lshrrev_b32 v28, 3, v1
    v_and_b32 v29, 7, v1
    v_lshrrev_b32 v30, 4, v1
    s_mov_b32 s25, 256
    v_add_u32 v31, 0, v30
    v_xor_b32 v31, v31, v29
    v_lshlrev_b32 v31, 4, v31
    v_add_u32 v10, 0, v28
    v_mul_lo_u32 v10, v10, s25
    v_add_u32 v10, v10, v31
    v_add_u32 v31, 4, v30
    v_xor_b32 v31, v31, v29
    v_lshlrev_b32 v31, 4, v31
    v_add_u32 v11, 8, v28
    v_mul_lo_u32 v11, v11, s25
    v_add_u32 v11, v11, v31
    v_subrev_u32 v11, 1024, v11
    s_mov_b32 s25, 1152
    v_add_u32 v28, 0, v1
    v_mul_u32_u24 v29, 1821, v28
    v_lshrrev_b32 v29, 16, v29
    v_mul_u32_u24 v30, 36, v29
    v_sub_u32 v28, v28, v30
    v_mul_lo_u32 v14, v29, s25
    v_lshl_add_u32 v14, v28, 4, v14
    v_add_u32 v28, 64, v1
    v_mul_u32_u24 v29, 1821, v28
    v_lshrrev_b32 v29, 16, v29
    v_mul_u32_u24 v30, 36, v29
    v_sub_u32 v28, v28, v30
    v_mul_lo_u32 v15, v29, s25
    v_lshl_add_u32 v15, v28, 4, v15
    v_subrev_u32 v15, 1024, v15
    v_add_u32 v28, 128, v1
    v_mul_u32_u24 v29, 1821, v28
    v_lshrrev_b32 v29, 16, v29
    v_mul_u32_u24 v30, 36, v29
    v_sub_u32 v28, v28, v30
    v_mul_lo_u32 v16, v29, s25
    v_lshl_add_u32 v16, v28, 4, v16
    v_subrev_u32 v16, 2048, v16
    v_add_u32 v28, 192, v1
    v_mul_u32_u24 v29, 1821, v28
    v_lshrrev_b32 v29, 16, v29
    v_mul_u32_u24 v30, 36, v29
    v_sub_u32 v28, v28, v30
    v_mul_lo_u32 v17, v29, s25
    v_lshl_add_u32 v17, v28, 4, v17
    v_subrev_u32 v17, 3072, v17
    v_add_u32 v28, 256, v1
    v_mul_u32_u24 v29, 1821, v28
    v_lshrrev_b32 v29, 16, v29
    v_mul_u32_u24 v30, 36, v29
    v_sub_u32 v28, v28, v30
    v_mul_lo_u32 v18, v29, s25
    v_lshl_add_u32 v18, v28, 4, v18
    v_add_u32 v28, 320, v1
    v_mul_u32_u24 v29, 1821, v28
    v_lshrrev_b32 v29, 16, v29
    v_mul_u32_u24 v30, 36, v29
    v_sub_u32 v28, v28, v30
    v_mul_lo_u32 v19, v29, s25
    v_lshl_add_u32 v19, v28, 4, v19
    v_subrev_u32 v19, 1024, v19
    v_add_u32 v28, 384, v1
    v_mul_u32_u24 v29, 1821, v28
    v_lshrrev_b32 v29, 16, v29
    v_mul_u32_u24 v30, 36, v29
    v_sub_u32 v28, v28, v30
    v_mul_lo_u32 v20, v29, s25
    v_lshl_add_u32 v20, v28, 4, v20
    v_subrev_u32 v20, 2048, v20
    v_add_u32 v28, 448, v1
    v_mul_u32_u24 v29, 1821, v28
    v_lshrrev_b32 v29, 16, v29
    v_mul_u32_u24 v30, 36, v29
    v_sub_u32 v28, v28, v30
    v_mul_lo_u32 v21, v29, s25
    v_lshl_add_u32 v21, v28, 4, v21
    v_subrev_u32 v21, 3072, v21
    v_add_u32 v28, 512, v1
    v_mul_u32_u24 v29, 1821, v28
    v_lshrrev_b32 v29, 16, v29
    v_mul_u32_u24 v30, 36, v29
    v_sub_u32 v28, v28, v30
    v_mul_lo_u32 v22, v29, s25
    v_lshl_add_u32 v22, v28, 4, v22
    v_lshrrev_b32 v28, 2, v1
    v_mul_lo_u32 v24, v28, s25
    v_and_b32 v28, 3, v1
    v_lshl_add_u32 v24, v28, 7, v24
    v_and_b32 v28, 15, v1
    v_mul_lo_u32 v25, v28, s25
    v_add_u32 v25, 512, v25
    v_and_b32 v28, 15, v1
    s_mov_b32 s25, 256
    v_mul_lo_u32 v26, v28, s25
    s_add_u32 s28, s20, 384
    s_add_u32 s29, s21, 221184
    s_add_u32 m0, s26, 0
    s_nop 0
    buffer_load_dwordx4 v10, s[8:11], s20 offen offset:0 lds
    buffer_load_dwordx4 v11, s[8:11], s20 offen offset:1024 lds
    s_add_u32 m0, s27, 0
    s_nop 0
    buffer_load_dwordx4 v14, s[12:15], s21 offen offset:0 lds
    buffer_load_dwordx4 v15, s[12:15], s21 offen offset:1024 lds
    buffer_load_dwordx4 v16, s[12:15], s21 offen offset:2048 lds
    buffer_load_dwordx4 v17, s[12:15], s21 offen offset:3072 lds
    s_add_u32 m0, s27, 4096
    s_nop 0
    buffer_load_dwordx4 v18, s[12:15], s21 offen offset:0 lds
    buffer_load_dwordx4 v19, s[12:15], s21 offen offset:1024 lds
    buffer_load_dwordx4 v20, s[12:15], s21 offen offset:2048 lds
    buffer_load_dwordx4 v21, s[12:15], s21 offen offset:3072 lds
    s_add_u32 m0, s27, 8192
    s_nop 0
    buffer_load_dwordx4 v22, s[12:15], s21 offen offset:0 lds
    s_add_u32 s20, s20, 128
    s_add_u32 s21, s21, 73728
    s_add_u32 m0, s26, 45056
    s_nop 0
    buffer_load_dwordx4 v10, s[8:11], s20 offen offset:0 lds
    buffer_load_dwordx4 v11, s[8:11], s20 offen offset:1024 lds
    s_add_u32 m0, s27, 45056
    s_nop 0
    buffer_load_dwordx4 v14, s[12:15], s21 offen offset:0 lds
    buffer_load_dwordx4 v15, s[12:15], s21 offen offset:1024 lds
    buffer_load_dwordx4 v16, s[12:15], s21 offen offset:2048 lds
    buffer_load_dwordx4 v17, s[12:15], s21 offen offset:3072 lds
    s_add_u32 m0, s27, 49152
    s_nop 0
    buffer_load_dwordx4 v18, s[12:15], s21 offen offset:0 lds
    buffer_load_dwordx4 v19, s[12:15], s21 offen offset:1024 lds
    buffer_load_dwordx4 v20, s[12:15], s21 offen offset:2048 lds
    buffer_load_dwordx4 v21, s[12:15], s21 offen offset:3072 lds
    s_add_u32 m0, s27, 53248
    s_nop 0
    buffer_load_dwordx4 v22, s[12:15], s21 offen offset:0 lds
    s_add_u32 s20, s20, 524160
    s_add_u32 s21, s21, 73728
    s_add_u32 m0, s26, 90112
    s_nop 0
    buffer_load_dwordx4 v10, s[8:11], s20 offen offset:0 lds
    buffer_load_dwordx4 v11, s[8:11], s20 offen offset:1024 lds
    s_add_u32 m0, s27, 90112
    s_nop 0
    buffer_load_dwordx4 v14, s[12:15], s21 offen offset:0 lds
    buffer_load_dwordx4 v15, s[12:15], s21 offen offset:1024 lds
    buffer_load_dwordx4 v16, s[12:15], s21 offen offset:2048 lds
    buffer_load_dwordx4 v17, s[12:15], s21 offen offset:3072 lds
    s_add_u32 m0, s27, 94208
    s_nop 0
    buffer_load_dwordx4 v18, s[12:15], s21 offen offset:0 lds
    buffer_load_dwordx4 v19, s[12:15], s21 offen offset:1024 lds
    buffer_load_dwordx4 v20, s[12:15], s21 offen offset:2048 lds
    buffer_load_dwordx4 v21, s[12:15], s21 offen offset:3072 lds
    s_add_u32 m0, s27, 98304
    s_nop 0
    buffer_load_dwordx4 v22, s[12:15], s21 offen offset:0 lds
    s_add_u32 s20, s20, 128
    s_add_u32 s21, s21, 73728
    s_waitcnt vmcnt(22)
    s_barrier
    s_waitcnt vmcnt(11)
    s_barrier
    s_add_u32 m0, s26, 0
    s_nop 0
    buffer_load_dwordx4 v10, s[8:11], s20 offen offset:0 lds
    buffer_load_dwordx4 v11, s[8:11], s20 offen offset:1024 lds
    s_add_u32 m0, s27, 0
    s_nop 0
    buffer_load_dwordx4 v14, s[12:15], s21 offen offset:0 lds
    buffer_load_dwordx4 v15, s[12:15], s21 offen offset:1024 lds
    buffer_load_dwordx4 v16, s[12:15], s21 offen offset:2048 lds
    buffer_load_dwordx4 v17, s[12:15], s21 offen offset:3072 lds
    s_add_u32 m0, s27, 4096
    s_nop 0
    buffer_load_dwordx4 v18, s[12:15], s21 offen offset:0 lds
    buffer_load_dwordx4 v19, s[12:15], s21 offen offset:1024 lds
    buffer_load_dwordx4 v20, s[12:15], s21 offen offset:2048 lds
    buffer_load_dwordx4 v21, s[12:15], s21 offen offset:3072 lds
    s_add_u32 m0, s27, 8192
    s_nop 0
    buffer_load_dwordx4 v22, s[12:15], s21 offen offset:0 lds
    s_add_u32 s20, s20, 524160
    s_add_u32 s21, s21, 73728
    s_waitcnt vmcnt(11)
    s_barrier
    s_add_u32 m0, s26, 45056
    s_nop 0
    buffer_load_dwordx4 v10, s[8:11], s20 offen offset:0 lds
    buffer_load_dwordx4 v11, s[8:11], s20 offen offset:1024 lds
    s_add_u32 m0, s27, 45056
    s_nop 0
    buffer_load_dwordx4 v14, s[12:15], s21 offen offset:0 lds
    buffer_load_dwordx4 v15, s[12:15], s21 offen offset:1024 lds
    buffer_load_dwordx4 v16, s[12:15], s21 offen offset:2048 lds
    buffer_load_dwordx4 v17, s[12:15], s21 offen offset:3072 lds
    s_add_u32 m0, s27, 49152
    s_nop 0
    buffer_load_dwordx4 v18, s[12:15], s21 offen offset:0 lds
    buffer_load_dwordx4 v19, s[12:15], s21 offen offset:1024 lds
    buffer_load_dwordx4 v20, s[12:15], s21 offen offset:2048 lds
    buffer_load_dwordx4 v21, s[12:15], s21 offen offset:3072 lds
    s_add_u32 m0, s27, 53248
    s_nop 0
    buffer_load_dwordx4 v22, s[12:15], s21 offen offset:0 lds
    s_add_u32 s20, s20, 128
    s_add_u32 s21, s21, 73728
    s_waitcnt vmcnt(11)
    s_barrier
    s_add_u32 m0, s26, 90112
    s_nop 0
    buffer_load_dwordx4 v10, s[8:11], s20 offen offset:0 lds
    buffer_load_dwordx4 v11, s[8:11], s20 offen offset:1024 lds
    s_add_u32 m0, s27, 90112
    s_nop 0
    buffer_load_dwordx4 v14, s[12:15], s21 offen offset:0 lds
    buffer_load_dwordx4 v15, s[12:15], s21 offen offset:1024 lds
    buffer_load_dwordx4 v16, s[12:15], s21 offen offset:2048 lds
    buffer_load_dwordx4 v17, s[12:15], s21 offen offset:3072 lds
    s_add_u32 m0, s27, 94208
    s_nop 0
    buffer_load_dwordx4 v18, s[12:15], s21 offen offset:0 lds
    buffer_load_dwordx4 v19, s[12:15], s21 offen offset:1024 lds
    buffer_load_dwordx4 v20, s[12:15], s21 offen offset:2048 lds
    buffer_load_dwordx4 v21, s[12:15], s21 offen offset:3072 lds
    s_add_u32 m0, s27, 98304
    s_nop 0
    buffer_load_dwordx4 v22, s[12:15], s21 offen offset:0 lds
    s_add_u32 s20, s20, 524160
    s_add_u32 s21, s21, 73728
    s_waitcnt vmcnt(11)
    s_barrier
    s_add_u32 m0, s26, 0
    s_nop 0
    buffer_load_dwordx4 v10, s[8:11], s20 offen offset:0 lds
    buffer_load_dwordx4 v11, s[8:11], s20 offen offset:1024 lds
    s_add_u32 m0, s27, 0
    s_nop 0
    buffer_load_dwordx4 v14, s[12:15], s21 offen offset:0 lds
    buffer_load_dwordx4 v15, s[12:15], s21 offen offset:1024 lds
    buffer_load_dwordx4 v16, s[12:15], s21 offen offset:2048 lds
    buffer_load_dwordx4 v17, s[12:15], s21 offen offset:3072 lds
    s_add_u32 m0, s27, 4096
    s_nop 0
    buffer_load_dwordx4 v18, s[12:15], s21 offen offset:0 lds
    buffer_load_dwordx4 v19, s[12:15], s21 offen offset:1024 lds
    buffer_load_dwordx4 v20, s[12:15], s21 offen offset:2048 lds
    buffer_load_dwordx4 v21, s[12:15], s21 offen offset:3072 lds
    s_add_u32 m0, s27, 8192
    s_nop 0
    buffer_load_dwordx4 v22, s[12:15], s21 offen offset:0 lds
    s_add_u32 s20, s20, 128
    s_add_u32 s21, s21, 73728
    s_waitcnt vmcnt(11)
    s_barrier
    s_add_u32 m0, s26, 45056
    s_nop 0
    buffer_load_dwordx4 v10, s[8:11], s20 offen offset:0 lds
    buffer_load_dwordx4 v11, s[8:11], s20 offen offset:1024 lds
    s_add_u32 m0, s27, 45056
    s_nop 0
    buffer_load_dwordx4 v14, s[12:15], s21 offen offset:0 lds
    buffer_load_dwordx4 v15, s[12:15], s21 offen offset:1024 lds
    buffer_load_dwordx4 v16, s[12:15], s21 offen offset:2048 lds
    buffer_load_dwordx4 v17, s[12:15], s21 offen offset:3072 lds
    s_add_u32 m0, s27, 49152
    s_nop 0
    buffer_load_dwordx4 v18, s[12:15], s21 offen offset:0 lds
    buffer_load_dwordx4 v19, s[12:15], s21 offen offset:1024 lds
    buffer_load_dwordx4 v20, s[12:15], s21 offen offset:2048 lds
    buffer_load_dwordx4 v21, s[12:15], s21 offen offset:3072 lds
    s_add_u32 m0, s27, 53248
    s_nop 0
    buffer_load_dwordx4 v22, s[12:15], s21 offen offset:0 lds
    s_add_u32 s20, s20, 524160
    s_add_u32 s21, s21, 73728
    s_waitcnt vmcnt(11)
    s_barrier
    s_add_u32 m0, s26, 90112
    s_nop 0
    buffer_load_dwordx4 v10, s[8:11], s20 offen offset:0 lds
    buffer_load_dwordx4 v11, s[8:11], s20 offen offset:1024 lds
    s_add_u32 m0, s27, 90112
    s_nop 0
    buffer_load_dwordx4 v14, s[12:15], s21 offen offset:0 lds
    buffer_load_dwordx4 v15, s[12:15], s21 offen offset:1024 lds
    buffer_load_dwordx4 v16, s[12:15], s21 offen offset:2048 lds
    buffer_load_dwordx4 v17, s[12:15], s21 offen offset:3072 lds
    s_add_u32 m0, s27, 94208
    s_nop 0
    buffer_load_dwordx4 v18, s[12:15], s21 offen offset:0 lds
    buffer_load_dwordx4 v19, s[12:15], s21 offen offset:1024 lds
    buffer_load_dwordx4 v20, s[12:15], s21 offen offset:2048 lds
    buffer_load_dwordx4 v21, s[12:15], s21 offen offset:3072 lds
    s_add_u32 m0, s27, 98304
    s_nop 0
    buffer_load_dwordx4 v22, s[12:15], s21 offen offset:0 lds
    s_add_u32 s20, s20, 128
    s_add_u32 s21, s21, 73728
    s_waitcnt vmcnt(11)
    s_barrier
    s_add_u32 m0, s26, 0
    s_nop 0
    buffer_load_dwordx4 v10, s[8:11], s20 offen offset:0 lds
    buffer_load_dwordx4 v11, s[8:11], s20 offen offset:1024 lds
    s_add_u32 m0, s27, 0
    s_nop 0
    buffer_load_dwordx4 v14, s[12:15], s21 offen offset:0 lds
    buffer_load_dwordx4 v15, s[12:15], s21 offen offset:1024 lds
    buffer_load_dwordx4 v16, s[12:15], s21 offen offset:2048 lds
    buffer_load_dwordx4 v17, s[12:15], s21 offen offset:3072 lds
    s_add_u32 m0, s27, 4096
    s_nop 0
    buffer_load_dwordx4 v18, s[12:15], s21 offen offset:0 lds
    buffer_load_dwordx4 v19, s[12:15], s21 offen offset:1024 lds
    buffer_load_dwordx4 v20, s[12:15], s21 offen offset:2048 lds
    buffer_load_dwordx4 v21, s[12:15], s21 offen offset:3072 lds
    s_add_u32 m0, s27, 8192
    s_nop 0
    buffer_load_dwordx4 v22, s[12:15], s21 offen offset:0 lds
    s_add_u32 s20, s20, 524160
    s_add_u32 s21, s21, 73728
    s_waitcnt vmcnt(11)
    s_barrier
    s_add_u32 m0, s26, 45056
    s_nop 0
    buffer_load_dwordx4 v10, s[8:11], s20 offen offset:0 lds
    buffer_load_dwordx4 v11, s[8:11], s20 offen offset:1024 lds
    s_add_u32 m0, s27, 45056
    s_nop 0
    buffer_load_dwordx4 v14, s[12:15], s21 offen offset:0 lds
    buffer_load_dwordx4 v15, s[12:15], s21 offen offset:1024 lds
    buffer_load_dwordx4 v16, s[12:15], s21 offen offset:2048 lds
    buffer_load_dwordx4 v17, s[12:15], s21 offen offset:3072 lds
    s_add_u32 m0, s27, 49152
    s_nop 0
    buffer_load_dwordx4 v18, s[12:15], s21 offen offset:0 lds
    buffer_load_dwordx4 v19, s[12:15], s21 offen offset:1024 lds
    buffer_load_dwordx4 v20, s[12:15], s21 offen offset:2048 lds
    buffer_load_dwordx4 v21, s[12:15], s21 offen offset:3072 lds
    s_add_u32 m0, s27, 53248
    s_nop 0
    buffer_load_dwordx4 v22, s[12:15], s21 offen offset:0 lds
    s_add_u32 s20, s20, 128
    s_add_u32 s21, s21, 73728
    s_waitcnt vmcnt(11)
    s_barrier
    s_add_u32 m0, s26, 90112
    s_nop 0
    buffer_load_dwordx4 v10, s[8:11], s20 offen offset:0 lds
    buffer_load_dwordx4 v11, s[8:11], s20 offen offset:1024 lds
    s_add_u32 m0, s27, 90112
    s_nop 0
    buffer_load_dwordx4 v14, s[12:15], s21 offen offset:0 lds
    buffer_load_dwordx4 v15, s[12:15], s21 offen offset:1024 lds
    buffer_load_dwordx4 v16, s[12:15], s21 offen offset:2048 lds
    buffer_load_dwordx4 v17, s[12:15], s21 offen offset:3072 lds
    s_add_u32 m0, s27, 94208
    s_nop 0
    buffer_load_dwordx4 v18, s[12:15], s21 offen offset:0 lds
    buffer_load_dwordx4 v19, s[12:15], s21 offen offset:1024 lds
    buffer_load_dwordx4 v20, s[12:15], s21 offen offset:2048 lds
    buffer_load_dwordx4 v21, s[12:15], s21 offen offset:3072 lds
    s_add_u32 m0, s27, 98304
    s_nop 0
    buffer_load_dwordx4 v22, s[12:15], s21 offen offset:0 lds
    s_add_u32 s20, s20, 524160
    s_add_u32 s21, s21, 73728
    s_waitcnt vmcnt(11)
    s_barrier
    s_add_u32 m0, s26, 0
    s_nop 0
    buffer_load_dwordx4 v10, s[8:11], s20 offen offset:0 lds
    buffer_load_dwordx4 v11, s[8:11], s20 offen offset:1024 lds
    s_add_u32 m0, s27, 0
    s_nop 0
    buffer_load_dwordx4 v14, s[12:15], s21 offen offset:0 lds
    buffer_load_dwordx4 v15, s[12:15], s21 offen offset:1024 lds
    buffer_load_dwordx4 v16, s[12:15], s21 offen offset:2048 lds
    buffer_load_dwordx4 v17, s[12:15], s21 offen offset:3072 lds
    s_add_u32 m0, s27, 4096
    s_nop 0
    buffer_load_dwordx4 v18, s[12:15], s21 offen offset:0 lds
    buffer_load_dwordx4 v19, s[12:15], s21 offen offset:1024 lds
    buffer_load_dwordx4 v20, s[12:15], s21 offen offset:2048 lds
    buffer_load_dwordx4 v21, s[12:15], s21 offen offset:3072 lds
    s_add_u32 m0, s27, 8192
    s_nop 0
    buffer_load_dwordx4 v22, s[12:15], s21 offen offset:0 lds
    s_add_u32 s20, s20, 128
    s_add_u32 s21, s21, 73728
    s_waitcnt vmcnt(11)
    s_barrier
    s_add_u32 m0, s26, 45056
    s_nop 0
    buffer_load_dwordx4 v10, s[8:11], s20 offen offset:0 lds
    buffer_load_dwordx4 v11, s[8:11], s20 offen offset:1024 lds
    s_add_u32 m0, s27, 45056
    s_nop 0
    buffer_load_dwordx4 v14, s[12:15], s21 offen offset:0 lds
    buffer_load_dwordx4 v15, s[12:15], s21 offen offset:1024 lds
    buffer_load_dwordx4 v16, s[12:15], s21 offen offset:2048 lds
    buffer_load_dwordx4 v17, s[12:15], s21 offen offset:3072 lds
    s_add_u32 m0, s27, 49152
    s_nop 0
    buffer_load_dwordx4 v18, s[12:15], s21 offen offset:0 lds
    buffer_load_dwordx4 v19, s[12:15], s21 offen offset:1024 lds
    buffer_load_dwordx4 v20, s[12:15], s21 offen offset:2048 lds
    buffer_load_dwordx4 v21, s[12:15], s21 offen offset:3072 lds
    s_add_u32 m0, s27, 53248
    s_nop 0
    buffer_load_dwordx4 v22, s[12:15], s21 offen offset:0 lds
    s_add_u32 s20, s20, 524160
    s_add_u32 s21, s21, 73728
    s_waitcnt vmcnt(11)
    s_barrier
    s_add_u32 m0, s26, 90112
    s_nop 0
    buffer_load_dwordx4 v10, s[8:11], s20 offen offset:0 lds
    buffer_load_dwordx4 v11, s[8:11], s20 offen offset:1024 lds
    s_add_u32 m0, s27, 90112
    s_nop 0
    buffer_load_dwordx4 v14, s[12:15], s21 offen offset:0 lds
    buffer_load_dwordx4 v15, s[12:15], s21 offen offset:1024 lds
    buffer_load_dwordx4 v16, s[12:15], s21 offen offset:2048 lds
    buffer_load_dwordx4 v17, s[12:15], s21 offen offset:3072 lds
    s_add_u32 m0, s27, 94208
    s_nop 0
    buffer_load_dwordx4 v18, s[12:15], s21 offen offset:0 lds
    buffer_load_dwordx4 v19, s[12:15], s21 offen offset:1024 lds
    buffer_load_dwordx4 v20, s[12:15], s21 offen offset:2048 lds
    buffer_load_dwordx4 v21, s[12:15], s21 offen offset:3072 lds
    s_add_u32 m0, s27, 98304
    s_nop 0
    buffer_load_dwordx4 v22, s[12:15], s21 offen offset:0 lds
    s_add_u32 s20, s20, 128
    s_add_u32 s21, s21, 73728
    s_waitcnt vmcnt(11)
    s_barrier
    s_add_u32 m0, s26, 0
    s_nop 0
    buffer_load_dwordx4 v10, s[8:11], s20 offen offset:0 lds
    buffer_load_dwordx4 v11, s[8:11], s20 offen offset:1024 lds
    s_add_u32 m0, s27, 0
    s_nop 0
    buffer_load_dwordx4 v14, s[12:15], s21 offen offset:0 lds
    buffer_load_dwordx4 v15, s[12:15], s21 offen offset:1024 lds
    buffer_load_dwordx4 v16, s[12:15], s21 offen offset:2048 lds
    buffer_load_dwordx4 v17, s[12:15], s21 offen offset:3072 lds
    s_add_u32 m0, s27, 4096
    s_nop 0
    buffer_load_dwordx4 v18, s[12:15], s21 offen offset:0 lds
    buffer_load_dwordx4 v19, s[12:15], s21 offen offset:1024 lds
    buffer_load_dwordx4 v20, s[12:15], s21 offen offset:2048 lds
    buffer_load_dwordx4 v21, s[12:15], s21 offen offset:3072 lds
    s_add_u32 m0, s27, 8192
    s_nop 0
    buffer_load_dwordx4 v22, s[12:15], s21 offen offset:0 lds
    s_add_u32 s20, s20, 524160
    s_add_u32 s21, s21, 73728
    s_waitcnt vmcnt(11)
    s_barrier
    s_waitcnt vmcnt(0)
    s_barrier
    s_barrier
    s_barrier
    s_add_u32 s5, s5, 4
oproj_kernel_store:
    s_barrier
    s_mul_i32 s25, s5, 4736
    s_add_u32 s25, s25, 81920
    s_mul_i32 s26, s5, 9216
    s_add_u32 s22, s22, s26
    v_add_u32 v28, 0, v1
    v_mul_u32_u24 v29, 1821, v28
    v_lshrrev_b32 v29, 16, v29
    v_mul_u32_u24 v30, 36, v29
    v_sub_u32 v28, v28, v30
    v_lshlrev_b32 v28, 4, v28
    v_mul_u32_u24 v30, 592, v29
    v_add3_u32 v30, v30, v28, s25
    ds_read_b128 v[32:35], v30
    v_mul_u32_u24 v30, 1152, v29
    v_add_u32 v5, v30, v28
    v_add_u32 v28, 64, v1
    v_mul_u32_u24 v29, 1821, v28
    v_lshrrev_b32 v29, 16, v29
    v_mul_u32_u24 v30, 36, v29
    v_sub_u32 v28, v28, v30
    v_lshlrev_b32 v28, 4, v28
    v_mul_u32_u24 v30, 592, v29
    v_add3_u32 v30, v30, v28, s25
    ds_read_b128 v[36:39], v30
    v_mul_u32_u24 v30, 1152, v29
    v_add_u32 v6, v30, v28
    v_add_u32 v28, 128, v1
    v_mul_u32_u24 v29, 1821, v28
    v_lshrrev_b32 v29, 16, v29
    v_mul_u32_u24 v30, 36, v29
    v_sub_u32 v28, v28, v30
    v_lshlrev_b32 v28, 4, v28
    v_mul_u32_u24 v30, 592, v29
    v_add3_u32 v30, v30, v28, s25
    ds_read_b128 v[40:43], v30
    v_mul_u32_u24 v30, 1152, v29
    v_add_u32 v7, v30, v28
    v_add_u32 v28, 192, v1
    v_mul_u32_u24 v29, 1821, v28
    v_lshrrev_b32 v29, 16, v29
    v_mul_u32_u24 v30, 36, v29
    v_sub_u32 v28, v28, v30
    v_lshlrev_b32 v28, 4, v28
    v_mul_u32_u24 v30, 592, v29
    v_add3_u32 v30, v30, v28, s25
    ds_read_b128 v[44:47], v30
    v_mul_u32_u24 v30, 1152, v29
    v_add_u32 v8, v30, v28
    s_mov_b64 exec, 0xffffffff
    v_add_u32 v28, 256, v1
    v_mul_u32_u24 v29, 1821, v28
    v_lshrrev_b32 v29, 16, v29
    v_mul_u32_u24 v30, 36, v29
    v_sub_u32 v28, v28, v30
    v_lshlrev_b32 v28, 4, v28
    v_mul_u32_u24 v30, 592, v29
    v_add3_u32 v30, v30, v28, s25
    ds_read_b128 v[48:51], v30
    v_mul_u32_u24 v30, 1152, v29
    v_add_u32 v9, v30, v28
    s_mov_b64 exec, -1
    s_waitcnt lgkmcnt(4)
    buffer_store_dwordx4 v[32:35], v5, s[16:19], s22 offen sc1
    s_waitcnt lgkmcnt(3)
    buffer_store_dwordx4 v[36:39], v6, s[16:19], s22 offen sc1
    s_waitcnt lgkmcnt(2)
    buffer_store_dwordx4 v[40:43], v7, s[16:19], s22 offen sc1
    s_waitcnt lgkmcnt(1)
    buffer_store_dwordx4 v[44:47], v8, s[16:19], s22 offen sc1
    s_mov_b64 exec, 0xffffffff
    s_waitcnt lgkmcnt(0)
    buffer_store_dwordx4 v[48:51], v9, s[16:19], s22 offen sc1
    s_mov_b64 exec, -1
oproj_kernel_fin:
oproj_kernel_done:
    s_endpgm

.globl ln2_kernel
.p2align 8
.type ln2_kernel,@function
ln2_kernel:
    s_cmp_ge_u32 s2, 512
    s_cbranch_scc1 ln2_done
    s_load_dwordx2 s[8:9], s[0:1], 0
    s_load_dwordx2 s[12:13], s[0:1], 96
    s_load_dwordx2 s[16:17], s[0:1], 96
    s_load_dwordx2 s[24:25], s[0:1], 96
    s_load_dwordx2 s[28:29], s[0:1], 96
    v_and_b32 v1, 63, v0
    v_lshrrev_b32 v2, 6, v0
    s_lshl_b32 s3, s2, 2
    v_add_u32 v2, s3, v2
    s_movk_i32 s4, 1152
    v_mul_lo_u32 v2, v2, s4
    v_lshlrev_b32 v3, 3, v1
    v_lshl_add_u32 v2, v1, 2, v2
    v_cmp_gt_u32 s[20:21], 32, v1
    v_mov_b32 v8, 0
    v_mov_b32 v72, 0
    s_mov_b32 s48, 0
    v_mov_b32 v82, 0
    s_mov_b32 s49, 2359296
    v_mov_b32 v92, 0
    s_mov_b32 s50, 4718592
    v_mov_b32 v102, 0
    s_mov_b32 s51, 7077888
    v_mov_b32 v48, 0
    v_mov_b32 v49, 0
    s_movk_i32 s5, 6912
    s_movk_i32 s6, 9216
    s_movk_i32 s7, 4608
    s_waitcnt lgkmcnt(0)
    s_and_b32 s9, s9, 0xffff
    s_mov_b32 s10, 0x240000
    s_mov_b32 s11, 0x00020000
    s_and_b32 s13, s13, 0xffff
    s_mov_b32 s14, 0x3600
    s_mov_b32 s15, 0x00020000
    s_add_u32 s16, s16, 0x700000
    s_addc_u32 s17, s17, 0
    s_and_b32 s17, s17, 0xffff
    s_mov_b32 s18, 0x240000
    s_mov_b32 s19, 0x00020000
    s_add_u32 s24, s24, 0x400000
    s_addc_u32 s25, s25, 0
    s_and_b32 s25, s25, 0xffff
    s_mov_b32 s26, 0x240000
    s_mov_b32 s27, 0x00020000
    s_add_u32 s28, s28, 0x4000000
    s_addc_u32 s29, s29, 0
    s_and_b32 s29, s29, 0xffff
    s_mov_b32 s30, 0x900000
    s_mov_b32 s31, 0x00020000
    buffer_load_dword v64, v2, s[28:31], s48 offen offset:0
    buffer_load_dword v66, v2, s[28:31], s48 offen offset:256
    buffer_load_dword v68, v2, s[28:31], s48 offen offset:512
    buffer_load_dword v70, v2, s[28:31], s48 offen offset:768
    buffer_load_dword v74, v2, s[28:31], s49 offen offset:0
    buffer_load_dword v76, v2, s[28:31], s49 offen offset:256
    buffer_load_dword v78, v2, s[28:31], s49 offen offset:512
    buffer_load_dword v80, v2, s[28:31], s49 offen offset:768
    buffer_load_dword v84, v2, s[28:31], s50 offen offset:0
    buffer_load_dword v86, v2, s[28:31], s50 offen offset:256
    buffer_load_dword v88, v2, s[28:31], s50 offen offset:512
    buffer_load_dword v90, v2, s[28:31], s50 offen offset:768
    buffer_load_dword v94, v2, s[28:31], s51 offen offset:0
    buffer_load_dword v96, v2, s[28:31], s51 offen offset:256
    buffer_load_dword v98, v2, s[28:31], s51 offen offset:512
    buffer_load_dword v100, v2, s[28:31], s51 offen offset:768
    buffer_load_dword v4, v2, s[8:11], 0 offen offset:0
    buffer_load_dword v5, v2, s[8:11], 0 offen offset:256
    buffer_load_dword v6, v2, s[8:11], 0 offen offset:512
    buffer_load_dword v7, v2, s[8:11], 0 offen offset:768
    buffer_load_dwordx2 v[40:41], v3, s[12:15], s7 offen offset:0
    buffer_load_dwordx2 v[42:43], v3, s[12:15], s7 offen offset:512
    buffer_load_dwordx2 v[44:45], v3, s[12:15], s7 offen offset:1024
    buffer_load_dwordx2 v[46:47], v3, s[12:15], s7 offen offset:1536
    buffer_load_dwordx2 v[20:21], v3, s[12:15], s6 offen offset:0
    buffer_load_dwordx2 v[30:31], v3, s[12:15], s5 offen offset:0
    buffer_load_dwordx2 v[22:23], v3, s[12:15], s6 offen offset:512
    buffer_load_dwordx2 v[32:33], v3, s[12:15], s5 offen offset:512
    buffer_load_dwordx2 v[24:25], v3, s[12:15], s6 offen offset:1024
    buffer_load_dwordx2 v[34:35], v3, s[12:15], s5 offen offset:1024
    buffer_load_dwordx2 v[26:27], v3, s[12:15], s6 offen offset:1536
    buffer_load_dwordx2 v[36:37], v3, s[12:15], s5 offen offset:1536
    s_mov_b64 s[22:23], exec
    s_mov_b64 exec, s[20:21]
    buffer_load_dword v72, v2, s[28:31], s48 offen offset:1024
    buffer_load_dword v82, v2, s[28:31], s49 offen offset:1024
    buffer_load_dword v92, v2, s[28:31], s50 offen offset:1024
    buffer_load_dword v102, v2, s[28:31], s51 offen offset:1024
    buffer_load_dword v8, v2, s[8:11], 0 offen offset:1024
    buffer_load_dwordx2 v[48:49], v3, s[12:15], s7 offen offset:2048
    buffer_load_dwordx2 v[28:29], v3, s[12:15], s6 offen offset:2048
    buffer_load_dwordx2 v[38:39], v3, s[12:15], s5 offen offset:2048
    s_mov_b64 exec, s[22:23]
    s_waitcnt vmcnt(0)
    v_and_b32 v65, 0xffff0000, v64
    v_lshlrev_b32 v64, 16, v64
    v_and_b32 v67, 0xffff0000, v66
    v_lshlrev_b32 v66, 16, v66
    v_and_b32 v69, 0xffff0000, v68
    v_lshlrev_b32 v68, 16, v68
    v_and_b32 v71, 0xffff0000, v70
    v_lshlrev_b32 v70, 16, v70
    v_and_b32 v73, 0xffff0000, v72
    v_lshlrev_b32 v72, 16, v72
    v_and_b32 v75, 0xffff0000, v74
    v_lshlrev_b32 v74, 16, v74
    v_and_b32 v77, 0xffff0000, v76
    v_lshlrev_b32 v76, 16, v76
    v_and_b32 v79, 0xffff0000, v78
    v_lshlrev_b32 v78, 16, v78
    v_and_b32 v81, 0xffff0000, v80
    v_lshlrev_b32 v80, 16, v80
    v_and_b32 v83, 0xffff0000, v82
    v_lshlrev_b32 v82, 16, v82
    v_and_b32 v85, 0xffff0000, v84
    v_lshlrev_b32 v84, 16, v84
    v_and_b32 v87, 0xffff0000, v86
    v_lshlrev_b32 v86, 16, v86
    v_and_b32 v89, 0xffff0000, v88
    v_lshlrev_b32 v88, 16, v88
    v_and_b32 v91, 0xffff0000, v90
    v_lshlrev_b32 v90, 16, v90
    v_and_b32 v93, 0xffff0000, v92
    v_lshlrev_b32 v92, 16, v92
    v_and_b32 v95, 0xffff0000, v94
    v_lshlrev_b32 v94, 16, v94
    v_and_b32 v97, 0xffff0000, v96
    v_lshlrev_b32 v96, 16, v96
    v_and_b32 v99, 0xffff0000, v98
    v_lshlrev_b32 v98, 16, v98
    v_and_b32 v101, 0xffff0000, v100
    v_lshlrev_b32 v100, 16, v100
    v_and_b32 v103, 0xffff0000, v102
    v_lshlrev_b32 v102, 16, v102
    v_add_f32 v64, v64, v74
    v_add_f32 v64, v64, v84
    v_add_f32 v64, v64, v94
    v_add_f32 v65, v65, v75
    v_add_f32 v65, v65, v85
    v_add_f32 v65, v65, v95
    v_add_f32 v66, v66, v76
    v_add_f32 v66, v66, v86
    v_add_f32 v66, v66, v96
    v_add_f32 v67, v67, v77
    v_add_f32 v67, v67, v87
    v_add_f32 v67, v67, v97
    v_add_f32 v68, v68, v78
    v_add_f32 v68, v68, v88
    v_add_f32 v68, v68, v98
    v_add_f32 v69, v69, v79
    v_add_f32 v69, v69, v89
    v_add_f32 v69, v69, v99
    v_add_f32 v70, v70, v80
    v_add_f32 v70, v70, v90
    v_add_f32 v70, v70, v100
    v_add_f32 v71, v71, v81
    v_add_f32 v71, v71, v91
    v_add_f32 v71, v71, v101
    v_add_f32 v72, v72, v82
    v_add_f32 v72, v72, v92
    v_add_f32 v72, v72, v102
    v_add_f32 v73, v73, v83
    v_add_f32 v73, v73, v93
    v_add_f32 v73, v73, v103
    v_cvt_pk_bf16_f32 v50, v64, v65
    v_lshlrev_b32 v64, 16, v50
    v_and_b32 v65, 0xffff0000, v50
    v_mul_f32 v64, v64, v40
    v_mul_f32 v65, v65, v41
    v_cvt_pk_bf16_f32 v50, v64, v65
    v_lshlrev_b32 v64, 16, v50
    v_and_b32 v65, 0xffff0000, v50
    v_lshlrev_b32 v10, 16, v4
    v_and_b32 v11, 0xffff0000, v4
    v_add_f32 v10, v10, v64
    v_add_f32 v11, v11, v65
    v_cvt_pk_bf16_f32 v4, v10, v11
    v_lshlrev_b32 v10, 16, v4
    v_and_b32 v11, 0xffff0000, v4
    v_cvt_pk_bf16_f32 v50, v66, v67
    v_lshlrev_b32 v66, 16, v50
    v_and_b32 v67, 0xffff0000, v50
    v_mul_f32 v66, v66, v42
    v_mul_f32 v67, v67, v43
    v_cvt_pk_bf16_f32 v50, v66, v67
    v_lshlrev_b32 v66, 16, v50
    v_and_b32 v67, 0xffff0000, v50
    v_lshlrev_b32 v12, 16, v5
    v_and_b32 v13, 0xffff0000, v5
    v_add_f32 v12, v12, v66
    v_add_f32 v13, v13, v67
    v_cvt_pk_bf16_f32 v5, v12, v13
    v_lshlrev_b32 v12, 16, v5
    v_and_b32 v13, 0xffff0000, v5
    v_cvt_pk_bf16_f32 v50, v68, v69
    v_lshlrev_b32 v68, 16, v50
    v_and_b32 v69, 0xffff0000, v50
    v_mul_f32 v68, v68, v44
    v_mul_f32 v69, v69, v45
    v_cvt_pk_bf16_f32 v50, v68, v69
    v_lshlrev_b32 v68, 16, v50
    v_and_b32 v69, 0xffff0000, v50
    v_lshlrev_b32 v14, 16, v6
    v_and_b32 v15, 0xffff0000, v6
    v_add_f32 v14, v14, v68
    v_add_f32 v15, v15, v69
    v_cvt_pk_bf16_f32 v6, v14, v15
    v_lshlrev_b32 v14, 16, v6
    v_and_b32 v15, 0xffff0000, v6
    v_cvt_pk_bf16_f32 v50, v70, v71
    v_lshlrev_b32 v70, 16, v50
    v_and_b32 v71, 0xffff0000, v50
    v_mul_f32 v70, v70, v46
    v_mul_f32 v71, v71, v47
    v_cvt_pk_bf16_f32 v50, v70, v71
    v_lshlrev_b32 v70, 16, v50
    v_and_b32 v71, 0xffff0000, v50
    v_lshlrev_b32 v16, 16, v7
    v_and_b32 v17, 0xffff0000, v7
    v_add_f32 v16, v16, v70
    v_add_f32 v17, v17, v71
    v_cvt_pk_bf16_f32 v7, v16, v17
    v_lshlrev_b32 v16, 16, v7
    v_and_b32 v17, 0xffff0000, v7
    v_cvt_pk_bf16_f32 v50, v72, v73
    v_lshlrev_b32 v72, 16, v50
    v_and_b32 v73, 0xffff0000, v50
    v_mul_f32 v72, v72, v48
    v_mul_f32 v73, v73, v49
    v_cvt_pk_bf16_f32 v50, v72, v73
    v_lshlrev_b32 v72, 16, v50
    v_and_b32 v73, 0xffff0000, v50
    v_lshlrev_b32 v18, 16, v8
    v_and_b32 v19, 0xffff0000, v8
    v_add_f32 v18, v18, v72
    v_add_f32 v19, v19, v73
    v_cvt_pk_bf16_f32 v8, v18, v19
    v_lshlrev_b32 v18, 16, v8
    v_and_b32 v19, 0xffff0000, v8
    buffer_store_dword v4, v2, s[24:27], 0 offen offset:0
    buffer_store_dword v5, v2, s[24:27], 0 offen offset:256
    buffer_store_dword v6, v2, s[24:27], 0 offen offset:512
    buffer_store_dword v7, v2, s[24:27], 0 offen offset:768
    s_mov_b64 exec, s[20:21]
    buffer_store_dword v8, v2, s[24:27], 0 offen offset:1024
    s_mov_b64 exec, s[22:23]
    v_add_f32 v52, v10, v11
    v_add_f32 v52, v52, v12
    v_add_f32 v52, v52, v13
    v_add_f32 v52, v52, v14
    v_add_f32 v52, v52, v15
    v_add_f32 v52, v52, v16
    v_add_f32 v52, v52, v17
    v_add_f32 v52, v52, v18
    v_add_f32 v52, v52, v19
    s_nop 1
    v_add_f32_dpp v52, v52, v52 quad_perm:[1,0,3,2] row_mask:0xf bank_mask:0xf
    s_nop 1
    v_add_f32_dpp v52, v52, v52 quad_perm:[2,3,0,1] row_mask:0xf bank_mask:0xf
    s_nop 1
    v_add_f32_dpp v52, v52, v52 row_half_mirror row_mask:0xf bank_mask:0xf
    s_nop 1
    v_add_f32_dpp v52, v52, v52 row_mirror row_mask:0xf bank_mask:0xf
    s_nop 1
    v_readlane_b32 s40, v52, 0
    v_readlane_b32 s41, v52, 16
    v_readlane_b32 s42, v52, 32
    v_readlane_b32 s43, v52, 48
    s_nop 1
    v_mov_b32 v52, s40
    v_add_f32 v52, s41, v52
    v_add_f32 v52, s42, v52
    v_add_f32 v52, s43, v52
    s_mov_b32 s44, 0x3ae38e39
    v_mul_f32 v52, s44, v52
    v_mov_b32 v53, 0
    v_sub_f32 v54, v10, v52
    v_fmac_f32 v53, v54, v54
    v_sub_f32 v54, v11, v52
    v_fmac_f32 v53, v54, v54
    v_sub_f32 v54, v12, v52
    v_fmac_f32 v53, v54, v54
    v_sub_f32 v54, v13, v52
    v_fmac_f32 v53, v54, v54
    v_sub_f32 v54, v14, v52
    v_fmac_f32 v53, v54, v54
    v_sub_f32 v54, v15, v52
    v_fmac_f32 v53, v54, v54
    v_sub_f32 v54, v16, v52
    v_fmac_f32 v53, v54, v54
    v_sub_f32 v54, v17, v52
    v_fmac_f32 v53, v54, v54
    s_mov_b64 s[46:47], exec
    s_mov_b64 exec, s[20:21]
    v_sub_f32 v54, v18, v52
    v_fmac_f32 v53, v54, v54
    v_sub_f32 v54, v19, v52
    v_fmac_f32 v53, v54, v54
    s_mov_b64 exec, s[46:47]
    s_nop 1
    v_add_f32_dpp v53, v53, v53 quad_perm:[1,0,3,2] row_mask:0xf bank_mask:0xf
    s_nop 1
    v_add_f32_dpp v53, v53, v53 quad_perm:[2,3,0,1] row_mask:0xf bank_mask:0xf
    s_nop 1
    v_add_f32_dpp v53, v53, v53 row_half_mirror row_mask:0xf bank_mask:0xf
    s_nop 1
    v_add_f32_dpp v53, v53, v53 row_mirror row_mask:0xf bank_mask:0xf
    s_nop 1
    v_readlane_b32 s40, v53, 0
    v_readlane_b32 s41, v53, 16
    v_readlane_b32 s42, v53, 32
    v_readlane_b32 s43, v53, 48
    s_nop 1
    v_mov_b32 v53, s40
    v_add_f32 v53, s41, v53
    v_add_f32 v53, s42, v53
    v_add_f32 v53, s43, v53
    v_mul_f32 v53, s44, v53
    v_cvt_pk_bf16_f32 v54, v52, v53
    v_lshlrev_b32 v52, 16, v54
    v_and_b32 v53, 0xffff0000, v54
    s_mov_b32 s45, 0x3727c5ac
    v_add_f32 v53, s45, v53
    v_cvt_pk_bf16_f32 v53, v53, v53
    v_lshlrev_b32 v53, 16, v53
    v_sqrt_f32 v53, v53
    s_nop 0
    v_cvt_pk_bf16_f32 v53, v53, v53
    v_lshlrev_b32 v53, 16, v53
    v_rcp_f32 v54, v53
    s_nop 0
    v_sub_f32 v10, v10, v52
    v_sub_f32 v11, v11, v52
    v_cvt_pk_bf16_f32 v55, v10, v11
    v_lshlrev_b32 v10, 16, v55
    v_and_b32 v11, 0xffff0000, v55
    v_mul_f32 v56, v10, v54
    v_fma_f32 v57, -v56, v53, v10
    v_fma_f32 v10, v57, v54, v56
    v_mul_f32 v56, v11, v54
    v_fma_f32 v57, -v56, v53, v11
    v_fma_f32 v11, v57, v54, v56
    v_cvt_pk_bf16_f32 v55, v10, v11
    v_lshlrev_b32 v10, 16, v55
    v_and_b32 v11, 0xffff0000, v55
    v_add_f32 v20, 1.0, v20
    v_add_f32 v21, 1.0, v21
    v_cvt_pk_bf16_f32 v55, v20, v21
    v_lshlrev_b32 v20, 16, v55
    v_and_b32 v21, 0xffff0000, v55
    v_mul_f32 v10, v10, v20
    v_mul_f32 v11, v11, v21
    v_cvt_pk_bf16_f32 v55, v10, v11
    v_lshlrev_b32 v10, 16, v55
    v_and_b32 v11, 0xffff0000, v55
    v_add_f32 v10, v10, v30
    v_add_f32 v11, v11, v31
    v_cvt_pk_bf16_f32 v40, v10, v11
    v_sub_f32 v12, v12, v52
    v_sub_f32 v13, v13, v52
    v_cvt_pk_bf16_f32 v55, v12, v13
    v_lshlrev_b32 v12, 16, v55
    v_and_b32 v13, 0xffff0000, v55
    v_mul_f32 v56, v12, v54
    v_fma_f32 v57, -v56, v53, v12
    v_fma_f32 v12, v57, v54, v56
    v_mul_f32 v56, v13, v54
    v_fma_f32 v57, -v56, v53, v13
    v_fma_f32 v13, v57, v54, v56
    v_cvt_pk_bf16_f32 v55, v12, v13
    v_lshlrev_b32 v12, 16, v55
    v_and_b32 v13, 0xffff0000, v55
    v_add_f32 v22, 1.0, v22
    v_add_f32 v23, 1.0, v23
    v_cvt_pk_bf16_f32 v55, v22, v23
    v_lshlrev_b32 v22, 16, v55
    v_and_b32 v23, 0xffff0000, v55
    v_mul_f32 v12, v12, v22
    v_mul_f32 v13, v13, v23
    v_cvt_pk_bf16_f32 v55, v12, v13
    v_lshlrev_b32 v12, 16, v55
    v_and_b32 v13, 0xffff0000, v55
    v_add_f32 v12, v12, v32
    v_add_f32 v13, v13, v33
    v_cvt_pk_bf16_f32 v41, v12, v13
    v_sub_f32 v14, v14, v52
    v_sub_f32 v15, v15, v52
    v_cvt_pk_bf16_f32 v55, v14, v15
    v_lshlrev_b32 v14, 16, v55
    v_and_b32 v15, 0xffff0000, v55
    v_mul_f32 v56, v14, v54
    v_fma_f32 v57, -v56, v53, v14
    v_fma_f32 v14, v57, v54, v56
    v_mul_f32 v56, v15, v54
    v_fma_f32 v57, -v56, v53, v15
    v_fma_f32 v15, v57, v54, v56
    v_cvt_pk_bf16_f32 v55, v14, v15
    v_lshlrev_b32 v14, 16, v55
    v_and_b32 v15, 0xffff0000, v55
    v_add_f32 v24, 1.0, v24
    v_add_f32 v25, 1.0, v25
    v_cvt_pk_bf16_f32 v55, v24, v25
    v_lshlrev_b32 v24, 16, v55
    v_and_b32 v25, 0xffff0000, v55
    v_mul_f32 v14, v14, v24
    v_mul_f32 v15, v15, v25
    v_cvt_pk_bf16_f32 v55, v14, v15
    v_lshlrev_b32 v14, 16, v55
    v_and_b32 v15, 0xffff0000, v55
    v_add_f32 v14, v14, v34
    v_add_f32 v15, v15, v35
    v_cvt_pk_bf16_f32 v42, v14, v15
    v_sub_f32 v16, v16, v52
    v_sub_f32 v17, v17, v52
    v_cvt_pk_bf16_f32 v55, v16, v17
    v_lshlrev_b32 v16, 16, v55
    v_and_b32 v17, 0xffff0000, v55
    v_mul_f32 v56, v16, v54
    v_fma_f32 v57, -v56, v53, v16
    v_fma_f32 v16, v57, v54, v56
    v_mul_f32 v56, v17, v54
    v_fma_f32 v57, -v56, v53, v17
    v_fma_f32 v17, v57, v54, v56
    v_cvt_pk_bf16_f32 v55, v16, v17
    v_lshlrev_b32 v16, 16, v55
    v_and_b32 v17, 0xffff0000, v55
    v_add_f32 v26, 1.0, v26
    v_add_f32 v27, 1.0, v27
    v_cvt_pk_bf16_f32 v55, v26, v27
    v_lshlrev_b32 v26, 16, v55
    v_and_b32 v27, 0xffff0000, v55
    v_mul_f32 v16, v16, v26
    v_mul_f32 v17, v17, v27
    v_cvt_pk_bf16_f32 v55, v16, v17
    v_lshlrev_b32 v16, 16, v55
    v_and_b32 v17, 0xffff0000, v55
    v_add_f32 v16, v16, v36
    v_add_f32 v17, v17, v37
    v_cvt_pk_bf16_f32 v43, v16, v17
    v_sub_f32 v18, v18, v52
    v_sub_f32 v19, v19, v52
    v_cvt_pk_bf16_f32 v55, v18, v19
    v_lshlrev_b32 v18, 16, v55
    v_and_b32 v19, 0xffff0000, v55
    v_mul_f32 v56, v18, v54
    v_fma_f32 v57, -v56, v53, v18
    v_fma_f32 v18, v57, v54, v56
    v_mul_f32 v56, v19, v54
    v_fma_f32 v57, -v56, v53, v19
    v_fma_f32 v19, v57, v54, v56
    v_cvt_pk_bf16_f32 v55, v18, v19
    v_lshlrev_b32 v18, 16, v55
    v_and_b32 v19, 0xffff0000, v55
    v_add_f32 v28, 1.0, v28
    v_add_f32 v29, 1.0, v29
    v_cvt_pk_bf16_f32 v55, v28, v29
    v_lshlrev_b32 v28, 16, v55
    v_and_b32 v29, 0xffff0000, v55
    v_mul_f32 v18, v18, v28
    v_mul_f32 v19, v19, v29
    v_cvt_pk_bf16_f32 v55, v18, v19
    v_lshlrev_b32 v18, 16, v55
    v_and_b32 v19, 0xffff0000, v55
    v_add_f32 v18, v18, v38
    v_add_f32 v19, v19, v39
    v_cvt_pk_bf16_f32 v44, v18, v19
    buffer_store_dword v40, v2, s[16:19], 0 offen offset:0
    buffer_store_dword v41, v2, s[16:19], 0 offen offset:256
    buffer_store_dword v42, v2, s[16:19], 0 offen offset:512
    buffer_store_dword v43, v2, s[16:19], 0 offen offset:768
    s_mov_b64 exec, s[20:21]
    buffer_store_dword v44, v2, s[16:19], 0 offen offset:1024
ln2_done:
    s_endpgm

.globl ffn1_kernel
.p2align 8
.type ffn1_kernel,@function
ffn1_kernel:
    s_cmp_ge_u32 s2, 256
    s_cbranch_scc1 ffn1_kernel_done
    s_load_dwordx2 s[8:9], s[0:1], 96
    s_load_dwordx2 s[12:13], s[0:1], 48
    s_load_dwordx2 s[16:17], s[0:1], 96
    v_lshrrev_b32 v4, 6, v0
    v_and_b32 v1, 63, v0
    v_readfirstlane_b32 s5, v4
    v_and_b32 v2, 31, v0
    v_lshrrev_b32 v3, 5, v1
    s_and_b32 s6, s2, 7
    s_lshr_b32 s7, s2, 3
    s_and_b32 s3, s6, 1
    s_lshl_b32 s3, s3, 3
    s_and_b32 s24, s7, 7
    s_add_u32 s3, s3, s24
    s_lshr_b32 s4, s6, 1
    s_lshl_b32 s4, s4, 2
    s_lshr_b32 s24, s7, 3
    s_add_u32 s4, s4, s24
    s_lshl_b32 s24, s3, 7
    s_lshl_b32 s22, s24, 7
    s_mul_i32 s30, s4, 36
    s_mov_b32 s25, 0xbfb8aa3b
    s_waitcnt lgkmcnt(0)
    s_add_u32 s8, s8, 0x700000
    s_addc_u32 s9, s9, 0
    s_and_b32 s9, s9, 0xffff
    s_mov_b32 s10, 0x240000
    s_mov_b32 s11, 0x00020000
    s_and_b32 s13, s13, 0xffff
    s_mov_b32 s14, 0x510000
    s_mov_b32 s15, 0x00020000
    s_add_u32 s16, s16, 0x2000000
    s_addc_u32 s17, s17, 0
    s_and_b32 s17, s17, 0xffff
    s_mov_b32 s18, 0x1200000
    s_mov_b32 s19, 0x00020000
    s_cmp_ge_u32 s5, 4
    s_cbranch_scc1 ffn1_kernel_loader
    s_lshl_b32 s26, s5, 12
    v_bfe_u32 v28, v2, 1, 3
    v_lshlrev_b32 v29, 7, v2
    v_add_u32 v29, s26, v29
    v_add_u32 v30, 0, v3
    v_xor_b32 v30, v30, v28
    v_lshl_add_u32 v4, v30, 4, v29
    v_add_u32 v30, 2, v3
    v_xor_b32 v30, v30, v28
    v_lshl_add_u32 v5, v30, 4, v29
    v_add_u32 v30, 4, v3
    v_xor_b32 v30, v30, v28
    v_lshl_add_u32 v6, v30, 4, v29
    v_add_u32 v30, 6, v3
    v_xor_b32 v30, v30, v28
    v_lshl_add_u32 v7, v30, 4, v29
    v_bfe_u32 v28, v1, 2, 2
    v_lshl_add_u32 v28, v3, 3, v28
    v_mul_u32_u24 v28, 320, v28
    v_bfe_u32 v29, v1, 4, 1
    v_lshl_add_u32 v28, v29, 5, v28
    v_and_b32 v29, 3, v1
    v_lshl_add_u32 v8, v29, 3, v28
    s_lshl_b32 s26, s5, 5
    v_add_u32 v28, s26, v2
    v_mul_u32_u24 v9, 336, v28
    v_lshl_add_u32 v9, v3, 4, v9
    v_add_u32 v9, 110592, v9
    v_mul_u32_u24 v10, 272, v28
    v_lshl_add_u32 v10, v3, 4, v10
    s_barrier
    ds_read_b128 v[84:87], v5
    ds_read_b128 v[80:83], v4
    ds_read_b64_tr_b16 v[32:33], v8 offset:16384
    ds_read_b64_tr_b16 v[34:35], v8 offset:17664
    ds_read_b64_tr_b16 v[36:37], v8 offset:16448
    ds_read_b64_tr_b16 v[38:39], v8 offset:17728
    ds_read_b64_tr_b16 v[40:41], v8 offset:16512
    ds_read_b64_tr_b16 v[42:43], v8 offset:17792
    ds_read_b64_tr_b16 v[44:45], v8 offset:16576
    ds_read_b64_tr_b16 v[46:47], v8 offset:17856
    ds_read_b64_tr_b16 v[48:49], v8 offset:16640
    ds_read_b64_tr_b16 v[50:51], v8 offset:17920
    ds_read_b64_tr_b16 v[52:53], v8 offset:21504
    ds_read_b64_tr_b16 v[54:55], v8 offset:22784
    ds_read_b64_tr_b16 v[56:57], v8 offset:21568
    ds_read_b64_tr_b16 v[58:59], v8 offset:22848
    ds_read_b64_tr_b16 v[60:61], v8 offset:21632
    ds_read_b64_tr_b16 v[62:63], v8 offset:22912
    s_waitcnt lgkmcnt(14)
    v_mfma_f32_32x32x16_bf16 v[100:115], v[32:35], v[80:83], 0
    ds_read_b64_tr_b16 v[64:65], v8 offset:21696
    ds_read_b64_tr_b16 v[66:67], v8 offset:22976
    s_waitcnt lgkmcnt(14)
    v_mfma_f32_32x32x16_bf16 v[116:131], v[36:39], v[80:83], 0
    ds_read_b128 v[88:91], v6
    ds_read_b64_tr_b16 v[68:69], v8 offset:21760
    ds_read_b64_tr_b16 v[70:71], v8 offset:23040
    s_waitcnt lgkmcnt(15)
    v_mfma_f32_32x32x16_bf16 v[132:147], v[40:43], v[80:83], 0
    ds_read_b64_tr_b16 v[32:33], v8 offset:26624
    ds_read_b64_tr_b16 v[34:35], v8 offset:27904
    s_waitcnt lgkmcnt(15)
    v_mfma_f32_32x32x16_bf16 v[148:163], v[44:47], v[80:83], 0
    ds_read_b64_tr_b16 v[36:37], v8 offset:26688
    ds_read_b64_tr_b16 v[38:39], v8 offset:27968
    s_waitcnt lgkmcnt(15)
    v_mfma_f32_32x32x16_bf16 v[164:179], v[48:51], v[80:83], 0
    ds_read_b64_tr_b16 v[40:41], v8 offset:26752
    ds_read_b64_tr_b16 v[42:43], v8 offset:28032
    s_waitcnt lgkmcnt(15)
    v_mfma_f32_32x32x16_bf16 v[100:115], v[52:55], v[84:87], v[100:115]
    ds_read_b64_tr_b16 v[44:45], v8 offset:26816
    ds_read_b64_tr_b16 v[46:47], v8 offset:28096
    s_waitcnt lgkmcnt(15)
    v_mfma_f32_32x32x16_bf16 v[116:131], v[56:59], v[84:87], v[116:131]
    ds_read_b128 v[92:95], v7
    ds_read_b64_tr_b16 v[48:49], v8 offset:26880
    ds_read_b64_tr_b16 v[50:51], v8 offset:28160
    s_waitcnt lgkmcnt(15)
    v_mfma_f32_32x32x16_bf16 v[132:147], v[60:63], v[84:87], v[132:147]
    ds_read_b64_tr_b16 v[52:53], v8 offset:31744
    ds_read_b64_tr_b16 v[54:55], v8 offset:33024
    s_waitcnt lgkmcnt(15)
    v_mfma_f32_32x32x16_bf16 v[148:163], v[64:67], v[84:87], v[148:163]
    ds_read_b64_tr_b16 v[56:57], v8 offset:31808
    ds_read_b64_tr_b16 v[58:59], v8 offset:33088
    s_waitcnt lgkmcnt(15)
    v_mfma_f32_32x32x16_bf16 v[164:179], v[68:71], v[84:87], v[164:179]
    ds_read_b64_tr_b16 v[60:61], v8 offset:31872
    ds_read_b64_tr_b16 v[62:63], v8 offset:33152
    s_waitcnt lgkmcnt(15)
    v_mfma_f32_32x32x16_bf16 v[100:115], v[32:35], v[88:91], v[100:115]
    ds_read_b64_tr_b16 v[64:65], v8 offset:31936
    ds_read_b64_tr_b16 v[66:67], v8 offset:33216
    s_waitcnt lgkmcnt(15)
    v_mfma_f32_32x32x16_bf16 v[116:131], v[36:39], v[88:91], v[116:131]
    ds_read_b64_tr_b16 v[68:69], v8 offset:32000
    ds_read_b64_tr_b16 v[70:71], v8 offset:33280
    s_waitcnt lgkmcnt(15)
    v_mfma_f32_32x32x16_bf16 v[132:147], v[40:43], v[88:91], v[132:147]
    s_waitcnt lgkmcnt(13)
    v_mfma_f32_32x32x16_bf16 v[148:163], v[44:47], v[88:91], v[148:163]
    s_waitcnt lgkmcnt(10)
    v_mfma_f32_32x32x16_bf16 v[164:179], v[48:51], v[88:91], v[164:179]
    s_waitcnt lgkmcnt(0)
    s_barrier
    v_add_u32 v4, 36864, v4
    v_add_u32 v5, 36864, v5
    v_add_u32 v6, 36864, v6
    v_add_u32 v7, 36864, v7
    v_add_u32 v8, 36864, v8
    ds_read_b128 v[80:83], v4
    ds_read_b64_tr_b16 v[32:33], v8 offset:16384
    ds_read_b64_tr_b16 v[34:35], v8 offset:17664
    ds_read_b64_tr_b16 v[36:37], v8 offset:16448
    ds_read_b64_tr_b16 v[38:39], v8 offset:17728
    ds_read_b64_tr_b16 v[40:41], v8 offset:16512
    ds_read_b64_tr_b16 v[42:43], v8 offset:17792
    s_waitcnt lgkmcnt(15)
    v_mfma_f32_32x32x16_bf16 v[100:115], v[52:55], v[92:95], v[100:115]
    ds_read_b64_tr_b16 v[44:45], v8 offset:16576
    ds_read_b64_tr_b16 v[46:47], v8 offset:17856
    s_waitcnt lgkmcnt(15)
    v_mfma_f32_32x32x16_bf16 v[116:131], v[56:59], v[92:95], v[116:131]
    ds_read_b128 v[84:87], v5
    ds_read_b64_tr_b16 v[48:49], v8 offset:16640
    ds_read_b64_tr_b16 v[50:51], v8 offset:17920
    s_waitcnt lgkmcnt(15)
    v_mfma_f32_32x32x16_bf16 v[132:147], v[60:63], v[92:95], v[132:147]
    ds_read_b64_tr_b16 v[52:53], v8 offset:21504
    ds_read_b64_tr_b16 v[54:55], v8 offset:22784
    s_waitcnt lgkmcnt(15)
    v_mfma_f32_32x32x16_bf16 v[148:163], v[64:67], v[92:95], v[148:163]
    ds_read_b64_tr_b16 v[56:57], v8 offset:21568
    ds_read_b64_tr_b16 v[58:59], v8 offset:22848
    s_waitcnt lgkmcnt(15)
    v_mfma_f32_32x32x16_bf16 v[164:179], v[68:71], v[92:95], v[164:179]
    ds_read_b64_tr_b16 v[60:61], v8 offset:21632
    ds_read_b64_tr_b16 v[62:63], v8 offset:22912
    s_waitcnt lgkmcnt(15)
    v_mfma_f32_32x32x16_bf16 v[100:115], v[32:35], v[80:83], v[100:115]
    ds_read_b64_tr_b16 v[64:65], v8 offset:21696
    ds_read_b64_tr_b16 v[66:67], v8 offset:22976
    s_waitcnt lgkmcnt(15)
    v_mfma_f32_32x32x16_bf16 v[116:131], v[36:39], v[80:83], v[116:131]
    ds_read_b128 v[88:91], v6
    ds_read_b64_tr_b16 v[68:69], v8 offset:21760
    ds_read_b64_tr_b16 v[70:71], v8 offset:23040
    s_waitcnt lgkmcnt(15)
    v_mfma_f32_32x32x16_bf16 v[132:147], v[40:43], v[80:83], v[132:147]
    ds_read_b64_tr_b16 v[32:33], v8 offset:26624
    ds_read_b64_tr_b16 v[34:35], v8 offset:27904
    s_waitcnt lgkmcnt(15)
    v_mfma_f32_32x32x16_bf16 v[148:163], v[44:47], v[80:83], v[148:163]
    ds_read_b64_tr_b16 v[36:37], v8 offset:26688
    ds_read_b64_tr_b16 v[38:39], v8 offset:27968
    s_waitcnt lgkmcnt(15)
    v_mfma_f32_32x32x16_bf16 v[164:179], v[48:51], v[80:83], v[164:179]
    ds_read_b64_tr_b16 v[40:41], v8 offset:26752
    ds_read_b64_tr_b16 v[42:43], v8 offset:28032
    s_waitcnt lgkmcnt(15)
    v_mfma_f32_32x32x16_bf16 v[100:115], v[52:55], v[84:87], v[100:115]
    ds_read_b64_tr_b16 v[44:45], v8 offset:26816
    ds_read_b64_tr_b16 v[46:47], v8 offset:28096
    s_waitcnt lgkmcnt(15)
    v_mfma_f32_32x32x16_bf16 v[116:131], v[56:59], v[84:87], v[116:131]
    ds_read_b128 v[92:95], v7
    ds_read_b64_tr_b16 v[48:49], v8 offset:26880
    ds_read_b64_tr_b16 v[50:51], v8 offset:28160
    s_waitcnt lgkmcnt(15)
    v_mfma_f32_32x32x16_bf16 v[132:147], v[60:63], v[84:87], v[132:147]
    ds_read_b64_tr_b16 v[52:53], v8 offset:31744
    ds_read_b64_tr_b16 v[54:55], v8 offset:33024
    s_waitcnt lgkmcnt(15)
    v_mfma_f32_32x32x16_bf16 v[148:163], v[64:67], v[84:87], v[148:163]
    ds_read_b64_tr_b16 v[56:57], v8 offset:31808
    ds_read_b64_tr_b16 v[58:59], v8 offset:33088
    s_waitcnt lgkmcnt(15)
    v_mfma_f32_32x32x16_bf16 v[164:179], v[68:71], v[84:87], v[164:179]
    ds_read_b64_tr_b16 v[60:61], v8 offset:31872
    ds_read_b64_tr_b16 v[62:63], v8 offset:33152
    s_waitcnt lgkmcnt(15)
    v_mfma_f32_32x32x16_bf16 v[100:115], v[32:35], v[88:91], v[100:115]
    ds_read_b64_tr_b16 v[64:65], v8 offset:31936
    ds_read_b64_tr_b16 v[66:67], v8 offset:33216
    s_waitcnt lgkmcnt(15)
    v_mfma_f32_32x32x16_bf16 v[116:131], v[36:39], v[88:91], v[116:131]
    ds_read_b64_tr_b16 v[68:69], v8 offset:32000
    ds_read_b64_tr_b16 v[70:71], v8 offset:33280
    s_waitcnt lgkmcnt(15)
    v_mfma_f32_32x32x16_bf16 v[132:147], v[40:43], v[88:91], v[132:147]
    s_waitcnt lgkmcnt(13)
    v_mfma_f32_32x32x16_bf16 v[148:163], v[44:47], v[88:91], v[148:163]
    s_waitcnt lgkmcnt(10)
    v_mfma_f32_32x32x16_bf16 v[164:179], v[48:51], v[88:91], v[164:179]
    s_waitcnt lgkmcnt(0)
    s_barrier
    v_add_u32 v4, 36864, v4
    v_add_u32 v5, 36864, v5
    v_add_u32 v6, 36864, v6
    v_add_u32 v7, 36864, v7
    v_add_u32 v8, 36864, v8
    ds_read_b128 v[80:83], v4
    ds_read_b64_tr_b16 v[32:33], v8 offset:16384
    ds_read_b64_tr_b16 v[34:35], v8 offset:17664
    ds_read_b64_tr_b16 v[36:37], v8 offset:16448
    ds_read_b64_tr_b16 v[38:39], v8 offset:17728
    ds_read_b64_tr_b16 v[40:41], v8 offset:16512
    ds_read_b64_tr_b16 v[42:43], v8 offset:17792
    s_waitcnt lgkmcnt(15)
    v_mfma_f32_32x32x16_bf16 v[100:115], v[52:55], v[92:95], v[100:115]
    ds_read_b64_tr_b16 v[44:45], v8 offset:16576
    ds_read_b64_tr_b16 v[46:47], v8 offset:17856
    s_waitcnt lgkmcnt(15)
    v_mfma_f32_32x32x16_bf16 v[116:131], v[56:59], v[92:95], v[116:131]
    ds_read_b128 v[84:87], v5
    ds_read_b64_tr_b16 v[48:49], v8 offset:16640
    ds_read_b64_tr_b16 v[50:51], v8 offset:17920
    s_waitcnt lgkmcnt(15)
    v_mfma_f32_32x32x16_bf16 v[132:147], v[60:63], v[92:95], v[132:147]
    ds_read_b64_tr_b16 v[52:53], v8 offset:21504
    ds_read_b64_tr_b16 v[54:55], v8 offset:22784
    s_waitcnt lgkmcnt(15)
    v_mfma_f32_32x32x16_bf16 v[148:163], v[64:67], v[92:95], v[148:163]
    ds_read_b64_tr_b16 v[56:57], v8 offset:21568
    ds_read_b64_tr_b16 v[58:59], v8 offset:22848
    s_waitcnt lgkmcnt(15)
    v_mfma_f32_32x32x16_bf16 v[164:179], v[68:71], v[92:95], v[164:179]
    ds_read_b64_tr_b16 v[60:61], v8 offset:21632
    ds_read_b64_tr_b16 v[62:63], v8 offset:22912
    s_waitcnt lgkmcnt(15)
    v_mfma_f32_32x32x16_bf16 v[100:115], v[32:35], v[80:83], v[100:115]
    ds_read_b64_tr_b16 v[64:65], v8 offset:21696
    ds_read_b64_tr_b16 v[66:67], v8 offset:22976
    s_waitcnt lgkmcnt(15)
    v_mfma_f32_32x32x16_bf16 v[116:131], v[36:39], v[80:83], v[116:131]
    ds_read_b128 v[88:91], v6
    ds_read_b64_tr_b16 v[68:69], v8 offset:21760
    ds_read_b64_tr_b16 v[70:71], v8 offset:23040
    s_waitcnt lgkmcnt(15)
    v_mfma_f32_32x32x16_bf16 v[132:147], v[40:43], v[80:83], v[132:147]
    ds_read_b64_tr_b16 v[32:33], v8 offset:26624
    ds_read_b64_tr_b16 v[34:35], v8 offset:27904
    s_waitcnt lgkmcnt(15)
    v_mfma_f32_32x32x16_bf16 v[148:163], v[44:47], v[80:83], v[148:163]
    ds_read_b64_tr_b16 v[36:37], v8 offset:26688
    ds_read_b64_tr_b16 v[38:39], v8 offset:27968
    s_waitcnt lgkmcnt(15)
    v_mfma_f32_32x32x16_bf16 v[164:179], v[48:51], v[80:83], v[164:179]
    ds_read_b64_tr_b16 v[40:41], v8 offset:26752
    ds_read_b64_tr_b16 v[42:43], v8 offset:28032
    s_waitcnt lgkmcnt(15)
    v_mfma_f32_32x32x16_bf16 v[100:115], v[52:55], v[84:87], v[100:115]
    ds_read_b64_tr_b16 v[44:45], v8 offset:26816
    ds_read_b64_tr_b16 v[46:47], v8 offset:28096
    s_waitcnt lgkmcnt(15)
    v_mfma_f32_32x32x16_bf16 v[116:131], v[56:59], v[84:87], v[116:131]
    ds_read_b128 v[92:95], v7
    ds_read_b64_tr_b16 v[48:49], v8 offset:26880
    ds_read_b64_tr_b16 v[50:51], v8 offset:28160
    s_waitcnt lgkmcnt(15)
    v_mfma_f32_32x32x16_bf16 v[132:147], v[60:63], v[84:87], v[132:147]
    ds_read_b64_tr_b16 v[52:53], v8 offset:31744
    ds_read_b64_tr_b16 v[54:55], v8 offset:33024
    s_waitcnt lgkmcnt(15)
    v_mfma_f32_32x32x16_bf16 v[148:163], v[64:67], v[84:87], v[148:163]
    ds_read_b64_tr_b16 v[56:57], v8 offset:31808
    ds_read_b64_tr_b16 v[58:59], v8 offset:33088
    s_waitcnt lgkmcnt(15)
    v_mfma_f32_32x32x16_bf16 v[164:179], v[68:71], v[84:87], v[164:179]
    ds_read_b64_tr_b16 v[60:61], v8 offset:31872
    ds_read_b64_tr_b16 v[62:63], v8 offset:33152
    s_waitcnt lgkmcnt(15)
    v_mfma_f32_32x32x16_bf16 v[100:115], v[32:35], v[88:91], v[100:115]
    ds_read_b64_tr_b16 v[64:65], v8 offset:31936
    ds_read_b64_tr_b16 v[66:67], v8 offset:33216
    s_waitcnt lgkmcnt(15)
    v_mfma_f32_32x32x16_bf16 v[116:131], v[36:39], v[88:91], v[116:131]
    ds_read_b64_tr_b16 v[68:69], v8 offset:32000
    ds_read_b64_tr_b16 v[70:71], v8 offset:33280
    s_waitcnt lgkmcnt(15)
    v_mfma_f32_32x32x16_bf16 v[132:147], v[40:43], v[88:91], v[132:147]
    s_waitcnt lgkmcnt(13)
    v_mfma_f32_32x32x16_bf16 v[148:163], v[44:47], v[88:91], v[148:163]
    s_waitcnt lgkmcnt(10)
    v_mfma_f32_32x32x16_bf16 v[164:179], v[48:51], v[88:91], v[164:179]
    s_waitcnt lgkmcnt(0)
    s_barrier
    v_subrev_u32 v4, 73728, v4
    v_subrev_u32 v5, 73728, v5
    v_subrev_u32 v6, 73728, v6
    v_subrev_u32 v7, 73728, v7
    v_subrev_u32 v8, 73728, v8
    ds_read_b128 v[80:83], v4
    ds_read_b64_tr_b16 v[32:33], v8 offset:16384
    ds_read_b64_tr_b16 v[34:35], v8 offset:17664
    ds_read_b64_tr_b16 v[36:37], v8 offset:16448
    ds_read_b64_tr_b16 v[38:39], v8 offset:17728
    ds_read_b64_tr_b16 v[40:41], v8 offset:16512
    ds_read_b64_tr_b16 v[42:43], v8 offset:17792
    s_waitcnt lgkmcnt(15)
    v_mfma_f32_32x32x16_bf16 v[100:115], v[52:55], v[92:95], v[100:115]
    ds_read_b64_tr_b16 v[44:45], v8 offset:16576
    ds_read_b64_tr_b16 v[46:47], v8 offset:17856
    s_waitcnt lgkmcnt(15)
    v_mfma_f32_32x32x16_bf16 v[116:131], v[56:59], v[92:95], v[116:131]
    ds_read_b128 v[84:87], v5
    ds_read_b64_tr_b16 v[48:49], v8 offset:16640
    ds_read_b64_tr_b16 v[50:51], v8 offset:17920
    s_waitcnt lgkmcnt(15)
    v_mfma_f32_32x32x16_bf16 v[132:147], v[60:63], v[92:95], v[132:147]
    ds_read_b64_tr_b16 v[52:53], v8 offset:21504
    ds_read_b64_tr_b16 v[54:55], v8 offset:22784
    s_waitcnt lgkmcnt(15)
    v_mfma_f32_32x32x16_bf16 v[148:163], v[64:67], v[92:95], v[148:163]
    ds_read_b64_tr_b16 v[56:57], v8 offset:21568
    ds_read_b64_tr_b16 v[58:59], v8 offset:22848
    s_waitcnt lgkmcnt(15)
    v_mfma_f32_32x32x16_bf16 v[164:179], v[68:71], v[92:95], v[164:179]
    ds_read_b64_tr_b16 v[60:61], v8 offset:21632
    ds_read_b64_tr_b16 v[62:63], v8 offset:22912
    s_waitcnt lgkmcnt(15)
    v_mfma_f32_32x32x16_bf16 v[100:115], v[32:35], v[80:83], v[100:115]
    ds_read_b64_tr_b16 v[64:65], v8 offset:21696
    ds_read_b64_tr_b16 v[66:67], v8 offset:22976
    s_waitcnt lgkmcnt(15)
    v_mfma_f32_32x32x16_bf16 v[116:131], v[36:39], v[80:83], v[116:131]
    ds_read_b128 v[88:91], v6
    ds_read_b64_tr_b16 v[68:69], v8 offset:21760
    ds_read_b64_tr_b16 v[70:71], v8 offset:23040
    s_waitcnt lgkmcnt(15)
    v_mfma_f32_32x32x16_bf16 v[132:147], v[40:43], v[80:83], v[132:147]
    ds_read_b64_tr_b16 v[32:33], v8 offset:26624
    ds_read_b64_tr_b16 v[34:35], v8 offset:27904
    s_waitcnt lgkmcnt(15)
    v_mfma_f32_32x32x16_bf16 v[148:163], v[44:47], v[80:83], v[148:163]
    ds_read_b64_tr_b16 v[36:37], v8 offset:26688
    ds_read_b64_tr_b16 v[38:39], v8 offset:27968
    s_waitcnt lgkmcnt(15)
    v_mfma_f32_32x32x16_bf16 v[164:179], v[48:51], v[80:83], v[164:179]
    ds_read_b64_tr_b16 v[40:41], v8 offset:26752
    ds_read_b64_tr_b16 v[42:43], v8 offset:28032
    s_waitcnt lgkmcnt(15)
    v_mfma_f32_32x32x16_bf16 v[100:115], v[52:55], v[84:87], v[100:115]
    ds_read_b64_tr_b16 v[44:45], v8 offset:26816
    ds_read_b64_tr_b16 v[46:47], v8 offset:28096
    s_waitcnt lgkmcnt(15)
    v_mfma_f32_32x32x16_bf16 v[116:131], v[56:59], v[84:87], v[116:131]
    ds_read_b128 v[92:95], v7
    ds_read_b64_tr_b16 v[48:49], v8 offset:26880
    ds_read_b64_tr_b16 v[50:51], v8 offset:28160
    s_waitcnt lgkmcnt(15)
    v_mfma_f32_32x32x16_bf16 v[132:147], v[60:63], v[84:87], v[132:147]
    ds_read_b64_tr_b16 v[52:53], v8 offset:31744
    ds_read_b64_tr_b16 v[54:55], v8 offset:33024
    s_waitcnt lgkmcnt(15)
    v_mfma_f32_32x32x16_bf16 v[148:163], v[64:67], v[84:87], v[148:163]
    ds_read_b64_tr_b16 v[56:57], v8 offset:31808
    ds_read_b64_tr_b16 v[58:59], v8 offset:33088
    s_waitcnt lgkmcnt(15)
    v_mfma_f32_32x32x16_bf16 v[164:179], v[68:71], v[84:87], v[164:179]
    ds_read_b64_tr_b16 v[60:61], v8 offset:31872
    ds_read_b64_tr_b16 v[62:63], v8 offset:33152
    s_waitcnt lgkmcnt(15)
    v_mfma_f32_32x32x16_bf16 v[100:115], v[32:35], v[88:91], v[100:115]
    ds_read_b64_tr_b16 v[64:65], v8 offset:31936
    ds_read_b64_tr_b16 v[66:67], v8 offset:33216
    s_waitcnt lgkmcnt(15)
    v_mfma_f32_32x32x16_bf16 v[116:131], v[36:39], v[88:91], v[116:131]
    ds_read_b64_tr_b16 v[68:69], v8 offset:32000
    ds_read_b64_tr_b16 v[70:71], v8 offset:33280
    s_waitcnt lgkmcnt(15)
    v_mfma_f32_32x32x16_bf16 v[132:147], v[40:43], v[88:91], v[132:147]
    s_waitcnt lgkmcnt(13)
    v_mfma_f32_32x32x16_bf16 v[148:163], v[44:47], v[88:91], v[148:163]
    s_waitcnt lgkmcnt(10)
    v_mfma_f32_32x32x16_bf16 v[164:179], v[48:51], v[88:91], v[164:179]
    s_waitcnt lgkmcnt(0)
    s_barrier
    v_add_u32 v4, 36864, v4
    v_add_u32 v5, 36864, v5
    v_add_u32 v6, 36864, v6
    v_add_u32 v7, 36864, v7
    v_add_u32 v8, 36864, v8
    ds_read_b128 v[80:83], v4
    ds_read_b64_tr_b16 v[32:33], v8 offset:16384
    ds_read_b64_tr_b16 v[34:35], v8 offset:17664
    ds_read_b64_tr_b16 v[36:37], v8 offset:16448
    ds_read_b64_tr_b16 v[38:39], v8 offset:17728
    ds_read_b64_tr_b16 v[40:41], v8 offset:16512
    ds_read_b64_tr_b16 v[42:43], v8 offset:17792
    s_waitcnt lgkmcnt(15)
    v_mfma_f32_32x32x16_bf16 v[100:115], v[52:55], v[92:95], v[100:115]
    ds_read_b64_tr_b16 v[44:45], v8 offset:16576
    ds_read_b64_tr_b16 v[46:47], v8 offset:17856
    s_waitcnt lgkmcnt(15)
    v_mfma_f32_32x32x16_bf16 v[116:131], v[56:59], v[92:95], v[116:131]
    ds_read_b128 v[84:87], v5
    ds_read_b64_tr_b16 v[48:49], v8 offset:16640
    ds_read_b64_tr_b16 v[50:51], v8 offset:17920
    s_waitcnt lgkmcnt(15)
    v_mfma_f32_32x32x16_bf16 v[132:147], v[60:63], v[92:95], v[132:147]
    ds_read_b64_tr_b16 v[52:53], v8 offset:21504
    ds_read_b64_tr_b16 v[54:55], v8 offset:22784
    s_waitcnt lgkmcnt(15)
    v_mfma_f32_32x32x16_bf16 v[148:163], v[64:67], v[92:95], v[148:163]
    ds_read_b64_tr_b16 v[56:57], v8 offset:21568
    ds_read_b64_tr_b16 v[58:59], v8 offset:22848
    s_waitcnt lgkmcnt(15)
    v_mfma_f32_32x32x16_bf16 v[164:179], v[68:71], v[92:95], v[164:179]
    ds_read_b64_tr_b16 v[60:61], v8 offset:21632
    ds_read_b64_tr_b16 v[62:63], v8 offset:22912
    s_waitcnt lgkmcnt(15)
    v_mfma_f32_32x32x16_bf16 v[100:115], v[32:35], v[80:83], v[100:115]
    ds_read_b64_tr_b16 v[64:65], v8 offset:21696
    ds_read_b64_tr_b16 v[66:67], v8 offset:22976
    s_waitcnt lgkmcnt(15)
    v_mfma_f32_32x32x16_bf16 v[116:131], v[36:39], v[80:83], v[116:131]
    ds_read_b128 v[88:91], v6
    ds_read_b64_tr_b16 v[68:69], v8 offset:21760
    ds_read_b64_tr_b16 v[70:71], v8 offset:23040
    s_waitcnt lgkmcnt(15)
    v_mfma_f32_32x32x16_bf16 v[132:147], v[40:43], v[80:83], v[132:147]
    ds_read_b64_tr_b16 v[32:33], v8 offset:26624
    ds_read_b64_tr_b16 v[34:35], v8 offset:27904
    s_waitcnt lgkmcnt(15)
    v_mfma_f32_32x32x16_bf16 v[148:163], v[44:47], v[80:83], v[148:163]
    ds_read_b64_tr_b16 v[36:37], v8 offset:26688
    ds_read_b64_tr_b16 v[38:39], v8 offset:27968
    s_waitcnt lgkmcnt(15)
    v_mfma_f32_32x32x16_bf16 v[164:179], v[48:51], v[80:83], v[164:179]
    ds_read_b64_tr_b16 v[40:41], v8 offset:26752
    ds_read_b64_tr_b16 v[42:43], v8 offset:28032
    s_waitcnt lgkmcnt(15)
    v_mfma_f32_32x32x16_bf16 v[100:115], v[52:55], v[84:87], v[100:115]
    ds_read_b64_tr_b16 v[44:45], v8 offset:26816
    ds_read_b64_tr_b16 v[46:47], v8 offset:28096
    s_waitcnt lgkmcnt(15)
    v_mfma_f32_32x32x16_bf16 v[116:131], v[56:59], v[84:87], v[116:131]
    ds_read_b128 v[92:95], v7
    ds_read_b64_tr_b16 v[48:49], v8 offset:26880
    ds_read_b64_tr_b16 v[50:51], v8 offset:28160
    s_waitcnt lgkmcnt(15)
    v_mfma_f32_32x32x16_bf16 v[132:147], v[60:63], v[84:87], v[132:147]
    ds_read_b64_tr_b16 v[52:53], v8 offset:31744
    ds_read_b64_tr_b16 v[54:55], v8 offset:33024
    s_waitcnt lgkmcnt(15)
    v_mfma_f32_32x32x16_bf16 v[148:163], v[64:67], v[84:87], v[148:163]
    ds_read_b64_tr_b16 v[56:57], v8 offset:31808
    ds_read_b64_tr_b16 v[58:59], v8 offset:33088
    s_waitcnt lgkmcnt(15)
    v_mfma_f32_32x32x16_bf16 v[164:179], v[68:71], v[84:87], v[164:179]
    ds_read_b64_tr_b16 v[60:61], v8 offset:31872
    ds_read_b64_tr_b16 v[62:63], v8 offset:33152
    s_waitcnt lgkmcnt(15)
    v_mfma_f32_32x32x16_bf16 v[100:115], v[32:35], v[88:91], v[100:115]
    ds_read_b64_tr_b16 v[64:65], v8 offset:31936
    ds_read_b64_tr_b16 v[66:67], v8 offset:33216
    s_waitcnt lgkmcnt(15)
    v_mfma_f32_32x32x16_bf16 v[116:131], v[36:39], v[88:91], v[116:131]
    ds_read_b64_tr_b16 v[68:69], v8 offset:32000
    ds_read_b64_tr_b16 v[70:71], v8 offset:33280
    s_waitcnt lgkmcnt(15)
    v_mfma_f32_32x32x16_bf16 v[132:147], v[40:43], v[88:91], v[132:147]
    s_waitcnt lgkmcnt(13)
    v_mfma_f32_32x32x16_bf16 v[148:163], v[44:47], v[88:91], v[148:163]
    s_waitcnt lgkmcnt(10)
    v_mfma_f32_32x32x16_bf16 v[164:179], v[48:51], v[88:91], v[164:179]
    s_waitcnt lgkmcnt(0)
    s_barrier
    v_add_u32 v4, 36864, v4
    v_add_u32 v5, 36864, v5
    v_add_u32 v6, 36864, v6
    v_add_u32 v7, 36864, v7
    v_add_u32 v8, 36864, v8
    ds_read_b128 v[80:83], v4
    ds_read_b64_tr_b16 v[32:33], v8 offset:16384
    ds_read_b64_tr_b16 v[34:35], v8 offset:17664
    ds_read_b64_tr_b16 v[36:37], v8 offset:16448
    ds_read_b64_tr_b16 v[38:39], v8 offset:17728
    ds_read_b64_tr_b16 v[40:41], v8 offset:16512
    ds_read_b64_tr_b16 v[42:43], v8 offset:17792
    s_waitcnt lgkmcnt(15)
    v_mfma_f32_32x32x16_bf16 v[100:115], v[52:55], v[92:95], v[100:115]
    ds_read_b64_tr_b16 v[44:45], v8 offset:16576
    ds_read_b64_tr_b16 v[46:47], v8 offset:17856
    s_waitcnt lgkmcnt(15)
    v_mfma_f32_32x32x16_bf16 v[116:131], v[56:59], v[92:95], v[116:131]
    ds_read_b128 v[84:87], v5
    ds_read_b64_tr_b16 v[48:49], v8 offset:16640
    ds_read_b64_tr_b16 v[50:51], v8 offset:17920
    s_waitcnt lgkmcnt(15)
    v_mfma_f32_32x32x16_bf16 v[132:147], v[60:63], v[92:95], v[132:147]
    ds_read_b64_tr_b16 v[52:53], v8 offset:21504
    ds_read_b64_tr_b16 v[54:55], v8 offset:22784
    s_waitcnt lgkmcnt(15)
    v_mfma_f32_32x32x16_bf16 v[148:163], v[64:67], v[92:95], v[148:163]
    ds_read_b64_tr_b16 v[56:57], v8 offset:21568
    ds_read_b64_tr_b16 v[58:59], v8 offset:22848
    s_waitcnt lgkmcnt(15)
    v_mfma_f32_32x32x16_bf16 v[164:179], v[68:71], v[92:95], v[164:179]
    ds_read_b64_tr_b16 v[60:61], v8 offset:21632
    ds_read_b64_tr_b16 v[62:63], v8 offset:22912
    s_waitcnt lgkmcnt(15)
    v_mfma_f32_32x32x16_bf16 v[100:115], v[32:35], v[80:83], v[100:115]
    ds_read_b64_tr_b16 v[64:65], v8 offset:21696
    ds_read_b64_tr_b16 v[66:67], v8 offset:22976
    s_waitcnt lgkmcnt(15)
    v_mfma_f32_32x32x16_bf16 v[116:131], v[36:39], v[80:83], v[116:131]
    ds_read_b128 v[88:91], v6
    ds_read_b64_tr_b16 v[68:69], v8 offset:21760
    ds_read_b64_tr_b16 v[70:71], v8 offset:23040
    s_waitcnt lgkmcnt(15)
    v_mfma_f32_32x32x16_bf16 v[132:147], v[40:43], v[80:83], v[132:147]
    ds_read_b64_tr_b16 v[32:33], v8 offset:26624
    ds_read_b64_tr_b16 v[34:35], v8 offset:27904
    s_waitcnt lgkmcnt(15)
    v_mfma_f32_32x32x16_bf16 v[148:163], v[44:47], v[80:83], v[148:163]
    ds_read_b64_tr_b16 v[36:37], v8 offset:26688
    ds_read_b64_tr_b16 v[38:39], v8 offset:27968
    s_waitcnt lgkmcnt(15)
    v_mfma_f32_32x32x16_bf16 v[164:179], v[48:51], v[80:83], v[164:179]
    ds_read_b64_tr_b16 v[40:41], v8 offset:26752
    ds_read_b64_tr_b16 v[42:43], v8 offset:28032
    s_waitcnt lgkmcnt(15)
    v_mfma_f32_32x32x16_bf16 v[100:115], v[52:55], v[84:87], v[100:115]
    ds_read_b64_tr_b16 v[44:45], v8 offset:26816
    ds_read_b64_tr_b16 v[46:47], v8 offset:28096
    s_waitcnt lgkmcnt(15)
    v_mfma_f32_32x32x16_bf16 v[116:131], v[56:59], v[84:87], v[116:131]
    ds_read_b128 v[92:95], v7
    ds_read_b64_tr_b16 v[48:49], v8 offset:26880
    ds_read_b64_tr_b16 v[50:51], v8 offset:28160
    s_waitcnt lgkmcnt(15)
    v_mfma_f32_32x32x16_bf16 v[132:147], v[60:63], v[84:87], v[132:147]
    ds_read_b64_tr_b16 v[52:53], v8 offset:31744
    ds_read_b64_tr_b16 v[54:55], v8 offset:33024
    s_waitcnt lgkmcnt(15)
    v_mfma_f32_32x32x16_bf16 v[148:163], v[64:67], v[84:87], v[148:163]
    ds_read_b64_tr_b16 v[56:57], v8 offset:31808
    ds_read_b64_tr_b16 v[58:59], v8 offset:33088
    s_waitcnt lgkmcnt(15)
    v_mfma_f32_32x32x16_bf16 v[164:179], v[68:71], v[84:87], v[164:179]
    ds_read_b64_tr_b16 v[60:61], v8 offset:31872
    ds_read_b64_tr_b16 v[62:63], v8 offset:33152
    s_waitcnt lgkmcnt(15)
    v_mfma_f32_32x32x16_bf16 v[100:115], v[32:35], v[88:91], v[100:115]
    ds_read_b64_tr_b16 v[64:65], v8 offset:31936
    ds_read_b64_tr_b16 v[66:67], v8 offset:33216
    s_waitcnt lgkmcnt(15)
    v_mfma_f32_32x32x16_bf16 v[116:131], v[36:39], v[88:91], v[116:131]
    ds_read_b64_tr_b16 v[68:69], v8 offset:32000
    ds_read_b64_tr_b16 v[70:71], v8 offset:33280
    s_waitcnt lgkmcnt(15)
    v_mfma_f32_32x32x16_bf16 v[132:147], v[40:43], v[88:91], v[132:147]
    s_waitcnt lgkmcnt(13)
    v_mfma_f32_32x32x16_bf16 v[148:163], v[44:47], v[88:91], v[148:163]
    s_waitcnt lgkmcnt(10)
    v_mfma_f32_32x32x16_bf16 v[164:179], v[48:51], v[88:91], v[164:179]
    s_waitcnt lgkmcnt(0)
    s_barrier
    v_subrev_u32 v4, 73728, v4
    v_subrev_u32 v5, 73728, v5
    v_subrev_u32 v6, 73728, v6
    v_subrev_u32 v7, 73728, v7
    v_subrev_u32 v8, 73728, v8
    ds_read_b128 v[80:83], v4
    ds_read_b64_tr_b16 v[32:33], v8 offset:16384
    ds_read_b64_tr_b16 v[34:35], v8 offset:17664
    ds_read_b64_tr_b16 v[36:37], v8 offset:16448
    ds_read_b64_tr_b16 v[38:39], v8 offset:17728
    ds_read_b64_tr_b16 v[40:41], v8 offset:16512
    ds_read_b64_tr_b16 v[42:43], v8 offset:17792
    s_waitcnt lgkmcnt(15)
    v_mfma_f32_32x32x16_bf16 v[100:115], v[52:55], v[92:95], v[100:115]
    ds_read_b64_tr_b16 v[44:45], v8 offset:16576
    ds_read_b64_tr_b16 v[46:47], v8 offset:17856
    s_waitcnt lgkmcnt(15)
    v_mfma_f32_32x32x16_bf16 v[116:131], v[56:59], v[92:95], v[116:131]
    ds_read_b128 v[84:87], v5
    ds_read_b64_tr_b16 v[48:49], v8 offset:16640
    ds_read_b64_tr_b16 v[50:51], v8 offset:17920
    s_waitcnt lgkmcnt(15)
    v_mfma_f32_32x32x16_bf16 v[132:147], v[60:63], v[92:95], v[132:147]
    ds_read_b64_tr_b16 v[52:53], v8 offset:21504
    ds_read_b64_tr_b16 v[54:55], v8 offset:22784
    s_waitcnt lgkmcnt(15)
    v_mfma_f32_32x32x16_bf16 v[148:163], v[64:67], v[92:95], v[148:163]
    ds_read_b64_tr_b16 v[56:57], v8 offset:21568
    ds_read_b64_tr_b16 v[58:59], v8 offset:22848
    s_waitcnt lgkmcnt(15)
    v_mfma_f32_32x32x16_bf16 v[164:179], v[68:71], v[92:95], v[164:179]
    ds_read_b64_tr_b16 v[60:61], v8 offset:21632
    ds_read_b64_tr_b16 v[62:63], v8 offset:22912
    s_waitcnt lgkmcnt(15)
    v_mfma_f32_32x32x16_bf16 v[100:115], v[32:35], v[80:83], v[100:115]
    ds_read_b64_tr_b16 v[64:65], v8 offset:21696
    ds_read_b64_tr_b16 v[66:67], v8 offset:22976
    s_waitcnt lgkmcnt(15)
    v_mfma_f32_32x32x16_bf16 v[116:131], v[36:39], v[80:83], v[116:131]
    ds_read_b128 v[88:91], v6
    ds_read_b64_tr_b16 v[68:69], v8 offset:21760
    ds_read_b64_tr_b16 v[70:71], v8 offset:23040
    s_waitcnt lgkmcnt(15)
    v_mfma_f32_32x32x16_bf16 v[132:147], v[40:43], v[80:83], v[132:147]
    ds_read_b64_tr_b16 v[32:33], v8 offset:26624
    ds_read_b64_tr_b16 v[34:35], v8 offset:27904
    s_waitcnt lgkmcnt(15)
    v_mfma_f32_32x32x16_bf16 v[148:163], v[44:47], v[80:83], v[148:163]
    ds_read_b64_tr_b16 v[36:37], v8 offset:26688
    ds_read_b64_tr_b16 v[38:39], v8 offset:27968
    s_waitcnt lgkmcnt(15)
    v_mfma_f32_32x32x16_bf16 v[164:179], v[48:51], v[80:83], v[164:179]
    ds_read_b64_tr_b16 v[40:41], v8 offset:26752
    ds_read_b64_tr_b16 v[42:43], v8 offset:28032
    s_waitcnt lgkmcnt(15)
    v_mfma_f32_32x32x16_bf16 v[100:115], v[52:55], v[84:87], v[100:115]
    ds_read_b64_tr_b16 v[44:45], v8 offset:26816
    ds_read_b64_tr_b16 v[46:47], v8 offset:28096
    s_waitcnt lgkmcnt(15)
    v_mfma_f32_32x32x16_bf16 v[116:131], v[56:59], v[84:87], v[116:131]
    ds_read_b128 v[92:95], v7
    ds_read_b64_tr_b16 v[48:49], v8 offset:26880
    ds_read_b64_tr_b16 v[50:51], v8 offset:28160
    s_waitcnt lgkmcnt(15)
    v_mfma_f32_32x32x16_bf16 v[132:147], v[60:63], v[84:87], v[132:147]
    ds_read_b64_tr_b16 v[52:53], v8 offset:31744
    ds_read_b64_tr_b16 v[54:55], v8 offset:33024
    s_waitcnt lgkmcnt(15)
    v_mfma_f32_32x32x16_bf16 v[148:163], v[64:67], v[84:87], v[148:163]
    ds_read_b64_tr_b16 v[56:57], v8 offset:31808
    ds_read_b64_tr_b16 v[58:59], v8 offset:33088
    s_waitcnt lgkmcnt(15)
    v_mfma_f32_32x32x16_bf16 v[164:179], v[68:71], v[84:87], v[164:179]
    ds_read_b64_tr_b16 v[60:61], v8 offset:31872
    ds_read_b64_tr_b16 v[62:63], v8 offset:33152
    s_waitcnt lgkmcnt(15)
    v_mfma_f32_32x32x16_bf16 v[100:115], v[32:35], v[88:91], v[100:115]
    ds_read_b64_tr_b16 v[64:65], v8 offset:31936
    ds_read_b64_tr_b16 v[66:67], v8 offset:33216
    s_waitcnt lgkmcnt(15)
    v_mfma_f32_32x32x16_bf16 v[116:131], v[36:39], v[88:91], v[116:131]
    ds_read_b64_tr_b16 v[68:69], v8 offset:32000
    ds_read_b64_tr_b16 v[70:71], v8 offset:33280
    s_waitcnt lgkmcnt(15)
    v_mfma_f32_32x32x16_bf16 v[132:147], v[40:43], v[88:91], v[132:147]
    s_waitcnt lgkmcnt(13)
    v_mfma_f32_32x32x16_bf16 v[148:163], v[44:47], v[88:91], v[148:163]
    s_waitcnt lgkmcnt(10)
    v_mfma_f32_32x32x16_bf16 v[164:179], v[48:51], v[88:91], v[164:179]
    s_waitcnt lgkmcnt(0)
    s_barrier
    v_add_u32 v4, 36864, v4
    v_add_u32 v5, 36864, v5
    v_add_u32 v6, 36864, v6
    v_add_u32 v7, 36864, v7
    v_add_u32 v8, 36864, v8
    ds_read_b128 v[80:83], v4
    ds_read_b64_tr_b16 v[32:33], v8 offset:16384
    ds_read_b64_tr_b16 v[34:35], v8 offset:17664
    ds_read_b64_tr_b16 v[36:37], v8 offset:16448
    ds_read_b64_tr_b16 v[38:39], v8 offset:17728
    ds_read_b64_tr_b16 v[40:41], v8 offset:16512
    ds_read_b64_tr_b16 v[42:43], v8 offset:17792
    s_waitcnt lgkmcnt(15)
    v_mfma_f32_32x32x16_bf16 v[100:115], v[52:55], v[92:95], v[100:115]
    ds_read_b64_tr_b16 v[44:45], v8 offset:16576
    ds_read_b64_tr_b16 v[46:47], v8 offset:17856
    s_waitcnt lgkmcnt(15)
    v_mfma_f32_32x32x16_bf16 v[116:131], v[56:59], v[92:95], v[116:131]
    ds_read_b128 v[84:87], v5
    ds_read_b64_tr_b16 v[48:49], v8 offset:16640
    ds_read_b64_tr_b16 v[50:51], v8 offset:17920
    s_waitcnt lgkmcnt(15)
    v_mfma_f32_32x32x16_bf16 v[132:147], v[60:63], v[92:95], v[132:147]
    ds_read_b64_tr_b16 v[52:53], v8 offset:21504
    ds_read_b64_tr_b16 v[54:55], v8 offset:22784
    s_waitcnt lgkmcnt(15)
    v_mfma_f32_32x32x16_bf16 v[148:163], v[64:67], v[92:95], v[148:163]
    ds_read_b64_tr_b16 v[56:57], v8 offset:21568
    ds_read_b64_tr_b16 v[58:59], v8 offset:22848
    s_waitcnt lgkmcnt(15)
    v_mfma_f32_32x32x16_bf16 v[164:179], v[68:71], v[92:95], v[164:179]
    ds_read_b64_tr_b16 v[60:61], v8 offset:21632
    ds_read_b64_tr_b16 v[62:63], v8 offset:22912
    s_waitcnt lgkmcnt(15)
    v_mfma_f32_32x32x16_bf16 v[100:115], v[32:35], v[80:83], v[100:115]
    ds_read_b64_tr_b16 v[64:65], v8 offset:21696
    ds_read_b64_tr_b16 v[66:67], v8 offset:22976
    s_waitcnt lgkmcnt(15)
    v_mfma_f32_32x32x16_bf16 v[116:131], v[36:39], v[80:83], v[116:131]
    ds_read_b128 v[88:91], v6
    ds_read_b64_tr_b16 v[68:69], v8 offset:21760
    ds_read_b64_tr_b16 v[70:71], v8 offset:23040
    s_waitcnt lgkmcnt(15)
    v_mfma_f32_32x32x16_bf16 v[132:147], v[40:43], v[80:83], v[132:147]
    ds_read_b64_tr_b16 v[32:33], v8 offset:26624
    ds_read_b64_tr_b16 v[34:35], v8 offset:27904
    s_waitcnt lgkmcnt(15)
    v_mfma_f32_32x32x16_bf16 v[148:163], v[44:47], v[80:83], v[148:163]
    ds_read_b64_tr_b16 v[36:37], v8 offset:26688
    ds_read_b64_tr_b16 v[38:39], v8 offset:27968
    s_waitcnt lgkmcnt(15)
    v_mfma_f32_32x32x16_bf16 v[164:179], v[48:51], v[80:83], v[164:179]
    ds_read_b64_tr_b16 v[40:41], v8 offset:26752
    ds_read_b64_tr_b16 v[42:43], v8 offset:28032
    s_waitcnt lgkmcnt(15)
    v_mfma_f32_32x32x16_bf16 v[100:115], v[52:55], v[84:87], v[100:115]
    ds_read_b64_tr_b16 v[44:45], v8 offset:26816
    ds_read_b64_tr_b16 v[46:47], v8 offset:28096
    s_waitcnt lgkmcnt(15)
    v_mfma_f32_32x32x16_bf16 v[116:131], v[56:59], v[84:87], v[116:131]
    ds_read_b128 v[92:95], v7
    ds_read_b64_tr_b16 v[48:49], v8 offset:26880
    ds_read_b64_tr_b16 v[50:51], v8 offset:28160
    s_waitcnt lgkmcnt(15)
    v_mfma_f32_32x32x16_bf16 v[132:147], v[60:63], v[84:87], v[132:147]
    ds_read_b64_tr_b16 v[52:53], v8 offset:31744
    ds_read_b64_tr_b16 v[54:55], v8 offset:33024
    s_waitcnt lgkmcnt(15)
    v_mfma_f32_32x32x16_bf16 v[148:163], v[64:67], v[84:87], v[148:163]
    ds_read_b64_tr_b16 v[56:57], v8 offset:31808
    ds_read_b64_tr_b16 v[58:59], v8 offset:33088
    s_waitcnt lgkmcnt(15)
    v_mfma_f32_32x32x16_bf16 v[164:179], v[68:71], v[84:87], v[164:179]
    ds_read_b64_tr_b16 v[60:61], v8 offset:31872
    ds_read_b64_tr_b16 v[62:63], v8 offset:33152
    s_waitcnt lgkmcnt(15)
    v_mfma_f32_32x32x16_bf16 v[100:115], v[32:35], v[88:91], v[100:115]
    ds_read_b64_tr_b16 v[64:65], v8 offset:31936
    ds_read_b64_tr_b16 v[66:67], v8 offset:33216
    s_waitcnt lgkmcnt(15)
    v_mfma_f32_32x32x16_bf16 v[116:131], v[36:39], v[88:91], v[116:131]
    ds_read_b64_tr_b16 v[68:69], v8 offset:32000
    ds_read_b64_tr_b16 v[70:71], v8 offset:33280
    s_waitcnt lgkmcnt(15)
    v_mfma_f32_32x32x16_bf16 v[132:147], v[40:43], v[88:91], v[132:147]
    s_waitcnt lgkmcnt(13)
    v_mfma_f32_32x32x16_bf16 v[148:163], v[44:47], v[88:91], v[148:163]
    s_waitcnt lgkmcnt(10)
    v_mfma_f32_32x32x16_bf16 v[164:179], v[48:51], v[88:91], v[164:179]
    s_waitcnt lgkmcnt(0)
    s_barrier
    v_add_u32 v4, 36864, v4
    v_add_u32 v5, 36864, v5
    v_add_u32 v6, 36864, v6
    v_add_u32 v7, 36864, v7
    v_add_u32 v8, 36864, v8
    ds_read_b128 v[80:83], v4
    ds_read_b64_tr_b16 v[32:33], v8 offset:16384
    ds_read_b64_tr_b16 v[34:35], v8 offset:17664
    ds_read_b64_tr_b16 v[36:37], v8 offset:16448
    ds_read_b64_tr_b16 v[38:39], v8 offset:17728
    ds_read_b64_tr_b16 v[40:41], v8 offset:16512
    ds_read_b64_tr_b16 v[42:43], v8 offset:17792
    s_waitcnt lgkmcnt(15)
    v_mfma_f32_32x32x16_bf16 v[100:115], v[52:55], v[92:95], v[100:115]
    ds_read_b64_tr_b16 v[44:45], v8 offset:16576
    ds_read_b64_tr_b16 v[46:47], v8 offset:17856
    s_waitcnt lgkmcnt(15)
    v_mfma_f32_32x32x16_bf16 v[116:131], v[56:59], v[92:95], v[116:131]
    ds_read_b128 v[84:87], v5
    ds_read_b64_tr_b16 v[48:49], v8 offset:16640
    ds_read_b64_tr_b16 v[50:51], v8 offset:17920
    s_waitcnt lgkmcnt(15)
    v_mfma_f32_32x32x16_bf16 v[132:147], v[60:63], v[92:95], v[132:147]
    ds_read_b64_tr_b16 v[52:53], v8 offset:21504
    ds_read_b64_tr_b16 v[54:55], v8 offset:22784
    s_waitcnt lgkmcnt(15)
    v_mfma_f32_32x32x16_bf16 v[148:163], v[64:67], v[92:95], v[148:163]
    ds_read_b64_tr_b16 v[56:57], v8 offset:21568
    ds_read_b64_tr_b16 v[58:59], v8 offset:22848
    s_waitcnt lgkmcnt(15)
    v_mfma_f32_32x32x16_bf16 v[164:179], v[68:71], v[92:95], v[164:179]
    ds_read_b64_tr_b16 v[60:61], v8 offset:21632
    ds_read_b64_tr_b16 v[62:63], v8 offset:22912
    s_waitcnt lgkmcnt(15)
    v_mfma_f32_32x32x16_bf16 v[100:115], v[32:35], v[80:83], v[100:115]
    ds_read_b64_tr_b16 v[64:65], v8 offset:21696
    ds_read_b64_tr_b16 v[66:67], v8 offset:22976
    s_waitcnt lgkmcnt(15)
    v_mfma_f32_32x32x16_bf16 v[116:131], v[36:39], v[80:83], v[116:131]
    ds_read_b128 v[88:91], v6
    ds_read_b64_tr_b16 v[68:69], v8 offset:21760
    ds_read_b64_tr_b16 v[70:71], v8 offset:23040
    s_waitcnt lgkmcnt(15)
    v_mfma_f32_32x32x16_bf16 v[132:147], v[40:43], v[80:83], v[132:147]
    ds_read_b64_tr_b16 v[32:33], v8 offset:26624
    ds_read_b64_tr_b16 v[34:35], v8 offset:27904
    s_waitcnt lgkmcnt(15)
    v_mfma_f32_32x32x16_bf16 v[148:163], v[44:47], v[80:83], v[148:163]
    ds_read_b64_tr_b16 v[36:37], v8 offset:26688
    ds_read_b64_tr_b16 v[38:39], v8 offset:27968
    s_waitcnt lgkmcnt(15)
    v_mfma_f32_32x32x16_bf16 v[164:179], v[48:51], v[80:83], v[164:179]
    ds_read_b64_tr_b16 v[40:41], v8 offset:26752
    ds_read_b64_tr_b16 v[42:43], v8 offset:28032
    s_waitcnt lgkmcnt(15)
    v_mfma_f32_32x32x16_bf16 v[100:115], v[52:55], v[84:87], v[100:115]
    ds_read_b64_tr_b16 v[44:45], v8 offset:26816
    ds_read_b64_tr_b16 v[46:47], v8 offset:28096
    s_waitcnt lgkmcnt(15)
    v_mfma_f32_32x32x16_bf16 v[116:131], v[56:59], v[84:87], v[116:131]
    ds_read_b128 v[92:95], v7
    ds_read_b64_tr_b16 v[48:49], v8 offset:26880
    ds_read_b64_tr_b16 v[50:51], v8 offset:28160
    s_waitcnt lgkmcnt(15)
    v_mfma_f32_32x32x16_bf16 v[132:147], v[60:63], v[84:87], v[132:147]
    ds_read_b64_tr_b16 v[52:53], v8 offset:31744
    ds_read_b64_tr_b16 v[54:55], v8 offset:33024
    s_waitcnt lgkmcnt(15)
    v_mfma_f32_32x32x16_bf16 v[148:163], v[64:67], v[84:87], v[148:163]
    ds_read_b64_tr_b16 v[56:57], v8 offset:31808
    ds_read_b64_tr_b16 v[58:59], v8 offset:33088
    s_waitcnt lgkmcnt(15)
    v_mfma_f32_32x32x16_bf16 v[164:179], v[68:71], v[84:87], v[164:179]
    ds_read_b64_tr_b16 v[60:61], v8 offset:31872
    ds_read_b64_tr_b16 v[62:63], v8 offset:33152
    s_waitcnt lgkmcnt(15)
    v_mfma_f32_32x32x16_bf16 v[100:115], v[32:35], v[88:91], v[100:115]
    ds_read_b64_tr_b16 v[64:65], v8 offset:31936
    ds_read_b64_tr_b16 v[66:67], v8 offset:33216
    s_waitcnt lgkmcnt(15)
    v_mfma_f32_32x32x16_bf16 v[116:131], v[36:39], v[88:91], v[116:131]
    ds_read_b64_tr_b16 v[68:69], v8 offset:32000
    ds_read_b64_tr_b16 v[70:71], v8 offset:33280
    s_waitcnt lgkmcnt(15)
    v_mfma_f32_32x32x16_bf16 v[132:147], v[40:43], v[88:91], v[132:147]
    s_waitcnt lgkmcnt(13)
    v_mfma_f32_32x32x16_bf16 v[148:163], v[44:47], v[88:91], v[148:163]
    s_waitcnt lgkmcnt(10)
    v_mfma_f32_32x32x16_bf16 v[164:179], v[48:51], v[88:91], v[164:179]
    s_waitcnt lgkmcnt(0)
    s_barrier
    v_subrev_u32 v4, 73728, v4
    v_subrev_u32 v5, 73728, v5
    v_subrev_u32 v6, 73728, v6
    v_subrev_u32 v7, 73728, v7
    v_subrev_u32 v8, 73728, v8
    ds_read_b128 v[80:83], v4
    ds_read_b64_tr_b16 v[32:33], v8 offset:16384
    ds_read_b64_tr_b16 v[34:35], v8 offset:17664
    ds_read_b64_tr_b16 v[36:37], v8 offset:16448
    ds_read_b64_tr_b16 v[38:39], v8 offset:17728
    ds_read_b64_tr_b16 v[40:41], v8 offset:16512
    ds_read_b64_tr_b16 v[42:43], v8 offset:17792
    s_waitcnt lgkmcnt(15)
    v_mfma_f32_32x32x16_bf16 v[100:115], v[52:55], v[92:95], v[100:115]
    ds_read_b128 v[84:87], v5
    ds_read_b64_tr_b16 v[44:45], v8 offset:16576
    ds_read_b64_tr_b16 v[46:47], v8 offset:17856
    s_waitcnt lgkmcnt(15)
    v_mfma_f32_32x32x16_bf16 v[116:131], v[56:59], v[92:95], v[116:131]
    ds_read_b64_tr_b16 v[48:49], v8 offset:21504
    ds_read_b64_tr_b16 v[50:51], v8 offset:22784
    s_waitcnt lgkmcnt(15)
    v_mfma_f32_32x32x16_bf16 v[132:147], v[60:63], v[92:95], v[132:147]
    ds_read_b64_tr_b16 v[52:53], v8 offset:21568
    ds_read_b64_tr_b16 v[54:55], v8 offset:22848
    s_waitcnt lgkmcnt(15)
    v_mfma_f32_32x32x16_bf16 v[148:163], v[64:67], v[92:95], v[148:163]
    ds_read_b64_tr_b16 v[56:57], v8 offset:21632
    ds_read_b64_tr_b16 v[58:59], v8 offset:22912
    s_waitcnt lgkmcnt(15)
    v_mfma_f32_32x32x16_bf16 v[164:179], v[68:71], v[92:95], v[164:179]
    ds_read_b128 v[88:91], v6
    ds_read_b64_tr_b16 v[60:61], v8 offset:21696
    ds_read_b64_tr_b16 v[62:63], v8 offset:22976
    s_waitcnt lgkmcnt(15)
    v_mfma_f32_32x32x16_bf16 v[180:195], v[32:35], v[80:83], 0
    ds_read_b64_tr_b16 v[64:65], v8 offset:26624
    ds_read_b64_tr_b16 v[66:67], v8 offset:27904
    s_waitcnt lgkmcnt(15)
    v_mfma_f32_32x32x16_bf16 v[196:211], v[36:39], v[80:83], 0
    ds_read_b64_tr_b16 v[68:69], v8 offset:26688
    ds_read_b64_tr_b16 v[70:71], v8 offset:27968
    s_waitcnt lgkmcnt(15)
    v_mfma_f32_32x32x16_bf16 v[212:227], v[40:43], v[80:83], 0
    ds_read_b64_tr_b16 v[32:33], v8 offset:26752
    ds_read_b64_tr_b16 v[34:35], v8 offset:28032
    s_waitcnt lgkmcnt(15)
    v_mfma_f32_32x32x16_bf16 v[228:243], v[44:47], v[80:83], 0
    ds_read_b128 v[92:95], v7
    ds_read_b64_tr_b16 v[36:37], v8 offset:26816
    ds_read_b64_tr_b16 v[38:39], v8 offset:28096
    s_waitcnt lgkmcnt(15)
    v_mfma_f32_32x32x16_bf16 v[180:195], v[48:51], v[84:87], v[180:195]
    ds_read_b64_tr_b16 v[40:41], v8 offset:31744
    ds_read_b64_tr_b16 v[42:43], v8 offset:33024
    s_waitcnt lgkmcnt(15)
    v_mfma_f32_32x32x16_bf16 v[196:211], v[52:55], v[84:87], v[196:211]
    ds_read_b64_tr_b16 v[44:45], v8 offset:31808
    ds_read_b64_tr_b16 v[46:47], v8 offset:33088
    s_waitcnt lgkmcnt(15)
    v_mfma_f32_32x32x16_bf16 v[212:227], v[56:59], v[84:87], v[212:227]
    v_cvt_pk_bf16_f32 v24, v100, v101
    v_cvt_pk_bf16_f32 v25, v102, v103
    v_cvt_pk_bf16_f32 v26, v104, v105
    v_cvt_pk_bf16_f32 v27, v106, v107
    s_nop 1
    v_permlane32_swap_b32 v24, v26
    v_permlane32_swap_b32 v25, v27
    ds_write_b128 v9, v[24:27] offset:0
    ds_read_b64_tr_b16 v[48:49], v8 offset:31872
    ds_read_b64_tr_b16 v[50:51], v8 offset:33152
    s_waitcnt lgkmcnt(15)
    v_mfma_f32_32x32x16_bf16 v[228:243], v[60:63], v[84:87], v[228:243]
    v_cvt_pk_bf16_f32 v28, v108, v109
    v_cvt_pk_bf16_f32 v29, v110, v111
    v_cvt_pk_bf16_f32 v30, v112, v113
    v_cvt_pk_bf16_f32 v31, v114, v115
    s_nop 1
    v_permlane32_swap_b32 v28, v30
    v_permlane32_swap_b32 v29, v31
    ds_write_b128 v9, v[28:31] offset:32
    ds_read_b64_tr_b16 v[52:53], v8 offset:31936
    ds_read_b64_tr_b16 v[54:55], v8 offset:33216
    s_waitcnt lgkmcnt(15)
    v_mfma_f32_32x32x16_bf16 v[180:195], v[64:67], v[88:91], v[180:195]
    v_cvt_pk_bf16_f32 v24, v116, v117
    v_cvt_pk_bf16_f32 v25, v118, v119
    v_cvt_pk_bf16_f32 v26, v120, v121
    v_cvt_pk_bf16_f32 v27, v122, v123
    s_nop 1
    v_permlane32_swap_b32 v24, v26
    v_permlane32_swap_b32 v25, v27
    ds_write_b128 v9, v[24:27] offset:64
    s_waitcnt lgkmcnt(15)
    v_mfma_f32_32x32x16_bf16 v[196:211], v[68:71], v[88:91], v[196:211]
    v_cvt_pk_bf16_f32 v28, v124, v125
    v_cvt_pk_bf16_f32 v29, v126, v127
    v_cvt_pk_bf16_f32 v30, v128, v129
    v_cvt_pk_bf16_f32 v31, v130, v131
    s_nop 1
    v_permlane32_swap_b32 v28, v30
    v_permlane32_swap_b32 v29, v31
    ds_write_b128 v9, v[28:31] offset:96
    s_waitcnt lgkmcnt(15)
    v_mfma_f32_32x32x16_bf16 v[212:227], v[32:35], v[88:91], v[212:227]
    v_cvt_pk_bf16_f32 v24, v132, v133
    v_cvt_pk_bf16_f32 v25, v134, v135
    v_cvt_pk_bf16_f32 v26, v136, v137
    v_cvt_pk_bf16_f32 v27, v138, v139
    s_nop 1
    v_permlane32_swap_b32 v24, v26
    v_permlane32_swap_b32 v25, v27
    ds_write_b128 v9, v[24:27] offset:128
    s_waitcnt lgkmcnt(0)
    s_barrier
    v_add_u32 v4, 36864, v4
    v_add_u32 v5, 36864, v5
    v_add_u32 v6, 36864, v6
    v_add_u32 v7, 36864, v7
    v_add_u32 v8, 36864, v8
    ds_read_b128 v[80:83], v4
    ds_read_b64_tr_b16 v[56:57], v8 offset:16384
    ds_read_b64_tr_b16 v[58:59], v8 offset:17664
    ds_read_b64_tr_b16 v[60:61], v8 offset:16448
    ds_read_b64_tr_b16 v[62:63], v8 offset:17728
    ds_read_b64_tr_b16 v[64:65], v8 offset:16512
    ds_read_b64_tr_b16 v[66:67], v8 offset:17792
    s_waitcnt lgkmcnt(15)
    v_mfma_f32_32x32x16_bf16 v[228:243], v[36:39], v[88:91], v[228:243]
    v_cvt_pk_bf16_f32 v28, v140, v141
    v_cvt_pk_bf16_f32 v29, v142, v143
    v_cvt_pk_bf16_f32 v30, v144, v145
    v_cvt_pk_bf16_f32 v31, v146, v147
    s_nop 1
    v_permlane32_swap_b32 v28, v30
    v_permlane32_swap_b32 v29, v31
    ds_write_b128 v9, v[28:31] offset:160
    ds_read_b128 v[84:87], v5
    ds_read_b64_tr_b16 v[68:69], v8 offset:16576
    ds_read_b64_tr_b16 v[70:71], v8 offset:17856
    s_waitcnt lgkmcnt(15)
    v_mfma_f32_32x32x16_bf16 v[180:195], v[40:43], v[92:95], v[180:195]
    v_cvt_pk_bf16_f32 v24, v148, v149
    v_cvt_pk_bf16_f32 v25, v150, v151
    v_cvt_pk_bf16_f32 v26, v152, v153
    v_cvt_pk_bf16_f32 v27, v154, v155
    s_nop 1
    v_permlane32_swap_b32 v24, v26
    v_permlane32_swap_b32 v25, v27
    ds_write_b128 v9, v[24:27] offset:192
    ds_read_b64_tr_b16 v[32:33], v8 offset:21504
    ds_read_b64_tr_b16 v[34:35], v8 offset:22784
    s_waitcnt lgkmcnt(15)
    v_mfma_f32_32x32x16_bf16 v[196:211], v[44:47], v[92:95], v[196:211]
    v_cvt_pk_bf16_f32 v28, v156, v157
    v_cvt_pk_bf16_f32 v29, v158, v159
    v_cvt_pk_bf16_f32 v30, v160, v161
    v_cvt_pk_bf16_f32 v31, v162, v163
    s_nop 1
    v_permlane32_swap_b32 v28, v30
    v_permlane32_swap_b32 v29, v31
    ds_write_b128 v9, v[28:31] offset:224
    ds_read_b64_tr_b16 v[36:37], v8 offset:21568
    ds_read_b64_tr_b16 v[38:39], v8 offset:22848
    s_waitcnt lgkmcnt(15)
    v_mfma_f32_32x32x16_bf16 v[212:227], v[48:51], v[92:95], v[212:227]
    v_cvt_pk_bf16_f32 v24, v164, v165
    v_cvt_pk_bf16_f32 v25, v166, v167
    v_cvt_pk_bf16_f32 v26, v168, v169
    v_cvt_pk_bf16_f32 v27, v170, v171
    s_nop 1
    v_permlane32_swap_b32 v24, v26
    v_permlane32_swap_b32 v25, v27
    ds_write_b128 v9, v[24:27] offset:256
    ds_read_b64_tr_b16 v[40:41], v8 offset:21632
    ds_read_b64_tr_b16 v[42:43], v8 offset:22912
    s_waitcnt lgkmcnt(15)
    v_mfma_f32_32x32x16_bf16 v[228:243], v[52:55], v[92:95], v[228:243]
    v_cvt_pk_bf16_f32 v28, v172, v173
    v_cvt_pk_bf16_f32 v29, v174, v175
    v_cvt_pk_bf16_f32 v30, v176, v177
    v_cvt_pk_bf16_f32 v31, v178, v179
    s_nop 1
    v_permlane32_swap_b32 v28, v30
    v_permlane32_swap_b32 v29, v31
    ds_write_b128 v9, v[28:31] offset:288
    ds_read_b128 v[88:91], v6
    ds_read_b64_tr_b16 v[44:45], v8 offset:21696
    ds_read_b64_tr_b16 v[46:47], v8 offset:22976
    s_waitcnt lgkmcnt(15)
    v_mfma_f32_32x32x16_bf16 v[180:195], v[56:59], v[80:83], v[180:195]
    ds_read_b64_tr_b16 v[48:49], v8 offset:26624
    ds_read_b64_tr_b16 v[50:51], v8 offset:27904
    s_waitcnt lgkmcnt(15)
    v_mfma_f32_32x32x16_bf16 v[196:211], v[60:63], v[80:83], v[196:211]
    ds_read_b64_tr_b16 v[52:53], v8 offset:26688
    ds_read_b64_tr_b16 v[54:55], v8 offset:27968
    s_waitcnt lgkmcnt(15)
    v_mfma_f32_32x32x16_bf16 v[212:227], v[64:67], v[80:83], v[212:227]
    ds_read_b64_tr_b16 v[56:57], v8 offset:26752
    ds_read_b64_tr_b16 v[58:59], v8 offset:28032
    s_waitcnt lgkmcnt(15)
    v_mfma_f32_32x32x16_bf16 v[228:243], v[68:71], v[80:83], v[228:243]
    ds_read_b128 v[92:95], v7
    ds_read_b64_tr_b16 v[60:61], v8 offset:26816
    ds_read_b64_tr_b16 v[62:63], v8 offset:28096
    s_waitcnt lgkmcnt(15)
    v_mfma_f32_32x32x16_bf16 v[180:195], v[32:35], v[84:87], v[180:195]
    ds_read_b64_tr_b16 v[64:65], v8 offset:31744
    ds_read_b64_tr_b16 v[66:67], v8 offset:33024
    s_waitcnt lgkmcnt(15)
    v_mfma_f32_32x32x16_bf16 v[196:211], v[36:39], v[84:87], v[196:211]
    ds_read_b64_tr_b16 v[68:69], v8 offset:31808
    ds_read_b64_tr_b16 v[70:71], v8 offset:33088
    s_waitcnt lgkmcnt(15)
    v_mfma_f32_32x32x16_bf16 v[212:227], v[40:43], v[84:87], v[212:227]
    ds_read_b64_tr_b16 v[32:33], v8 offset:31872
    ds_read_b64_tr_b16 v[34:35], v8 offset:33152
    s_waitcnt lgkmcnt(15)
    v_mfma_f32_32x32x16_bf16 v[228:243], v[44:47], v[84:87], v[228:243]
    ds_read_b64_tr_b16 v[36:37], v8 offset:31936
    ds_read_b64_tr_b16 v[38:39], v8 offset:33216
    s_waitcnt lgkmcnt(15)
    v_mfma_f32_32x32x16_bf16 v[180:195], v[48:51], v[88:91], v[180:195]
    s_waitcnt lgkmcnt(13)
    v_mfma_f32_32x32x16_bf16 v[196:211], v[52:55], v[88:91], v[196:211]
    s_waitcnt lgkmcnt(11)
    v_mfma_f32_32x32x16_bf16 v[212:227], v[56:59], v[88:91], v[212:227]
    s_waitcnt lgkmcnt(0)
    s_barrier
    v_add_u32 v4, 36864, v4
    v_add_u32 v5, 36864, v5
    v_add_u32 v6, 36864, v6
    v_add_u32 v7, 36864, v7
    v_add_u32 v8, 36864, v8
    ds_read_b128 v[80:83], v4
    ds_read_b64_tr_b16 v[40:41], v8 offset:16384
    ds_read_b64_tr_b16 v[42:43], v8 offset:17664
    ds_read_b64_tr_b16 v[44:45], v8 offset:16448
    ds_read_b64_tr_b16 v[46:47], v8 offset:17728
    ds_read_b64_tr_b16 v[48:49], v8 offset:16512
    ds_read_b64_tr_b16 v[50:51], v8 offset:17792
    s_waitcnt lgkmcnt(15)
    v_mfma_f32_32x32x16_bf16 v[228:243], v[60:63], v[88:91], v[228:243]
    ds_read_b128 v[84:87], v5
    ds_read_b64_tr_b16 v[52:53], v8 offset:16576
    ds_read_b64_tr_b16 v[54:55], v8 offset:17856
    s_waitcnt lgkmcnt(15)
    v_mfma_f32_32x32x16_bf16 v[180:195], v[64:67], v[92:95], v[180:195]
    ds_read_b64_tr_b16 v[56:57], v8 offset:21504
    ds_read_b64_tr_b16 v[58:59], v8 offset:22784
    s_waitcnt lgkmcnt(15)
    v_mfma_f32_32x32x16_bf16 v[196:211], v[68:71], v[92:95], v[196:211]
    ds_read_b64_tr_b16 v[60:61], v8 offset:21568
    ds_read_b64_tr_b16 v[62:63], v8 offset:22848
    s_waitcnt lgkmcnt(15)
    v_mfma_f32_32x32x16_bf16 v[212:227], v[32:35], v[92:95], v[212:227]
    ds_read_b64_tr_b16 v[64:65], v8 offset:21632
    ds_read_b64_tr_b16 v[66:67], v8 offset:22912
    s_waitcnt lgkmcnt(15)
    v_mfma_f32_32x32x16_bf16 v[228:243], v[36:39], v[92:95], v[228:243]
    ds_read_b128 v[88:91], v6
    ds_read_b64_tr_b16 v[68:69], v8 offset:21696
    ds_read_b64_tr_b16 v[70:71], v8 offset:22976
    s_waitcnt lgkmcnt(15)
    v_mfma_f32_32x32x16_bf16 v[180:195], v[40:43], v[80:83], v[180:195]
    ds_read_b64_tr_b16 v[32:33], v8 offset:26624
    ds_read_b64_tr_b16 v[34:35], v8 offset:27904
    s_waitcnt lgkmcnt(15)
    v_mfma_f32_32x32x16_bf16 v[196:211], v[44:47], v[80:83], v[196:211]
    ds_read_b64_tr_b16 v[36:37], v8 offset:26688
    ds_read_b64_tr_b16 v[38:39], v8 offset:27968
    s_waitcnt lgkmcnt(15)
    v_mfma_f32_32x32x16_bf16 v[212:227], v[48:51], v[80:83], v[212:227]
    ds_read_b64_tr_b16 v[40:41], v8 offset:26752
    ds_read_b64_tr_b16 v[42:43], v8 offset:28032
    s_waitcnt lgkmcnt(15)
    v_mfma_f32_32x32x16_bf16 v[228:243], v[52:55], v[80:83], v[228:243]
    ds_read_b128 v[92:95], v7
    ds_read_b64_tr_b16 v[44:45], v8 offset:26816
    ds_read_b64_tr_b16 v[46:47], v8 offset:28096
    s_waitcnt lgkmcnt(15)
    v_mfma_f32_32x32x16_bf16 v[180:195], v[56:59], v[84:87], v[180:195]
    ds_read_b64_tr_b16 v[48:49], v8 offset:31744
    ds_read_b64_tr_b16 v[50:51], v8 offset:33024
    s_waitcnt lgkmcnt(15)
    v_mfma_f32_32x32x16_bf16 v[196:211], v[60:63], v[84:87], v[196:211]
    ds_read_b64_tr_b16 v[52:53], v8 offset:31808
    ds_read_b64_tr_b16 v[54:55], v8 offset:33088
    s_waitcnt lgkmcnt(15)
    v_mfma_f32_32x32x16_bf16 v[212:227], v[64:67], v[84:87], v[212:227]
    ds_read_b64_tr_b16 v[56:57], v8 offset:31872
    ds_read_b64_tr_b16 v[58:59], v8 offset:33152
    s_waitcnt lgkmcnt(15)
    v_mfma_f32_32x32x16_bf16 v[228:243], v[68:71], v[84:87], v[228:243]
    ds_read_b64_tr_b16 v[60:61], v8 offset:31936
    ds_read_b64_tr_b16 v[62:63], v8 offset:33216
    s_waitcnt lgkmcnt(15)
    v_mfma_f32_32x32x16_bf16 v[180:195], v[32:35], v[88:91], v[180:195]
    s_waitcnt lgkmcnt(13)
    v_mfma_f32_32x32x16_bf16 v[196:211], v[36:39], v[88:91], v[196:211]
    s_waitcnt lgkmcnt(11)
    v_mfma_f32_32x32x16_bf16 v[212:227], v[40:43], v[88:91], v[212:227]
    s_waitcnt lgkmcnt(0)
    s_barrier
    v_subrev_u32 v4, 73728, v4
    v_subrev_u32 v5, 73728, v5
    v_subrev_u32 v6, 73728, v6
    v_subrev_u32 v7, 73728, v7
    v_subrev_u32 v8, 73728, v8
    ds_read_b128 v[80:83], v4
    ds_read_b64_tr_b16 v[64:65], v8 offset:16384
    ds_read_b64_tr_b16 v[66:67], v8 offset:17664
    ds_read_b64_tr_b16 v[68:69], v8 offset:16448
    ds_read_b64_tr_b16 v[70:71], v8 offset:17728
    ds_read_b64_tr_b16 v[32:33], v8 offset:16512
    ds_read_b64_tr_b16 v[34:35], v8 offset:17792
    s_waitcnt lgkmcnt(15)
    v_mfma_f32_32x32x16_bf16 v[228:243], v[44:47], v[88:91], v[228:243]
    ds_read_b128 v[84:87], v5
    ds_read_b64_tr_b16 v[36:37], v8 offset:16576
    ds_read_b64_tr_b16 v[38:39], v8 offset:17856
    s_waitcnt lgkmcnt(15)
    v_mfma_f32_32x32x16_bf16 v[180:195], v[48:51], v[92:95], v[180:195]
    ds_read_b64_tr_b16 v[40:41], v8 offset:21504
    ds_read_b64_tr_b16 v[42:43], v8 offset:22784
    s_waitcnt lgkmcnt(15)
    v_mfma_f32_32x32x16_bf16 v[196:211], v[52:55], v[92:95], v[196:211]
    ds_read_b64_tr_b16 v[44:45], v8 offset:21568
    ds_read_b64_tr_b16 v[46:47], v8 offset:22848
    s_waitcnt lgkmcnt(15)
    v_mfma_f32_32x32x16_bf16 v[212:227], v[56:59], v[92:95], v[212:227]
    ds_read_b64_tr_b16 v[48:49], v8 offset:21632
    ds_read_b64_tr_b16 v[50:51], v8 offset:22912
    s_waitcnt lgkmcnt(15)
    v_mfma_f32_32x32x16_bf16 v[228:243], v[60:63], v[92:95], v[228:243]
    ds_read_b128 v[88:91], v6
    ds_read_b64_tr_b16 v[52:53], v8 offset:21696
    ds_read_b64_tr_b16 v[54:55], v8 offset:22976
    s_waitcnt lgkmcnt(15)
    v_mfma_f32_32x32x16_bf16 v[180:195], v[64:67], v[80:83], v[180:195]
    ds_read_b64_tr_b16 v[56:57], v8 offset:26624
    ds_read_b64_tr_b16 v[58:59], v8 offset:27904
    s_waitcnt lgkmcnt(15)
    v_mfma_f32_32x32x16_bf16 v[196:211], v[68:71], v[80:83], v[196:211]
    ds_read_b64_tr_b16 v[60:61], v8 offset:26688
    ds_read_b64_tr_b16 v[62:63], v8 offset:27968
    s_waitcnt lgkmcnt(15)
    v_mfma_f32_32x32x16_bf16 v[212:227], v[32:35], v[80:83], v[212:227]
    ds_read_b64_tr_b16 v[64:65], v8 offset:26752
    ds_read_b64_tr_b16 v[66:67], v8 offset:28032
    s_waitcnt lgkmcnt(15)
    v_mfma_f32_32x32x16_bf16 v[228:243], v[36:39], v[80:83], v[228:243]
    ds_read_b128 v[92:95], v7
    ds_read_b64_tr_b16 v[68:69], v8 offset:26816
    ds_read_b64_tr_b16 v[70:71], v8 offset:28096
    s_waitcnt lgkmcnt(15)
    v_mfma_f32_32x32x16_bf16 v[180:195], v[40:43], v[84:87], v[180:195]
    ds_read_b64_tr_b16 v[32:33], v8 offset:31744
    ds_read_b64_tr_b16 v[34:35], v8 offset:33024
    s_waitcnt lgkmcnt(15)
    v_mfma_f32_32x32x16_bf16 v[196:211], v[44:47], v[84:87], v[196:211]
    ds_read_b64_tr_b16 v[36:37], v8 offset:31808
    ds_read_b64_tr_b16 v[38:39], v8 offset:33088
    s_waitcnt lgkmcnt(15)
    v_mfma_f32_32x32x16_bf16 v[212:227], v[48:51], v[84:87], v[212:227]
    ds_read_b64_tr_b16 v[40:41], v8 offset:31872
    ds_read_b64_tr_b16 v[42:43], v8 offset:33152
    s_waitcnt lgkmcnt(15)
    v_mfma_f32_32x32x16_bf16 v[228:243], v[52:55], v[84:87], v[228:243]
    ds_read_b64_tr_b16 v[44:45], v8 offset:31936
    ds_read_b64_tr_b16 v[46:47], v8 offset:33216
    s_waitcnt lgkmcnt(15)
    v_mfma_f32_32x32x16_bf16 v[180:195], v[56:59], v[88:91], v[180:195]
    s_waitcnt lgkmcnt(13)
    v_mfma_f32_32x32x16_bf16 v[196:211], v[60:63], v[88:91], v[196:211]
    s_waitcnt lgkmcnt(11)
    v_mfma_f32_32x32x16_bf16 v[212:227], v[64:67], v[88:91], v[212:227]
    s_waitcnt lgkmcnt(0)
    s_barrier
    v_add_u32 v4, 36864, v4
    v_add_u32 v5, 36864, v5
    v_add_u32 v6, 36864, v6
    v_add_u32 v7, 36864, v7
    v_add_u32 v8, 36864, v8
    ds_read_b128 v[80:83], v4
    ds_read_b64_tr_b16 v[48:49], v8 offset:16384
    ds_read_b64_tr_b16 v[50:51], v8 offset:17664
    ds_read_b64_tr_b16 v[52:53], v8 offset:16448
    ds_read_b64_tr_b16 v[54:55], v8 offset:17728
    ds_read_b64_tr_b16 v[56:57], v8 offset:16512
    ds_read_b64_tr_b16 v[58:59], v8 offset:17792
    s_waitcnt lgkmcnt(15)
    v_mfma_f32_32x32x16_bf16 v[228:243], v[68:71], v[88:91], v[228:243]
    ds_read_b128 v[84:87], v5
    ds_read_b64_tr_b16 v[60:61], v8 offset:16576
    ds_read_b64_tr_b16 v[62:63], v8 offset:17856
    s_waitcnt lgkmcnt(15)
    v_mfma_f32_32x32x16_bf16 v[180:195], v[32:35], v[92:95], v[180:195]
    ds_read_b64_tr_b16 v[64:65], v8 offset:21504
    ds_read_b64_tr_b16 v[66:67], v8 offset:22784
    s_waitcnt lgkmcnt(15)
    v_mfma_f32_32x32x16_bf16 v[196:211], v[36:39], v[92:95], v[196:211]
    ds_read_b64_tr_b16 v[68:69], v8 offset:21568
    ds_read_b64_tr_b16 v[70:71], v8 offset:22848
    s_waitcnt lgkmcnt(15)
    v_mfma_f32_32x32x16_bf16 v[212:227], v[40:43], v[92:95], v[212:227]
    ds_read_b64_tr_b16 v[32:33], v8 offset:21632
    ds_read_b64_tr_b16 v[34:35], v8 offset:22912
    s_waitcnt lgkmcnt(15)
    v_mfma_f32_32x32x16_bf16 v[228:243], v[44:47], v[92:95], v[228:243]
    ds_read_b128 v[88:91], v6
    ds_read_b64_tr_b16 v[36:37], v8 offset:21696
    ds_read_b64_tr_b16 v[38:39], v8 offset:22976
    s_waitcnt lgkmcnt(15)
    v_mfma_f32_32x32x16_bf16 v[180:195], v[48:51], v[80:83], v[180:195]
    ds_read_b64_tr_b16 v[40:41], v8 offset:26624
    ds_read_b64_tr_b16 v[42:43], v8 offset:27904
    s_waitcnt lgkmcnt(15)
    v_mfma_f32_32x32x16_bf16 v[196:211], v[52:55], v[80:83], v[196:211]
    ds_read_b64_tr_b16 v[44:45], v8 offset:26688
    ds_read_b64_tr_b16 v[46:47], v8 offset:27968
    s_waitcnt lgkmcnt(15)
    v_mfma_f32_32x32x16_bf16 v[212:227], v[56:59], v[80:83], v[212:227]
    ds_read_b64_tr_b16 v[48:49], v8 offset:26752
    ds_read_b64_tr_b16 v[50:51], v8 offset:28032
    s_waitcnt lgkmcnt(15)
    v_mfma_f32_32x32x16_bf16 v[228:243], v[60:63], v[80:83], v[228:243]
    ds_read_b128 v[92:95], v7
    ds_read_b64_tr_b16 v[52:53], v8 offset:26816
    ds_read_b64_tr_b16 v[54:55], v8 offset:28096
    s_waitcnt lgkmcnt(15)
    v_mfma_f32_32x32x16_bf16 v[180:195], v[64:67], v[84:87], v[180:195]
    ds_read_b64_tr_b16 v[56:57], v8 offset:31744
    ds_read_b64_tr_b16 v[58:59], v8 offset:33024
    s_waitcnt lgkmcnt(15)
    v_mfma_f32_32x32x16_bf16 v[196:211], v[68:71], v[84:87], v[196:211]
    ds_read_b64_tr_b16 v[60:61], v8 offset:31808
    ds_read_b64_tr_b16 v[62:63], v8 offset:33088
    s_waitcnt lgkmcnt(15)
    v_mfma_f32_32x32x16_bf16 v[212:227], v[32:35], v[84:87], v[212:227]
    ds_read_b64_tr_b16 v[64:65], v8 offset:31872
    ds_read_b64_tr_b16 v[66:67], v8 offset:33152
    s_waitcnt lgkmcnt(15)
    v_mfma_f32_32x32x16_bf16 v[228:243], v[36:39], v[84:87], v[228:243]
    ds_read_b64_tr_b16 v[68:69], v8 offset:31936
    ds_read_b64_tr_b16 v[70:71], v8 offset:33216
    s_waitcnt lgkmcnt(15)
    v_mfma_f32_32x32x16_bf16 v[180:195], v[40:43], v[88:91], v[180:195]
    s_waitcnt lgkmcnt(13)
    v_mfma_f32_32x32x16_bf16 v[196:211], v[44:47], v[88:91], v[196:211]
    s_waitcnt lgkmcnt(11)
    v_mfma_f32_32x32x16_bf16 v[212:227], v[48:51], v[88:91], v[212:227]
    s_waitcnt lgkmcnt(0)
    s_barrier
    v_add_u32 v4, 36864, v4
    v_add_u32 v5, 36864, v5
    v_add_u32 v6, 36864, v6
    v_add_u32 v7, 36864, v7
    v_add_u32 v8, 36864, v8
    ds_read_b128 v[80:83], v4
    ds_read_b64_tr_b16 v[32:33], v8 offset:16384
    ds_read_b64_tr_b16 v[34:35], v8 offset:17664
    ds_read_b64_tr_b16 v[36:37], v8 offset:16448
    ds_read_b64_tr_b16 v[38:39], v8 offset:17728
    ds_read_b64_tr_b16 v[40:41], v8 offset:16512
    ds_read_b64_tr_b16 v[42:43], v8 offset:17792
    s_waitcnt lgkmcnt(15)
    v_mfma_f32_32x32x16_bf16 v[228:243], v[52:55], v[88:91], v[228:243]
    ds_read_b128 v[84:87], v5
    ds_read_b64_tr_b16 v[44:45], v8 offset:16576
    ds_read_b64_tr_b16 v[46:47], v8 offset:17856
    s_waitcnt lgkmcnt(15)
    v_mfma_f32_32x32x16_bf16 v[180:195], v[56:59], v[92:95], v[180:195]
    ds_read_b64_tr_b16 v[48:49], v8 offset:21504
    ds_read_b64_tr_b16 v[50:51], v8 offset:22784
    s_waitcnt lgkmcnt(15)
    v_mfma_f32_32x32x16_bf16 v[196:211], v[60:63], v[92:95], v[196:211]
    ds_read_b64_tr_b16 v[52:53], v8 offset:21568
    ds_read_b64_tr_b16 v[54:55], v8 offset:22848
    s_waitcnt lgkmcnt(15)
    v_mfma_f32_32x32x16_bf16 v[212:227], v[64:67], v[92:95], v[212:227]
    ds_read_b64_tr_b16 v[56:57], v8 offset:21632
    ds_read_b64_tr_b16 v[58:59], v8 offset:22912
    s_waitcnt lgkmcnt(15)
    v_mfma_f32_32x32x16_bf16 v[228:243], v[68:71], v[92:95], v[228:243]
    ds_read_b128 v[88:91], v6
    ds_read_b64_tr_b16 v[60:61], v8 offset:21696
    ds_read_b64_tr_b16 v[62:63], v8 offset:22976
    s_waitcnt lgkmcnt(15)
    v_mfma_f32_32x32x16_bf16 v[180:195], v[32:35], v[80:83], v[180:195]
    ds_read_b64_tr_b16 v[64:65], v8 offset:26624
    ds_read_b64_tr_b16 v[66:67], v8 offset:27904
    s_waitcnt lgkmcnt(15)
    v_mfma_f32_32x32x16_bf16 v[196:211], v[36:39], v[80:83], v[196:211]
    ds_read_b64_tr_b16 v[68:69], v8 offset:26688
    ds_read_b64_tr_b16 v[70:71], v8 offset:27968
    s_waitcnt lgkmcnt(15)
    v_mfma_f32_32x32x16_bf16 v[212:227], v[40:43], v[80:83], v[212:227]
    ds_read_b64_tr_b16 v[32:33], v8 offset:26752
    ds_read_b64_tr_b16 v[34:35], v8 offset:28032
    s_waitcnt lgkmcnt(15)
    v_mfma_f32_32x32x16_bf16 v[228:243], v[44:47], v[80:83], v[228:243]
    ds_read_b128 v[92:95], v7
    ds_read_b64_tr_b16 v[36:37], v8 offset:26816
    ds_read_b64_tr_b16 v[38:39], v8 offset:28096
    s_waitcnt lgkmcnt(15)
    v_mfma_f32_32x32x16_bf16 v[180:195], v[48:51], v[84:87], v[180:195]
    ds_read_b64_tr_b16 v[40:41], v8 offset:31744
    ds_read_b64_tr_b16 v[42:43], v8 offset:33024
    s_waitcnt lgkmcnt(15)
    v_mfma_f32_32x32x16_bf16 v[196:211], v[52:55], v[84:87], v[196:211]
    ds_read_b64_tr_b16 v[44:45], v8 offset:31808
    ds_read_b64_tr_b16 v[46:47], v8 offset:33088
    s_waitcnt lgkmcnt(15)
    v_mfma_f32_32x32x16_bf16 v[212:227], v[56:59], v[84:87], v[212:227]
    ds_read_b64_tr_b16 v[48:49], v8 offset:31872
    ds_read_b64_tr_b16 v[50:51], v8 offset:33152
    s_waitcnt lgkmcnt(15)
    v_mfma_f32_32x32x16_bf16 v[228:243], v[60:63], v[84:87], v[228:243]
    ds_read_b64_tr_b16 v[52:53], v8 offset:31936
    ds_read_b64_tr_b16 v[54:55], v8 offset:33216
    s_waitcnt lgkmcnt(15)
    v_mfma_f32_32x32x16_bf16 v[180:195], v[64:67], v[88:91], v[180:195]
    s_waitcnt lgkmcnt(13)
    v_mfma_f32_32x32x16_bf16 v[196:211], v[68:71], v[88:91], v[196:211]
    s_waitcnt lgkmcnt(11)
    v_mfma_f32_32x32x16_bf16 v[212:227], v[32:35], v[88:91], v[212:227]
    s_waitcnt lgkmcnt(0)
    s_barrier
    v_subrev_u32 v4, 73728, v4
    v_subrev_u32 v5, 73728, v5
    v_subrev_u32 v6, 73728, v6
    v_subrev_u32 v7, 73728, v7
    v_subrev_u32 v8, 73728, v8
    ds_read_b128 v[80:83], v4
    ds_read_b64_tr_b16 v[56:57], v8 offset:16384
    ds_read_b64_tr_b16 v[58:59], v8 offset:17664
    ds_read_b64_tr_b16 v[60:61], v8 offset:16448
    ds_read_b64_tr_b16 v[62:63], v8 offset:17728
    ds_read_b64_tr_b16 v[64:65], v8 offset:16512
    ds_read_b64_tr_b16 v[66:67], v8 offset:17792
    s_waitcnt lgkmcnt(15)
    v_mfma_f32_32x32x16_bf16 v[228:243], v[36:39], v[88:91], v[228:243]
    ds_read_b128 v[84:87], v5
    ds_read_b64_tr_b16 v[68:69], v8 offset:16576
    ds_read_b64_tr_b16 v[70:71], v8 offset:17856
    s_waitcnt lgkmcnt(15)
    v_mfma_f32_32x32x16_bf16 v[180:195], v[40:43], v[92:95], v[180:195]
    ds_read_b64_tr_b16 v[32:33], v8 offset:21504
    ds_read_b64_tr_b16 v[34:35], v8 offset:22784
    s_waitcnt lgkmcnt(15)
    v_mfma_f32_32x32x16_bf16 v[196:211], v[44:47], v[92:95], v[196:211]
    ds_read_b64_tr_b16 v[36:37], v8 offset:21568
    ds_read_b64_tr_b16 v[38:39], v8 offset:22848
    s_waitcnt lgkmcnt(15)
    v_mfma_f32_32x32x16_bf16 v[212:227], v[48:51], v[92:95], v[212:227]
    ds_read_b64_tr_b16 v[40:41], v8 offset:21632
    ds_read_b64_tr_b16 v[42:43], v8 offset:22912
    s_waitcnt lgkmcnt(15)
    v_mfma_f32_32x32x16_bf16 v[228:243], v[52:55], v[92:95], v[228:243]
    ds_read_b128 v[88:91], v6
    ds_read_b64_tr_b16 v[44:45], v8 offset:21696
    ds_read_b64_tr_b16 v[46:47], v8 offset:22976
    s_waitcnt lgkmcnt(15)
    v_mfma_f32_32x32x16_bf16 v[180:195], v[56:59], v[80:83], v[180:195]
    ds_read_b64_tr_b16 v[48:49], v8 offset:26624
    ds_read_b64_tr_b16 v[50:51], v8 offset:27904
    s_waitcnt lgkmcnt(15)
    v_mfma_f32_32x32x16_bf16 v[196:211], v[60:63], v[80:83], v[196:211]
    ds_read_b64_tr_b16 v[52:53], v8 offset:26688
    ds_read_b64_tr_b16 v[54:55], v8 offset:27968
    s_waitcnt lgkmcnt(15)
    v_mfma_f32_32x32x16_bf16 v[212:227], v[64:67], v[80:83], v[212:227]
    ds_read_b64_tr_b16 v[56:57], v8 offset:26752
    ds_read_b64_tr_b16 v[58:59], v8 offset:28032
    s_waitcnt lgkmcnt(15)
    v_mfma_f32_32x32x16_bf16 v[228:243], v[68:71], v[80:83], v[228:243]
    ds_read_b128 v[92:95], v7
    ds_read_b64_tr_b16 v[60:61], v8 offset:26816
    ds_read_b64_tr_b16 v[62:63], v8 offset:28096
    s_waitcnt lgkmcnt(15)
    v_mfma_f32_32x32x16_bf16 v[180:195], v[32:35], v[84:87], v[180:195]
    ds_read_b64_tr_b16 v[64:65], v8 offset:31744
    ds_read_b64_tr_b16 v[66:67], v8 offset:33024
    s_waitcnt lgkmcnt(15)
    v_mfma_f32_32x32x16_bf16 v[196:211], v[36:39], v[84:87], v[196:211]
    ds_read_b64_tr_b16 v[68:69], v8 offset:31808
    ds_read_b64_tr_b16 v[70:71], v8 offset:33088
    s_waitcnt lgkmcnt(15)
    v_mfma_f32_32x32x16_bf16 v[212:227], v[40:43], v[84:87], v[212:227]
    ds_read_b64_tr_b16 v[32:33], v8 offset:31872
    ds_read_b64_tr_b16 v[34:35], v8 offset:33152
    s_waitcnt lgkmcnt(15)
    v_mfma_f32_32x32x16_bf16 v[228:243], v[44:47], v[84:87], v[228:243]
    ds_read_b64_tr_b16 v[36:37], v8 offset:31936
    ds_read_b64_tr_b16 v[38:39], v8 offset:33216
    s_waitcnt lgkmcnt(15)
    v_mfma_f32_32x32x16_bf16 v[180:195], v[48:51], v[88:91], v[180:195]
    s_waitcnt lgkmcnt(13)
    v_mfma_f32_32x32x16_bf16 v[196:211], v[52:55], v[88:91], v[196:211]
    s_waitcnt lgkmcnt(11)
    v_mfma_f32_32x32x16_bf16 v[212:227], v[56:59], v[88:91], v[212:227]
    s_waitcnt lgkmcnt(0)
    s_barrier
    v_add_u32 v4, 36864, v4
    v_add_u32 v5, 36864, v5
    v_add_u32 v6, 36864, v6
    v_add_u32 v7, 36864, v7
    v_add_u32 v8, 36864, v8
    ds_read_b128 v[80:83], v4
    ds_read_b64_tr_b16 v[40:41], v8 offset:16384
    ds_read_b64_tr_b16 v[42:43], v8 offset:17664
    ds_read_b64_tr_b16 v[44:45], v8 offset:16448
    ds_read_b64_tr_b16 v[46:47], v8 offset:17728
    ds_read_b64_tr_b16 v[48:49], v8 offset:16512
    ds_read_b64_tr_b16 v[50:51], v8 offset:17792
    s_waitcnt lgkmcnt(15)
    v_mfma_f32_32x32x16_bf16 v[228:243], v[60:63], v[88:91], v[228:243]
    ds_read_b128 v[84:87], v5
    ds_read_b64_tr_b16 v[52:53], v8 offset:16576
    ds_read_b64_tr_b16 v[54:55], v8 offset:17856
    s_waitcnt lgkmcnt(15)
    v_mfma_f32_32x32x16_bf16 v[180:195], v[64:67], v[92:95], v[180:195]
    ds_read_b64_tr_b16 v[56:57], v8 offset:21504
    ds_read_b64_tr_b16 v[58:59], v8 offset:22784
    s_waitcnt lgkmcnt(15)
    v_mfma_f32_32x32x16_bf16 v[196:211], v[68:71], v[92:95], v[196:211]
    ds_read_b64_tr_b16 v[60:61], v8 offset:21568
    ds_read_b64_tr_b16 v[62:63], v8 offset:22848
    s_waitcnt lgkmcnt(15)
    v_mfma_f32_32x32x16_bf16 v[212:227], v[32:35], v[92:95], v[212:227]
    ds_read_b64_tr_b16 v[64:65], v8 offset:21632
    ds_read_b64_tr_b16 v[66:67], v8 offset:22912
    s_waitcnt lgkmcnt(15)
    v_mfma_f32_32x32x16_bf16 v[228:243], v[36:39], v[92:95], v[228:243]
    ds_read_b128 v[88:91], v6
    ds_read_b64_tr_b16 v[68:69], v8 offset:21696
    ds_read_b64_tr_b16 v[70:71], v8 offset:22976
    s_waitcnt lgkmcnt(15)
    v_mfma_f32_32x32x16_bf16 v[180:195], v[40:43], v[80:83], v[180:195]
    ds_read_b64_tr_b16 v[32:33], v8 offset:26624
    ds_read_b64_tr_b16 v[34:35], v8 offset:27904
    s_waitcnt lgkmcnt(15)
    v_mfma_f32_32x32x16_bf16 v[196:211], v[44:47], v[80:83], v[196:211]
    ds_read_b64_tr_b16 v[36:37], v8 offset:26688
    ds_read_b64_tr_b16 v[38:39], v8 offset:27968
    s_waitcnt lgkmcnt(15)
    v_mfma_f32_32x32x16_bf16 v[212:227], v[48:51], v[80:83], v[212:227]
    ds_read_b64_tr_b16 v[40:41], v8 offset:26752
    ds_read_b64_tr_b16 v[42:43], v8 offset:28032
    s_waitcnt lgkmcnt(15)
    v_mfma_f32_32x32x16_bf16 v[228:243], v[52:55], v[80:83], v[228:243]
    ds_read_b128 v[92:95], v7
    ds_read_b64_tr_b16 v[44:45], v8 offset:26816
    ds_read_b64_tr_b16 v[46:47], v8 offset:28096
    s_waitcnt lgkmcnt(15)
    v_mfma_f32_32x32x16_bf16 v[180:195], v[56:59], v[84:87], v[180:195]
    ds_read_b64_tr_b16 v[48:49], v8 offset:31744
    ds_read_b64_tr_b16 v[50:51], v8 offset:33024
    s_waitcnt lgkmcnt(15)
    v_mfma_f32_32x32x16_bf16 v[196:211], v[60:63], v[84:87], v[196:211]
    ds_read_b64_tr_b16 v[52:53], v8 offset:31808
    ds_read_b64_tr_b16 v[54:55], v8 offset:33088
    s_waitcnt lgkmcnt(15)
    v_mfma_f32_32x32x16_bf16 v[212:227], v[64:67], v[84:87], v[212:227]
    ds_read_b64_tr_b16 v[56:57], v8 offset:31872
    ds_read_b64_tr_b16 v[58:59], v8 offset:33152
    s_waitcnt lgkmcnt(15)
    v_mfma_f32_32x32x16_bf16 v[228:243], v[68:71], v[84:87], v[228:243]
    ds_read_b64_tr_b16 v[60:61], v8 offset:31936
    ds_read_b64_tr_b16 v[62:63], v8 offset:33216
    s_waitcnt lgkmcnt(15)
    v_mfma_f32_32x32x16_bf16 v[180:195], v[32:35], v[88:91], v[180:195]
    s_waitcnt lgkmcnt(13)
    v_mfma_f32_32x32x16_bf16 v[196:211], v[36:39], v[88:91], v[196:211]
    s_waitcnt lgkmcnt(11)
    v_mfma_f32_32x32x16_bf16 v[212:227], v[40:43], v[88:91], v[212:227]
    s_waitcnt lgkmcnt(0)
    s_barrier
    v_add_u32 v4, 36864, v4
    v_add_u32 v5, 36864, v5
    v_add_u32 v6, 36864, v6
    v_add_u32 v7, 36864, v7
    v_add_u32 v8, 36864, v8
    ds_read_b128 v[80:83], v4
    ds_read_b64_tr_b16 v[64:65], v8 offset:16384
    ds_read_b64_tr_b16 v[66:67], v8 offset:17664
    ds_read_b64_tr_b16 v[68:69], v8 offset:16448
    ds_read_b64_tr_b16 v[70:71], v8 offset:17728
    ds_read_b64_tr_b16 v[32:33], v8 offset:16512
    ds_read_b64_tr_b16 v[34:35], v8 offset:17792
    s_waitcnt lgkmcnt(15)
    v_mfma_f32_32x32x16_bf16 v[228:243], v[44:47], v[88:91], v[228:243]
    ds_read_b128 v[84:87], v5
    ds_read_b64_tr_b16 v[36:37], v8 offset:16576
    ds_read_b64_tr_b16 v[38:39], v8 offset:17856
    s_waitcnt lgkmcnt(15)
    v_mfma_f32_32x32x16_bf16 v[180:195], v[48:51], v[92:95], v[180:195]
    ds_read_b64_tr_b16 v[40:41], v8 offset:21504
    ds_read_b64_tr_b16 v[42:43], v8 offset:22784
    s_waitcnt lgkmcnt(15)
    v_mfma_f32_32x32x16_bf16 v[196:211], v[52:55], v[92:95], v[196:211]
    ds_read_b64_tr_b16 v[44:45], v8 offset:21568
    ds_read_b64_tr_b16 v[46:47], v8 offset:22848
    s_waitcnt lgkmcnt(15)
    v_mfma_f32_32x32x16_bf16 v[212:227], v[56:59], v[92:95], v[212:227]
    ds_read_b64_tr_b16 v[48:49], v8 offset:21632
    ds_read_b64_tr_b16 v[50:51], v8 offset:22912
    s_waitcnt lgkmcnt(15)
    v_mfma_f32_32x32x16_bf16 v[228:243], v[60:63], v[92:95], v[228:243]
    ds_read_b128 v[88:91], v6
    ds_read_b64_tr_b16 v[52:53], v8 offset:21696
    ds_read_b64_tr_b16 v[54:55], v8 offset:22976
    s_waitcnt lgkmcnt(15)
    v_mfma_f32_32x32x16_bf16 v[180:195], v[64:67], v[80:83], v[180:195]
    ds_read_b64_tr_b16 v[56:57], v8 offset:26624
    ds_read_b64_tr_b16 v[58:59], v8 offset:27904
    s_waitcnt lgkmcnt(15)
    v_mfma_f32_32x32x16_bf16 v[196:211], v[68:71], v[80:83], v[196:211]
    ds_read_b64_tr_b16 v[60:61], v8 offset:26688
    ds_read_b64_tr_b16 v[62:63], v8 offset:27968
    s_waitcnt lgkmcnt(15)
    v_mfma_f32_32x32x16_bf16 v[212:227], v[32:35], v[80:83], v[212:227]
    ds_read_b64_tr_b16 v[64:65], v8 offset:26752
    ds_read_b64_tr_b16 v[66:67], v8 offset:28032
    s_waitcnt lgkmcnt(15)
    v_mfma_f32_32x32x16_bf16 v[228:243], v[36:39], v[80:83], v[228:243]
    ds_read_b128 v[92:95], v7
    ds_read_b64_tr_b16 v[68:69], v8 offset:26816
    ds_read_b64_tr_b16 v[70:71], v8 offset:28096
    s_waitcnt lgkmcnt(15)
    v_mfma_f32_32x32x16_bf16 v[180:195], v[40:43], v[84:87], v[180:195]
    ds_read_b64_tr_b16 v[32:33], v8 offset:31744
    ds_read_b64_tr_b16 v[34:35], v8 offset:33024
    s_waitcnt lgkmcnt(15)
    v_mfma_f32_32x32x16_bf16 v[196:211], v[44:47], v[84:87], v[196:211]
    ds_read_b64_tr_b16 v[36:37], v8 offset:31808
    ds_read_b64_tr_b16 v[38:39], v8 offset:33088
    s_waitcnt lgkmcnt(15)
    v_mfma_f32_32x32x16_bf16 v[212:227], v[48:51], v[84:87], v[212:227]
    ds_read_b64_tr_b16 v[40:41], v8 offset:31872
    ds_read_b64_tr_b16 v[42:43], v8 offset:33152
    s_waitcnt lgkmcnt(15)
    v_mfma_f32_32x32x16_bf16 v[228:243], v[52:55], v[84:87], v[228:243]
    ds_read_b64_tr_b16 v[44:45], v8 offset:31936
    ds_read_b64_tr_b16 v[46:47], v8 offset:33216
    s_waitcnt lgkmcnt(15)
    v_mfma_f32_32x32x16_bf16 v[180:195], v[56:59], v[88:91], v[180:195]
    s_waitcnt lgkmcnt(13)
    v_mfma_f32_32x32x16_bf16 v[196:211], v[60:63], v[88:91], v[196:211]
    s_waitcnt lgkmcnt(11)
    v_mfma_f32_32x32x16_bf16 v[212:227], v[64:67], v[88:91], v[212:227]
    s_waitcnt lgkmcnt(8)
    v_mfma_f32_32x32x16_bf16 v[228:243], v[68:71], v[88:91], v[228:243]
    s_waitcnt lgkmcnt(6)
    v_mfma_f32_32x32x16_bf16 v[180:195], v[32:35], v[92:95], v[180:195]
    s_waitcnt lgkmcnt(4)
    v_mfma_f32_32x32x16_bf16 v[196:211], v[36:39], v[92:95], v[196:211]
    s_waitcnt lgkmcnt(2)
    v_mfma_f32_32x32x16_bf16 v[212:227], v[40:43], v[92:95], v[212:227]
    s_waitcnt lgkmcnt(0)
    v_mfma_f32_32x32x16_bf16 v[228:243], v[44:47], v[92:95], v[228:243]
    s_nop 15
    s_barrier
    v_cvt_pk_bf16_f32 v32, v180, v181
    v_cvt_pk_bf16_f32 v33, v182, v183
    v_cvt_pk_bf16_f32 v34, v184, v185
    v_cvt_pk_bf16_f32 v35, v186, v187
    s_nop 1
    v_permlane32_swap_b32 v32, v34
    v_permlane32_swap_b32 v33, v35
    ds_write_b128 v10, v[32:35] offset:0
    v_cvt_pk_bf16_f32 v36, v188, v189
    v_cvt_pk_bf16_f32 v37, v190, v191
    v_cvt_pk_bf16_f32 v38, v192, v193
    v_cvt_pk_bf16_f32 v39, v194, v195
    s_nop 1
    v_permlane32_swap_b32 v36, v38
    v_permlane32_swap_b32 v37, v39
    ds_write_b128 v10, v[36:39] offset:32
    v_cvt_pk_bf16_f32 v32, v196, v197
    v_cvt_pk_bf16_f32 v33, v198, v199
    v_cvt_pk_bf16_f32 v34, v200, v201
    v_cvt_pk_bf16_f32 v35, v202, v203
    s_nop 1
    v_permlane32_swap_b32 v32, v34
    v_permlane32_swap_b32 v33, v35
    ds_write_b128 v10, v[32:35] offset:64
    v_cvt_pk_bf16_f32 v36, v204, v205
    v_cvt_pk_bf16_f32 v37, v206, v207
    v_cvt_pk_bf16_f32 v38, v208, v209
    v_cvt_pk_bf16_f32 v39, v210, v211
    s_nop 1
    v_permlane32_swap_b32 v36, v38
    v_permlane32_swap_b32 v37, v39
    ds_write_b128 v10, v[36:39] offset:96
    v_cvt_pk_bf16_f32 v32, v212, v213
    v_cvt_pk_bf16_f32 v33, v214, v215
    v_cvt_pk_bf16_f32 v34, v216, v217
    v_cvt_pk_bf16_f32 v35, v218, v219
    s_nop 1
    v_permlane32_swap_b32 v32, v34
    v_permlane32_swap_b32 v33, v35
    ds_write_b128 v10, v[32:35] offset:128
    v_cvt_pk_bf16_f32 v36, v220, v221
    v_cvt_pk_bf16_f32 v37, v222, v223
    v_cvt_pk_bf16_f32 v38, v224, v225
    v_cvt_pk_bf16_f32 v39, v226, v227
    s_nop 1
    v_permlane32_swap_b32 v36, v38
    v_permlane32_swap_b32 v37, v39
    ds_write_b128 v10, v[36:39] offset:160
    v_cvt_pk_bf16_f32 v32, v228, v229
    v_cvt_pk_bf16_f32 v33, v230, v231
    v_cvt_pk_bf16_f32 v34, v232, v233
    v_cvt_pk_bf16_f32 v35, v234, v235
    s_nop 1
    v_permlane32_swap_b32 v32, v34
    v_permlane32_swap_b32 v33, v35
    ds_write_b128 v10, v[32:35] offset:192
    v_cvt_pk_bf16_f32 v36, v236, v237
    v_cvt_pk_bf16_f32 v37, v238, v239
    v_cvt_pk_bf16_f32 v38, v240, v241
    v_cvt_pk_bf16_f32 v39, v242, v243
    s_nop 1
    v_permlane32_swap_b32 v36, v38
    v_permlane32_swap_b32 v37, v39
    ds_write_b128 v10, v[36:39] offset:224
    s_waitcnt lgkmcnt(0)
    s_branch ffn1_kernel_store
ffn1_kernel_loader:
    s_sub_u32 s5, s5, 4
    s_lshl_b32 s27, s5, 5
    s_add_u32 s27, s27, s24
    s_mul_i32 s20, s27, 1152
    s_lshl_b32 s27, s5, 4
    s_mul_i32 s21, s27, 9216
    s_mul_i32 s27, s4, 576
    s_add_u32 s21, s21, s27
    s_lshl_b32 s26, s5, 12
    s_mul_i32 s27, s5, 5120
    s_add_u32 s27, s27, 16384
    v_lshrrev_b32 v28, 3, v1
    v_and_b32 v29, 7, v1
    v_lshrrev_b32 v30, 4, v1
    s_mov_b32 s28, 1152
    v_add_u32 v31, 0, v30
    v_xor_b32 v31, v31, v29
    v_lshlrev_b32 v31, 4, v31
    v_add_u32 v10, 0, v28
    v_mul_lo_u32 v10, v10, s28
    v_add_u32 v10, v10, v31
    v_add_u32 v31, 4, v30
    v_xor_b32 v31, v31, v29
    v_lshlrev_b32 v31, 4, v31
    v_add_u32 v11, 8, v28
    v_mul_lo_u32 v11, v11, s28
    v_add_u32 v11, v11, v31
    v_subrev_u32 v11, 1024, v11
    v_add_u32 v31, 0, v30
    v_xor_b32 v31, v31, v29
    v_lshlrev_b32 v31, 4, v31
    v_add_u32 v12, 16, v28
    v_mul_lo_u32 v12, v12, s28
    v_add_u32 v12, v12, v31
    v_subrev_u32 v12, 2048, v12
    v_add_u32 v31, 4, v30
    v_xor_b32 v31, v31, v29
    v_lshlrev_b32 v31, 4, v31
    v_add_u32 v13, 24, v28
    v_mul_lo_u32 v13, v13, s28
    v_add_u32 v13, v13, v31
    v_subrev_u32 v13, 3072, v13
    s_mov_b32 s28, 9216
    v_add_u32 v28, 0, v1
    v_mul_u32_u24 v29, 3277, v28
    v_lshrrev_b32 v29, 16, v29
    v_mul_u32_u24 v30, 20, v29
    v_sub_u32 v28, v28, v30
    v_mul_lo_u32 v14, v29, s28
    v_lshl_add_u32 v14, v28, 4, v14
    v_mul_u32_u24 v30, 336, v29
    v_lshl_add_u32 v40, v28, 4, v30
    v_add_u32 v31, s30, v28
    v_lshlrev_b32 v29, 7, v29
    v_and_b32 v28, 7, v31
    v_lshl_add_u32 v29, v28, 4, v29
    v_lshrrev_b32 v31, 3, v31
    v_lshl_add_u32 v45, v31, 18, v29
    v_add_u32 v28, 64, v1
    v_mul_u32_u24 v29, 3277, v28
    v_lshrrev_b32 v29, 16, v29
    v_mul_u32_u24 v30, 20, v29
    v_sub_u32 v28, v28, v30
    v_mul_lo_u32 v15, v29, s28
    v_lshl_add_u32 v15, v28, 4, v15
    v_subrev_u32 v15, 1024, v15
    v_mul_u32_u24 v30, 336, v29
    v_lshl_add_u32 v41, v28, 4, v30
    v_add_u32 v31, s30, v28
    v_lshlrev_b32 v29, 7, v29
    v_and_b32 v28, 7, v31
    v_lshl_add_u32 v29, v28, 4, v29
    v_lshrrev_b32 v31, 3, v31
    v_lshl_add_u32 v46, v31, 18, v29
    v_add_u32 v28, 128, v1
    v_mul_u32_u24 v29, 3277, v28
    v_lshrrev_b32 v29, 16, v29
    v_mul_u32_u24 v30, 20, v29
    v_sub_u32 v28, v28, v30
    v_mul_lo_u32 v16, v29, s28
    v_lshl_add_u32 v16, v28, 4, v16
    v_subrev_u32 v16, 2048, v16
    v_mul_u32_u24 v30, 336, v29
    v_lshl_add_u32 v42, v28, 4, v30
    v_add_u32 v31, s30, v28
    v_lshlrev_b32 v29, 7, v29
    v_and_b32 v28, 7, v31
    v_lshl_add_u32 v29, v28, 4, v29
    v_lshrrev_b32 v31, 3, v31
    v_lshl_add_u32 v47, v31, 18, v29
    v_add_u32 v28, 192, v1
    v_mul_u32_u24 v29, 3277, v28
    v_lshrrev_b32 v29, 16, v29
    v_mul_u32_u24 v30, 20, v29
    v_sub_u32 v28, v28, v30
    v_mul_lo_u32 v17, v29, s28
    v_lshl_add_u32 v17, v28, 4, v17
    v_subrev_u32 v17, 3072, v17
    v_mul_u32_u24 v30, 336, v29
    v_lshl_add_u32 v43, v28, 4, v30
    v_add_u32 v31, s30, v28
    v_lshlrev_b32 v29, 7, v29
    v_and_b32 v28, 7, v31
    v_lshl_add_u32 v29, v28, 4, v29
    v_lshrrev_b32 v31, 3, v31
    v_lshl_add_u32 v48, v31, 18, v29
    v_add_u32 v28, 256, v1
    v_mul_u32_u24 v29, 3277, v28
    v_lshrrev_b32 v29, 16, v29
    v_mul_u32_u24 v30, 20, v29
    v_sub_u32 v28, v28, v30
    v_mul_lo_u32 v18, v29, s28
    v_lshl_add_u32 v18, v28, 4, v18
    v_mul_u32_u24 v30, 336, v29
    v_lshl_add_u32 v44, v28, 4, v30
    v_add_u32 v31, s30, v28
    v_lshlrev_b32 v29, 7, v29
    v_and_b32 v28, 7, v31
    v_lshl_add_u32 v29, v28, 4, v29
    v_lshrrev_b32 v31, 3, v31
    v_lshl_add_u32 v49, v31, 18, v29
    s_mul_i32 s28, s5, 10752
    s_add_u32 s28, s28, 110592
    v_add_u32 v40, s28, v40
    v_add_u32 v41, s28, v41
    v_add_u32 v42, s28, v42
    v_add_u32 v43, s28, v43
    v_add_u32 v44, s28, v44
    s_lshl_b32 s29, s5, 12
    s_add_u32 s29, s29, s22
    s_add_u32 m0, s26, 0
    s_nop 0
    buffer_load_dwordx4 v10, s[8:11], s20 offen offset:0 lds
    buffer_load_dwordx4 v11, s[8:11], s20 offen offset:1024 lds
    buffer_load_dwordx4 v12, s[8:11], s20 offen offset:2048 lds
    buffer_load_dwordx4 v13, s[8:11], s20 offen offset:3072 lds
    s_add_u32 m0, s27, 0
    s_nop 0
    buffer_load_dwordx4 v14, s[12:15], s21 offen offset:0 lds
    buffer_load_dwordx4 v15, s[12:15], s21 offen offset:1024 lds
    buffer_load_dwordx4 v16, s[12:15], s21 offen offset:2048 lds
    buffer_load_dwordx4 v17, s[12:15], s21 offen offset:3072 lds
    s_add_u32 m0, s27, 4096
    s_nop 0
    buffer_load_dwordx4 v18, s[12:15], s21 offen offset:0 lds
    s_add_u32 s20, s20, 128
    s_add_u32 s21, s21, 589824
    s_add_u32 m0, s26, 36864
    s_nop 0
    buffer_load_dwordx4 v10, s[8:11], s20 offen offset:0 lds
    buffer_load_dwordx4 v11, s[8:11], s20 offen offset:1024 lds
    buffer_load_dwordx4 v12, s[8:11], s20 offen offset:2048 lds
    buffer_load_dwordx4 v13, s[8:11], s20 offen offset:3072 lds
    s_add_u32 m0, s27, 36864
    s_nop 0
    buffer_load_dwordx4 v14, s[12:15], s21 offen offset:0 lds
    buffer_load_dwordx4 v15, s[12:15], s21 offen offset:1024 lds
    buffer_load_dwordx4 v16, s[12:15], s21 offen offset:2048 lds
    buffer_load_dwordx4 v17, s[12:15], s21 offen offset:3072 lds
    s_add_u32 m0, s27, 40960
    s_nop 0
    buffer_load_dwordx4 v18, s[12:15], s21 offen offset:0 lds
    s_add_u32 s20, s20, 128
    s_add_u32 s21, s21, 589824
    s_add_u32 m0, s26, 73728
    s_nop 0
    buffer_load_dwordx4 v10, s[8:11], s20 offen offset:0 lds
    buffer_load_dwordx4 v11, s[8:11], s20 offen offset:1024 lds
    buffer_load_dwordx4 v12, s[8:11], s20 offen offset:2048 lds
    buffer_load_dwordx4 v13, s[8:11], s20 offen offset:3072 lds
    s_add_u32 m0, s27, 73728
    s_nop 0
    buffer_load_dwordx4 v14, s[12:15], s21 offen offset:0 lds
    buffer_load_dwordx4 v15, s[12:15], s21 offen offset:1024 lds
    buffer_load_dwordx4 v16, s[12:15], s21 offen offset:2048 lds
    buffer_load_dwordx4 v17, s[12:15], s21 offen offset:3072 lds
    s_add_u32 m0, s27, 77824
    s_nop 0
    buffer_load_dwordx4 v18, s[12:15], s21 offen offset:0 lds
    s_add_u32 s20, s20, 128
    s_add_u32 s21, s21, 589824
    s_waitcnt vmcnt(18)
    s_barrier
    s_waitcnt vmcnt(9)
    s_barrier
    s_add_u32 m0, s26, 0
    s_nop 0
    buffer_load_dwordx4 v10, s[8:11], s20 offen offset:0 lds
    buffer_load_dwordx4 v11, s[8:11], s20 offen offset:1024 lds
    buffer_load_dwordx4 v12, s[8:11], s20 offen offset:2048 lds
    buffer_load_dwordx4 v13, s[8:11], s20 offen offset:3072 lds
    s_add_u32 m0, s27, 0
    s_nop 0
    buffer_load_dwordx4 v14, s[12:15], s21 offen offset:0 lds
    buffer_load_dwordx4 v15, s[12:15], s21 offen offset:1024 lds
    buffer_load_dwordx4 v16, s[12:15], s21 offen offset:2048 lds
    buffer_load_dwordx4 v17, s[12:15], s21 offen offset:3072 lds
    s_add_u32 m0, s27, 4096
    s_nop 0
    buffer_load_dwordx4 v18, s[12:15], s21 offen offset:0 lds
    s_add_u32 s20, s20, 128
    s_add_u32 s21, s21, 589824
    s_waitcnt vmcnt(9)
    s_barrier
    s_add_u32 m0, s26, 36864
    s_nop 0
    buffer_load_dwordx4 v10, s[8:11], s20 offen offset:0 lds
    buffer_load_dwordx4 v11, s[8:11], s20 offen offset:1024 lds
    buffer_load_dwordx4 v12, s[8:11], s20 offen offset:2048 lds
    buffer_load_dwordx4 v13, s[8:11], s20 offen offset:3072 lds
    s_add_u32 m0, s27, 36864
    s_nop 0
    buffer_load_dwordx4 v14, s[12:15], s21 offen offset:0 lds
    buffer_load_dwordx4 v15, s[12:15], s21 offen offset:1024 lds
    buffer_load_dwordx4 v16, s[12:15], s21 offen offset:2048 lds
    buffer_load_dwordx4 v17, s[12:15], s21 offen offset:3072 lds
    s_add_u32 m0, s27, 40960
    s_nop 0
    buffer_load_dwordx4 v18, s[12:15], s21 offen offset:0 lds
    s_add_u32 s20, s20, 128
    s_add_u32 s21, s21, 589824
    s_waitcnt vmcnt(9)
    s_barrier
    s_add_u32 m0, s26, 73728
    s_nop 0
    buffer_load_dwordx4 v10, s[8:11], s20 offen offset:0 lds
    buffer_load_dwordx4 v11, s[8:11], s20 offen offset:1024 lds
    buffer_load_dwordx4 v12, s[8:11], s20 offen offset:2048 lds
    buffer_load_dwordx4 v13, s[8:11], s20 offen offset:3072 lds
    s_add_u32 m0, s27, 73728
    s_nop 0
    buffer_load_dwordx4 v14, s[12:15], s21 offen offset:0 lds
    buffer_load_dwordx4 v15, s[12:15], s21 offen offset:1024 lds
    buffer_load_dwordx4 v16, s[12:15], s21 offen offset:2048 lds
    buffer_load_dwordx4 v17, s[12:15], s21 offen offset:3072 lds
    s_add_u32 m0, s27, 77824
    s_nop 0
    buffer_load_dwordx4 v18, s[12:15], s21 offen offset:0 lds
    s_add_u32 s20, s20, 128
    s_add_u32 s21, s21, 589824
    s_waitcnt vmcnt(9)
    s_barrier
    s_add_u32 m0, s26, 0
    s_nop 0
    buffer_load_dwordx4 v10, s[8:11], s20 offen offset:0 lds
    buffer_load_dwordx4 v11, s[8:11], s20 offen offset:1024 lds
    buffer_load_dwordx4 v12, s[8:11], s20 offen offset:2048 lds
    buffer_load_dwordx4 v13, s[8:11], s20 offen offset:3072 lds
    s_add_u32 m0, s27, 0
    s_nop 0
    buffer_load_dwordx4 v14, s[12:15], s21 offen offset:0 lds
    buffer_load_dwordx4 v15, s[12:15], s21 offen offset:1024 lds
    buffer_load_dwordx4 v16, s[12:15], s21 offen offset:2048 lds
    buffer_load_dwordx4 v17, s[12:15], s21 offen offset:3072 lds
    s_add_u32 m0, s27, 4096
    s_nop 0
    buffer_load_dwordx4 v18, s[12:15], s21 offen offset:0 lds
    s_add_u32 s20, s20, 128
    s_add_u32 s21, s21, 589824
    s_waitcnt vmcnt(9)
    s_barrier
    s_add_u32 m0, s26, 36864
    s_nop 0
    buffer_load_dwordx4 v10, s[8:11], s20 offen offset:0 lds
    buffer_load_dwordx4 v11, s[8:11], s20 offen offset:1024 lds
    buffer_load_dwordx4 v12, s[8:11], s20 offen offset:2048 lds
    buffer_load_dwordx4 v13, s[8:11], s20 offen offset:3072 lds
    s_add_u32 m0, s27, 36864
    s_nop 0
    buffer_load_dwordx4 v14, s[12:15], s21 offen offset:0 lds
    buffer_load_dwordx4 v15, s[12:15], s21 offen offset:1024 lds
    buffer_load_dwordx4 v16, s[12:15], s21 offen offset:2048 lds
    buffer_load_dwordx4 v17, s[12:15], s21 offen offset:3072 lds
    s_add_u32 m0, s27, 40960
    s_nop 0
    buffer_load_dwordx4 v18, s[12:15], s21 offen offset:0 lds
    s_add_u32 s20, s20, 128
    s_add_u32 s21, s21, 589824
    s_waitcnt vmcnt(9)
    s_barrier
    s_add_u32 m0, s26, 73728
    s_nop 0
    buffer_load_dwordx4 v10, s[8:11], s20 offen offset:0 lds
    buffer_load_dwordx4 v11, s[8:11], s20 offen offset:1024 lds
    buffer_load_dwordx4 v12, s[8:11], s20 offen offset:2048 lds
    buffer_load_dwordx4 v13, s[8:11], s20 offen offset:3072 lds
    s_add_u32 m0, s27, 73728
    s_nop 0
    buffer_load_dwordx4 v14, s[12:15], s21 offen offset:0 lds
    buffer_load_dwordx4 v15, s[12:15], s21 offen offset:1024 lds
    buffer_load_dwordx4 v16, s[12:15], s21 offen offset:2048 lds
    buffer_load_dwordx4 v17, s[12:15], s21 offen offset:3072 lds
    s_add_u32 m0, s27, 77824
    s_nop 0
    buffer_load_dwordx4 v18, s[12:15], s21 offen offset:0 lds
    s_sub_u32 s20, s20, 1024
    s_sub_u32 s21, s21, 4718272
    s_waitcnt vmcnt(9)
    s_barrier
    s_add_u32 m0, s26, 0
    s_nop 0
    buffer_load_dwordx4 v10, s[8:11], s20 offen offset:0 lds
    buffer_load_dwordx4 v11, s[8:11], s20 offen offset:1024 lds
    buffer_load_dwordx4 v12, s[8:11], s20 offen offset:2048 lds
    buffer_load_dwordx4 v13, s[8:11], s20 offen offset:3072 lds
    s_add_u32 m0, s27, 0
    s_nop 0
    buffer_load_dwordx4 v14, s[12:15], s21 offen offset:0 lds
    buffer_load_dwordx4 v15, s[12:15], s21 offen offset:1024 lds
    buffer_load_dwordx4 v16, s[12:15], s21 offen offset:2048 lds
    buffer_load_dwordx4 v17, s[12:15], s21 offen offset:3072 lds
    s_add_u32 m0, s27, 4096
    s_nop 0
    buffer_load_dwordx4 v18, s[12:15], s21 offen offset:0 lds
    s_add_u32 s20, s20, 128
    s_add_u32 s21, s21, 589824
    s_waitcnt vmcnt(9)
    s_barrier
    s_add_u32 m0, s26, 36864
    s_nop 0
    buffer_load_dwordx4 v10, s[8:11], s20 offen offset:0 lds
    buffer_load_dwordx4 v11, s[8:11], s20 offen offset:1024 lds
    buffer_load_dwordx4 v12, s[8:11], s20 offen offset:2048 lds
    buffer_load_dwordx4 v13, s[8:11], s20 offen offset:3072 lds
    s_add_u32 m0, s27, 36864
    s_nop 0
    buffer_load_dwordx4 v14, s[12:15], s21 offen offset:0 lds
    buffer_load_dwordx4 v15, s[12:15], s21 offen offset:1024 lds
    buffer_load_dwordx4 v16, s[12:15], s21 offen offset:2048 lds
    buffer_load_dwordx4 v17, s[12:15], s21 offen offset:3072 lds
    s_add_u32 m0, s27, 40960
    s_nop 0
    buffer_load_dwordx4 v18, s[12:15], s21 offen offset:0 lds
    s_add_u32 s20, s20, 128
    s_add_u32 s21, s21, 589824
    s_waitcnt vmcnt(9)
    s_barrier
    s_add_u32 m0, s26, 73728
    s_nop 0
    buffer_load_dwordx4 v10, s[8:11], s20 offen offset:0 lds
    buffer_load_dwordx4 v11, s[8:11], s20 offen offset:1024 lds
    buffer_load_dwordx4 v12, s[8:11], s20 offen offset:2048 lds
    buffer_load_dwordx4 v13, s[8:11], s20 offen offset:3072 lds
    s_add_u32 m0, s27, 73728
    s_nop 0
    buffer_load_dwordx4 v14, s[12:15], s21 offen offset:0 lds
    buffer_load_dwordx4 v15, s[12:15], s21 offen offset:1024 lds
    buffer_load_dwordx4 v16, s[12:15], s21 offen offset:2048 lds
    buffer_load_dwordx4 v17, s[12:15], s21 offen offset:3072 lds
    s_add_u32 m0, s27, 77824
    s_nop 0
    buffer_load_dwordx4 v18, s[12:15], s21 offen offset:0 lds
    s_add_u32 s20, s20, 128
    s_add_u32 s21, s21, 589824
    s_waitcnt vmcnt(9)
    s_barrier
    s_add_u32 m0, s26, 0
    s_nop 0
    buffer_load_dwordx4 v10, s[8:11], s20 offen offset:0 lds
    buffer_load_dwordx4 v11, s[8:11], s20 offen offset:1024 lds
    buffer_load_dwordx4 v12, s[8:11], s20 offen offset:2048 lds
    buffer_load_dwordx4 v13, s[8:11], s20 offen offset:3072 lds
    s_add_u32 m0, s27, 0
    s_nop 0
    buffer_load_dwordx4 v14, s[12:15], s21 offen offset:0 lds
    buffer_load_dwordx4 v15, s[12:15], s21 offen offset:1024 lds
    buffer_load_dwordx4 v16, s[12:15], s21 offen offset:2048 lds
    buffer_load_dwordx4 v17, s[12:15], s21 offen offset:3072 lds
    s_add_u32 m0, s27, 4096
    s_nop 0
    buffer_load_dwordx4 v18, s[12:15], s21 offen offset:0 lds
    s_add_u32 s20, s20, 128
    s_add_u32 s21, s21, 589824
    s_waitcnt vmcnt(9)
    s_barrier
    s_add_u32 m0, s26, 36864
    s_nop 0
    buffer_load_dwordx4 v10, s[8:11], s20 offen offset:0 lds
    buffer_load_dwordx4 v11, s[8:11], s20 offen offset:1024 lds
    buffer_load_dwordx4 v12, s[8:11], s20 offen offset:2048 lds
    buffer_load_dwordx4 v13, s[8:11], s20 offen offset:3072 lds
    s_add_u32 m0, s27, 36864
    s_nop 0
    buffer_load_dwordx4 v14, s[12:15], s21 offen offset:0 lds
    buffer_load_dwordx4 v15, s[12:15], s21 offen offset:1024 lds
    buffer_load_dwordx4 v16, s[12:15], s21 offen offset:2048 lds
    buffer_load_dwordx4 v17, s[12:15], s21 offen offset:3072 lds
    s_add_u32 m0, s27, 40960
    s_nop 0
    buffer_load_dwordx4 v18, s[12:15], s21 offen offset:0 lds
    s_add_u32 s20, s20, 128
    s_add_u32 s21, s21, 589824
    ds_read_b128 v[52:55], v40 offset:0
    s_waitcnt lgkmcnt(0)
    v_lshlrev_b32 v64, 16, v52
    v_and_b32 v65, 0xffff0000, v52
    v_lshlrev_b32 v66, 16, v53
    v_and_b32 v67, 0xffff0000, v53
    v_lshlrev_b32 v68, 16, v54
    v_and_b32 v69, 0xffff0000, v54
    v_lshlrev_b32 v70, 16, v55
    v_and_b32 v71, 0xffff0000, v55
    v_mul_f32 v72, s25, v64
    v_mul_f32 v73, s25, v65
    v_mul_f32 v74, s25, v66
    v_mul_f32 v75, s25, v67
    v_mul_f32 v76, s25, v68
    v_mul_f32 v77, s25, v69
    v_mul_f32 v78, s25, v70
    v_mul_f32 v79, s25, v71
    v_exp_f32 v72, v72
    v_exp_f32 v73, v73
    v_exp_f32 v74, v74
    v_exp_f32 v75, v75
    v_exp_f32 v76, v76
    v_exp_f32 v77, v77
    v_exp_f32 v78, v78
    v_exp_f32 v79, v79
    v_add_f32 v72, 1.0, v72
    v_add_f32 v73, 1.0, v73
    v_add_f32 v74, 1.0, v74
    v_add_f32 v75, 1.0, v75
    v_add_f32 v76, 1.0, v76
    v_add_f32 v77, 1.0, v77
    v_add_f32 v78, 1.0, v78
    v_add_f32 v79, 1.0, v79
    v_rcp_f32 v72, v72
    v_rcp_f32 v73, v73
    v_rcp_f32 v74, v74
    v_rcp_f32 v75, v75
    v_rcp_f32 v76, v76
    v_rcp_f32 v77, v77
    v_rcp_f32 v78, v78
    v_rcp_f32 v79, v79
    v_mul_f32 v64, v64, v72
    v_mul_f32 v65, v65, v73
    v_mul_f32 v66, v66, v74
    v_mul_f32 v67, v67, v75
    v_mul_f32 v68, v68, v76
    v_mul_f32 v69, v69, v77
    v_mul_f32 v70, v70, v78
    v_mul_f32 v71, v71, v79
    v_cvt_pk_bf16_f32 v52, v64, v65
    v_cvt_pk_bf16_f32 v53, v66, v67
    v_cvt_pk_bf16_f32 v54, v68, v69
    v_cvt_pk_bf16_f32 v55, v70, v71
    buffer_store_dwordx4 v[52:55], v45, s[16:19], s29 offen offset:0 sc1
    ds_read_b128 v[56:59], v41 offset:0
    s_waitcnt lgkmcnt(0)
    v_lshlrev_b32 v64, 16, v56
    v_and_b32 v65, 0xffff0000, v56
    v_lshlrev_b32 v66, 16, v57
    v_and_b32 v67, 0xffff0000, v57
    v_lshlrev_b32 v68, 16, v58
    v_and_b32 v69, 0xffff0000, v58
    v_lshlrev_b32 v70, 16, v59
    v_and_b32 v71, 0xffff0000, v59
    v_mul_f32 v72, s25, v64
    v_mul_f32 v73, s25, v65
    v_mul_f32 v74, s25, v66
    v_mul_f32 v75, s25, v67
    v_mul_f32 v76, s25, v68
    v_mul_f32 v77, s25, v69
    v_mul_f32 v78, s25, v70
    v_mul_f32 v79, s25, v71
    v_exp_f32 v72, v72
    v_exp_f32 v73, v73
    v_exp_f32 v74, v74
    v_exp_f32 v75, v75
    v_exp_f32 v76, v76
    v_exp_f32 v77, v77
    v_exp_f32 v78, v78
    v_exp_f32 v79, v79
    v_add_f32 v72, 1.0, v72
    v_add_f32 v73, 1.0, v73
    v_add_f32 v74, 1.0, v74
    v_add_f32 v75, 1.0, v75
    v_add_f32 v76, 1.0, v76
    v_add_f32 v77, 1.0, v77
    v_add_f32 v78, 1.0, v78
    v_add_f32 v79, 1.0, v79
    v_rcp_f32 v72, v72
    v_rcp_f32 v73, v73
    v_rcp_f32 v74, v74
    v_rcp_f32 v75, v75
    v_rcp_f32 v76, v76
    v_rcp_f32 v77, v77
    v_rcp_f32 v78, v78
    v_rcp_f32 v79, v79
    v_mul_f32 v64, v64, v72
    v_mul_f32 v65, v65, v73
    v_mul_f32 v66, v66, v74
    v_mul_f32 v67, v67, v75
    v_mul_f32 v68, v68, v76
    v_mul_f32 v69, v69, v77
    v_mul_f32 v70, v70, v78
    v_mul_f32 v71, v71, v79
    v_cvt_pk_bf16_f32 v56, v64, v65
    v_cvt_pk_bf16_f32 v57, v66, v67
    v_cvt_pk_bf16_f32 v58, v68, v69
    v_cvt_pk_bf16_f32 v59, v70, v71
    buffer_store_dwordx4 v[56:59], v46, s[16:19], s29 offen offset:0 sc1
    s_waitcnt vmcnt(11)
    s_barrier
    s_add_u32 m0, s26, 73728
    s_nop 0
    buffer_load_dwordx4 v10, s[8:11], s20 offen offset:0 lds
    buffer_load_dwordx4 v11, s[8:11], s20 offen offset:1024 lds
    buffer_load_dwordx4 v12, s[8:11], s20 offen offset:2048 lds
    buffer_load_dwordx4 v13, s[8:11], s20 offen offset:3072 lds
    s_add_u32 m0, s27, 73728
    s_nop 0
    buffer_load_dwordx4 v14, s[12:15], s21 offen offset:0 lds
    buffer_load_dwordx4 v15, s[12:15], s21 offen offset:1024 lds
    buffer_load_dwordx4 v16, s[12:15], s21 offen offset:2048 lds
    buffer_load_dwordx4 v17, s[12:15], s21 offen offset:3072 lds
    s_add_u32 m0, s27, 77824
    s_nop 0
    buffer_load_dwordx4 v18, s[12:15], s21 offen offset:0 lds
    s_add_u32 s20, s20, 128
    s_add_u32 s21, s21, 589824
    ds_read_b128 v[52:55], v42 offset:0
    s_waitcnt lgkmcnt(0)
    v_lshlrev_b32 v64, 16, v52
    v_and_b32 v65, 0xffff0000, v52
    v_lshlrev_b32 v66, 16, v53
    v_and_b32 v67, 0xffff0000, v53
    v_lshlrev_b32 v68, 16, v54
    v_and_b32 v69, 0xffff0000, v54
    v_lshlrev_b32 v70, 16, v55
    v_and_b32 v71, 0xffff0000, v55
    v_mul_f32 v72, s25, v64
    v_mul_f32 v73, s25, v65
    v_mul_f32 v74, s25, v66
    v_mul_f32 v75, s25, v67
    v_mul_f32 v76, s25, v68
    v_mul_f32 v77, s25, v69
    v_mul_f32 v78, s25, v70
    v_mul_f32 v79, s25, v71
    v_exp_f32 v72, v72
    v_exp_f32 v73, v73
    v_exp_f32 v74, v74
    v_exp_f32 v75, v75
    v_exp_f32 v76, v76
    v_exp_f32 v77, v77
    v_exp_f32 v78, v78
    v_exp_f32 v79, v79
    v_add_f32 v72, 1.0, v72
    v_add_f32 v73, 1.0, v73
    v_add_f32 v74, 1.0, v74
    v_add_f32 v75, 1.0, v75
    v_add_f32 v76, 1.0, v76
    v_add_f32 v77, 1.0, v77
    v_add_f32 v78, 1.0, v78
    v_add_f32 v79, 1.0, v79
    v_rcp_f32 v72, v72
    v_rcp_f32 v73, v73
    v_rcp_f32 v74, v74
    v_rcp_f32 v75, v75
    v_rcp_f32 v76, v76
    v_rcp_f32 v77, v77
    v_rcp_f32 v78, v78
    v_rcp_f32 v79, v79
    v_mul_f32 v64, v64, v72
    v_mul_f32 v65, v65, v73
    v_mul_f32 v66, v66, v74
    v_mul_f32 v67, v67, v75
    v_mul_f32 v68, v68, v76
    v_mul_f32 v69, v69, v77
    v_mul_f32 v70, v70, v78
    v_mul_f32 v71, v71, v79
    v_cvt_pk_bf16_f32 v52, v64, v65
    v_cvt_pk_bf16_f32 v53, v66, v67
    v_cvt_pk_bf16_f32 v54, v68, v69
    v_cvt_pk_bf16_f32 v55, v70, v71
    buffer_store_dwordx4 v[52:55], v47, s[16:19], s29 offen offset:0 sc1
    ds_read_b128 v[56:59], v43 offset:0
    s_waitcnt lgkmcnt(0)
    v_lshlrev_b32 v64, 16, v56
    v_and_b32 v65, 0xffff0000, v56
    v_lshlrev_b32 v66, 16, v57
    v_and_b32 v67, 0xffff0000, v57
    v_lshlrev_b32 v68, 16, v58
    v_and_b32 v69, 0xffff0000, v58
    v_lshlrev_b32 v70, 16, v59
    v_and_b32 v71, 0xffff0000, v59
    v_mul_f32 v72, s25, v64
    v_mul_f32 v73, s25, v65
    v_mul_f32 v74, s25, v66
    v_mul_f32 v75, s25, v67
    v_mul_f32 v76, s25, v68
    v_mul_f32 v77, s25, v69
    v_mul_f32 v78, s25, v70
    v_mul_f32 v79, s25, v71
    v_exp_f32 v72, v72
    v_exp_f32 v73, v73
    v_exp_f32 v74, v74
    v_exp_f32 v75, v75
    v_exp_f32 v76, v76
    v_exp_f32 v77, v77
    v_exp_f32 v78, v78
    v_exp_f32 v79, v79
    v_add_f32 v72, 1.0, v72
    v_add_f32 v73, 1.0, v73
    v_add_f32 v74, 1.0, v74
    v_add_f32 v75, 1.0, v75
    v_add_f32 v76, 1.0, v76
    v_add_f32 v77, 1.0, v77
    v_add_f32 v78, 1.0, v78
    v_add_f32 v79, 1.0, v79
    v_rcp_f32 v72, v72
    v_rcp_f32 v73, v73
    v_rcp_f32 v74, v74
    v_rcp_f32 v75, v75
    v_rcp_f32 v76, v76
    v_rcp_f32 v77, v77
    v_rcp_f32 v78, v78
    v_rcp_f32 v79, v79
    v_mul_f32 v64, v64, v72
    v_mul_f32 v65, v65, v73
    v_mul_f32 v66, v66, v74
    v_mul_f32 v67, v67, v75
    v_mul_f32 v68, v68, v76
    v_mul_f32 v69, v69, v77
    v_mul_f32 v70, v70, v78
    v_mul_f32 v71, v71, v79
    v_cvt_pk_bf16_f32 v56, v64, v65
    v_cvt_pk_bf16_f32 v57, v66, v67
    v_cvt_pk_bf16_f32 v58, v68, v69
    v_cvt_pk_bf16_f32 v59, v70, v71
    buffer_store_dwordx4 v[56:59], v48, s[16:19], s29 offen offset:0 sc1
    s_waitcnt vmcnt(13)
    s_barrier
    s_add_u32 m0, s26, 0
    s_nop 0
    buffer_load_dwordx4 v10, s[8:11], s20 offen offset:0 lds
    buffer_load_dwordx4 v11, s[8:11], s20 offen offset:1024 lds
    buffer_load_dwordx4 v12, s[8:11], s20 offen offset:2048 lds
    buffer_load_dwordx4 v13, s[8:11], s20 offen offset:3072 lds
    s_add_u32 m0, s27, 0
    s_nop 0
    buffer_load_dwordx4 v14, s[12:15], s21 offen offset:0 lds
    buffer_load_dwordx4 v15, s[12:15], s21 offen offset:1024 lds
    buffer_load_dwordx4 v16, s[12:15], s21 offen offset:2048 lds
    buffer_load_dwordx4 v17, s[12:15], s21 offen offset:3072 lds
    s_add_u32 m0, s27, 4096
    s_nop 0
    buffer_load_dwordx4 v18, s[12:15], s21 offen offset:0 lds
    s_add_u32 s20, s20, 128
    s_add_u32 s21, s21, 589824
    ds_read_b128 v[52:55], v44 offset:0
    s_waitcnt lgkmcnt(0)
    v_lshlrev_b32 v64, 16, v52
    v_and_b32 v65, 0xffff0000, v52
    v_lshlrev_b32 v66, 16, v53
    v_and_b32 v67, 0xffff0000, v53
    v_lshlrev_b32 v68, 16, v54
    v_and_b32 v69, 0xffff0000, v54
    v_lshlrev_b32 v70, 16, v55
    v_and_b32 v71, 0xffff0000, v55
    v_mul_f32 v72, s25, v64
    v_mul_f32 v73, s25, v65
    v_mul_f32 v74, s25, v66
    v_mul_f32 v75, s25, v67
    v_mul_f32 v76, s25, v68
    v_mul_f32 v77, s25, v69
    v_mul_f32 v78, s25, v70
    v_mul_f32 v79, s25, v71
    v_exp_f32 v72, v72
    v_exp_f32 v73, v73
    v_exp_f32 v74, v74
    v_exp_f32 v75, v75
    v_exp_f32 v76, v76
    v_exp_f32 v77, v77
    v_exp_f32 v78, v78
    v_exp_f32 v79, v79
    v_add_f32 v72, 1.0, v72
    v_add_f32 v73, 1.0, v73
    v_add_f32 v74, 1.0, v74
    v_add_f32 v75, 1.0, v75
    v_add_f32 v76, 1.0, v76
    v_add_f32 v77, 1.0, v77
    v_add_f32 v78, 1.0, v78
    v_add_f32 v79, 1.0, v79
    v_rcp_f32 v72, v72
    v_rcp_f32 v73, v73
    v_rcp_f32 v74, v74
    v_rcp_f32 v75, v75
    v_rcp_f32 v76, v76
    v_rcp_f32 v77, v77
    v_rcp_f32 v78, v78
    v_rcp_f32 v79, v79
    v_mul_f32 v64, v64, v72
    v_mul_f32 v65, v65, v73
    v_mul_f32 v66, v66, v74
    v_mul_f32 v67, v67, v75
    v_mul_f32 v68, v68, v76
    v_mul_f32 v69, v69, v77
    v_mul_f32 v70, v70, v78
    v_mul_f32 v71, v71, v79
    v_cvt_pk_bf16_f32 v52, v64, v65
    v_cvt_pk_bf16_f32 v53, v66, v67
    v_cvt_pk_bf16_f32 v54, v68, v69
    v_cvt_pk_bf16_f32 v55, v70, v71
    buffer_store_dwordx4 v[52:55], v49, s[16:19], s29 offen offset:0 sc1
    ds_read_b128 v[56:59], v40 offset:5376
    s_waitcnt lgkmcnt(0)
    v_lshlrev_b32 v64, 16, v56
    v_and_b32 v65, 0xffff0000, v56
    v_lshlrev_b32 v66, 16, v57
    v_and_b32 v67, 0xffff0000, v57
    v_lshlrev_b32 v68, 16, v58
    v_and_b32 v69, 0xffff0000, v58
    v_lshlrev_b32 v70, 16, v59
    v_and_b32 v71, 0xffff0000, v59
    v_mul_f32 v72, s25, v64
    v_mul_f32 v73, s25, v65
    v_mul_f32 v74, s25, v66
    v_mul_f32 v75, s25, v67
    v_mul_f32 v76, s25, v68
    v_mul_f32 v77, s25, v69
    v_mul_f32 v78, s25, v70
    v_mul_f32 v79, s25, v71
    v_exp_f32 v72, v72
    v_exp_f32 v73, v73
    v_exp_f32 v74, v74
    v_exp_f32 v75, v75
    v_exp_f32 v76, v76
    v_exp_f32 v77, v77
    v_exp_f32 v78, v78
    v_exp_f32 v79, v79
    v_add_f32 v72, 1.0, v72
    v_add_f32 v73, 1.0, v73
    v_add_f32 v74, 1.0, v74
    v_add_f32 v75, 1.0, v75
    v_add_f32 v76, 1.0, v76
    v_add_f32 v77, 1.0, v77
    v_add_f32 v78, 1.0, v78
    v_add_f32 v79, 1.0, v79
    v_rcp_f32 v72, v72
    v_rcp_f32 v73, v73
    v_rcp_f32 v74, v74
    v_rcp_f32 v75, v75
    v_rcp_f32 v76, v76
    v_rcp_f32 v77, v77
    v_rcp_f32 v78, v78
    v_rcp_f32 v79, v79
    v_mul_f32 v64, v64, v72
    v_mul_f32 v65, v65, v73
    v_mul_f32 v66, v66, v74
    v_mul_f32 v67, v67, v75
    v_mul_f32 v68, v68, v76
    v_mul_f32 v69, v69, v77
    v_mul_f32 v70, v70, v78
    v_mul_f32 v71, v71, v79
    v_cvt_pk_bf16_f32 v56, v64, v65
    v_cvt_pk_bf16_f32 v57, v66, v67
    v_cvt_pk_bf16_f32 v58, v68, v69
    v_cvt_pk_bf16_f32 v59, v70, v71
    buffer_store_dwordx4 v[56:59], v45, s[16:19], s29 offen offset:2048 sc1
    s_waitcnt vmcnt(13)
    s_barrier
    s_add_u32 m0, s26, 36864
    s_nop 0
    buffer_load_dwordx4 v10, s[8:11], s20 offen offset:0 lds
    buffer_load_dwordx4 v11, s[8:11], s20 offen offset:1024 lds
    buffer_load_dwordx4 v12, s[8:11], s20 offen offset:2048 lds
    buffer_load_dwordx4 v13, s[8:11], s20 offen offset:3072 lds
    s_add_u32 m0, s27, 36864
    s_nop 0
    buffer_load_dwordx4 v14, s[12:15], s21 offen offset:0 lds
    buffer_load_dwordx4 v15, s[12:15], s21 offen offset:1024 lds
    buffer_load_dwordx4 v16, s[12:15], s21 offen offset:2048 lds
    buffer_load_dwordx4 v17, s[12:15], s21 offen offset:3072 lds
    s_add_u32 m0, s27, 40960
    s_nop 0
    buffer_load_dwordx4 v18, s[12:15], s21 offen offset:0 lds
    s_add_u32 s20, s20, 128
    s_add_u32 s21, s21, 589824
    ds_read_b128 v[52:55], v41 offset:5376
    s_waitcnt lgkmcnt(0)
    v_lshlrev_b32 v64, 16, v52
    v_and_b32 v65, 0xffff0000, v52
    v_lshlrev_b32 v66, 16, v53
    v_and_b32 v67, 0xffff0000, v53
    v_lshlrev_b32 v68, 16, v54
    v_and_b32 v69, 0xffff0000, v54
    v_lshlrev_b32 v70, 16, v55
    v_and_b32 v71, 0xffff0000, v55
    v_mul_f32 v72, s25, v64
    v_mul_f32 v73, s25, v65
    v_mul_f32 v74, s25, v66
    v_mul_f32 v75, s25, v67
    v_mul_f32 v76, s25, v68
    v_mul_f32 v77, s25, v69
    v_mul_f32 v78, s25, v70
    v_mul_f32 v79, s25, v71
    v_exp_f32 v72, v72
    v_exp_f32 v73, v73
    v_exp_f32 v74, v74
    v_exp_f32 v75, v75
    v_exp_f32 v76, v76
    v_exp_f32 v77, v77
    v_exp_f32 v78, v78
    v_exp_f32 v79, v79
    v_add_f32 v72, 1.0, v72
    v_add_f32 v73, 1.0, v73
    v_add_f32 v74, 1.0, v74
    v_add_f32 v75, 1.0, v75
    v_add_f32 v76, 1.0, v76
    v_add_f32 v77, 1.0, v77
    v_add_f32 v78, 1.0, v78
    v_add_f32 v79, 1.0, v79
    v_rcp_f32 v72, v72
    v_rcp_f32 v73, v73
    v_rcp_f32 v74, v74
    v_rcp_f32 v75, v75
    v_rcp_f32 v76, v76
    v_rcp_f32 v77, v77
    v_rcp_f32 v78, v78
    v_rcp_f32 v79, v79
    v_mul_f32 v64, v64, v72
    v_mul_f32 v65, v65, v73
    v_mul_f32 v66, v66, v74
    v_mul_f32 v67, v67, v75
    v_mul_f32 v68, v68, v76
    v_mul_f32 v69, v69, v77
    v_mul_f32 v70, v70, v78
    v_mul_f32 v71, v71, v79
    v_cvt_pk_bf16_f32 v52, v64, v65
    v_cvt_pk_bf16_f32 v53, v66, v67
    v_cvt_pk_bf16_f32 v54, v68, v69
    v_cvt_pk_bf16_f32 v55, v70, v71
    buffer_store_dwordx4 v[52:55], v46, s[16:19], s29 offen offset:2048 sc1
    ds_read_b128 v[56:59], v42 offset:5376
    s_waitcnt lgkmcnt(0)
    v_lshlrev_b32 v64, 16, v56
    v_and_b32 v65, 0xffff0000, v56
    v_lshlrev_b32 v66, 16, v57
    v_and_b32 v67, 0xffff0000, v57
    v_lshlrev_b32 v68, 16, v58
    v_and_b32 v69, 0xffff0000, v58
    v_lshlrev_b32 v70, 16, v59
    v_and_b32 v71, 0xffff0000, v59
    v_mul_f32 v72, s25, v64
    v_mul_f32 v73, s25, v65
    v_mul_f32 v74, s25, v66
    v_mul_f32 v75, s25, v67
    v_mul_f32 v76, s25, v68
    v_mul_f32 v77, s25, v69
    v_mul_f32 v78, s25, v70
    v_mul_f32 v79, s25, v71
    v_exp_f32 v72, v72
    v_exp_f32 v73, v73
    v_exp_f32 v74, v74
    v_exp_f32 v75, v75
    v_exp_f32 v76, v76
    v_exp_f32 v77, v77
    v_exp_f32 v78, v78
    v_exp_f32 v79, v79
    v_add_f32 v72, 1.0, v72
    v_add_f32 v73, 1.0, v73
    v_add_f32 v74, 1.0, v74
    v_add_f32 v75, 1.0, v75
    v_add_f32 v76, 1.0, v76
    v_add_f32 v77, 1.0, v77
    v_add_f32 v78, 1.0, v78
    v_add_f32 v79, 1.0, v79
    v_rcp_f32 v72, v72
    v_rcp_f32 v73, v73
    v_rcp_f32 v74, v74
    v_rcp_f32 v75, v75
    v_rcp_f32 v76, v76
    v_rcp_f32 v77, v77
    v_rcp_f32 v78, v78
    v_rcp_f32 v79, v79
    v_mul_f32 v64, v64, v72
    v_mul_f32 v65, v65, v73
    v_mul_f32 v66, v66, v74
    v_mul_f32 v67, v67, v75
    v_mul_f32 v68, v68, v76
    v_mul_f32 v69, v69, v77
    v_mul_f32 v70, v70, v78
    v_mul_f32 v71, v71, v79
    v_cvt_pk_bf16_f32 v56, v64, v65
    v_cvt_pk_bf16_f32 v57, v66, v67
    v_cvt_pk_bf16_f32 v58, v68, v69
    v_cvt_pk_bf16_f32 v59, v70, v71
    buffer_store_dwordx4 v[56:59], v47, s[16:19], s29 offen offset:2048 sc1
    s_waitcnt vmcnt(13)
    s_barrier
    s_add_u32 m0, s26, 73728
    s_nop 0
    buffer_load_dwordx4 v10, s[8:11], s20 offen offset:0 lds
    buffer_load_dwordx4 v11, s[8:11], s20 offen offset:1024 lds
    buffer_load_dwordx4 v12, s[8:11], s20 offen offset:2048 lds
    buffer_load_dwordx4 v13, s[8:11], s20 offen offset:3072 lds
    s_add_u32 m0, s27, 73728
    s_nop 0
    buffer_load_dwordx4 v14, s[12:15], s21 offen offset:0 lds
    buffer_load_dwordx4 v15, s[12:15], s21 offen offset:1024 lds
    buffer_load_dwordx4 v16, s[12:15], s21 offen offset:2048 lds
    buffer_load_dwordx4 v17, s[12:15], s21 offen offset:3072 lds
    s_add_u32 m0, s27, 77824
    s_nop 0
    buffer_load_dwordx4 v18, s[12:15], s21 offen offset:0 lds
    s_add_u32 s20, s20, 128
    s_add_u32 s21, s21, 589824
    ds_read_b128 v[52:55], v43 offset:5376
    s_waitcnt lgkmcnt(0)
    v_lshlrev_b32 v64, 16, v52
    v_and_b32 v65, 0xffff0000, v52
    v_lshlrev_b32 v66, 16, v53
    v_and_b32 v67, 0xffff0000, v53
    v_lshlrev_b32 v68, 16, v54
    v_and_b32 v69, 0xffff0000, v54
    v_lshlrev_b32 v70, 16, v55
    v_and_b32 v71, 0xffff0000, v55
    v_mul_f32 v72, s25, v64
    v_mul_f32 v73, s25, v65
    v_mul_f32 v74, s25, v66
    v_mul_f32 v75, s25, v67
    v_mul_f32 v76, s25, v68
    v_mul_f32 v77, s25, v69
    v_mul_f32 v78, s25, v70
    v_mul_f32 v79, s25, v71
    v_exp_f32 v72, v72
    v_exp_f32 v73, v73
    v_exp_f32 v74, v74
    v_exp_f32 v75, v75
    v_exp_f32 v76, v76
    v_exp_f32 v77, v77
    v_exp_f32 v78, v78
    v_exp_f32 v79, v79
    v_add_f32 v72, 1.0, v72
    v_add_f32 v73, 1.0, v73
    v_add_f32 v74, 1.0, v74
    v_add_f32 v75, 1.0, v75
    v_add_f32 v76, 1.0, v76
    v_add_f32 v77, 1.0, v77
    v_add_f32 v78, 1.0, v78
    v_add_f32 v79, 1.0, v79
    v_rcp_f32 v72, v72
    v_rcp_f32 v73, v73
    v_rcp_f32 v74, v74
    v_rcp_f32 v75, v75
    v_rcp_f32 v76, v76
    v_rcp_f32 v77, v77
    v_rcp_f32 v78, v78
    v_rcp_f32 v79, v79
    v_mul_f32 v64, v64, v72
    v_mul_f32 v65, v65, v73
    v_mul_f32 v66, v66, v74
    v_mul_f32 v67, v67, v75
    v_mul_f32 v68, v68, v76
    v_mul_f32 v69, v69, v77
    v_mul_f32 v70, v70, v78
    v_mul_f32 v71, v71, v79
    v_cvt_pk_bf16_f32 v52, v64, v65
    v_cvt_pk_bf16_f32 v53, v66, v67
    v_cvt_pk_bf16_f32 v54, v68, v69
    v_cvt_pk_bf16_f32 v55, v70, v71
    buffer_store_dwordx4 v[52:55], v48, s[16:19], s29 offen offset:2048 sc1
    ds_read_b128 v[56:59], v44 offset:5376
    s_waitcnt lgkmcnt(0)
    v_lshlrev_b32 v64, 16, v56
    v_and_b32 v65, 0xffff0000, v56
    v_lshlrev_b32 v66, 16, v57
    v_and_b32 v67, 0xffff0000, v57
    v_lshlrev_b32 v68, 16, v58
    v_and_b32 v69, 0xffff0000, v58
    v_lshlrev_b32 v70, 16, v59
    v_and_b32 v71, 0xffff0000, v59
    v_mul_f32 v72, s25, v64
    v_mul_f32 v73, s25, v65
    v_mul_f32 v74, s25, v66
    v_mul_f32 v75, s25, v67
    v_mul_f32 v76, s25, v68
    v_mul_f32 v77, s25, v69
    v_mul_f32 v78, s25, v70
    v_mul_f32 v79, s25, v71
    v_exp_f32 v72, v72
    v_exp_f32 v73, v73
    v_exp_f32 v74, v74
    v_exp_f32 v75, v75
    v_exp_f32 v76, v76
    v_exp_f32 v77, v77
    v_exp_f32 v78, v78
    v_exp_f32 v79, v79
    v_add_f32 v72, 1.0, v72
    v_add_f32 v73, 1.0, v73
    v_add_f32 v74, 1.0, v74
    v_add_f32 v75, 1.0, v75
    v_add_f32 v76, 1.0, v76
    v_add_f32 v77, 1.0, v77
    v_add_f32 v78, 1.0, v78
    v_add_f32 v79, 1.0, v79
    v_rcp_f32 v72, v72
    v_rcp_f32 v73, v73
    v_rcp_f32 v74, v74
    v_rcp_f32 v75, v75
    v_rcp_f32 v76, v76
    v_rcp_f32 v77, v77
    v_rcp_f32 v78, v78
    v_rcp_f32 v79, v79
    v_mul_f32 v64, v64, v72
    v_mul_f32 v65, v65, v73
    v_mul_f32 v66, v66, v74
    v_mul_f32 v67, v67, v75
    v_mul_f32 v68, v68, v76
    v_mul_f32 v69, v69, v77
    v_mul_f32 v70, v70, v78
    v_mul_f32 v71, v71, v79
    v_cvt_pk_bf16_f32 v56, v64, v65
    v_cvt_pk_bf16_f32 v57, v66, v67
    v_cvt_pk_bf16_f32 v58, v68, v69
    v_cvt_pk_bf16_f32 v59, v70, v71
    buffer_store_dwordx4 v[56:59], v49, s[16:19], s29 offen offset:2048 sc1
    s_waitcnt vmcnt(13)
    s_barrier
    s_waitcnt vmcnt(2)
    s_barrier
    s_barrier
    s_add_u32 s5, s5, 4
ffn1_kernel_store:
    s_barrier
    v_and_b32 v28, 15, v1
    v_lshrrev_b32 v29, 4, v1
    s_lshl_b32 s26, s5, 4
    v_add_u32 v29, s26, v29
    v_mul_u32_u24 v30, 272, v29
    v_lshl_add_u32 v30, v28, 4, v30
    v_add_u32 v31, s30, v28
    v_add_u32 v31, 20, v31
    v_lshlrev_b32 v29, 7, v29
    v_and_b32 v28, 7, v31
    v_lshl_add_u32 v29, v28, 4, v29
    v_lshrrev_b32 v31, 3, v31
    v_lshl_add_u32 v31, v31, 18, v29
    ds_read_b128 v[32:35], v30 offset:0
    ds_read_b128 v[36:39], v30 offset:1088
    ds_read_b128 v[40:43], v30 offset:2176
    ds_read_b128 v[44:47], v30 offset:3264
    s_waitcnt lgkmcnt(3)
    v_lshlrev_b32 v64, 16, v32
    v_and_b32 v65, 0xffff0000, v32
    v_lshlrev_b32 v66, 16, v33
    v_and_b32 v67, 0xffff0000, v33
    v_lshlrev_b32 v68, 16, v34
    v_and_b32 v69, 0xffff0000, v34
    v_lshlrev_b32 v70, 16, v35
    v_and_b32 v71, 0xffff0000, v35
    v_mul_f32 v72, s25, v64
    v_mul_f32 v73, s25, v65
    v_mul_f32 v74, s25, v66
    v_mul_f32 v75, s25, v67
    v_mul_f32 v76, s25, v68
    v_mul_f32 v77, s25, v69
    v_mul_f32 v78, s25, v70
    v_mul_f32 v79, s25, v71
    v_exp_f32 v72, v72
    v_exp_f32 v73, v73
    v_exp_f32 v74, v74
    v_exp_f32 v75, v75
    v_exp_f32 v76, v76
    v_exp_f32 v77, v77
    v_exp_f32 v78, v78
    v_exp_f32 v79, v79
    v_add_f32 v72, 1.0, v72
    v_add_f32 v73, 1.0, v73
    v_add_f32 v74, 1.0, v74
    v_add_f32 v75, 1.0, v75
    v_add_f32 v76, 1.0, v76
    v_add_f32 v77, 1.0, v77
    v_add_f32 v78, 1.0, v78
    v_add_f32 v79, 1.0, v79
    v_rcp_f32 v72, v72
    v_rcp_f32 v73, v73
    v_rcp_f32 v74, v74
    v_rcp_f32 v75, v75
    v_rcp_f32 v76, v76
    v_rcp_f32 v77, v77
    v_rcp_f32 v78, v78
    v_rcp_f32 v79, v79
    v_mul_f32 v64, v64, v72
    v_mul_f32 v65, v65, v73
    v_mul_f32 v66, v66, v74
    v_mul_f32 v67, v67, v75
    v_mul_f32 v68, v68, v76
    v_mul_f32 v69, v69, v77
    v_mul_f32 v70, v70, v78
    v_mul_f32 v71, v71, v79
    v_cvt_pk_bf16_f32 v32, v64, v65
    v_cvt_pk_bf16_f32 v33, v66, v67
    v_cvt_pk_bf16_f32 v34, v68, v69
    v_cvt_pk_bf16_f32 v35, v70, v71
    buffer_store_dwordx4 v[32:35], v31, s[16:19], s22 offen offset:0 sc1
    s_waitcnt lgkmcnt(2)
    v_lshlrev_b32 v64, 16, v36
    v_and_b32 v65, 0xffff0000, v36
    v_lshlrev_b32 v66, 16, v37
    v_and_b32 v67, 0xffff0000, v37
    v_lshlrev_b32 v68, 16, v38
    v_and_b32 v69, 0xffff0000, v38
    v_lshlrev_b32 v70, 16, v39
    v_and_b32 v71, 0xffff0000, v39
    v_mul_f32 v72, s25, v64
    v_mul_f32 v73, s25, v65
    v_mul_f32 v74, s25, v66
    v_mul_f32 v75, s25, v67
    v_mul_f32 v76, s25, v68
    v_mul_f32 v77, s25, v69
    v_mul_f32 v78, s25, v70
    v_mul_f32 v79, s25, v71
    v_exp_f32 v72, v72
    v_exp_f32 v73, v73
    v_exp_f32 v74, v74
    v_exp_f32 v75, v75
    v_exp_f32 v76, v76
    v_exp_f32 v77, v77
    v_exp_f32 v78, v78
    v_exp_f32 v79, v79
    v_add_f32 v72, 1.0, v72
    v_add_f32 v73, 1.0, v73
    v_add_f32 v74, 1.0, v74
    v_add_f32 v75, 1.0, v75
    v_add_f32 v76, 1.0, v76
    v_add_f32 v77, 1.0, v77
    v_add_f32 v78, 1.0, v78
    v_add_f32 v79, 1.0, v79
    v_rcp_f32 v72, v72
    v_rcp_f32 v73, v73
    v_rcp_f32 v74, v74
    v_rcp_f32 v75, v75
    v_rcp_f32 v76, v76
    v_rcp_f32 v77, v77
    v_rcp_f32 v78, v78
    v_rcp_f32 v79, v79
    v_mul_f32 v64, v64, v72
    v_mul_f32 v65, v65, v73
    v_mul_f32 v66, v66, v74
    v_mul_f32 v67, v67, v75
    v_mul_f32 v68, v68, v76
    v_mul_f32 v69, v69, v77
    v_mul_f32 v70, v70, v78
    v_mul_f32 v71, v71, v79
    v_cvt_pk_bf16_f32 v36, v64, v65
    v_cvt_pk_bf16_f32 v37, v66, v67
    v_cvt_pk_bf16_f32 v38, v68, v69
    v_cvt_pk_bf16_f32 v39, v70, v71
    buffer_store_dwordx4 v[36:39], v31, s[16:19], s22 offen offset:512 sc1
    s_waitcnt lgkmcnt(1)
    v_lshlrev_b32 v64, 16, v40
    v_and_b32 v65, 0xffff0000, v40
    v_lshlrev_b32 v66, 16, v41
    v_and_b32 v67, 0xffff0000, v41
    v_lshlrev_b32 v68, 16, v42
    v_and_b32 v69, 0xffff0000, v42
    v_lshlrev_b32 v70, 16, v43
    v_and_b32 v71, 0xffff0000, v43
    v_mul_f32 v72, s25, v64
    v_mul_f32 v73, s25, v65
    v_mul_f32 v74, s25, v66
    v_mul_f32 v75, s25, v67
    v_mul_f32 v76, s25, v68
    v_mul_f32 v77, s25, v69
    v_mul_f32 v78, s25, v70
    v_mul_f32 v79, s25, v71
    v_exp_f32 v72, v72
    v_exp_f32 v73, v73
    v_exp_f32 v74, v74
    v_exp_f32 v75, v75
    v_exp_f32 v76, v76
    v_exp_f32 v77, v77
    v_exp_f32 v78, v78
    v_exp_f32 v79, v79
    v_add_f32 v72, 1.0, v72
    v_add_f32 v73, 1.0, v73
    v_add_f32 v74, 1.0, v74
    v_add_f32 v75, 1.0, v75
    v_add_f32 v76, 1.0, v76
    v_add_f32 v77, 1.0, v77
    v_add_f32 v78, 1.0, v78
    v_add_f32 v79, 1.0, v79
    v_rcp_f32 v72, v72
    v_rcp_f32 v73, v73
    v_rcp_f32 v74, v74
    v_rcp_f32 v75, v75
    v_rcp_f32 v76, v76
    v_rcp_f32 v77, v77
    v_rcp_f32 v78, v78
    v_rcp_f32 v79, v79
    v_mul_f32 v64, v64, v72
    v_mul_f32 v65, v65, v73
    v_mul_f32 v66, v66, v74
    v_mul_f32 v67, v67, v75
    v_mul_f32 v68, v68, v76
    v_mul_f32 v69, v69, v77
    v_mul_f32 v70, v70, v78
    v_mul_f32 v71, v71, v79
    v_cvt_pk_bf16_f32 v40, v64, v65
    v_cvt_pk_bf16_f32 v41, v66, v67
    v_cvt_pk_bf16_f32 v42, v68, v69
    v_cvt_pk_bf16_f32 v43, v70, v71
    buffer_store_dwordx4 v[40:43], v31, s[16:19], s22 offen offset:1024 sc1
    s_waitcnt lgkmcnt(0)
    v_lshlrev_b32 v64, 16, v44
    v_and_b32 v65, 0xffff0000, v44
    v_lshlrev_b32 v66, 16, v45
    v_and_b32 v67, 0xffff0000, v45
    v_lshlrev_b32 v68, 16, v46
    v_and_b32 v69, 0xffff0000, v46
    v_lshlrev_b32 v70, 16, v47
    v_and_b32 v71, 0xffff0000, v47
    v_mul_f32 v72, s25, v64
    v_mul_f32 v73, s25, v65
    v_mul_f32 v74, s25, v66
    v_mul_f32 v75, s25, v67
    v_mul_f32 v76, s25, v68
    v_mul_f32 v77, s25, v69
    v_mul_f32 v78, s25, v70
    v_mul_f32 v79, s25, v71
    v_exp_f32 v72, v72
    v_exp_f32 v73, v73
    v_exp_f32 v74, v74
    v_exp_f32 v75, v75
    v_exp_f32 v76, v76
    v_exp_f32 v77, v77
    v_exp_f32 v78, v78
    v_exp_f32 v79, v79
    v_add_f32 v72, 1.0, v72
    v_add_f32 v73, 1.0, v73
    v_add_f32 v74, 1.0, v74
    v_add_f32 v75, 1.0, v75
    v_add_f32 v76, 1.0, v76
    v_add_f32 v77, 1.0, v77
    v_add_f32 v78, 1.0, v78
    v_add_f32 v79, 1.0, v79
    v_rcp_f32 v72, v72
    v_rcp_f32 v73, v73
    v_rcp_f32 v74, v74
    v_rcp_f32 v75, v75
    v_rcp_f32 v76, v76
    v_rcp_f32 v77, v77
    v_rcp_f32 v78, v78
    v_rcp_f32 v79, v79
    v_mul_f32 v64, v64, v72
    v_mul_f32 v65, v65, v73
    v_mul_f32 v66, v66, v74
    v_mul_f32 v67, v67, v75
    v_mul_f32 v68, v68, v76
    v_mul_f32 v69, v69, v77
    v_mul_f32 v70, v70, v78
    v_mul_f32 v71, v71, v79
    v_cvt_pk_bf16_f32 v44, v64, v65
    v_cvt_pk_bf16_f32 v45, v66, v67
    v_cvt_pk_bf16_f32 v46, v68, v69
    v_cvt_pk_bf16_f32 v47, v70, v71
    buffer_store_dwordx4 v[44:47], v31, s[16:19], s22 offen offset:1536 sc1
ffn1_kernel_done:
    s_endpgm

.globl ffn2_kernel
.p2align 8
.type ffn2_kernel,@function
ffn2_kernel:
    s_cmp_ge_u32 s2, 256
    s_cbranch_scc1 ffn2_kernel_done
    s_load_dwordx2 s[8:9], s[0:1], 96
    s_load_dwordx2 s[12:13], s[0:1], 56
    s_load_dwordx2 s[16:17], s[0:1], 96
    v_lshrrev_b32 v4, 6, v0
    v_and_b32 v1, 63, v0
    v_readfirstlane_b32 s5, v4
    v_and_b32 v2, 31, v0
    v_lshrrev_b32 v3, 5, v1
    s_and_b32 s6, s2, 7
    s_lshr_b32 s7, s2, 3
    s_and_b32 s3, s6, 1
    s_lshl_b32 s3, s3, 4
    s_and_b32 s24, s7, 15
    s_add_u32 s3, s3, s24
    s_lshr_b32 s4, s7, 4
    s_lshr_b32 s6, s6, 1
    s_mul_i32 s23, s6, 1152
    s_mul_i32 s24, s3, 64
    s_mul_i32 s22, s24, 1152
    s_mul_i32 s25, s6, 2359296
    s_add_u32 s22, s22, s25
    s_mul_i32 s25, s4, 576
    s_add_u32 s22, s22, s25
    s_waitcnt lgkmcnt(0)
    s_add_u32 s8, s8, 0x2000000
    s_addc_u32 s9, s9, 0
    s_and_b32 s9, s9, 0xffff
    s_mov_b32 s10, 0x1200000
    s_mov_b32 s11, 0x00020000
    s_and_b32 s13, s13, 0xffff
    s_mov_b32 s14, 0x510000
    s_mov_b32 s15, 0x00020000
    s_add_u32 s16, s16, 0x5000000
    s_addc_u32 s17, s17, 0
    s_and_b32 s17, s17, 0xffff
    s_mov_b32 s18, 0x900000
    s_mov_b32 s19, 0x00020000
    s_cmp_ge_u32 s5, 4
    s_cbranch_scc1 ffn2_kernel_loader
    s_and_b32 s26, s5, 1
    s_lshr_b32 s27, s5, 1
    s_lshl_b32 s26, s26, 12
    s_lshl_b32 s28, s27, 2
    s_mul_i32 s27, s27, 18432
    v_bfe_u32 v28, v2, 1, 3
    v_lshlrev_b32 v29, 7, v2
    v_add_u32 v29, s26, v29
    v_add_u32 v31, s28, v3
    v_add_u32 v30, 0, v31
    v_xor_b32 v30, v30, v28
    v_lshl_add_u32 v4, v30, 4, v29
    v_add_u32 v30, 2, v31
    v_xor_b32 v30, v30, v28
    v_lshl_add_u32 v5, v30, 4, v29
    v_bfe_u32 v28, v1, 2, 2
    v_lshl_add_u32 v28, v3, 3, v28
    v_mul_u32_u24 v28, 576, v28
    v_bfe_u32 v29, v1, 4, 1
    v_lshl_add_u32 v28, v29, 5, v28
    v_and_b32 v29, 3, v1
    v_lshl_add_u32 v28, v29, 3, v28
    v_add_u32 v8, s27, v28
    s_barrier
    ds_read_b128 v[80:83], v4
    ds_read_b64_tr_b16 v[32:33], v8 offset:8192
    ds_read_b64_tr_b16 v[34:35], v8 offset:10496
    ds_read_b64_tr_b16 v[36:37], v8 offset:8256
    ds_read_b64_tr_b16 v[38:39], v8 offset:10560
    ds_read_b64_tr_b16 v[40:41], v8 offset:8320
    ds_read_b64_tr_b16 v[42:43], v8 offset:10624
    ds_read_b64_tr_b16 v[44:45], v8 offset:8384
    ds_read_b64_tr_b16 v[46:47], v8 offset:10688
    ds_read_b64_tr_b16 v[48:49], v8 offset:8448
    ds_read_b64_tr_b16 v[50:51], v8 offset:10752
    ds_read_b64_tr_b16 v[52:53], v8 offset:8512
    ds_read_b64_tr_b16 v[54:55], v8 offset:10816
    ds_read_b64_tr_b16 v[56:57], v8 offset:8576
    ds_read_b64_tr_b16 v[58:59], v8 offset:10880
    ds_read_b64_tr_b16 v[60:61], v8 offset:8640
    ds_read_b64_tr_b16 v[62:63], v8 offset:10944
    s_waitcnt lgkmcnt(14)
    v_mfma_f32_32x32x16_bf16 v[100:115], v[32:35], v[80:83], 0
    ds_read_b128 v[84:87], v5
    ds_read_b64_tr_b16 v[64:65], v8 offset:8704
    ds_read_b64_tr_b16 v[66:67], v8 offset:11008
    s_waitcnt lgkmcnt(15)
    v_mfma_f32_32x32x16_bf16 v[116:131], v[36:39], v[80:83], 0
    ds_read_b64_tr_b16 v[68:69], v8 offset:17408
    ds_read_b64_tr_b16 v[70:71], v8 offset:19712
    s_waitcnt lgkmcnt(15)
    v_mfma_f32_32x32x16_bf16 v[132:147], v[40:43], v[80:83], 0
    ds_read_b64_tr_b16 v[32:33], v8 offset:17472
    ds_read_b64_tr_b16 v[34:35], v8 offset:19776
    s_waitcnt lgkmcnt(15)
    v_mfma_f32_32x32x16_bf16 v[148:163], v[44:47], v[80:83], 0
    ds_read_b64_tr_b16 v[36:37], v8 offset:17536
    ds_read_b64_tr_b16 v[38:39], v8 offset:19840
    s_waitcnt lgkmcnt(15)
    v_mfma_f32_32x32x16_bf16 v[164:179], v[48:51], v[80:83], 0
    ds_read_b64_tr_b16 v[40:41], v8 offset:17600
    ds_read_b64_tr_b16 v[42:43], v8 offset:19904
    s_waitcnt lgkmcnt(15)
    v_mfma_f32_32x32x16_bf16 v[180:195], v[52:55], v[80:83], 0
    ds_read_b64_tr_b16 v[44:45], v8 offset:17664
    ds_read_b64_tr_b16 v[46:47], v8 offset:19968
    s_waitcnt lgkmcnt(15)
    v_mfma_f32_32x32x16_bf16 v[196:211], v[56:59], v[80:83], 0
    ds_read_b64_tr_b16 v[48:49], v8 offset:17728
    ds_read_b64_tr_b16 v[50:51], v8 offset:20032
    s_waitcnt lgkmcnt(15)
    v_mfma_f32_32x32x16_bf16 v[212:227], v[60:63], v[80:83], 0
    ds_read_b64_tr_b16 v[52:53], v8 offset:17792
    ds_read_b64_tr_b16 v[54:55], v8 offset:20096
    s_waitcnt lgkmcnt(14)
    v_mfma_f32_32x32x16_bf16 v[228:243], v[64:67], v[80:83], 0
    ds_read_b64_tr_b16 v[56:57], v8 offset:17856
    ds_read_b64_tr_b16 v[58:59], v8 offset:20160
    s_waitcnt lgkmcnt(14)
    v_mfma_f32_32x32x16_bf16 v[100:115], v[68:71], v[84:87], v[100:115]
    ds_read_b64_tr_b16 v[60:61], v8 offset:17920
    ds_read_b64_tr_b16 v[62:63], v8 offset:20224
    s_waitcnt lgkmcnt(14)
    v_mfma_f32_32x32x16_bf16 v[116:131], v[32:35], v[84:87], v[116:131]
    s_waitcnt lgkmcnt(12)
    v_mfma_f32_32x32x16_bf16 v[132:147], v[36:39], v[84:87], v[132:147]
    s_waitcnt lgkmcnt(10)
    v_mfma_f32_32x32x16_bf16 v[148:163], v[40:43], v[84:87], v[148:163]
    s_waitcnt lgkmcnt(0)
    s_barrier
    v_add_u32 v4, 45056, v4
    v_add_u32 v5, 45056, v5
    v_add_u32 v8, 45056, v8
    ds_read_b128 v[88:91], v4
    ds_read_b64_tr_b16 v[64:65], v8 offset:8192
    ds_read_b64_tr_b16 v[66:67], v8 offset:10496
    ds_read_b64_tr_b16 v[68:69], v8 offset:8256
    ds_read_b64_tr_b16 v[70:71], v8 offset:10560
    ds_read_b64_tr_b16 v[32:33], v8 offset:8320
    ds_read_b64_tr_b16 v[34:35], v8 offset:10624
    s_waitcnt lgkmcnt(15)
    v_mfma_f32_32x32x16_bf16 v[164:179], v[44:47], v[84:87], v[164:179]
    ds_read_b64_tr_b16 v[36:37], v8 offset:8384
    ds_read_b64_tr_b16 v[38:39], v8 offset:10688
    s_waitcnt lgkmcnt(15)
    v_mfma_f32_32x32x16_bf16 v[180:195], v[48:51], v[84:87], v[180:195]
    ds_read_b64_tr_b16 v[40:41], v8 offset:8448
    ds_read_b64_tr_b16 v[42:43], v8 offset:10752
    s_waitcnt lgkmcnt(15)
    v_mfma_f32_32x32x16_bf16 v[196:211], v[52:55], v[84:87], v[196:211]
    ds_read_b64_tr_b16 v[44:45], v8 offset:8512
    ds_read_b64_tr_b16 v[46:47], v8 offset:10816
    s_waitcnt lgkmcnt(15)
    v_mfma_f32_32x32x16_bf16 v[212:227], v[56:59], v[84:87], v[212:227]
    ds_read_b64_tr_b16 v[48:49], v8 offset:8576
    ds_read_b64_tr_b16 v[50:51], v8 offset:10880
    s_waitcnt lgkmcnt(15)
    v_mfma_f32_32x32x16_bf16 v[228:243], v[60:63], v[84:87], v[228:243]
    ds_read_b64_tr_b16 v[52:53], v8 offset:8640
    ds_read_b64_tr_b16 v[54:55], v8 offset:10944
    s_waitcnt lgkmcnt(14)
    v_mfma_f32_32x32x16_bf16 v[100:115], v[64:67], v[88:91], v[100:115]
    ds_read_b128 v[92:95], v5
    ds_read_b64_tr_b16 v[56:57], v8 offset:8704
    ds_read_b64_tr_b16 v[58:59], v8 offset:11008
    s_waitcnt lgkmcnt(15)
    v_mfma_f32_32x32x16_bf16 v[116:131], v[68:71], v[88:91], v[116:131]
    ds_read_b64_tr_b16 v[60:61], v8 offset:17408
    ds_read_b64_tr_b16 v[62:63], v8 offset:19712
    s_waitcnt lgkmcnt(15)
    v_mfma_f32_32x32x16_bf16 v[132:147], v[32:35], v[88:91], v[132:147]
    ds_read_b64_tr_b16 v[64:65], v8 offset:17472
    ds_read_b64_tr_b16 v[66:67], v8 offset:19776
    s_waitcnt lgkmcnt(15)
    v_mfma_f32_32x32x16_bf16 v[148:163], v[36:39], v[88:91], v[148:163]
    ds_read_b64_tr_b16 v[68:69], v8 offset:17536
    ds_read_b64_tr_b16 v[70:71], v8 offset:19840
    s_waitcnt lgkmcnt(15)
    v_mfma_f32_32x32x16_bf16 v[164:179], v[40:43], v[88:91], v[164:179]
    ds_read_b64_tr_b16 v[32:33], v8 offset:17600
    ds_read_b64_tr_b16 v[34:35], v8 offset:19904
    s_waitcnt lgkmcnt(15)
    v_mfma_f32_32x32x16_bf16 v[180:195], v[44:47], v[88:91], v[180:195]
    ds_read_b64_tr_b16 v[36:37], v8 offset:17664
    ds_read_b64_tr_b16 v[38:39], v8 offset:19968
    s_waitcnt lgkmcnt(15)
    v_mfma_f32_32x32x16_bf16 v[196:211], v[48:51], v[88:91], v[196:211]
    ds_read_b64_tr_b16 v[40:41], v8 offset:17728
    ds_read_b64_tr_b16 v[42:43], v8 offset:20032
    s_waitcnt lgkmcnt(15)
    v_mfma_f32_32x32x16_bf16 v[212:227], v[52:55], v[88:91], v[212:227]
    ds_read_b64_tr_b16 v[44:45], v8 offset:17792
    ds_read_b64_tr_b16 v[46:47], v8 offset:20096
    s_waitcnt lgkmcnt(14)
    v_mfma_f32_32x32x16_bf16 v[228:243], v[56:59], v[88:91], v[228:243]
    ds_read_b64_tr_b16 v[48:49], v8 offset:17856
    ds_read_b64_tr_b16 v[50:51], v8 offset:20160
    s_waitcnt lgkmcnt(14)
    v_mfma_f32_32x32x16_bf16 v[100:115], v[60:63], v[92:95], v[100:115]
    ds_read_b64_tr_b16 v[52:53], v8 offset:17920
    ds_read_b64_tr_b16 v[54:55], v8 offset:20224
    s_waitcnt lgkmcnt(14)
    v_mfma_f32_32x32x16_bf16 v[116:131], v[64:67], v[92:95], v[116:131]
    s_waitcnt lgkmcnt(12)
    v_mfma_f32_32x32x16_bf16 v[132:147], v[68:71], v[92:95], v[132:147]
    s_waitcnt lgkmcnt(10)
    v_mfma_f32_32x32x16_bf16 v[148:163], v[32:35], v[92:95], v[148:163]
    s_waitcnt lgkmcnt(0)
    s_barrier
    v_add_u32 v4, 45056, v4
    v_add_u32 v5, 45056, v5
    v_add_u32 v8, 45056, v8
    ds_read_b128 v[80:83], v4
    ds_read_b64_tr_b16 v[56:57], v8 offset:8192
    ds_read_b64_tr_b16 v[58:59], v8 offset:10496
    ds_read_b64_tr_b16 v[60:61], v8 offset:8256
    ds_read_b64_tr_b16 v[62:63], v8 offset:10560
    ds_read_b64_tr_b16 v[64:65], v8 offset:8320
    ds_read_b64_tr_b16 v[66:67], v8 offset:10624
    s_waitcnt lgkmcnt(15)
    v_mfma_f32_32x32x16_bf16 v[164:179], v[36:39], v[92:95], v[164:179]
    ds_read_b64_tr_b16 v[68:69], v8 offset:8384
    ds_read_b64_tr_b16 v[70:71], v8 offset:10688
    s_waitcnt lgkmcnt(15)
    v_mfma_f32_32x32x16_bf16 v[180:195], v[40:43], v[92:95], v[180:195]
    ds_read_b64_tr_b16 v[32:33], v8 offset:8448
    ds_read_b64_tr_b16 v[34:35], v8 offset:10752
    s_waitcnt lgkmcnt(15)
    v_mfma_f32_32x32x16_bf16 v[196:211], v[44:47], v[92:95], v[196:211]
    ds_read_b64_tr_b16 v[36:37], v8 offset:8512
    ds_read_b64_tr_b16 v[38:39], v8 offset:10816
    s_waitcnt lgkmcnt(15)
    v_mfma_f32_32x32x16_bf16 v[212:227], v[48:51], v[92:95], v[212:227]
    ds_read_b64_tr_b16 v[40:41], v8 offset:8576
    ds_read_b64_tr_b16 v[42:43], v8 offset:10880
    s_waitcnt lgkmcnt(15)
    v_mfma_f32_32x32x16_bf16 v[228:243], v[52:55], v[92:95], v[228:243]
    ds_read_b64_tr_b16 v[44:45], v8 offset:8640
    ds_read_b64_tr_b16 v[46:47], v8 offset:10944
    s_waitcnt lgkmcnt(14)
    v_mfma_f32_32x32x16_bf16 v[100:115], v[56:59], v[80:83], v[100:115]
    ds_read_b128 v[84:87], v5
    ds_read_b64_tr_b16 v[48:49], v8 offset:8704
    ds_read_b64_tr_b16 v[50:51], v8 offset:11008
    s_waitcnt lgkmcnt(15)
    v_mfma_f32_32x32x16_bf16 v[116:131], v[60:63], v[80:83], v[116:131]
    ds_read_b64_tr_b16 v[52:53], v8 offset:17408
    ds_read_b64_tr_b16 v[54:55], v8 offset:19712
    s_waitcnt lgkmcnt(15)
    v_mfma_f32_32x32x16_bf16 v[132:147], v[64:67], v[80:83], v[132:147]
    ds_read_b64_tr_b16 v[56:57], v8 offset:17472
    ds_read_b64_tr_b16 v[58:59], v8 offset:19776
    s_waitcnt lgkmcnt(15)
    v_mfma_f32_32x32x16_bf16 v[148:163], v[68:71], v[80:83], v[148:163]
    ds_read_b64_tr_b16 v[60:61], v8 offset:17536
    ds_read_b64_tr_b16 v[62:63], v8 offset:19840
    s_waitcnt lgkmcnt(15)
    v_mfma_f32_32x32x16_bf16 v[164:179], v[32:35], v[80:83], v[164:179]
    ds_read_b64_tr_b16 v[64:65], v8 offset:17600
    ds_read_b64_tr_b16 v[66:67], v8 offset:19904
    s_waitcnt lgkmcnt(15)
    v_mfma_f32_32x32x16_bf16 v[180:195], v[36:39], v[80:83], v[180:195]
    ds_read_b64_tr_b16 v[68:69], v8 offset:17664
    ds_read_b64_tr_b16 v[70:71], v8 offset:19968
    s_waitcnt lgkmcnt(15)
    v_mfma_f32_32x32x16_bf16 v[196:211], v[40:43], v[80:83], v[196:211]
    ds_read_b64_tr_b16 v[32:33], v8 offset:17728
    ds_read_b64_tr_b16 v[34:35], v8 offset:20032
    s_waitcnt lgkmcnt(15)
    v_mfma_f32_32x32x16_bf16 v[212:227], v[44:47], v[80:83], v[212:227]
    ds_read_b64_tr_b16 v[36:37], v8 offset:17792
    ds_read_b64_tr_b16 v[38:39], v8 offset:20096
    s_waitcnt lgkmcnt(14)
    v_mfma_f32_32x32x16_bf16 v[228:243], v[48:51], v[80:83], v[228:243]
    ds_read_b64_tr_b16 v[40:41], v8 offset:17856
    ds_read_b64_tr_b16 v[42:43], v8 offset:20160
    s_waitcnt lgkmcnt(14)
    v_mfma_f32_32x32x16_bf16 v[100:115], v[52:55], v[84:87], v[100:115]
    ds_read_b64_tr_b16 v[44:45], v8 offset:17920
    ds_read_b64_tr_b16 v[46:47], v8 offset:20224
    s_waitcnt lgkmcnt(14)
    v_mfma_f32_32x32x16_bf16 v[116:131], v[56:59], v[84:87], v[116:131]
    s_waitcnt lgkmcnt(12)
    v_mfma_f32_32x32x16_bf16 v[132:147], v[60:63], v[84:87], v[132:147]
    s_waitcnt lgkmcnt(10)
    v_mfma_f32_32x32x16_bf16 v[148:163], v[64:67], v[84:87], v[148:163]
    s_waitcnt lgkmcnt(0)
    s_barrier
    v_subrev_u32 v4, 90112, v4
    v_subrev_u32 v5, 90112, v5
    v_subrev_u32 v8, 90112, v8
    ds_read_b128 v[88:91], v4
    ds_read_b64_tr_b16 v[48:49], v8 offset:8192
    ds_read_b64_tr_b16 v[50:51], v8 offset:10496
    ds_read_b64_tr_b16 v[52:53], v8 offset:8256
    ds_read_b64_tr_b16 v[54:55], v8 offset:10560
    ds_read_b64_tr_b16 v[56:57], v8 offset:8320
    ds_read_b64_tr_b16 v[58:59], v8 offset:10624
    s_waitcnt lgkmcnt(15)
    v_mfma_f32_32x32x16_bf16 v[164:179], v[68:71], v[84:87], v[164:179]
    ds_read_b64_tr_b16 v[60:61], v8 offset:8384
    ds_read_b64_tr_b16 v[62:63], v8 offset:10688
    s_waitcnt lgkmcnt(15)
    v_mfma_f32_32x32x16_bf16 v[180:195], v[32:35], v[84:87], v[180:195]
    ds_read_b64_tr_b16 v[64:65], v8 offset:8448
    ds_read_b64_tr_b16 v[66:67], v8 offset:10752
    s_waitcnt lgkmcnt(15)
    v_mfma_f32_32x32x16_bf16 v[196:211], v[36:39], v[84:87], v[196:211]
    ds_read_b64_tr_b16 v[68:69], v8 offset:8512
    ds_read_b64_tr_b16 v[70:71], v8 offset:10816
    s_waitcnt lgkmcnt(15)
    v_mfma_f32_32x32x16_bf16 v[212:227], v[40:43], v[84:87], v[212:227]
    ds_read_b64_tr_b16 v[32:33], v8 offset:8576
    ds_read_b64_tr_b16 v[34:35], v8 offset:10880
    s_waitcnt lgkmcnt(15)
    v_mfma_f32_32x32x16_bf16 v[228:243], v[44:47], v[84:87], v[228:243]
    ds_read_b64_tr_b16 v[36:37], v8 offset:8640
    ds_read_b64_tr_b16 v[38:39], v8 offset:10944
    s_waitcnt lgkmcnt(14)
    v_mfma_f32_32x32x16_bf16 v[100:115], v[48:51], v[88:91], v[100:115]
    ds_read_b128 v[92:95], v5
    ds_read_b64_tr_b16 v[40:41], v8 offset:8704
    ds_read_b64_tr_b16 v[42:43], v8 offset:11008
    s_waitcnt lgkmcnt(15)
    v_mfma_f32_32x32x16_bf16 v[116:131], v[52:55], v[88:91], v[116:131]
    ds_read_b64_tr_b16 v[44:45], v8 offset:17408
    ds_read_b64_tr_b16 v[46:47], v8 offset:19712
    s_waitcnt lgkmcnt(15)
    v_mfma_f32_32x32x16_bf16 v[132:147], v[56:59], v[88:91], v[132:147]
    ds_read_b64_tr_b16 v[48:49], v8 offset:17472
    ds_read_b64_tr_b16 v[50:51], v8 offset:19776
    s_waitcnt lgkmcnt(15)
    v_mfma_f32_32x32x16_bf16 v[148:163], v[60:63], v[88:91], v[148:163]
    ds_read_b64_tr_b16 v[52:53], v8 offset:17536
    ds_read_b64_tr_b16 v[54:55], v8 offset:19840
    s_waitcnt lgkmcnt(15)
    v_mfma_f32_32x32x16_bf16 v[164:179], v[64:67], v[88:91], v[164:179]
    ds_read_b64_tr_b16 v[56:57], v8 offset:17600
    ds_read_b64_tr_b16 v[58:59], v8 offset:19904
    s_waitcnt lgkmcnt(15)
    v_mfma_f32_32x32x16_bf16 v[180:195], v[68:71], v[88:91], v[180:195]
    ds_read_b64_tr_b16 v[60:61], v8 offset:17664
    ds_read_b64_tr_b16 v[62:63], v8 offset:19968
    s_waitcnt lgkmcnt(15)
    v_mfma_f32_32x32x16_bf16 v[196:211], v[32:35], v[88:91], v[196:211]
    ds_read_b64_tr_b16 v[64:65], v8 offset:17728
    ds_read_b64_tr_b16 v[66:67], v8 offset:20032
    s_waitcnt lgkmcnt(15)
    v_mfma_f32_32x32x16_bf16 v[212:227], v[36:39], v[88:91], v[212:227]
    ds_read_b64_tr_b16 v[68:69], v8 offset:17792
    ds_read_b64_tr_b16 v[70:71], v8 offset:20096
    s_waitcnt lgkmcnt(14)
    v_mfma_f32_32x32x16_bf16 v[228:243], v[40:43], v[88:91], v[228:243]
    ds_read_b64_tr_b16 v[32:33], v8 offset:17856
    ds_read_b64_tr_b16 v[34:35], v8 offset:20160
    s_waitcnt lgkmcnt(14)
    v_mfma_f32_32x32x16_bf16 v[100:115], v[44:47], v[92:95], v[100:115]
    ds_read_b64_tr_b16 v[36:37], v8 offset:17920
    ds_read_b64_tr_b16 v[38:39], v8 offset:20224
    s_waitcnt lgkmcnt(14)
    v_mfma_f32_32x32x16_bf16 v[116:131], v[48:51], v[92:95], v[116:131]
    s_waitcnt lgkmcnt(12)
    v_mfma_f32_32x32x16_bf16 v[132:147], v[52:55], v[92:95], v[132:147]
    s_waitcnt lgkmcnt(10)
    v_mfma_f32_32x32x16_bf16 v[148:163], v[56:59], v[92:95], v[148:163]
    s_waitcnt lgkmcnt(0)
    s_barrier
    v_add_u32 v4, 45056, v4
    v_add_u32 v5, 45056, v5
    v_add_u32 v8, 45056, v8
    ds_read_b128 v[80:83], v4
    ds_read_b64_tr_b16 v[40:41], v8 offset:8192
    ds_read_b64_tr_b16 v[42:43], v8 offset:10496
    ds_read_b64_tr_b16 v[44:45], v8 offset:8256
    ds_read_b64_tr_b16 v[46:47], v8 offset:10560
    ds_read_b64_tr_b16 v[48:49], v8 offset:8320
    ds_read_b64_tr_b16 v[50:51], v8 offset:10624
    s_waitcnt lgkmcnt(15)
    v_mfma_f32_32x32x16_bf16 v[164:179], v[60:63], v[92:95], v[164:179]
    ds_read_b64_tr_b16 v[52:53], v8 offset:8384
    ds_read_b64_tr_b16 v[54:55], v8 offset:10688
    s_waitcnt lgkmcnt(15)
    v_mfma_f32_32x32x16_bf16 v[180:195], v[64:67], v[92:95], v[180:195]
    ds_read_b64_tr_b16 v[56:57], v8 offset:8448
    ds_read_b64_tr_b16 v[58:59], v8 offset:10752
    s_waitcnt lgkmcnt(15)
    v_mfma_f32_32x32x16_bf16 v[196:211], v[68:71], v[92:95], v[196:211]
    ds_read_b64_tr_b16 v[60:61], v8 offset:8512
    ds_read_b64_tr_b16 v[62:63], v8 offset:10816
    s_waitcnt lgkmcnt(15)
    v_mfma_f32_32x32x16_bf16 v[212:227], v[32:35], v[92:95], v[212:227]
    ds_read_b64_tr_b16 v[64:65], v8 offset:8576
    ds_read_b64_tr_b16 v[66:67], v8 offset:10880
    s_waitcnt lgkmcnt(15)
    v_mfma_f32_32x32x16_bf16 v[228:243], v[36:39], v[92:95], v[228:243]
    ds_read_b64_tr_b16 v[68:69], v8 offset:8640
    ds_read_b64_tr_b16 v[70:71], v8 offset:10944
    s_waitcnt lgkmcnt(14)
    v_mfma_f32_32x32x16_bf16 v[100:115], v[40:43], v[80:83], v[100:115]
    ds_read_b128 v[84:87], v5
    ds_read_b64_tr_b16 v[32:33], v8 offset:8704
    ds_read_b64_tr_b16 v[34:35], v8 offset:11008
    s_waitcnt lgkmcnt(15)
    v_mfma_f32_32x32x16_bf16 v[116:131], v[44:47], v[80:83], v[116:131]
    ds_read_b64_tr_b16 v[36:37], v8 offset:17408
    ds_read_b64_tr_b16 v[38:39], v8 offset:19712
    s_waitcnt lgkmcnt(15)
    v_mfma_f32_32x32x16_bf16 v[132:147], v[48:51], v[80:83], v[132:147]
    ds_read_b64_tr_b16 v[40:41], v8 offset:17472
    ds_read_b64_tr_b16 v[42:43], v8 offset:19776
    s_waitcnt lgkmcnt(15)
    v_mfma_f32_32x32x16_bf16 v[148:163], v[52:55], v[80:83], v[148:163]
    ds_read_b64_tr_b16 v[44:45], v8 offset:17536
    ds_read_b64_tr_b16 v[46:47], v8 offset:19840
    s_waitcnt lgkmcnt(15)
    v_mfma_f32_32x32x16_bf16 v[164:179], v[56:59], v[80:83], v[164:179]
    ds_read_b64_tr_b16 v[48:49], v8 offset:17600
    ds_read_b64_tr_b16 v[50:51], v8 offset:19904
    s_waitcnt lgkmcnt(15)
    v_mfma_f32_32x32x16_bf16 v[180:195], v[60:63], v[80:83], v[180:195]
    ds_read_b64_tr_b16 v[52:53], v8 offset:17664
    ds_read_b64_tr_b16 v[54:55], v8 offset:19968
    s_waitcnt lgkmcnt(15)
    v_mfma_f32_32x32x16_bf16 v[196:211], v[64:67], v[80:83], v[196:211]
    ds_read_b64_tr_b16 v[56:57], v8 offset:17728
    ds_read_b64_tr_b16 v[58:59], v8 offset:20032
    s_waitcnt lgkmcnt(15)
    v_mfma_f32_32x32x16_bf16 v[212:227], v[68:71], v[80:83], v[212:227]
    ds_read_b64_tr_b16 v[60:61], v8 offset:17792
    ds_read_b64_tr_b16 v[62:63], v8 offset:20096
    s_waitcnt lgkmcnt(14)
    v_mfma_f32_32x32x16_bf16 v[228:243], v[32:35], v[80:83], v[228:243]
    ds_read_b64_tr_b16 v[64:65], v8 offset:17856
    ds_read_b64_tr_b16 v[66:67], v8 offset:20160
    s_waitcnt lgkmcnt(14)
    v_mfma_f32_32x32x16_bf16 v[100:115], v[36:39], v[84:87], v[100:115]
    ds_read_b64_tr_b16 v[68:69], v8 offset:17920
    ds_read_b64_tr_b16 v[70:71], v8 offset:20224
    s_waitcnt lgkmcnt(14)
    v_mfma_f32_32x32x16_bf16 v[116:131], v[40:43], v[84:87], v[116:131]
    s_waitcnt lgkmcnt(12)
    v_mfma_f32_32x32x16_bf16 v[132:147], v[44:47], v[84:87], v[132:147]
    s_waitcnt lgkmcnt(10)
    v_mfma_f32_32x32x16_bf16 v[148:163], v[48:51], v[84:87], v[148:163]
    s_waitcnt lgkmcnt(0)
    s_barrier
    v_add_u32 v4, 45056, v4
    v_add_u32 v5, 45056, v5
    v_add_u32 v8, 45056, v8
    ds_read_b128 v[88:91], v4
    ds_read_b64_tr_b16 v[32:33], v8 offset:8192
    ds_read_b64_tr_b16 v[34:35], v8 offset:10496
    ds_read_b64_tr_b16 v[36:37], v8 offset:8256
    ds_read_b64_tr_b16 v[38:39], v8 offset:10560
    ds_read_b64_tr_b16 v[40:41], v8 offset:8320
    ds_read_b64_tr_b16 v[42:43], v8 offset:10624
    s_waitcnt lgkmcnt(15)
    v_mfma_f32_32x32x16_bf16 v[164:179], v[52:55], v[84:87], v[164:179]
    ds_read_b64_tr_b16 v[44:45], v8 offset:8384
    ds_read_b64_tr_b16 v[46:47], v8 offset:10688
    s_waitcnt lgkmcnt(15)
    v_mfma_f32_32x32x16_bf16 v[180:195], v[56:59], v[84:87], v[180:195]
    ds_read_b64_tr_b16 v[48:49], v8 offset:8448
    ds_read_b64_tr_b16 v[50:51], v8 offset:10752
    s_waitcnt lgkmcnt(15)
    v_mfma_f32_32x32x16_bf16 v[196:211], v[60:63], v[84:87], v[196:211]
    ds_read_b64_tr_b16 v[52:53], v8 offset:8512
    ds_read_b64_tr_b16 v[54:55], v8 offset:10816
    s_waitcnt lgkmcnt(15)
    v_mfma_f32_32x32x16_bf16 v[212:227], v[64:67], v[84:87], v[212:227]
    ds_read_b64_tr_b16 v[56:57], v8 offset:8576
    ds_read_b64_tr_b16 v[58:59], v8 offset:10880
    s_waitcnt lgkmcnt(15)
    v_mfma_f32_32x32x16_bf16 v[228:243], v[68:71], v[84:87], v[228:243]
    ds_read_b64_tr_b16 v[60:61], v8 offset:8640
    ds_read_b64_tr_b16 v[62:63], v8 offset:10944
    s_waitcnt lgkmcnt(14)
    v_mfma_f32_32x32x16_bf16 v[100:115], v[32:35], v[88:91], v[100:115]
    ds_read_b128 v[92:95], v5
    ds_read_b64_tr_b16 v[64:65], v8 offset:8704
    ds_read_b64_tr_b16 v[66:67], v8 offset:11008
    s_waitcnt lgkmcnt(15)
    v_mfma_f32_32x32x16_bf16 v[116:131], v[36:39], v[88:91], v[116:131]
    ds_read_b64_tr_b16 v[68:69], v8 offset:17408
    ds_read_b64_tr_b16 v[70:71], v8 offset:19712
    s_waitcnt lgkmcnt(15)
    v_mfma_f32_32x32x16_bf16 v[132:147], v[40:43], v[88:91], v[132:147]
    ds_read_b64_tr_b16 v[32:33], v8 offset:17472
    ds_read_b64_tr_b16 v[34:35], v8 offset:19776
    s_waitcnt lgkmcnt(15)
    v_mfma_f32_32x32x16_bf16 v[148:163], v[44:47], v[88:91], v[148:163]
    ds_read_b64_tr_b16 v[36:37], v8 offset:17536
    ds_read_b64_tr_b16 v[38:39], v8 offset:19840
    s_waitcnt lgkmcnt(15)
    v_mfma_f32_32x32x16_bf16 v[164:179], v[48:51], v[88:91], v[164:179]
    ds_read_b64_tr_b16 v[40:41], v8 offset:17600
    ds_read_b64_tr_b16 v[42:43], v8 offset:19904
    s_waitcnt lgkmcnt(15)
    v_mfma_f32_32x32x16_bf16 v[180:195], v[52:55], v[88:91], v[180:195]
    ds_read_b64_tr_b16 v[44:45], v8 offset:17664
    ds_read_b64_tr_b16 v[46:47], v8 offset:19968
    s_waitcnt lgkmcnt(15)
    v_mfma_f32_32x32x16_bf16 v[196:211], v[56:59], v[88:91], v[196:211]
    ds_read_b64_tr_b16 v[48:49], v8 offset:17728
    ds_read_b64_tr_b16 v[50:51], v8 offset:20032
    s_waitcnt lgkmcnt(15)
    v_mfma_f32_32x32x16_bf16 v[212:227], v[60:63], v[88:91], v[212:227]
    ds_read_b64_tr_b16 v[52:53], v8 offset:17792
    ds_read_b64_tr_b16 v[54:55], v8 offset:20096
    s_waitcnt lgkmcnt(14)
    v_mfma_f32_32x32x16_bf16 v[228:243], v[64:67], v[88:91], v[228:243]
    ds_read_b64_tr_b16 v[56:57], v8 offset:17856
    ds_read_b64_tr_b16 v[58:59], v8 offset:20160
    s_waitcnt lgkmcnt(14)
    v_mfma_f32_32x32x16_bf16 v[100:115], v[68:71], v[92:95], v[100:115]
    ds_read_b64_tr_b16 v[60:61], v8 offset:17920
    ds_read_b64_tr_b16 v[62:63], v8 offset:20224
    s_waitcnt lgkmcnt(14)
    v_mfma_f32_32x32x16_bf16 v[116:131], v[32:35], v[92:95], v[116:131]
    s_waitcnt lgkmcnt(12)
    v_mfma_f32_32x32x16_bf16 v[132:147], v[36:39], v[92:95], v[132:147]
    s_waitcnt lgkmcnt(10)
    v_mfma_f32_32x32x16_bf16 v[148:163], v[40:43], v[92:95], v[148:163]
    s_waitcnt lgkmcnt(0)
    s_barrier
    v_subrev_u32 v4, 90112, v4
    v_subrev_u32 v5, 90112, v5
    v_subrev_u32 v8, 90112, v8
    ds_read_b128 v[80:83], v4
    ds_read_b64_tr_b16 v[64:65], v8 offset:8192
    ds_read_b64_tr_b16 v[66:67], v8 offset:10496
    ds_read_b64_tr_b16 v[68:69], v8 offset:8256
    ds_read_b64_tr_b16 v[70:71], v8 offset:10560
    ds_read_b64_tr_b16 v[32:33], v8 offset:8320
    ds_read_b64_tr_b16 v[34:35], v8 offset:10624
    s_waitcnt lgkmcnt(15)
    v_mfma_f32_32x32x16_bf16 v[164:179], v[44:47], v[92:95], v[164:179]
    ds_read_b64_tr_b16 v[36:37], v8 offset:8384
    ds_read_b64_tr_b16 v[38:39], v8 offset:10688
    s_waitcnt lgkmcnt(15)
    v_mfma_f32_32x32x16_bf16 v[180:195], v[48:51], v[92:95], v[180:195]
    ds_read_b64_tr_b16 v[40:41], v8 offset:8448
    ds_read_b64_tr_b16 v[42:43], v8 offset:10752
    s_waitcnt lgkmcnt(15)
    v_mfma_f32_32x32x16_bf16 v[196:211], v[52:55], v[92:95], v[196:211]
    ds_read_b64_tr_b16 v[44:45], v8 offset:8512
    ds_read_b64_tr_b16 v[46:47], v8 offset:10816
    s_waitcnt lgkmcnt(15)
    v_mfma_f32_32x32x16_bf16 v[212:227], v[56:59], v[92:95], v[212:227]
    ds_read_b64_tr_b16 v[48:49], v8 offset:8576
    ds_read_b64_tr_b16 v[50:51], v8 offset:10880
    s_waitcnt lgkmcnt(15)
    v_mfma_f32_32x32x16_bf16 v[228:243], v[60:63], v[92:95], v[228:243]
    ds_read_b64_tr_b16 v[52:53], v8 offset:8640
    ds_read_b64_tr_b16 v[54:55], v8 offset:10944
    s_waitcnt lgkmcnt(14)
    v_mfma_f32_32x32x16_bf16 v[100:115], v[64:67], v[80:83], v[100:115]
    ds_read_b128 v[84:87], v5
    ds_read_b64_tr_b16 v[56:57], v8 offset:8704
    ds_read_b64_tr_b16 v[58:59], v8 offset:11008
    s_waitcnt lgkmcnt(15)
    v_mfma_f32_32x32x16_bf16 v[116:131], v[68:71], v[80:83], v[116:131]
    ds_read_b64_tr_b16 v[60:61], v8 offset:17408
    ds_read_b64_tr_b16 v[62:63], v8 offset:19712
    s_waitcnt lgkmcnt(15)
    v_mfma_f32_32x32x16_bf16 v[132:147], v[32:35], v[80:83], v[132:147]
    ds_read_b64_tr_b16 v[64:65], v8 offset:17472
    ds_read_b64_tr_b16 v[66:67], v8 offset:19776
    s_waitcnt lgkmcnt(15)
    v_mfma_f32_32x32x16_bf16 v[148:163], v[36:39], v[80:83], v[148:163]
    ds_read_b64_tr_b16 v[68:69], v8 offset:17536
    ds_read_b64_tr_b16 v[70:71], v8 offset:19840
    s_waitcnt lgkmcnt(15)
    v_mfma_f32_32x32x16_bf16 v[164:179], v[40:43], v[80:83], v[164:179]
    ds_read_b64_tr_b16 v[32:33], v8 offset:17600
    ds_read_b64_tr_b16 v[34:35], v8 offset:19904
    s_waitcnt lgkmcnt(15)
    v_mfma_f32_32x32x16_bf16 v[180:195], v[44:47], v[80:83], v[180:195]
    ds_read_b64_tr_b16 v[36:37], v8 offset:17664
    ds_read_b64_tr_b16 v[38:39], v8 offset:19968
    s_waitcnt lgkmcnt(15)
    v_mfma_f32_32x32x16_bf16 v[196:211], v[48:51], v[80:83], v[196:211]
    ds_read_b64_tr_b16 v[40:41], v8 offset:17728
    ds_read_b64_tr_b16 v[42:43], v8 offset:20032
    s_waitcnt lgkmcnt(15)
    v_mfma_f32_32x32x16_bf16 v[212:227], v[52:55], v[80:83], v[212:227]
    ds_read_b64_tr_b16 v[44:45], v8 offset:17792
    ds_read_b64_tr_b16 v[46:47], v8 offset:20096
    s_waitcnt lgkmcnt(14)
    v_mfma_f32_32x32x16_bf16 v[228:243], v[56:59], v[80:83], v[228:243]
    ds_read_b64_tr_b16 v[48:49], v8 offset:17856
    ds_read_b64_tr_b16 v[50:51], v8 offset:20160
    s_waitcnt lgkmcnt(14)
    v_mfma_f32_32x32x16_bf16 v[100:115], v[60:63], v[84:87], v[100:115]
    ds_read_b64_tr_b16 v[52:53], v8 offset:17920
    ds_read_b64_tr_b16 v[54:55], v8 offset:20224
    s_waitcnt lgkmcnt(14)
    v_mfma_f32_32x32x16_bf16 v[116:131], v[64:67], v[84:87], v[116:131]
    s_waitcnt lgkmcnt(12)
    v_mfma_f32_32x32x16_bf16 v[132:147], v[68:71], v[84:87], v[132:147]
    s_waitcnt lgkmcnt(10)
    v_mfma_f32_32x32x16_bf16 v[148:163], v[32:35], v[84:87], v[148:163]
    s_waitcnt lgkmcnt(0)
    s_barrier
    v_add_u32 v4, 45056, v4
    v_add_u32 v5, 45056, v5
    v_add_u32 v8, 45056, v8
    ds_read_b128 v[88:91], v4
    ds_read_b64_tr_b16 v[56:57], v8 offset:8192
    ds_read_b64_tr_b16 v[58:59], v8 offset:10496
    ds_read_b64_tr_b16 v[60:61], v8 offset:8256
    ds_read_b64_tr_b16 v[62:63], v8 offset:10560
    ds_read_b64_tr_b16 v[64:65], v8 offset:8320
    ds_read_b64_tr_b16 v[66:67], v8 offset:10624
    s_waitcnt lgkmcnt(15)
    v_mfma_f32_32x32x16_bf16 v[164:179], v[36:39], v[84:87], v[164:179]
    ds_read_b64_tr_b16 v[68:69], v8 offset:8384
    ds_read_b64_tr_b16 v[70:71], v8 offset:10688
    s_waitcnt lgkmcnt(15)
    v_mfma_f32_32x32x16_bf16 v[180:195], v[40:43], v[84:87], v[180:195]
    ds_read_b64_tr_b16 v[32:33], v8 offset:8448
    ds_read_b64_tr_b16 v[34:35], v8 offset:10752
    s_waitcnt lgkmcnt(15)
    v_mfma_f32_32x32x16_bf16 v[196:211], v[44:47], v[84:87], v[196:211]
    ds_read_b64_tr_b16 v[36:37], v8 offset:8512
    ds_read_b64_tr_b16 v[38:39], v8 offset:10816
    s_waitcnt lgkmcnt(15)
    v_mfma_f32_32x32x16_bf16 v[212:227], v[48:51], v[84:87], v[212:227]
    ds_read_b64_tr_b16 v[40:41], v8 offset:8576
    ds_read_b64_tr_b16 v[42:43], v8 offset:10880
    s_waitcnt lgkmcnt(15)
    v_mfma_f32_32x32x16_bf16 v[228:243], v[52:55], v[84:87], v[228:243]
    ds_read_b64_tr_b16 v[44:45], v8 offset:8640
    ds_read_b64_tr_b16 v[46:47], v8 offset:10944
    s_waitcnt lgkmcnt(14)
    v_mfma_f32_32x32x16_bf16 v[100:115], v[56:59], v[88:91], v[100:115]
    ds_read_b128 v[92:95], v5
    ds_read_b64_tr_b16 v[48:49], v8 offset:8704
    ds_read_b64_tr_b16 v[50:51], v8 offset:11008
    s_waitcnt lgkmcnt(15)
    v_mfma_f32_32x32x16_bf16 v[116:131], v[60:63], v[88:91], v[116:131]
    ds_read_b64_tr_b16 v[52:53], v8 offset:17408
    ds_read_b64_tr_b16 v[54:55], v8 offset:19712
    s_waitcnt lgkmcnt(15)
    v_mfma_f32_32x32x16_bf16 v[132:147], v[64:67], v[88:91], v[132:147]
    ds_read_b64_tr_b16 v[56:57], v8 offset:17472
    ds_read_b64_tr_b16 v[58:59], v8 offset:19776
    s_waitcnt lgkmcnt(15)
    v_mfma_f32_32x32x16_bf16 v[148:163], v[68:71], v[88:91], v[148:163]
    ds_read_b64_tr_b16 v[60:61], v8 offset:17536
    ds_read_b64_tr_b16 v[62:63], v8 offset:19840
    s_waitcnt lgkmcnt(15)
    v_mfma_f32_32x32x16_bf16 v[164:179], v[32:35], v[88:91], v[164:179]
    ds_read_b64_tr_b16 v[64:65], v8 offset:17600
    ds_read_b64_tr_b16 v[66:67], v8 offset:19904
    s_waitcnt lgkmcnt(15)
    v_mfma_f32_32x32x16_bf16 v[180:195], v[36:39], v[88:91], v[180:195]
    ds_read_b64_tr_b16 v[68:69], v8 offset:17664
    ds_read_b64_tr_b16 v[70:71], v8 offset:19968
    s_waitcnt lgkmcnt(15)
    v_mfma_f32_32x32x16_bf16 v[196:211], v[40:43], v[88:91], v[196:211]
    ds_read_b64_tr_b16 v[32:33], v8 offset:17728
    ds_read_b64_tr_b16 v[34:35], v8 offset:20032
    s_waitcnt lgkmcnt(15)
    v_mfma_f32_32x32x16_bf16 v[212:227], v[44:47], v[88:91], v[212:227]
    ds_read_b64_tr_b16 v[36:37], v8 offset:17792
    ds_read_b64_tr_b16 v[38:39], v8 offset:20096
    s_waitcnt lgkmcnt(14)
    v_mfma_f32_32x32x16_bf16 v[228:243], v[48:51], v[88:91], v[228:243]
    ds_read_b64_tr_b16 v[40:41], v8 offset:17856
    ds_read_b64_tr_b16 v[42:43], v8 offset:20160
    s_waitcnt lgkmcnt(14)
    v_mfma_f32_32x32x16_bf16 v[100:115], v[52:55], v[92:95], v[100:115]
    ds_read_b64_tr_b16 v[44:45], v8 offset:17920
    ds_read_b64_tr_b16 v[46:47], v8 offset:20224
    s_waitcnt lgkmcnt(14)
    v_mfma_f32_32x32x16_bf16 v[116:131], v[56:59], v[92:95], v[116:131]
    s_waitcnt lgkmcnt(12)
    v_mfma_f32_32x32x16_bf16 v[132:147], v[60:63], v[92:95], v[132:147]
    s_waitcnt lgkmcnt(10)
    v_mfma_f32_32x32x16_bf16 v[148:163], v[64:67], v[92:95], v[148:163]
    s_waitcnt lgkmcnt(0)
    s_barrier
    v_add_u32 v4, 45056, v4
    v_add_u32 v5, 45056, v5
    v_add_u32 v8, 45056, v8
    ds_read_b128 v[80:83], v4
    ds_read_b64_tr_b16 v[48:49], v8 offset:8192
    ds_read_b64_tr_b16 v[50:51], v8 offset:10496
    ds_read_b64_tr_b16 v[52:53], v8 offset:8256
    ds_read_b64_tr_b16 v[54:55], v8 offset:10560
    ds_read_b64_tr_b16 v[56:57], v8 offset:8320
    ds_read_b64_tr_b16 v[58:59], v8 offset:10624
    s_waitcnt lgkmcnt(15)
    v_mfma_f32_32x32x16_bf16 v[164:179], v[68:71], v[92:95], v[164:179]
    ds_read_b64_tr_b16 v[60:61], v8 offset:8384
    ds_read_b64_tr_b16 v[62:63], v8 offset:10688
    s_waitcnt lgkmcnt(15)
    v_mfma_f32_32x32x16_bf16 v[180:195], v[32:35], v[92:95], v[180:195]
    ds_read_b64_tr_b16 v[64:65], v8 offset:8448
    ds_read_b64_tr_b16 v[66:67], v8 offset:10752
    s_waitcnt lgkmcnt(15)
    v_mfma_f32_32x32x16_bf16 v[196:211], v[36:39], v[92:95], v[196:211]
    ds_read_b64_tr_b16 v[68:69], v8 offset:8512
    ds_read_b64_tr_b16 v[70:71], v8 offset:10816
    s_waitcnt lgkmcnt(15)
    v_mfma_f32_32x32x16_bf16 v[212:227], v[40:43], v[92:95], v[212:227]
    ds_read_b64_tr_b16 v[32:33], v8 offset:8576
    ds_read_b64_tr_b16 v[34:35], v8 offset:10880
    s_waitcnt lgkmcnt(15)
    v_mfma_f32_32x32x16_bf16 v[228:243], v[44:47], v[92:95], v[228:243]
    ds_read_b64_tr_b16 v[36:37], v8 offset:8640
    ds_read_b64_tr_b16 v[38:39], v8 offset:10944
    s_waitcnt lgkmcnt(14)
    v_mfma_f32_32x32x16_bf16 v[100:115], v[48:51], v[80:83], v[100:115]
    ds_read_b128 v[84:87], v5
    ds_read_b64_tr_b16 v[40:41], v8 offset:8704
    ds_read_b64_tr_b16 v[42:43], v8 offset:11008
    s_waitcnt lgkmcnt(15)
    v_mfma_f32_32x32x16_bf16 v[116:131], v[52:55], v[80:83], v[116:131]
    ds_read_b64_tr_b16 v[44:45], v8 offset:17408
    ds_read_b64_tr_b16 v[46:47], v8 offset:19712
    s_waitcnt lgkmcnt(15)
    v_mfma_f32_32x32x16_bf16 v[132:147], v[56:59], v[80:83], v[132:147]
    ds_read_b64_tr_b16 v[48:49], v8 offset:17472
    ds_read_b64_tr_b16 v[50:51], v8 offset:19776
    s_waitcnt lgkmcnt(15)
    v_mfma_f32_32x32x16_bf16 v[148:163], v[60:63], v[80:83], v[148:163]
    ds_read_b64_tr_b16 v[52:53], v8 offset:17536
    ds_read_b64_tr_b16 v[54:55], v8 offset:19840
    s_waitcnt lgkmcnt(15)
    v_mfma_f32_32x32x16_bf16 v[164:179], v[64:67], v[80:83], v[164:179]
    ds_read_b64_tr_b16 v[56:57], v8 offset:17600
    ds_read_b64_tr_b16 v[58:59], v8 offset:19904
    s_waitcnt lgkmcnt(15)
    v_mfma_f32_32x32x16_bf16 v[180:195], v[68:71], v[80:83], v[180:195]
    ds_read_b64_tr_b16 v[60:61], v8 offset:17664
    ds_read_b64_tr_b16 v[62:63], v8 offset:19968
    s_waitcnt lgkmcnt(15)
    v_mfma_f32_32x32x16_bf16 v[196:211], v[32:35], v[80:83], v[196:211]
    ds_read_b64_tr_b16 v[64:65], v8 offset:17728
    ds_read_b64_tr_b16 v[66:67], v8 offset:20032
    s_waitcnt lgkmcnt(15)
    v_mfma_f32_32x32x16_bf16 v[212:227], v[36:39], v[80:83], v[212:227]
    ds_read_b64_tr_b16 v[68:69], v8 offset:17792
    ds_read_b64_tr_b16 v[70:71], v8 offset:20096
    s_waitcnt lgkmcnt(14)
    v_mfma_f32_32x32x16_bf16 v[228:243], v[40:43], v[80:83], v[228:243]
    ds_read_b64_tr_b16 v[32:33], v8 offset:17856
    ds_read_b64_tr_b16 v[34:35], v8 offset:20160
    s_waitcnt lgkmcnt(14)
    v_mfma_f32_32x32x16_bf16 v[100:115], v[44:47], v[84:87], v[100:115]
    ds_read_b64_tr_b16 v[36:37], v8 offset:17920
    ds_read_b64_tr_b16 v[38:39], v8 offset:20224
    s_waitcnt lgkmcnt(14)
    v_mfma_f32_32x32x16_bf16 v[116:131], v[48:51], v[84:87], v[116:131]
    s_waitcnt lgkmcnt(12)
    v_mfma_f32_32x32x16_bf16 v[132:147], v[52:55], v[84:87], v[132:147]
    s_waitcnt lgkmcnt(10)
    v_mfma_f32_32x32x16_bf16 v[148:163], v[56:59], v[84:87], v[148:163]
    s_waitcnt lgkmcnt(0)
    s_barrier
    v_subrev_u32 v4, 90112, v4
    v_subrev_u32 v5, 90112, v5
    v_subrev_u32 v8, 90112, v8
    ds_read_b128 v[88:91], v4
    ds_read_b64_tr_b16 v[40:41], v8 offset:8192
    ds_read_b64_tr_b16 v[42:43], v8 offset:10496
    ds_read_b64_tr_b16 v[44:45], v8 offset:8256
    ds_read_b64_tr_b16 v[46:47], v8 offset:10560
    ds_read_b64_tr_b16 v[48:49], v8 offset:8320
    ds_read_b64_tr_b16 v[50:51], v8 offset:10624
    s_waitcnt lgkmcnt(15)
    v_mfma_f32_32x32x16_bf16 v[164:179], v[60:63], v[84:87], v[164:179]
    ds_read_b64_tr_b16 v[52:53], v8 offset:8384
    ds_read_b64_tr_b16 v[54:55], v8 offset:10688
    s_waitcnt lgkmcnt(15)
    v_mfma_f32_32x32x16_bf16 v[180:195], v[64:67], v[84:87], v[180:195]
    ds_read_b64_tr_b16 v[56:57], v8 offset:8448
    ds_read_b64_tr_b16 v[58:59], v8 offset:10752
    s_waitcnt lgkmcnt(15)
    v_mfma_f32_32x32x16_bf16 v[196:211], v[68:71], v[84:87], v[196:211]
    ds_read_b64_tr_b16 v[60:61], v8 offset:8512
    ds_read_b64_tr_b16 v[62:63], v8 offset:10816
    s_waitcnt lgkmcnt(15)
    v_mfma_f32_32x32x16_bf16 v[212:227], v[32:35], v[84:87], v[212:227]
    ds_read_b64_tr_b16 v[64:65], v8 offset:8576
    ds_read_b64_tr_b16 v[66:67], v8 offset:10880
    s_waitcnt lgkmcnt(15)
    v_mfma_f32_32x32x16_bf16 v[228:243], v[36:39], v[84:87], v[228:243]
    ds_read_b64_tr_b16 v[68:69], v8 offset:8640
    ds_read_b64_tr_b16 v[70:71], v8 offset:10944
    s_waitcnt lgkmcnt(14)
    v_mfma_f32_32x32x16_bf16 v[100:115], v[40:43], v[88:91], v[100:115]
    ds_read_b128 v[92:95], v5
    ds_read_b64_tr_b16 v[32:33], v8 offset:8704
    ds_read_b64_tr_b16 v[34:35], v8 offset:11008
    s_waitcnt lgkmcnt(15)
    v_mfma_f32_32x32x16_bf16 v[116:131], v[44:47], v[88:91], v[116:131]
    ds_read_b64_tr_b16 v[36:37], v8 offset:17408
    ds_read_b64_tr_b16 v[38:39], v8 offset:19712
    s_waitcnt lgkmcnt(15)
    v_mfma_f32_32x32x16_bf16 v[132:147], v[48:51], v[88:91], v[132:147]
    ds_read_b64_tr_b16 v[40:41], v8 offset:17472
    ds_read_b64_tr_b16 v[42:43], v8 offset:19776
    s_waitcnt lgkmcnt(15)
    v_mfma_f32_32x32x16_bf16 v[148:163], v[52:55], v[88:91], v[148:163]
    ds_read_b64_tr_b16 v[44:45], v8 offset:17536
    ds_read_b64_tr_b16 v[46:47], v8 offset:19840
    s_waitcnt lgkmcnt(15)
    v_mfma_f32_32x32x16_bf16 v[164:179], v[56:59], v[88:91], v[164:179]
    ds_read_b64_tr_b16 v[48:49], v8 offset:17600
    ds_read_b64_tr_b16 v[50:51], v8 offset:19904
    s_waitcnt lgkmcnt(15)
    v_mfma_f32_32x32x16_bf16 v[180:195], v[60:63], v[88:91], v[180:195]
    ds_read_b64_tr_b16 v[52:53], v8 offset:17664
    ds_read_b64_tr_b16 v[54:55], v8 offset:19968
    s_waitcnt lgkmcnt(15)
    v_mfma_f32_32x32x16_bf16 v[196:211], v[64:67], v[88:91], v[196:211]
    ds_read_b64_tr_b16 v[56:57], v8 offset:17728
    ds_read_b64_tr_b16 v[58:59], v8 offset:20032
    s_waitcnt lgkmcnt(15)
    v_mfma_f32_32x32x16_bf16 v[212:227], v[68:71], v[88:91], v[212:227]
    ds_read_b64_tr_b16 v[60:61], v8 offset:17792
    ds_read_b64_tr_b16 v[62:63], v8 offset:20096
    s_waitcnt lgkmcnt(14)
    v_mfma_f32_32x32x16_bf16 v[228:243], v[32:35], v[88:91], v[228:243]
    ds_read_b64_tr_b16 v[64:65], v8 offset:17856
    ds_read_b64_tr_b16 v[66:67], v8 offset:20160
    s_waitcnt lgkmcnt(14)
    v_mfma_f32_32x32x16_bf16 v[100:115], v[36:39], v[92:95], v[100:115]
    ds_read_b64_tr_b16 v[68:69], v8 offset:17920
    ds_read_b64_tr_b16 v[70:71], v8 offset:20224
    s_waitcnt lgkmcnt(14)
    v_mfma_f32_32x32x16_bf16 v[116:131], v[40:43], v[92:95], v[116:131]
    s_waitcnt lgkmcnt(12)
    v_mfma_f32_32x32x16_bf16 v[132:147], v[44:47], v[92:95], v[132:147]
    s_waitcnt lgkmcnt(10)
    v_mfma_f32_32x32x16_bf16 v[148:163], v[48:51], v[92:95], v[148:163]
    s_waitcnt lgkmcnt(0)
    s_barrier
    v_add_u32 v4, 45056, v4
    v_add_u32 v5, 45056, v5
    v_add_u32 v8, 45056, v8
    ds_read_b128 v[80:83], v4
    ds_read_b64_tr_b16 v[32:33], v8 offset:8192
    ds_read_b64_tr_b16 v[34:35], v8 offset:10496
    ds_read_b64_tr_b16 v[36:37], v8 offset:8256
    ds_read_b64_tr_b16 v[38:39], v8 offset:10560
    ds_read_b64_tr_b16 v[40:41], v8 offset:8320
    ds_read_b64_tr_b16 v[42:43], v8 offset:10624
    s_waitcnt lgkmcnt(15)
    v_mfma_f32_32x32x16_bf16 v[164:179], v[52:55], v[92:95], v[164:179]
    ds_read_b64_tr_b16 v[44:45], v8 offset:8384
    ds_read_b64_tr_b16 v[46:47], v8 offset:10688
    s_waitcnt lgkmcnt(15)
    v_mfma_f32_32x32x16_bf16 v[180:195], v[56:59], v[92:95], v[180:195]
    ds_read_b64_tr_b16 v[48:49], v8 offset:8448
    ds_read_b64_tr_b16 v[50:51], v8 offset:10752
    s_waitcnt lgkmcnt(15)
    v_mfma_f32_32x32x16_bf16 v[196:211], v[60:63], v[92:95], v[196:211]
    ds_read_b64_tr_b16 v[52:53], v8 offset:8512
    ds_read_b64_tr_b16 v[54:55], v8 offset:10816
    s_waitcnt lgkmcnt(15)
    v_mfma_f32_32x32x16_bf16 v[212:227], v[64:67], v[92:95], v[212:227]
    ds_read_b64_tr_b16 v[56:57], v8 offset:8576
    ds_read_b64_tr_b16 v[58:59], v8 offset:10880
    s_waitcnt lgkmcnt(15)
    v_mfma_f32_32x32x16_bf16 v[228:243], v[68:71], v[92:95], v[228:243]
    ds_read_b64_tr_b16 v[60:61], v8 offset:8640
    ds_read_b64_tr_b16 v[62:63], v8 offset:10944
    s_waitcnt lgkmcnt(14)
    v_mfma_f32_32x32x16_bf16 v[100:115], v[32:35], v[80:83], v[100:115]
    ds_read_b128 v[84:87], v5
    ds_read_b64_tr_b16 v[64:65], v8 offset:8704
    ds_read_b64_tr_b16 v[66:67], v8 offset:11008
    s_waitcnt lgkmcnt(15)
    v_mfma_f32_32x32x16_bf16 v[116:131], v[36:39], v[80:83], v[116:131]
    ds_read_b64_tr_b16 v[68:69], v8 offset:17408
    ds_read_b64_tr_b16 v[70:71], v8 offset:19712
    s_waitcnt lgkmcnt(15)
    v_mfma_f32_32x32x16_bf16 v[132:147], v[40:43], v[80:83], v[132:147]
    ds_read_b64_tr_b16 v[32:33], v8 offset:17472
    ds_read_b64_tr_b16 v[34:35], v8 offset:19776
    s_waitcnt lgkmcnt(15)
    v_mfma_f32_32x32x16_bf16 v[148:163], v[44:47], v[80:83], v[148:163]
    ds_read_b64_tr_b16 v[36:37], v8 offset:17536
    ds_read_b64_tr_b16 v[38:39], v8 offset:19840
    s_waitcnt lgkmcnt(15)
    v_mfma_f32_32x32x16_bf16 v[164:179], v[48:51], v[80:83], v[164:179]
    ds_read_b64_tr_b16 v[40:41], v8 offset:17600
    ds_read_b64_tr_b16 v[42:43], v8 offset:19904
    s_waitcnt lgkmcnt(15)
    v_mfma_f32_32x32x16_bf16 v[180:195], v[52:55], v[80:83], v[180:195]
    ds_read_b64_tr_b16 v[44:45], v8 offset:17664
    ds_read_b64_tr_b16 v[46:47], v8 offset:19968
    s_waitcnt lgkmcnt(15)
    v_mfma_f32_32x32x16_bf16 v[196:211], v[56:59], v[80:83], v[196:211]
    ds_read_b64_tr_b16 v[48:49], v8 offset:17728
    ds_read_b64_tr_b16 v[50:51], v8 offset:20032
    s_waitcnt lgkmcnt(15)
    v_mfma_f32_32x32x16_bf16 v[212:227], v[60:63], v[80:83], v[212:227]
    ds_read_b64_tr_b16 v[52:53], v8 offset:17792
    ds_read_b64_tr_b16 v[54:55], v8 offset:20096
    s_waitcnt lgkmcnt(14)
    v_mfma_f32_32x32x16_bf16 v[228:243], v[64:67], v[80:83], v[228:243]
    ds_read_b64_tr_b16 v[56:57], v8 offset:17856
    ds_read_b64_tr_b16 v[58:59], v8 offset:20160
    s_waitcnt lgkmcnt(14)
    v_mfma_f32_32x32x16_bf16 v[100:115], v[68:71], v[84:87], v[100:115]
    ds_read_b64_tr_b16 v[60:61], v8 offset:17920
    ds_read_b64_tr_b16 v[62:63], v8 offset:20224
    s_waitcnt lgkmcnt(14)
    v_mfma_f32_32x32x16_bf16 v[116:131], v[32:35], v[84:87], v[116:131]
    s_waitcnt lgkmcnt(12)
    v_mfma_f32_32x32x16_bf16 v[132:147], v[36:39], v[84:87], v[132:147]
    s_waitcnt lgkmcnt(10)
    v_mfma_f32_32x32x16_bf16 v[148:163], v[40:43], v[84:87], v[148:163]
    s_waitcnt lgkmcnt(0)
    s_barrier
    v_add_u32 v4, 45056, v4
    v_add_u32 v5, 45056, v5
    v_add_u32 v8, 45056, v8
    ds_read_b128 v[88:91], v4
    ds_read_b64_tr_b16 v[64:65], v8 offset:8192
    ds_read_b64_tr_b16 v[66:67], v8 offset:10496
    ds_read_b64_tr_b16 v[68:69], v8 offset:8256
    ds_read_b64_tr_b16 v[70:71], v8 offset:10560
    ds_read_b64_tr_b16 v[32:33], v8 offset:8320
    ds_read_b64_tr_b16 v[34:35], v8 offset:10624
    s_waitcnt lgkmcnt(15)
    v_mfma_f32_32x32x16_bf16 v[164:179], v[44:47], v[84:87], v[164:179]
    ds_read_b64_tr_b16 v[36:37], v8 offset:8384
    ds_read_b64_tr_b16 v[38:39], v8 offset:10688
    s_waitcnt lgkmcnt(15)
    v_mfma_f32_32x32x16_bf16 v[180:195], v[48:51], v[84:87], v[180:195]
    ds_read_b64_tr_b16 v[40:41], v8 offset:8448
    ds_read_b64_tr_b16 v[42:43], v8 offset:10752
    s_waitcnt lgkmcnt(15)
    v_mfma_f32_32x32x16_bf16 v[196:211], v[52:55], v[84:87], v[196:211]
    ds_read_b64_tr_b16 v[44:45], v8 offset:8512
    ds_read_b64_tr_b16 v[46:47], v8 offset:10816
    s_waitcnt lgkmcnt(15)
    v_mfma_f32_32x32x16_bf16 v[212:227], v[56:59], v[84:87], v[212:227]
    ds_read_b64_tr_b16 v[48:49], v8 offset:8576
    ds_read_b64_tr_b16 v[50:51], v8 offset:10880
    s_waitcnt lgkmcnt(15)
    v_mfma_f32_32x32x16_bf16 v[228:243], v[60:63], v[84:87], v[228:243]
    ds_read_b64_tr_b16 v[52:53], v8 offset:8640
    ds_read_b64_tr_b16 v[54:55], v8 offset:10944
    s_waitcnt lgkmcnt(14)
    v_mfma_f32_32x32x16_bf16 v[100:115], v[64:67], v[88:91], v[100:115]
    ds_read_b128 v[92:95], v5
    ds_read_b64_tr_b16 v[56:57], v8 offset:8704
    ds_read_b64_tr_b16 v[58:59], v8 offset:11008
    s_waitcnt lgkmcnt(15)
    v_mfma_f32_32x32x16_bf16 v[116:131], v[68:71], v[88:91], v[116:131]
    ds_read_b64_tr_b16 v[60:61], v8 offset:17408
    ds_read_b64_tr_b16 v[62:63], v8 offset:19712
    s_waitcnt lgkmcnt(15)
    v_mfma_f32_32x32x16_bf16 v[132:147], v[32:35], v[88:91], v[132:147]
    ds_read_b64_tr_b16 v[64:65], v8 offset:17472
    ds_read_b64_tr_b16 v[66:67], v8 offset:19776
    s_waitcnt lgkmcnt(15)
    v_mfma_f32_32x32x16_bf16 v[148:163], v[36:39], v[88:91], v[148:163]
    ds_read_b64_tr_b16 v[68:69], v8 offset:17536
    ds_read_b64_tr_b16 v[70:71], v8 offset:19840
    s_waitcnt lgkmcnt(15)
    v_mfma_f32_32x32x16_bf16 v[164:179], v[40:43], v[88:91], v[164:179]
    ds_read_b64_tr_b16 v[32:33], v8 offset:17600
    ds_read_b64_tr_b16 v[34:35], v8 offset:19904
    s_waitcnt lgkmcnt(15)
    v_mfma_f32_32x32x16_bf16 v[180:195], v[44:47], v[88:91], v[180:195]
    ds_read_b64_tr_b16 v[36:37], v8 offset:17664
    ds_read_b64_tr_b16 v[38:39], v8 offset:19968
    s_waitcnt lgkmcnt(15)
    v_mfma_f32_32x32x16_bf16 v[196:211], v[48:51], v[88:91], v[196:211]
    ds_read_b64_tr_b16 v[40:41], v8 offset:17728
    ds_read_b64_tr_b16 v[42:43], v8 offset:20032
    s_waitcnt lgkmcnt(15)
    v_mfma_f32_32x32x16_bf16 v[212:227], v[52:55], v[88:91], v[212:227]
    ds_read_b64_tr_b16 v[44:45], v8 offset:17792
    ds_read_b64_tr_b16 v[46:47], v8 offset:20096
    s_waitcnt lgkmcnt(14)
    v_mfma_f32_32x32x16_bf16 v[228:243], v[56:59], v[88:91], v[228:243]
    ds_read_b64_tr_b16 v[48:49], v8 offset:17856
    ds_read_b64_tr_b16 v[50:51], v8 offset:20160
    s_waitcnt lgkmcnt(14)
    v_mfma_f32_32x32x16_bf16 v[100:115], v[60:63], v[92:95], v[100:115]
    ds_read_b64_tr_b16 v[52:53], v8 offset:17920
    ds_read_b64_tr_b16 v[54:55], v8 offset:20224
    s_waitcnt lgkmcnt(14)
    v_mfma_f32_32x32x16_bf16 v[116:131], v[64:67], v[92:95], v[116:131]
    s_waitcnt lgkmcnt(12)
    v_mfma_f32_32x32x16_bf16 v[132:147], v[68:71], v[92:95], v[132:147]
    s_waitcnt lgkmcnt(10)
    v_mfma_f32_32x32x16_bf16 v[148:163], v[32:35], v[92:95], v[148:163]
    s_waitcnt lgkmcnt(0)
    s_barrier
    v_subrev_u32 v4, 90112, v4
    v_subrev_u32 v5, 90112, v5
    v_subrev_u32 v8, 90112, v8
    ds_read_b128 v[80:83], v4
    ds_read_b64_tr_b16 v[56:57], v8 offset:8192
    ds_read_b64_tr_b16 v[58:59], v8 offset:10496
    ds_read_b64_tr_b16 v[60:61], v8 offset:8256
    ds_read_b64_tr_b16 v[62:63], v8 offset:10560
    ds_read_b64_tr_b16 v[64:65], v8 offset:8320
    ds_read_b64_tr_b16 v[66:67], v8 offset:10624
    s_waitcnt lgkmcnt(15)
    v_mfma_f32_32x32x16_bf16 v[164:179], v[36:39], v[92:95], v[164:179]
    ds_read_b64_tr_b16 v[68:69], v8 offset:8384
    ds_read_b64_tr_b16 v[70:71], v8 offset:10688
    s_waitcnt lgkmcnt(15)
    v_mfma_f32_32x32x16_bf16 v[180:195], v[40:43], v[92:95], v[180:195]
    ds_read_b64_tr_b16 v[32:33], v8 offset:8448
    ds_read_b64_tr_b16 v[34:35], v8 offset:10752
    s_waitcnt lgkmcnt(15)
    v_mfma_f32_32x32x16_bf16 v[196:211], v[44:47], v[92:95], v[196:211]
    ds_read_b64_tr_b16 v[36:37], v8 offset:8512
    ds_read_b64_tr_b16 v[38:39], v8 offset:10816
    s_waitcnt lgkmcnt(15)
    v_mfma_f32_32x32x16_bf16 v[212:227], v[48:51], v[92:95], v[212:227]
    ds_read_b64_tr_b16 v[40:41], v8 offset:8576
    ds_read_b64_tr_b16 v[42:43], v8 offset:10880
    s_waitcnt lgkmcnt(15)
    v_mfma_f32_32x32x16_bf16 v[228:243], v[52:55], v[92:95], v[228:243]
    ds_read_b64_tr_b16 v[44:45], v8 offset:8640
    ds_read_b64_tr_b16 v[46:47], v8 offset:10944
    s_waitcnt lgkmcnt(14)
    v_mfma_f32_32x32x16_bf16 v[100:115], v[56:59], v[80:83], v[100:115]
    ds_read_b128 v[84:87], v5
    ds_read_b64_tr_b16 v[48:49], v8 offset:8704
    ds_read_b64_tr_b16 v[50:51], v8 offset:11008
    s_waitcnt lgkmcnt(15)
    v_mfma_f32_32x32x16_bf16 v[116:131], v[60:63], v[80:83], v[116:131]
    ds_read_b64_tr_b16 v[52:53], v8 offset:17408
    ds_read_b64_tr_b16 v[54:55], v8 offset:19712
    s_waitcnt lgkmcnt(15)
    v_mfma_f32_32x32x16_bf16 v[132:147], v[64:67], v[80:83], v[132:147]
    ds_read_b64_tr_b16 v[56:57], v8 offset:17472
    ds_read_b64_tr_b16 v[58:59], v8 offset:19776
    s_waitcnt lgkmcnt(15)
    v_mfma_f32_32x32x16_bf16 v[148:163], v[68:71], v[80:83], v[148:163]
    ds_read_b64_tr_b16 v[60:61], v8 offset:17536
    ds_read_b64_tr_b16 v[62:63], v8 offset:19840
    s_waitcnt lgkmcnt(15)
    v_mfma_f32_32x32x16_bf16 v[164:179], v[32:35], v[80:83], v[164:179]
    ds_read_b64_tr_b16 v[64:65], v8 offset:17600
    ds_read_b64_tr_b16 v[66:67], v8 offset:19904
    s_waitcnt lgkmcnt(15)
    v_mfma_f32_32x32x16_bf16 v[180:195], v[36:39], v[80:83], v[180:195]
    ds_read_b64_tr_b16 v[68:69], v8 offset:17664
    ds_read_b64_tr_b16 v[70:71], v8 offset:19968
    s_waitcnt lgkmcnt(15)
    v_mfma_f32_32x32x16_bf16 v[196:211], v[40:43], v[80:83], v[196:211]
    ds_read_b64_tr_b16 v[32:33], v8 offset:17728
    ds_read_b64_tr_b16 v[34:35], v8 offset:20032
    s_waitcnt lgkmcnt(15)
    v_mfma_f32_32x32x16_bf16 v[212:227], v[44:47], v[80:83], v[212:227]
    ds_read_b64_tr_b16 v[36:37], v8 offset:17792
    ds_read_b64_tr_b16 v[38:39], v8 offset:20096
    s_waitcnt lgkmcnt(14)
    v_mfma_f32_32x32x16_bf16 v[228:243], v[48:51], v[80:83], v[228:243]
    ds_read_b64_tr_b16 v[40:41], v8 offset:17856
    ds_read_b64_tr_b16 v[42:43], v8 offset:20160
    s_waitcnt lgkmcnt(14)
    v_mfma_f32_32x32x16_bf16 v[100:115], v[52:55], v[84:87], v[100:115]
    ds_read_b64_tr_b16 v[44:45], v8 offset:17920
    ds_read_b64_tr_b16 v[46:47], v8 offset:20224
    s_waitcnt lgkmcnt(14)
    v_mfma_f32_32x32x16_bf16 v[116:131], v[56:59], v[84:87], v[116:131]
    s_waitcnt lgkmcnt(12)
    v_mfma_f32_32x32x16_bf16 v[132:147], v[60:63], v[84:87], v[132:147]
    s_waitcnt lgkmcnt(10)
    v_mfma_f32_32x32x16_bf16 v[148:163], v[64:67], v[84:87], v[148:163]
    s_waitcnt lgkmcnt(0)
    s_barrier
    v_add_u32 v4, 45056, v4
    v_add_u32 v5, 45056, v5
    v_add_u32 v8, 45056, v8
    ds_read_b128 v[88:91], v4
    ds_read_b64_tr_b16 v[48:49], v8 offset:8192
    ds_read_b64_tr_b16 v[50:51], v8 offset:10496
    ds_read_b64_tr_b16 v[52:53], v8 offset:8256
    ds_read_b64_tr_b16 v[54:55], v8 offset:10560
    ds_read_b64_tr_b16 v[56:57], v8 offset:8320
    ds_read_b64_tr_b16 v[58:59], v8 offset:10624
    s_waitcnt lgkmcnt(15)
    v_mfma_f32_32x32x16_bf16 v[164:179], v[68:71], v[84:87], v[164:179]
    ds_read_b64_tr_b16 v[60:61], v8 offset:8384
    ds_read_b64_tr_b16 v[62:63], v8 offset:10688
    s_waitcnt lgkmcnt(15)
    v_mfma_f32_32x32x16_bf16 v[180:195], v[32:35], v[84:87], v[180:195]
    ds_read_b64_tr_b16 v[64:65], v8 offset:8448
    ds_read_b64_tr_b16 v[66:67], v8 offset:10752
    s_waitcnt lgkmcnt(15)
    v_mfma_f32_32x32x16_bf16 v[196:211], v[36:39], v[84:87], v[196:211]
    ds_read_b64_tr_b16 v[68:69], v8 offset:8512
    ds_read_b64_tr_b16 v[70:71], v8 offset:10816
    s_waitcnt lgkmcnt(15)
    v_mfma_f32_32x32x16_bf16 v[212:227], v[40:43], v[84:87], v[212:227]
    ds_read_b64_tr_b16 v[32:33], v8 offset:8576
    ds_read_b64_tr_b16 v[34:35], v8 offset:10880
    s_waitcnt lgkmcnt(15)
    v_mfma_f32_32x32x16_bf16 v[228:243], v[44:47], v[84:87], v[228:243]
    ds_read_b64_tr_b16 v[36:37], v8 offset:8640
    ds_read_b64_tr_b16 v[38:39], v8 offset:10944
    s_waitcnt lgkmcnt(14)
    v_mfma_f32_32x32x16_bf16 v[100:115], v[48:51], v[88:91], v[100:115]
    ds_read_b128 v[92:95], v5
    ds_read_b64_tr_b16 v[40:41], v8 offset:8704
    ds_read_b64_tr_b16 v[42:43], v8 offset:11008
    s_waitcnt lgkmcnt(15)
    v_mfma_f32_32x32x16_bf16 v[116:131], v[52:55], v[88:91], v[116:131]
    ds_read_b64_tr_b16 v[44:45], v8 offset:17408
    ds_read_b64_tr_b16 v[46:47], v8 offset:19712
    s_waitcnt lgkmcnt(15)
    v_mfma_f32_32x32x16_bf16 v[132:147], v[56:59], v[88:91], v[132:147]
    ds_read_b64_tr_b16 v[48:49], v8 offset:17472
    ds_read_b64_tr_b16 v[50:51], v8 offset:19776
    s_waitcnt lgkmcnt(15)
    v_mfma_f32_32x32x16_bf16 v[148:163], v[60:63], v[88:91], v[148:163]
    ds_read_b64_tr_b16 v[52:53], v8 offset:17536
    ds_read_b64_tr_b16 v[54:55], v8 offset:19840
    s_waitcnt lgkmcnt(15)
    v_mfma_f32_32x32x16_bf16 v[164:179], v[64:67], v[88:91], v[164:179]
    ds_read_b64_tr_b16 v[56:57], v8 offset:17600
    ds_read_b64_tr_b16 v[58:59], v8 offset:19904
    s_waitcnt lgkmcnt(15)
    v_mfma_f32_32x32x16_bf16 v[180:195], v[68:71], v[88:91], v[180:195]
    ds_read_b64_tr_b16 v[60:61], v8 offset:17664
    ds_read_b64_tr_b16 v[62:63], v8 offset:19968
    s_waitcnt lgkmcnt(15)
    v_mfma_f32_32x32x16_bf16 v[196:211], v[32:35], v[88:91], v[196:211]
    ds_read_b64_tr_b16 v[64:65], v8 offset:17728
    ds_read_b64_tr_b16 v[66:67], v8 offset:20032
    s_waitcnt lgkmcnt(15)
    v_mfma_f32_32x32x16_bf16 v[212:227], v[36:39], v[88:91], v[212:227]
    ds_read_b64_tr_b16 v[68:69], v8 offset:17792
    ds_read_b64_tr_b16 v[70:71], v8 offset:20096
    s_waitcnt lgkmcnt(14)
    v_mfma_f32_32x32x16_bf16 v[228:243], v[40:43], v[88:91], v[228:243]
    ds_read_b64_tr_b16 v[32:33], v8 offset:17856
    ds_read_b64_tr_b16 v[34:35], v8 offset:20160
    s_waitcnt lgkmcnt(14)
    v_mfma_f32_32x32x16_bf16 v[100:115], v[44:47], v[92:95], v[100:115]
    ds_read_b64_tr_b16 v[36:37], v8 offset:17920
    ds_read_b64_tr_b16 v[38:39], v8 offset:20224
    s_waitcnt lgkmcnt(14)
    v_mfma_f32_32x32x16_bf16 v[116:131], v[48:51], v[92:95], v[116:131]
    s_waitcnt lgkmcnt(12)
    v_mfma_f32_32x32x16_bf16 v[132:147], v[52:55], v[92:95], v[132:147]
    s_waitcnt lgkmcnt(10)
    v_mfma_f32_32x32x16_bf16 v[148:163], v[56:59], v[92:95], v[148:163]
    s_waitcnt lgkmcnt(0)
    s_barrier
    v_add_u32 v4, 45056, v4
    v_add_u32 v5, 45056, v5
    v_add_u32 v8, 45056, v8
    ds_read_b128 v[80:83], v4
    ds_read_b64_tr_b16 v[40:41], v8 offset:8192
    ds_read_b64_tr_b16 v[42:43], v8 offset:10496
    ds_read_b64_tr_b16 v[44:45], v8 offset:8256
    ds_read_b64_tr_b16 v[46:47], v8 offset:10560
    ds_read_b64_tr_b16 v[48:49], v8 offset:8320
    ds_read_b64_tr_b16 v[50:51], v8 offset:10624
    s_waitcnt lgkmcnt(15)
    v_mfma_f32_32x32x16_bf16 v[164:179], v[60:63], v[92:95], v[164:179]
    ds_read_b64_tr_b16 v[52:53], v8 offset:8384
    ds_read_b64_tr_b16 v[54:55], v8 offset:10688
    s_waitcnt lgkmcnt(15)
    v_mfma_f32_32x32x16_bf16 v[180:195], v[64:67], v[92:95], v[180:195]
    ds_read_b64_tr_b16 v[56:57], v8 offset:8448
    ds_read_b64_tr_b16 v[58:59], v8 offset:10752
    s_waitcnt lgkmcnt(15)
    v_mfma_f32_32x32x16_bf16 v[196:211], v[68:71], v[92:95], v[196:211]
    ds_read_b64_tr_b16 v[60:61], v8 offset:8512
    ds_read_b64_tr_b16 v[62:63], v8 offset:10816
    s_waitcnt lgkmcnt(15)
    v_mfma_f32_32x32x16_bf16 v[212:227], v[32:35], v[92:95], v[212:227]
    ds_read_b64_tr_b16 v[64:65], v8 offset:8576
    ds_read_b64_tr_b16 v[66:67], v8 offset:10880
    s_waitcnt lgkmcnt(15)
    v_mfma_f32_32x32x16_bf16 v[228:243], v[36:39], v[92:95], v[228:243]
    ds_read_b64_tr_b16 v[68:69], v8 offset:8640
    ds_read_b64_tr_b16 v[70:71], v8 offset:10944
    s_waitcnt lgkmcnt(14)
    v_mfma_f32_32x32x16_bf16 v[100:115], v[40:43], v[80:83], v[100:115]
    ds_read_b128 v[84:87], v5
    ds_read_b64_tr_b16 v[32:33], v8 offset:8704
    ds_read_b64_tr_b16 v[34:35], v8 offset:11008
    s_waitcnt lgkmcnt(15)
    v_mfma_f32_32x32x16_bf16 v[116:131], v[44:47], v[80:83], v[116:131]
    ds_read_b64_tr_b16 v[36:37], v8 offset:17408
    ds_read_b64_tr_b16 v[38:39], v8 offset:19712
    s_waitcnt lgkmcnt(15)
    v_mfma_f32_32x32x16_bf16 v[132:147], v[48:51], v[80:83], v[132:147]
    ds_read_b64_tr_b16 v[40:41], v8 offset:17472
    ds_read_b64_tr_b16 v[42:43], v8 offset:19776
    s_waitcnt lgkmcnt(15)
    v_mfma_f32_32x32x16_bf16 v[148:163], v[52:55], v[80:83], v[148:163]
    ds_read_b64_tr_b16 v[44:45], v8 offset:17536
    ds_read_b64_tr_b16 v[46:47], v8 offset:19840
    s_waitcnt lgkmcnt(15)
    v_mfma_f32_32x32x16_bf16 v[164:179], v[56:59], v[80:83], v[164:179]
    ds_read_b64_tr_b16 v[48:49], v8 offset:17600
    ds_read_b64_tr_b16 v[50:51], v8 offset:19904
    s_waitcnt lgkmcnt(15)
    v_mfma_f32_32x32x16_bf16 v[180:195], v[60:63], v[80:83], v[180:195]
    ds_read_b64_tr_b16 v[52:53], v8 offset:17664
    ds_read_b64_tr_b16 v[54:55], v8 offset:19968
    s_waitcnt lgkmcnt(15)
    v_mfma_f32_32x32x16_bf16 v[196:211], v[64:67], v[80:83], v[196:211]
    ds_read_b64_tr_b16 v[56:57], v8 offset:17728
    ds_read_b64_tr_b16 v[58:59], v8 offset:20032
    s_waitcnt lgkmcnt(15)
    v_mfma_f32_32x32x16_bf16 v[212:227], v[68:71], v[80:83], v[212:227]
    ds_read_b64_tr_b16 v[60:61], v8 offset:17792
    ds_read_b64_tr_b16 v[62:63], v8 offset:20096
    s_waitcnt lgkmcnt(14)
    v_mfma_f32_32x32x16_bf16 v[228:243], v[32:35], v[80:83], v[228:243]
    ds_read_b64_tr_b16 v[64:65], v8 offset:17856
    ds_read_b64_tr_b16 v[66:67], v8 offset:20160
    s_waitcnt lgkmcnt(14)
    v_mfma_f32_32x32x16_bf16 v[100:115], v[36:39], v[84:87], v[100:115]
    ds_read_b64_tr_b16 v[68:69], v8 offset:17920
    ds_read_b64_tr_b16 v[70:71], v8 offset:20224
    s_waitcnt lgkmcnt(14)
    v_mfma_f32_32x32x16_bf16 v[116:131], v[40:43], v[84:87], v[116:131]
    s_waitcnt lgkmcnt(12)
    v_mfma_f32_32x32x16_bf16 v[132:147], v[44:47], v[84:87], v[132:147]
    s_waitcnt lgkmcnt(10)
    v_mfma_f32_32x32x16_bf16 v[148:163], v[48:51], v[84:87], v[148:163]
    s_waitcnt lgkmcnt(0)
    s_barrier
    v_subrev_u32 v4, 90112, v4
    v_subrev_u32 v5, 90112, v5
    v_subrev_u32 v8, 90112, v8
    ds_read_b128 v[88:91], v4
    ds_read_b64_tr_b16 v[32:33], v8 offset:8192
    ds_read_b64_tr_b16 v[34:35], v8 offset:10496
    ds_read_b64_tr_b16 v[36:37], v8 offset:8256
    ds_read_b64_tr_b16 v[38:39], v8 offset:10560
    ds_read_b64_tr_b16 v[40:41], v8 offset:8320
    ds_read_b64_tr_b16 v[42:43], v8 offset:10624
    s_waitcnt lgkmcnt(15)
    v_mfma_f32_32x32x16_bf16 v[164:179], v[52:55], v[84:87], v[164:179]
    ds_read_b64_tr_b16 v[44:45], v8 offset:8384
    ds_read_b64_tr_b16 v[46:47], v8 offset:10688
    s_waitcnt lgkmcnt(15)
    v_mfma_f32_32x32x16_bf16 v[180:195], v[56:59], v[84:87], v[180:195]
    ds_read_b64_tr_b16 v[48:49], v8 offset:8448
    ds_read_b64_tr_b16 v[50:51], v8 offset:10752
    s_waitcnt lgkmcnt(15)
    v_mfma_f32_32x32x16_bf16 v[196:211], v[60:63], v[84:87], v[196:211]
    ds_read_b64_tr_b16 v[52:53], v8 offset:8512
    ds_read_b64_tr_b16 v[54:55], v8 offset:10816
    s_waitcnt lgkmcnt(15)
    v_mfma_f32_32x32x16_bf16 v[212:227], v[64:67], v[84:87], v[212:227]
    ds_read_b64_tr_b16 v[56:57], v8 offset:8576
    ds_read_b64_tr_b16 v[58:59], v8 offset:10880
    s_waitcnt lgkmcnt(15)
    v_mfma_f32_32x32x16_bf16 v[228:243], v[68:71], v[84:87], v[228:243]
    ds_read_b64_tr_b16 v[60:61], v8 offset:8640
    ds_read_b64_tr_b16 v[62:63], v8 offset:10944
    s_waitcnt lgkmcnt(14)
    v_mfma_f32_32x32x16_bf16 v[100:115], v[32:35], v[88:91], v[100:115]
    ds_read_b128 v[92:95], v5
    ds_read_b64_tr_b16 v[64:65], v8 offset:8704
    ds_read_b64_tr_b16 v[66:67], v8 offset:11008
    s_waitcnt lgkmcnt(15)
    v_mfma_f32_32x32x16_bf16 v[116:131], v[36:39], v[88:91], v[116:131]
    ds_read_b64_tr_b16 v[68:69], v8 offset:17408
    ds_read_b64_tr_b16 v[70:71], v8 offset:19712
    s_waitcnt lgkmcnt(15)
    v_mfma_f32_32x32x16_bf16 v[132:147], v[40:43], v[88:91], v[132:147]
    ds_read_b64_tr_b16 v[32:33], v8 offset:17472
    ds_read_b64_tr_b16 v[34:35], v8 offset:19776
    s_waitcnt lgkmcnt(15)
    v_mfma_f32_32x32x16_bf16 v[148:163], v[44:47], v[88:91], v[148:163]
    ds_read_b64_tr_b16 v[36:37], v8 offset:17536
    ds_read_b64_tr_b16 v[38:39], v8 offset:19840
    s_waitcnt lgkmcnt(15)
    v_mfma_f32_32x32x16_bf16 v[164:179], v[48:51], v[88:91], v[164:179]
    ds_read_b64_tr_b16 v[40:41], v8 offset:17600
    ds_read_b64_tr_b16 v[42:43], v8 offset:19904
    s_waitcnt lgkmcnt(15)
    v_mfma_f32_32x32x16_bf16 v[180:195], v[52:55], v[88:91], v[180:195]
    ds_read_b64_tr_b16 v[44:45], v8 offset:17664
    ds_read_b64_tr_b16 v[46:47], v8 offset:19968
    s_waitcnt lgkmcnt(15)
    v_mfma_f32_32x32x16_bf16 v[196:211], v[56:59], v[88:91], v[196:211]
    ds_read_b64_tr_b16 v[48:49], v8 offset:17728
    ds_read_b64_tr_b16 v[50:51], v8 offset:20032
    s_waitcnt lgkmcnt(15)
    v_mfma_f32_32x32x16_bf16 v[212:227], v[60:63], v[88:91], v[212:227]
    ds_read_b64_tr_b16 v[52:53], v8 offset:17792
    ds_read_b64_tr_b16 v[54:55], v8 offset:20096
    s_waitcnt lgkmcnt(14)
    v_mfma_f32_32x32x16_bf16 v[228:243], v[64:67], v[88:91], v[228:243]
    ds_read_b64_tr_b16 v[56:57], v8 offset:17856
    ds_read_b64_tr_b16 v[58:59], v8 offset:20160
    s_waitcnt lgkmcnt(14)
    v_mfma_f32_32x32x16_bf16 v[100:115], v[68:71], v[92:95], v[100:115]
    ds_read_b64_tr_b16 v[60:61], v8 offset:17920
    ds_read_b64_tr_b16 v[62:63], v8 offset:20224
    s_waitcnt lgkmcnt(14)
    v_mfma_f32_32x32x16_bf16 v[116:131], v[32:35], v[92:95], v[116:131]
    s_waitcnt lgkmcnt(12)
    v_mfma_f32_32x32x16_bf16 v[132:147], v[36:39], v[92:95], v[132:147]
    s_waitcnt lgkmcnt(10)
    v_mfma_f32_32x32x16_bf16 v[148:163], v[40:43], v[92:95], v[148:163]
    s_waitcnt lgkmcnt(0)
    s_barrier
    v_add_u32 v4, 45056, v4
    v_add_u32 v5, 45056, v5
    v_add_u32 v8, 45056, v8
    ds_read_b128 v[80:83], v4
    ds_read_b64_tr_b16 v[64:65], v8 offset:8192
    ds_read_b64_tr_b16 v[66:67], v8 offset:10496
    ds_read_b64_tr_b16 v[68:69], v8 offset:8256
    ds_read_b64_tr_b16 v[70:71], v8 offset:10560
    ds_read_b64_tr_b16 v[32:33], v8 offset:8320
    ds_read_b64_tr_b16 v[34:35], v8 offset:10624
    s_waitcnt lgkmcnt(15)
    v_mfma_f32_32x32x16_bf16 v[164:179], v[44:47], v[92:95], v[164:179]
    ds_read_b64_tr_b16 v[36:37], v8 offset:8384
    ds_read_b64_tr_b16 v[38:39], v8 offset:10688
    s_waitcnt lgkmcnt(15)
    v_mfma_f32_32x32x16_bf16 v[180:195], v[48:51], v[92:95], v[180:195]
    ds_read_b64_tr_b16 v[40:41], v8 offset:8448
    ds_read_b64_tr_b16 v[42:43], v8 offset:10752
    s_waitcnt lgkmcnt(15)
    v_mfma_f32_32x32x16_bf16 v[196:211], v[52:55], v[92:95], v[196:211]
    ds_read_b64_tr_b16 v[44:45], v8 offset:8512
    ds_read_b64_tr_b16 v[46:47], v8 offset:10816
    s_waitcnt lgkmcnt(15)
    v_mfma_f32_32x32x16_bf16 v[212:227], v[56:59], v[92:95], v[212:227]
    ds_read_b64_tr_b16 v[48:49], v8 offset:8576
    ds_read_b64_tr_b16 v[50:51], v8 offset:10880
    s_waitcnt lgkmcnt(15)
    v_mfma_f32_32x32x16_bf16 v[228:243], v[60:63], v[92:95], v[228:243]
    ds_read_b64_tr_b16 v[52:53], v8 offset:8640
    ds_read_b64_tr_b16 v[54:55], v8 offset:10944
    s_waitcnt lgkmcnt(14)
    v_mfma_f32_32x32x16_bf16 v[100:115], v[64:67], v[80:83], v[100:115]
    ds_read_b128 v[84:87], v5
    ds_read_b64_tr_b16 v[56:57], v8 offset:8704
    ds_read_b64_tr_b16 v[58:59], v8 offset:11008
    s_waitcnt lgkmcnt(15)
    v_mfma_f32_32x32x16_bf16 v[116:131], v[68:71], v[80:83], v[116:131]
    ds_read_b64_tr_b16 v[60:61], v8 offset:17408
    ds_read_b64_tr_b16 v[62:63], v8 offset:19712
    s_waitcnt lgkmcnt(15)
    v_mfma_f32_32x32x16_bf16 v[132:147], v[32:35], v[80:83], v[132:147]
    ds_read_b64_tr_b16 v[64:65], v8 offset:17472
    ds_read_b64_tr_b16 v[66:67], v8 offset:19776
    s_waitcnt lgkmcnt(15)
    v_mfma_f32_32x32x16_bf16 v[148:163], v[36:39], v[80:83], v[148:163]
    ds_read_b64_tr_b16 v[68:69], v8 offset:17536
    ds_read_b64_tr_b16 v[70:71], v8 offset:19840
    s_waitcnt lgkmcnt(15)
    v_mfma_f32_32x32x16_bf16 v[164:179], v[40:43], v[80:83], v[164:179]
    ds_read_b64_tr_b16 v[32:33], v8 offset:17600
    ds_read_b64_tr_b16 v[34:35], v8 offset:19904
    s_waitcnt lgkmcnt(15)
    v_mfma_f32_32x32x16_bf16 v[180:195], v[44:47], v[80:83], v[180:195]
    ds_read_b64_tr_b16 v[36:37], v8 offset:17664
    ds_read_b64_tr_b16 v[38:39], v8 offset:19968
    s_waitcnt lgkmcnt(15)
    v_mfma_f32_32x32x16_bf16 v[196:211], v[48:51], v[80:83], v[196:211]
    ds_read_b64_tr_b16 v[40:41], v8 offset:17728
    ds_read_b64_tr_b16 v[42:43], v8 offset:20032
    s_waitcnt lgkmcnt(15)
    v_mfma_f32_32x32x16_bf16 v[212:227], v[52:55], v[80:83], v[212:227]
    ds_read_b64_tr_b16 v[44:45], v8 offset:17792
    ds_read_b64_tr_b16 v[46:47], v8 offset:20096
    s_waitcnt lgkmcnt(14)
    v_mfma_f32_32x32x16_bf16 v[228:243], v[56:59], v[80:83], v[228:243]
    ds_read_b64_tr_b16 v[48:49], v8 offset:17856
    ds_read_b64_tr_b16 v[50:51], v8 offset:20160
    s_waitcnt lgkmcnt(14)
    v_mfma_f32_32x32x16_bf16 v[100:115], v[60:63], v[84:87], v[100:115]
    ds_read_b64_tr_b16 v[52:53], v8 offset:17920
    ds_read_b64_tr_b16 v[54:55], v8 offset:20224
    s_waitcnt lgkmcnt(14)
    v_mfma_f32_32x32x16_bf16 v[116:131], v[64:67], v[84:87], v[116:131]
    s_waitcnt lgkmcnt(12)
    v_mfma_f32_32x32x16_bf16 v[132:147], v[68:71], v[84:87], v[132:147]
    s_waitcnt lgkmcnt(10)
    v_mfma_f32_32x32x16_bf16 v[148:163], v[32:35], v[84:87], v[148:163]
    s_waitcnt lgkmcnt(0)
    s_barrier
    v_add_u32 v4, 45056, v4
    v_add_u32 v5, 45056, v5
    v_add_u32 v8, 45056, v8
    ds_read_b128 v[88:91], v4
    ds_read_b64_tr_b16 v[56:57], v8 offset:8192
    ds_read_b64_tr_b16 v[58:59], v8 offset:10496
    ds_read_b64_tr_b16 v[60:61], v8 offset:8256
    ds_read_b64_tr_b16 v[62:63], v8 offset:10560
    ds_read_b64_tr_b16 v[64:65], v8 offset:8320
    ds_read_b64_tr_b16 v[66:67], v8 offset:10624
    s_waitcnt lgkmcnt(15)
    v_mfma_f32_32x32x16_bf16 v[164:179], v[36:39], v[84:87], v[164:179]
    ds_read_b64_tr_b16 v[68:69], v8 offset:8384
    ds_read_b64_tr_b16 v[70:71], v8 offset:10688
    s_waitcnt lgkmcnt(15)
    v_mfma_f32_32x32x16_bf16 v[180:195], v[40:43], v[84:87], v[180:195]
    ds_read_b64_tr_b16 v[32:33], v8 offset:8448
    ds_read_b64_tr_b16 v[34:35], v8 offset:10752
    s_waitcnt lgkmcnt(15)
    v_mfma_f32_32x32x16_bf16 v[196:211], v[44:47], v[84:87], v[196:211]
    ds_read_b64_tr_b16 v[36:37], v8 offset:8512
    ds_read_b64_tr_b16 v[38:39], v8 offset:10816
    s_waitcnt lgkmcnt(15)
    v_mfma_f32_32x32x16_bf16 v[212:227], v[48:51], v[84:87], v[212:227]
    ds_read_b64_tr_b16 v[40:41], v8 offset:8576
    ds_read_b64_tr_b16 v[42:43], v8 offset:10880
    s_waitcnt lgkmcnt(15)
    v_mfma_f32_32x32x16_bf16 v[228:243], v[52:55], v[84:87], v[228:243]
    ds_read_b64_tr_b16 v[44:45], v8 offset:8640
    ds_read_b64_tr_b16 v[46:47], v8 offset:10944
    s_waitcnt lgkmcnt(14)
    v_mfma_f32_32x32x16_bf16 v[100:115], v[56:59], v[88:91], v[100:115]
    ds_read_b128 v[92:95], v5
    ds_read_b64_tr_b16 v[48:49], v8 offset:8704
    ds_read_b64_tr_b16 v[50:51], v8 offset:11008
    s_waitcnt lgkmcnt(15)
    v_mfma_f32_32x32x16_bf16 v[116:131], v[60:63], v[88:91], v[116:131]
    ds_read_b64_tr_b16 v[52:53], v8 offset:17408
    ds_read_b64_tr_b16 v[54:55], v8 offset:19712
    s_waitcnt lgkmcnt(15)
    v_mfma_f32_32x32x16_bf16 v[132:147], v[64:67], v[88:91], v[132:147]
    ds_read_b64_tr_b16 v[56:57], v8 offset:17472
    ds_read_b64_tr_b16 v[58:59], v8 offset:19776
    s_waitcnt lgkmcnt(15)
    v_mfma_f32_32x32x16_bf16 v[148:163], v[68:71], v[88:91], v[148:163]
    ds_read_b64_tr_b16 v[60:61], v8 offset:17536
    ds_read_b64_tr_b16 v[62:63], v8 offset:19840
    s_waitcnt lgkmcnt(15)
    v_mfma_f32_32x32x16_bf16 v[164:179], v[32:35], v[88:91], v[164:179]
    ds_read_b64_tr_b16 v[64:65], v8 offset:17600
    ds_read_b64_tr_b16 v[66:67], v8 offset:19904
    s_waitcnt lgkmcnt(15)
    v_mfma_f32_32x32x16_bf16 v[180:195], v[36:39], v[88:91], v[180:195]
    ds_read_b64_tr_b16 v[68:69], v8 offset:17664
    ds_read_b64_tr_b16 v[70:71], v8 offset:19968
    s_waitcnt lgkmcnt(15)
    v_mfma_f32_32x32x16_bf16 v[196:211], v[40:43], v[88:91], v[196:211]
    ds_read_b64_tr_b16 v[32:33], v8 offset:17728
    ds_read_b64_tr_b16 v[34:35], v8 offset:20032
    s_waitcnt lgkmcnt(15)
    v_mfma_f32_32x32x16_bf16 v[212:227], v[44:47], v[88:91], v[212:227]
    ds_read_b64_tr_b16 v[36:37], v8 offset:17792
    ds_read_b64_tr_b16 v[38:39], v8 offset:20096
    s_waitcnt lgkmcnt(14)
    v_mfma_f32_32x32x16_bf16 v[228:243], v[48:51], v[88:91], v[228:243]
    ds_read_b64_tr_b16 v[40:41], v8 offset:17856
    ds_read_b64_tr_b16 v[42:43], v8 offset:20160
    s_waitcnt lgkmcnt(14)
    v_mfma_f32_32x32x16_bf16 v[100:115], v[52:55], v[92:95], v[100:115]
    ds_read_b64_tr_b16 v[44:45], v8 offset:17920
    ds_read_b64_tr_b16 v[46:47], v8 offset:20224
    s_waitcnt lgkmcnt(14)
    v_mfma_f32_32x32x16_bf16 v[116:131], v[56:59], v[92:95], v[116:131]
    s_waitcnt lgkmcnt(12)
    v_mfma_f32_32x32x16_bf16 v[132:147], v[60:63], v[92:95], v[132:147]
    s_waitcnt lgkmcnt(10)
    v_mfma_f32_32x32x16_bf16 v[148:163], v[64:67], v[92:95], v[148:163]
    s_waitcnt lgkmcnt(8)
    v_mfma_f32_32x32x16_bf16 v[164:179], v[68:71], v[92:95], v[164:179]
    s_waitcnt lgkmcnt(6)
    v_mfma_f32_32x32x16_bf16 v[180:195], v[32:35], v[92:95], v[180:195]
    s_waitcnt lgkmcnt(4)
    v_mfma_f32_32x32x16_bf16 v[196:211], v[36:39], v[92:95], v[196:211]
    s_waitcnt lgkmcnt(2)
    v_mfma_f32_32x32x16_bf16 v[212:227], v[40:43], v[92:95], v[212:227]
    s_waitcnt lgkmcnt(0)
    v_mfma_f32_32x32x16_bf16 v[228:243], v[44:47], v[92:95], v[228:243]
    s_nop 15
    s_barrier
    s_lshr_b32 s26, s26, 7
    v_add_u32 v4, s26, v2
    v_mul_u32_u24 v4, 1168, v4
    v_lshl_add_u32 v4, v3, 4, v4
    s_cmp_lg_u32 s28, 0
    s_cbranch_scc1 ffn2_kernel_wk11
    s_barrier
    v_add_u32 v5, s26, v2
    v_mul_u32_u24 v5, 592, v5
    v_lshl_add_u32 v5, v3, 4, v5
    v_add_u32 v5, 81920, v5
    ds_read_b128 v[32:35], v4 offset:0
    ds_read_b128 v[36:39], v4 offset:32
    ds_read_b128 v[40:43], v4 offset:64
    ds_read_b128 v[44:47], v4 offset:96
    ds_read_b128 v[48:51], v4 offset:128
    ds_read_b128 v[52:55], v4 offset:160
    ds_read_b128 v[56:59], v4 offset:192
    ds_read_b128 v[60:63], v4 offset:224
    ds_read_b128 v[64:67], v4 offset:256
    ds_read_b128 v[68:71], v4 offset:288
    ds_read_b128 v[72:75], v4 offset:320
    ds_read_b128 v[76:79], v4 offset:352
    s_waitcnt lgkmcnt(0)
    v_add_f32 v100, v100, v32
    v_add_f32 v101, v101, v33
    v_add_f32 v102, v102, v34
    v_add_f32 v103, v103, v35
    v_add_f32 v104, v104, v36
    v_add_f32 v105, v105, v37
    v_add_f32 v106, v106, v38
    v_add_f32 v107, v107, v39
    v_cvt_pk_bf16_f32 v80, v100, v101
    v_cvt_pk_bf16_f32 v81, v102, v103
    v_cvt_pk_bf16_f32 v82, v104, v105
    v_cvt_pk_bf16_f32 v83, v106, v107
    s_nop 1
    v_permlane32_swap_b32 v80, v82
    v_permlane32_swap_b32 v81, v83
    ds_write_b128 v5, v[80:83] offset:0
    v_add_f32 v108, v108, v40
    v_add_f32 v109, v109, v41
    v_add_f32 v110, v110, v42
    v_add_f32 v111, v111, v43
    v_add_f32 v112, v112, v44
    v_add_f32 v113, v113, v45
    v_add_f32 v114, v114, v46
    v_add_f32 v115, v115, v47
    v_cvt_pk_bf16_f32 v84, v108, v109
    v_cvt_pk_bf16_f32 v85, v110, v111
    v_cvt_pk_bf16_f32 v86, v112, v113
    v_cvt_pk_bf16_f32 v87, v114, v115
    s_nop 1
    v_permlane32_swap_b32 v84, v86
    v_permlane32_swap_b32 v85, v87
    ds_write_b128 v5, v[84:87] offset:32
    v_add_f32 v116, v116, v48
    v_add_f32 v117, v117, v49
    v_add_f32 v118, v118, v50
    v_add_f32 v119, v119, v51
    v_add_f32 v120, v120, v52
    v_add_f32 v121, v121, v53
    v_add_f32 v122, v122, v54
    v_add_f32 v123, v123, v55
    v_cvt_pk_bf16_f32 v80, v116, v117
    v_cvt_pk_bf16_f32 v81, v118, v119
    v_cvt_pk_bf16_f32 v82, v120, v121
    v_cvt_pk_bf16_f32 v83, v122, v123
    s_nop 1
    v_permlane32_swap_b32 v80, v82
    v_permlane32_swap_b32 v81, v83
    ds_write_b128 v5, v[80:83] offset:64
    v_add_f32 v124, v124, v56
    v_add_f32 v125, v125, v57
    v_add_f32 v126, v126, v58
    v_add_f32 v127, v127, v59
    v_add_f32 v128, v128, v60
    v_add_f32 v129, v129, v61
    v_add_f32 v130, v130, v62
    v_add_f32 v131, v131, v63
    v_cvt_pk_bf16_f32 v84, v124, v125
    v_cvt_pk_bf16_f32 v85, v126, v127
    v_cvt_pk_bf16_f32 v86, v128, v129
    v_cvt_pk_bf16_f32 v87, v130, v131
    s_nop 1
    v_permlane32_swap_b32 v84, v86
    v_permlane32_swap_b32 v85, v87
    ds_write_b128 v5, v[84:87] offset:96
    v_add_f32 v132, v132, v64
    v_add_f32 v133, v133, v65
    v_add_f32 v134, v134, v66
    v_add_f32 v135, v135, v67
    v_add_f32 v136, v136, v68
    v_add_f32 v137, v137, v69
    v_add_f32 v138, v138, v70
    v_add_f32 v139, v139, v71
    v_cvt_pk_bf16_f32 v80, v132, v133
    v_cvt_pk_bf16_f32 v81, v134, v135
    v_cvt_pk_bf16_f32 v82, v136, v137
    v_cvt_pk_bf16_f32 v83, v138, v139
    s_nop 1
    v_permlane32_swap_b32 v80, v82
    v_permlane32_swap_b32 v81, v83
    ds_write_b128 v5, v[80:83] offset:128
    v_add_f32 v140, v140, v72
    v_add_f32 v141, v141, v73
    v_add_f32 v142, v142, v74
    v_add_f32 v143, v143, v75
    v_add_f32 v144, v144, v76
    v_add_f32 v145, v145, v77
    v_add_f32 v146, v146, v78
    v_add_f32 v147, v147, v79
    v_cvt_pk_bf16_f32 v84, v140, v141
    v_cvt_pk_bf16_f32 v85, v142, v143
    v_cvt_pk_bf16_f32 v86, v144, v145
    v_cvt_pk_bf16_f32 v87, v146, v147
    s_nop 1
    v_permlane32_swap_b32 v84, v86
    v_permlane32_swap_b32 v85, v87
    ds_write_b128 v5, v[84:87] offset:160
    ds_read_b128 v[32:35], v4 offset:384
    ds_read_b128 v[36:39], v4 offset:416
    ds_read_b128 v[40:43], v4 offset:448
    ds_read_b128 v[44:47], v4 offset:480
    ds_read_b128 v[48:51], v4 offset:512
    ds_read_b128 v[52:55], v4 offset:544
    ds_read_b128 v[56:59], v4 offset:576
    ds_read_b128 v[60:63], v4 offset:608
    ds_read_b128 v[64:67], v4 offset:640
    ds_read_b128 v[68:71], v4 offset:672
    ds_read_b128 v[72:75], v4 offset:704
    ds_read_b128 v[76:79], v4 offset:736
    s_waitcnt lgkmcnt(0)
    v_add_f32 v148, v148, v32
    v_add_f32 v149, v149, v33
    v_add_f32 v150, v150, v34
    v_add_f32 v151, v151, v35
    v_add_f32 v152, v152, v36
    v_add_f32 v153, v153, v37
    v_add_f32 v154, v154, v38
    v_add_f32 v155, v155, v39
    v_cvt_pk_bf16_f32 v80, v148, v149
    v_cvt_pk_bf16_f32 v81, v150, v151
    v_cvt_pk_bf16_f32 v82, v152, v153
    v_cvt_pk_bf16_f32 v83, v154, v155
    s_nop 1
    v_permlane32_swap_b32 v80, v82
    v_permlane32_swap_b32 v81, v83
    ds_write_b128 v5, v[80:83] offset:192
    v_add_f32 v156, v156, v40
    v_add_f32 v157, v157, v41
    v_add_f32 v158, v158, v42
    v_add_f32 v159, v159, v43
    v_add_f32 v160, v160, v44
    v_add_f32 v161, v161, v45
    v_add_f32 v162, v162, v46
    v_add_f32 v163, v163, v47
    v_cvt_pk_bf16_f32 v84, v156, v157
    v_cvt_pk_bf16_f32 v85, v158, v159
    v_cvt_pk_bf16_f32 v86, v160, v161
    v_cvt_pk_bf16_f32 v87, v162, v163
    s_nop 1
    v_permlane32_swap_b32 v84, v86
    v_permlane32_swap_b32 v85, v87
    ds_write_b128 v5, v[84:87] offset:224
    v_add_f32 v164, v164, v48
    v_add_f32 v165, v165, v49
    v_add_f32 v166, v166, v50
    v_add_f32 v167, v167, v51
    v_add_f32 v168, v168, v52
    v_add_f32 v169, v169, v53
    v_add_f32 v170, v170, v54
    v_add_f32 v171, v171, v55
    v_cvt_pk_bf16_f32 v80, v164, v165
    v_cvt_pk_bf16_f32 v81, v166, v167
    v_cvt_pk_bf16_f32 v82, v168, v169
    v_cvt_pk_bf16_f32 v83, v170, v171
    s_nop 1
    v_permlane32_swap_b32 v80, v82
    v_permlane32_swap_b32 v81, v83
    ds_write_b128 v5, v[80:83] offset:256
    v_add_f32 v172, v172, v56
    v_add_f32 v173, v173, v57
    v_add_f32 v174, v174, v58
    v_add_f32 v175, v175, v59
    v_add_f32 v176, v176, v60
    v_add_f32 v177, v177, v61
    v_add_f32 v178, v178, v62
    v_add_f32 v179, v179, v63
    v_cvt_pk_bf16_f32 v84, v172, v173
    v_cvt_pk_bf16_f32 v85, v174, v175
    v_cvt_pk_bf16_f32 v86, v176, v177
    v_cvt_pk_bf16_f32 v87, v178, v179
    s_nop 1
    v_permlane32_swap_b32 v84, v86
    v_permlane32_swap_b32 v85, v87
    ds_write_b128 v5, v[84:87] offset:288
    v_add_f32 v180, v180, v64
    v_add_f32 v181, v181, v65
    v_add_f32 v182, v182, v66
    v_add_f32 v183, v183, v67
    v_add_f32 v184, v184, v68
    v_add_f32 v185, v185, v69
    v_add_f32 v186, v186, v70
    v_add_f32 v187, v187, v71
    v_cvt_pk_bf16_f32 v80, v180, v181
    v_cvt_pk_bf16_f32 v81, v182, v183
    v_cvt_pk_bf16_f32 v82, v184, v185
    v_cvt_pk_bf16_f32 v83, v186, v187
    s_nop 1
    v_permlane32_swap_b32 v80, v82
    v_permlane32_swap_b32 v81, v83
    ds_write_b128 v5, v[80:83] offset:320
    v_add_f32 v188, v188, v72
    v_add_f32 v189, v189, v73
    v_add_f32 v190, v190, v74
    v_add_f32 v191, v191, v75
    v_add_f32 v192, v192, v76
    v_add_f32 v193, v193, v77
    v_add_f32 v194, v194, v78
    v_add_f32 v195, v195, v79
    v_cvt_pk_bf16_f32 v84, v188, v189
    v_cvt_pk_bf16_f32 v85, v190, v191
    v_cvt_pk_bf16_f32 v86, v192, v193
    v_cvt_pk_bf16_f32 v87, v194, v195
    s_nop 1
    v_permlane32_swap_b32 v84, v86
    v_permlane32_swap_b32 v85, v87
    ds_write_b128 v5, v[84:87] offset:352
    ds_read_b128 v[32:35], v4 offset:768
    ds_read_b128 v[36:39], v4 offset:800
    ds_read_b128 v[40:43], v4 offset:832
    ds_read_b128 v[44:47], v4 offset:864
    ds_read_b128 v[48:51], v4 offset:896
    ds_read_b128 v[52:55], v4 offset:928
    ds_read_b128 v[56:59], v4 offset:960
    ds_read_b128 v[60:63], v4 offset:992
    ds_read_b128 v[64:67], v4 offset:1024
    ds_read_b128 v[68:71], v4 offset:1056
    ds_read_b128 v[72:75], v4 offset:1088
    ds_read_b128 v[76:79], v4 offset:1120
    s_waitcnt lgkmcnt(0)
    v_add_f32 v196, v196, v32
    v_add_f32 v197, v197, v33
    v_add_f32 v198, v198, v34
    v_add_f32 v199, v199, v35
    v_add_f32 v200, v200, v36
    v_add_f32 v201, v201, v37
    v_add_f32 v202, v202, v38
    v_add_f32 v203, v203, v39
    v_cvt_pk_bf16_f32 v80, v196, v197
    v_cvt_pk_bf16_f32 v81, v198, v199
    v_cvt_pk_bf16_f32 v82, v200, v201
    v_cvt_pk_bf16_f32 v83, v202, v203
    s_nop 1
    v_permlane32_swap_b32 v80, v82
    v_permlane32_swap_b32 v81, v83
    ds_write_b128 v5, v[80:83] offset:384
    v_add_f32 v204, v204, v40
    v_add_f32 v205, v205, v41
    v_add_f32 v206, v206, v42
    v_add_f32 v207, v207, v43
    v_add_f32 v208, v208, v44
    v_add_f32 v209, v209, v45
    v_add_f32 v210, v210, v46
    v_add_f32 v211, v211, v47
    v_cvt_pk_bf16_f32 v84, v204, v205
    v_cvt_pk_bf16_f32 v85, v206, v207
    v_cvt_pk_bf16_f32 v86, v208, v209
    v_cvt_pk_bf16_f32 v87, v210, v211
    s_nop 1
    v_permlane32_swap_b32 v84, v86
    v_permlane32_swap_b32 v85, v87
    ds_write_b128 v5, v[84:87] offset:416
    v_add_f32 v212, v212, v48
    v_add_f32 v213, v213, v49
    v_add_f32 v214, v214, v50
    v_add_f32 v215, v215, v51
    v_add_f32 v216, v216, v52
    v_add_f32 v217, v217, v53
    v_add_f32 v218, v218, v54
    v_add_f32 v219, v219, v55
    v_cvt_pk_bf16_f32 v80, v212, v213
    v_cvt_pk_bf16_f32 v81, v214, v215
    v_cvt_pk_bf16_f32 v82, v216, v217
    v_cvt_pk_bf16_f32 v83, v218, v219
    s_nop 1
    v_permlane32_swap_b32 v80, v82
    v_permlane32_swap_b32 v81, v83
    ds_write_b128 v5, v[80:83] offset:448
    v_add_f32 v220, v220, v56
    v_add_f32 v221, v221, v57
    v_add_f32 v222, v222, v58
    v_add_f32 v223, v223, v59
    v_add_f32 v224, v224, v60
    v_add_f32 v225, v225, v61
    v_add_f32 v226, v226, v62
    v_add_f32 v227, v227, v63
    v_cvt_pk_bf16_f32 v84, v220, v221
    v_cvt_pk_bf16_f32 v85, v222, v223
    v_cvt_pk_bf16_f32 v86, v224, v225
    v_cvt_pk_bf16_f32 v87, v226, v227
    s_nop 1
    v_permlane32_swap_b32 v84, v86
    v_permlane32_swap_b32 v85, v87
    ds_write_b128 v5, v[84:87] offset:480
    v_add_f32 v228, v228, v64
    v_add_f32 v229, v229, v65
    v_add_f32 v230, v230, v66
    v_add_f32 v231, v231, v67
    v_add_f32 v232, v232, v68
    v_add_f32 v233, v233, v69
    v_add_f32 v234, v234, v70
    v_add_f32 v235, v235, v71
    v_cvt_pk_bf16_f32 v80, v228, v229
    v_cvt_pk_bf16_f32 v81, v230, v231
    v_cvt_pk_bf16_f32 v82, v232, v233
    v_cvt_pk_bf16_f32 v83, v234, v235
    s_nop 1
    v_permlane32_swap_b32 v80, v82
    v_permlane32_swap_b32 v81, v83
    ds_write_b128 v5, v[80:83] offset:512
    v_add_f32 v236, v236, v72
    v_add_f32 v237, v237, v73
    v_add_f32 v238, v238, v74
    v_add_f32 v239, v239, v75
    v_add_f32 v240, v240, v76
    v_add_f32 v241, v241, v77
    v_add_f32 v242, v242, v78
    v_add_f32 v243, v243, v79
    v_cvt_pk_bf16_f32 v84, v236, v237
    v_cvt_pk_bf16_f32 v85, v238, v239
    v_cvt_pk_bf16_f32 v86, v240, v241
    v_cvt_pk_bf16_f32 v87, v242, v243
    s_nop 1
    v_permlane32_swap_b32 v84, v86
    v_permlane32_swap_b32 v85, v87
    ds_write_b128 v5, v[84:87] offset:544
    s_waitcnt lgkmcnt(0)
    s_branch ffn2_kernel_wkj2
ffn2_kernel_wk11:
    ds_write_b128 v4, v[100:103] offset:0
    ds_write_b128 v4, v[104:107] offset:32
    ds_write_b128 v4, v[108:111] offset:64
    ds_write_b128 v4, v[112:115] offset:96
    ds_write_b128 v4, v[116:119] offset:128
    ds_write_b128 v4, v[120:123] offset:160
    ds_write_b128 v4, v[124:127] offset:192
    ds_write_b128 v4, v[128:131] offset:224
    ds_write_b128 v4, v[132:135] offset:256
    ds_write_b128 v4, v[136:139] offset:288
    ds_write_b128 v4, v[140:143] offset:320
    ds_write_b128 v4, v[144:147] offset:352
    ds_write_b128 v4, v[148:151] offset:384
    ds_write_b128 v4, v[152:155] offset:416
    ds_write_b128 v4, v[156:159] offset:448
    ds_write_b128 v4, v[160:163] offset:480
    ds_write_b128 v4, v[164:167] offset:512
    ds_write_b128 v4, v[168:171] offset:544
    ds_write_b128 v4, v[172:175] offset:576
    ds_write_b128 v4, v[176:179] offset:608
    ds_write_b128 v4, v[180:183] offset:640
    ds_write_b128 v4, v[184:187] offset:672
    ds_write_b128 v4, v[188:191] offset:704
    ds_write_b128 v4, v[192:195] offset:736
    ds_write_b128 v4, v[196:199] offset:768
    ds_write_b128 v4, v[200:203] offset:800
    ds_write_b128 v4, v[204:207] offset:832
    ds_write_b128 v4, v[208:211] offset:864
    ds_write_b128 v4, v[212:215] offset:896
    ds_write_b128 v4, v[216:219] offset:928
    ds_write_b128 v4, v[220:223] offset:960
    ds_write_b128 v4, v[224:227] offset:992
    ds_write_b128 v4, v[228:231] offset:1024
    ds_write_b128 v4, v[232:235] offset:1056
    ds_write_b128 v4, v[236:239] offset:1088
    ds_write_b128 v4, v[240:243] offset:1120
    s_waitcnt lgkmcnt(0)
    s_barrier
ffn2_kernel_wkj2:
    s_branch ffn2_kernel_store
ffn2_kernel_loader:
    s_sub_u32 s5, s5, 4
    s_mul_i32 s25, s5, 16
    s_add_u32 s25, s25, s24
    s_mul_i32 s20, s25, 128
    s_lshr_b32 s25, s23, 6
    s_mul_i32 s25, s25, 262144
    s_add_u32 s20, s20, s25
    s_lshl_b32 s25, s5, 4
    s_add_u32 s25, s25, s23
    s_mul_i32 s21, s25, 1152
    s_mul_i32 s25, s4, 576
    s_add_u32 s21, s21, s25
    s_mul_i32 s26, s5, 2048
    s_mul_i32 s27, s5, 9216
    s_add_u32 s27, s27, 8192
    v_lshrrev_b32 v28, 3, v1
    v_and_b32 v29, 7, v1
    v_lshrrev_b32 v30, 4, v1
    s_mov_b32 s25, 128
    v_add_u32 v31, 0, v30
    v_xor_b32 v31, v31, v29
    v_lshlrev_b32 v31, 4, v31
    v_add_u32 v10, 0, v28
    v_mul_lo_u32 v10, v10, s25
    v_add_u32 v10, v10, v31
    v_add_u32 v31, 4, v30
    v_xor_b32 v31, v31, v29
    v_lshlrev_b32 v31, 4, v31
    v_add_u32 v11, 8, v28
    v_mul_lo_u32 v11, v11, s25
    v_add_u32 v11, v11, v31
    v_subrev_u32 v11, 1024, v11
    s_mov_b32 s25, 1152
    v_add_u32 v28, 0, v1
    v_mul_u32_u24 v29, 1821, v28
    v_lshrrev_b32 v29, 16, v29
    v_mul_u32_u24 v30, 36, v29
    v_sub_u32 v28, v28, v30
    v_mul_lo_u32 v14, v29, s25
    v_lshl_add_u32 v14, v28, 4, v14
    v_add_u32 v28, 64, v1
    v_mul_u32_u24 v29, 1821, v28
    v_lshrrev_b32 v29, 16, v29
    v_mul_u32_u24 v30, 36, v29
    v_sub_u32 v28, v28, v30
    v_mul_lo_u32 v15, v29, s25
    v_lshl_add_u32 v15, v28, 4, v15
    v_subrev_u32 v15, 1024, v15
    v_add_u32 v28, 128, v1
    v_mul_u32_u24 v29, 1821, v28
    v_lshrrev_b32 v29, 16, v29
    v_mul_u32_u24 v30, 36, v29
    v_sub_u32 v28, v28, v30
    v_mul_lo_u32 v16, v29, s25
    v_lshl_add_u32 v16, v28, 4, v16
    v_subrev_u32 v16, 2048, v16
    v_add_u32 v28, 192, v1
    v_mul_u32_u24 v29, 1821, v28
    v_lshrrev_b32 v29, 16, v29
    v_mul_u32_u24 v30, 36, v29
    v_sub_u32 v28, v28, v30
    v_mul_lo_u32 v17, v29, s25
    v_lshl_add_u32 v17, v28, 4, v17
    v_subrev_u32 v17, 3072, v17
    v_add_u32 v28, 256, v1
    v_mul_u32_u24 v29, 1821, v28
    v_lshrrev_b32 v29, 16, v29
    v_mul_u32_u24 v30, 36, v29
    v_sub_u32 v28, v28, v30
    v_mul_lo_u32 v18, v29, s25
    v_lshl_add_u32 v18, v28, 4, v18
    v_add_u32 v28, 320, v1
    v_mul_u32_u24 v29, 1821, v28
    v_lshrrev_b32 v29, 16, v29
    v_mul_u32_u24 v30, 36, v29
    v_sub_u32 v28, v28, v30
    v_mul_lo_u32 v19, v29, s25
    v_lshl_add_u32 v19, v28, 4, v19
    v_subrev_u32 v19, 1024, v19
    v_add_u32 v28, 384, v1
    v_mul_u32_u24 v29, 1821, v28
    v_lshrrev_b32 v29, 16, v29
    v_mul_u32_u24 v30, 36, v29
    v_sub_u32 v28, v28, v30
    v_mul_lo_u32 v20, v29, s25
    v_lshl_add_u32 v20, v28, 4, v20
    v_subrev_u32 v20, 2048, v20
    v_add_u32 v28, 448, v1
    v_mul_u32_u24 v29, 1821, v28
    v_lshrrev_b32 v29, 16, v29
    v_mul_u32_u24 v30, 36, v29
    v_sub_u32 v28, v28, v30
    v_mul_lo_u32 v21, v29, s25
    v_lshl_add_u32 v21, v28, 4, v21
    v_subrev_u32 v21, 3072, v21
    v_add_u32 v28, 512, v1
    v_mul_u32_u24 v29, 1821, v28
    v_lshrrev_b32 v29, 16, v29
    v_mul_u32_u24 v30, 36, v29
    v_sub_u32 v28, v28, v30
    v_mul_lo_u32 v22, v29, s25
    v_lshl_add_u32 v22, v28, 4, v22
    v_lshrrev_b32 v28, 2, v1
    v_mul_lo_u32 v24, v28, s25
    v_and_b32 v28, 3, v1
    v_lshl_add_u32 v24, v28, 7, v24
    v_and_b32 v28, 15, v1
    v_mul_lo_u32 v25, v28, s25
    v_add_u32 v25, 512, v25
    v_and_b32 v28, 15, v1
    s_mov_b32 s25, 128
    v_mul_lo_u32 v26, v28, s25
    s_add_u32 s28, s20, 384
    s_add_u32 s29, s21, 221184
    s_add_u32 m0, s26, 0
    s_nop 0
    buffer_load_dwordx4 v10, s[8:11], s20 offen offset:0 lds
    buffer_load_dwordx4 v11, s[8:11], s20 offen offset:1024 lds
    s_add_u32 m0, s27, 0
    s_nop 0
    buffer_load_dwordx4 v14, s[12:15], s21 offen offset:0 lds
    buffer_load_dwordx4 v15, s[12:15], s21 offen offset:1024 lds
    buffer_load_dwordx4 v16, s[12:15], s21 offen offset:2048 lds
    buffer_load_dwordx4 v17, s[12:15], s21 offen offset:3072 lds
    s_add_u32 m0, s27, 4096
    s_nop 0
    buffer_load_dwordx4 v18, s[12:15], s21 offen offset:0 lds
    buffer_load_dwordx4 v19, s[12:15], s21 offen offset:1024 lds
    buffer_load_dwordx4 v20, s[12:15], s21 offen offset:2048 lds
    buffer_load_dwordx4 v21, s[12:15], s21 offen offset:3072 lds
    s_add_u32 m0, s27, 8192
    s_nop 0
    buffer_load_dwordx4 v22, s[12:15], s21 offen offset:0 lds
    s_add_u32 s20, s20, 262144
    s_add_u32 s21, s21, 73728
    s_add_u32 m0, s26, 45056
    s_nop 0
    buffer_load_dwordx4 v10, s[8:11], s20 offen offset:0 lds
    buffer_load_dwordx4 v11, s[8:11], s20 offen offset:1024 lds
    s_add_u32 m0, s27, 45056
    s_nop 0
    buffer_load_dwordx4 v14, s[12:15], s21 offen offset:0 lds
    buffer_load_dwordx4 v15, s[12:15], s21 offen offset:1024 lds
    buffer_load_dwordx4 v16, s[12:15], s21 offen offset:2048 lds
    buffer_load_dwordx4 v17, s[12:15], s21 offen offset:3072 lds
    s_add_u32 m0, s27, 49152
    s_nop 0
    buffer_load_dwordx4 v18, s[12:15], s21 offen offset:0 lds
    buffer_load_dwordx4 v19, s[12:15], s21 offen offset:1024 lds
    buffer_load_dwordx4 v20, s[12:15], s21 offen offset:2048 lds
    buffer_load_dwordx4 v21, s[12:15], s21 offen offset:3072 lds
    s_add_u32 m0, s27, 53248
    s_nop 0
    buffer_load_dwordx4 v22, s[12:15], s21 offen offset:0 lds
    s_add_u32 s20, s20, 262144
    s_add_u32 s21, s21, 73728
    s_add_u32 m0, s26, 90112
    s_nop 0
    buffer_load_dwordx4 v10, s[8:11], s20 offen offset:0 lds
    buffer_load_dwordx4 v11, s[8:11], s20 offen offset:1024 lds
    s_add_u32 m0, s27, 90112
    s_nop 0
    buffer_load_dwordx4 v14, s[12:15], s21 offen offset:0 lds
    buffer_load_dwordx4 v15, s[12:15], s21 offen offset:1024 lds
    buffer_load_dwordx4 v16, s[12:15], s21 offen offset:2048 lds
    buffer_load_dwordx4 v17, s[12:15], s21 offen offset:3072 lds
    s_add_u32 m0, s27, 94208
    s_nop 0
    buffer_load_dwordx4 v18, s[12:15], s21 offen offset:0 lds
    buffer_load_dwordx4 v19, s[12:15], s21 offen offset:1024 lds
    buffer_load_dwordx4 v20, s[12:15], s21 offen offset:2048 lds
    buffer_load_dwordx4 v21, s[12:15], s21 offen offset:3072 lds
    s_add_u32 m0, s27, 98304
    s_nop 0
    buffer_load_dwordx4 v22, s[12:15], s21 offen offset:0 lds
    s_add_u32 s20, s20, 262144
    s_add_u32 s21, s21, 73728
    s_waitcnt vmcnt(22)
    s_barrier
    s_waitcnt vmcnt(11)
    s_barrier
    s_add_u32 m0, s26, 0
    s_nop 0
    buffer_load_dwordx4 v10, s[8:11], s20 offen offset:0 lds
    buffer_load_dwordx4 v11, s[8:11], s20 offen offset:1024 lds
    s_add_u32 m0, s27, 0
    s_nop 0
    buffer_load_dwordx4 v14, s[12:15], s21 offen offset:0 lds
    buffer_load_dwordx4 v15, s[12:15], s21 offen offset:1024 lds
    buffer_load_dwordx4 v16, s[12:15], s21 offen offset:2048 lds
    buffer_load_dwordx4 v17, s[12:15], s21 offen offset:3072 lds
    s_add_u32 m0, s27, 4096
    s_nop 0
    buffer_load_dwordx4 v18, s[12:15], s21 offen offset:0 lds
    buffer_load_dwordx4 v19, s[12:15], s21 offen offset:1024 lds
    buffer_load_dwordx4 v20, s[12:15], s21 offen offset:2048 lds
    buffer_load_dwordx4 v21, s[12:15], s21 offen offset:3072 lds
    s_add_u32 m0, s27, 8192
    s_nop 0
    buffer_load_dwordx4 v22, s[12:15], s21 offen offset:0 lds
    s_add_u32 s20, s20, 262144
    s_add_u32 s21, s21, 73728
    s_waitcnt vmcnt(11)
    s_barrier
    s_add_u32 m0, s26, 45056
    s_nop 0
    buffer_load_dwordx4 v10, s[8:11], s20 offen offset:0 lds
    buffer_load_dwordx4 v11, s[8:11], s20 offen offset:1024 lds
    s_add_u32 m0, s27, 45056
    s_nop 0
    buffer_load_dwordx4 v14, s[12:15], s21 offen offset:0 lds
    buffer_load_dwordx4 v15, s[12:15], s21 offen offset:1024 lds
    buffer_load_dwordx4 v16, s[12:15], s21 offen offset:2048 lds
    buffer_load_dwordx4 v17, s[12:15], s21 offen offset:3072 lds
    s_add_u32 m0, s27, 49152
    s_nop 0
    buffer_load_dwordx4 v18, s[12:15], s21 offen offset:0 lds
    buffer_load_dwordx4 v19, s[12:15], s21 offen offset:1024 lds
    buffer_load_dwordx4 v20, s[12:15], s21 offen offset:2048 lds
    buffer_load_dwordx4 v21, s[12:15], s21 offen offset:3072 lds
    s_add_u32 m0, s27, 53248
    s_nop 0
    buffer_load_dwordx4 v22, s[12:15], s21 offen offset:0 lds
    s_add_u32 s20, s20, 262144
    s_add_u32 s21, s21, 73728
    s_waitcnt vmcnt(11)
    s_barrier
    s_add_u32 m0, s26, 90112
    s_nop 0
    buffer_load_dwordx4 v10, s[8:11], s20 offen offset:0 lds
    buffer_load_dwordx4 v11, s[8:11], s20 offen offset:1024 lds
    s_add_u32 m0, s27, 90112
    s_nop 0
    buffer_load_dwordx4 v14, s[12:15], s21 offen offset:0 lds
    buffer_load_dwordx4 v15, s[12:15], s21 offen offset:1024 lds
    buffer_load_dwordx4 v16, s[12:15], s21 offen offset:2048 lds
    buffer_load_dwordx4 v17, s[12:15], s21 offen offset:3072 lds
    s_add_u32 m0, s27, 94208
    s_nop 0
    buffer_load_dwordx4 v18, s[12:15], s21 offen offset:0 lds
    buffer_load_dwordx4 v19, s[12:15], s21 offen offset:1024 lds
    buffer_load_dwordx4 v20, s[12:15], s21 offen offset:2048 lds
    buffer_load_dwordx4 v21, s[12:15], s21 offen offset:3072 lds
    s_add_u32 m0, s27, 98304
    s_nop 0
    buffer_load_dwordx4 v22, s[12:15], s21 offen offset:0 lds
    s_add_u32 s20, s20, 262144
    s_add_u32 s21, s21, 73728
    s_waitcnt vmcnt(11)
    s_barrier
    s_add_u32 m0, s26, 0
    s_nop 0
    buffer_load_dwordx4 v10, s[8:11], s20 offen offset:0 lds
    buffer_load_dwordx4 v11, s[8:11], s20 offen offset:1024 lds
    s_add_u32 m0, s27, 0
    s_nop 0
    buffer_load_dwordx4 v14, s[12:15], s21 offen offset:0 lds
    buffer_load_dwordx4 v15, s[12:15], s21 offen offset:1024 lds
    buffer_load_dwordx4 v16, s[12:15], s21 offen offset:2048 lds
    buffer_load_dwordx4 v17, s[12:15], s21 offen offset:3072 lds
    s_add_u32 m0, s27, 4096
    s_nop 0
    buffer_load_dwordx4 v18, s[12:15], s21 offen offset:0 lds
    buffer_load_dwordx4 v19, s[12:15], s21 offen offset:1024 lds
    buffer_load_dwordx4 v20, s[12:15], s21 offen offset:2048 lds
    buffer_load_dwordx4 v21, s[12:15], s21 offen offset:3072 lds
    s_add_u32 m0, s27, 8192
    s_nop 0
    buffer_load_dwordx4 v22, s[12:15], s21 offen offset:0 lds
    s_add_u32 s20, s20, 262144
    s_add_u32 s21, s21, 73728
    s_waitcnt vmcnt(11)
    s_barrier
    s_add_u32 m0, s26, 45056
    s_nop 0
    buffer_load_dwordx4 v10, s[8:11], s20 offen offset:0 lds
    buffer_load_dwordx4 v11, s[8:11], s20 offen offset:1024 lds
    s_add_u32 m0, s27, 45056
    s_nop 0
    buffer_load_dwordx4 v14, s[12:15], s21 offen offset:0 lds
    buffer_load_dwordx4 v15, s[12:15], s21 offen offset:1024 lds
    buffer_load_dwordx4 v16, s[12:15], s21 offen offset:2048 lds
    buffer_load_dwordx4 v17, s[12:15], s21 offen offset:3072 lds
    s_add_u32 m0, s27, 49152
    s_nop 0
    buffer_load_dwordx4 v18, s[12:15], s21 offen offset:0 lds
    buffer_load_dwordx4 v19, s[12:15], s21 offen offset:1024 lds
    buffer_load_dwordx4 v20, s[12:15], s21 offen offset:2048 lds
    buffer_load_dwordx4 v21, s[12:15], s21 offen offset:3072 lds
    s_add_u32 m0, s27, 53248
    s_nop 0
    buffer_load_dwordx4 v22, s[12:15], s21 offen offset:0 lds
    s_add_u32 s20, s20, 262144
    s_add_u32 s21, s21, 73728
    s_waitcnt vmcnt(11)
    s_barrier
    s_add_u32 m0, s26, 90112
    s_nop 0
    buffer_load_dwordx4 v10, s[8:11], s20 offen offset:0 lds
    buffer_load_dwordx4 v11, s[8:11], s20 offen offset:1024 lds
    s_add_u32 m0, s27, 90112
    s_nop 0
    buffer_load_dwordx4 v14, s[12:15], s21 offen offset:0 lds
    buffer_load_dwordx4 v15, s[12:15], s21 offen offset:1024 lds
    buffer_load_dwordx4 v16, s[12:15], s21 offen offset:2048 lds
    buffer_load_dwordx4 v17, s[12:15], s21 offen offset:3072 lds
    s_add_u32 m0, s27, 94208
    s_nop 0
    buffer_load_dwordx4 v18, s[12:15], s21 offen offset:0 lds
    buffer_load_dwordx4 v19, s[12:15], s21 offen offset:1024 lds
    buffer_load_dwordx4 v20, s[12:15], s21 offen offset:2048 lds
    buffer_load_dwordx4 v21, s[12:15], s21 offen offset:3072 lds
    s_add_u32 m0, s27, 98304
    s_nop 0
    buffer_load_dwordx4 v22, s[12:15], s21 offen offset:0 lds
    s_add_u32 s20, s20, 262144
    s_add_u32 s21, s21, 73728
    s_waitcnt vmcnt(11)
    s_barrier
    s_add_u32 m0, s26, 0
    s_nop 0
    buffer_load_dwordx4 v10, s[8:11], s20 offen offset:0 lds
    buffer_load_dwordx4 v11, s[8:11], s20 offen offset:1024 lds
    s_add_u32 m0, s27, 0
    s_nop 0
    buffer_load_dwordx4 v14, s[12:15], s21 offen offset:0 lds
    buffer_load_dwordx4 v15, s[12:15], s21 offen offset:1024 lds
    buffer_load_dwordx4 v16, s[12:15], s21 offen offset:2048 lds
    buffer_load_dwordx4 v17, s[12:15], s21 offen offset:3072 lds
    s_add_u32 m0, s27, 4096
    s_nop 0
    buffer_load_dwordx4 v18, s[12:15], s21 offen offset:0 lds
    buffer_load_dwordx4 v19, s[12:15], s21 offen offset:1024 lds
    buffer_load_dwordx4 v20, s[12:15], s21 offen offset:2048 lds
    buffer_load_dwordx4 v21, s[12:15], s21 offen offset:3072 lds
    s_add_u32 m0, s27, 8192
    s_nop 0
    buffer_load_dwordx4 v22, s[12:15], s21 offen offset:0 lds
    s_add_u32 s20, s20, 262144
    s_add_u32 s21, s21, 73728
    s_waitcnt vmcnt(11)
    s_barrier
    s_add_u32 m0, s26, 45056
    s_nop 0
    buffer_load_dwordx4 v10, s[8:11], s20 offen offset:0 lds
    buffer_load_dwordx4 v11, s[8:11], s20 offen offset:1024 lds
    s_add_u32 m0, s27, 45056
    s_nop 0
    buffer_load_dwordx4 v14, s[12:15], s21 offen offset:0 lds
    buffer_load_dwordx4 v15, s[12:15], s21 offen offset:1024 lds
    buffer_load_dwordx4 v16, s[12:15], s21 offen offset:2048 lds
    buffer_load_dwordx4 v17, s[12:15], s21 offen offset:3072 lds
    s_add_u32 m0, s27, 49152
    s_nop 0
    buffer_load_dwordx4 v18, s[12:15], s21 offen offset:0 lds
    buffer_load_dwordx4 v19, s[12:15], s21 offen offset:1024 lds
    buffer_load_dwordx4 v20, s[12:15], s21 offen offset:2048 lds
    buffer_load_dwordx4 v21, s[12:15], s21 offen offset:3072 lds
    s_add_u32 m0, s27, 53248
    s_nop 0
    buffer_load_dwordx4 v22, s[12:15], s21 offen offset:0 lds
    s_add_u32 s20, s20, 262144
    s_add_u32 s21, s21, 73728
    s_waitcnt vmcnt(11)
    s_barrier
    s_add_u32 m0, s26, 90112
    s_nop 0
    buffer_load_dwordx4 v10, s[8:11], s20 offen offset:0 lds
    buffer_load_dwordx4 v11, s[8:11], s20 offen offset:1024 lds
    s_add_u32 m0, s27, 90112
    s_nop 0
    buffer_load_dwordx4 v14, s[12:15], s21 offen offset:0 lds
    buffer_load_dwordx4 v15, s[12:15], s21 offen offset:1024 lds
    buffer_load_dwordx4 v16, s[12:15], s21 offen offset:2048 lds
    buffer_load_dwordx4 v17, s[12:15], s21 offen offset:3072 lds
    s_add_u32 m0, s27, 94208
    s_nop 0
    buffer_load_dwordx4 v18, s[12:15], s21 offen offset:0 lds
    buffer_load_dwordx4 v19, s[12:15], s21 offen offset:1024 lds
    buffer_load_dwordx4 v20, s[12:15], s21 offen offset:2048 lds
    buffer_load_dwordx4 v21, s[12:15], s21 offen offset:3072 lds
    s_add_u32 m0, s27, 98304
    s_nop 0
    buffer_load_dwordx4 v22, s[12:15], s21 offen offset:0 lds
    s_add_u32 s20, s20, 262144
    s_add_u32 s21, s21, 73728
    s_waitcnt vmcnt(11)
    s_barrier
    s_add_u32 m0, s26, 0
    s_nop 0
    buffer_load_dwordx4 v10, s[8:11], s20 offen offset:0 lds
    buffer_load_dwordx4 v11, s[8:11], s20 offen offset:1024 lds
    s_add_u32 m0, s27, 0
    s_nop 0
    buffer_load_dwordx4 v14, s[12:15], s21 offen offset:0 lds
    buffer_load_dwordx4 v15, s[12:15], s21 offen offset:1024 lds
    buffer_load_dwordx4 v16, s[12:15], s21 offen offset:2048 lds
    buffer_load_dwordx4 v17, s[12:15], s21 offen offset:3072 lds
    s_add_u32 m0, s27, 4096
    s_nop 0
    buffer_load_dwordx4 v18, s[12:15], s21 offen offset:0 lds
    buffer_load_dwordx4 v19, s[12:15], s21 offen offset:1024 lds
    buffer_load_dwordx4 v20, s[12:15], s21 offen offset:2048 lds
    buffer_load_dwordx4 v21, s[12:15], s21 offen offset:3072 lds
    s_add_u32 m0, s27, 8192
    s_nop 0
    buffer_load_dwordx4 v22, s[12:15], s21 offen offset:0 lds
    s_add_u32 s20, s20, 262144
    s_add_u32 s21, s21, 73728
    s_waitcnt vmcnt(11)
    s_barrier
    s_add_u32 m0, s26, 45056
    s_nop 0
    buffer_load_dwordx4 v10, s[8:11], s20 offen offset:0 lds
    buffer_load_dwordx4 v11, s[8:11], s20 offen offset:1024 lds
    s_add_u32 m0, s27, 45056
    s_nop 0
    buffer_load_dwordx4 v14, s[12:15], s21 offen offset:0 lds
    buffer_load_dwordx4 v15, s[12:15], s21 offen offset:1024 lds
    buffer_load_dwordx4 v16, s[12:15], s21 offen offset:2048 lds
    buffer_load_dwordx4 v17, s[12:15], s21 offen offset:3072 lds
    s_add_u32 m0, s27, 49152
    s_nop 0
    buffer_load_dwordx4 v18, s[12:15], s21 offen offset:0 lds
    buffer_load_dwordx4 v19, s[12:15], s21 offen offset:1024 lds
    buffer_load_dwordx4 v20, s[12:15], s21 offen offset:2048 lds
    buffer_load_dwordx4 v21, s[12:15], s21 offen offset:3072 lds
    s_add_u32 m0, s27, 53248
    s_nop 0
    buffer_load_dwordx4 v22, s[12:15], s21 offen offset:0 lds
    s_add_u32 s20, s20, 262144
    s_add_u32 s21, s21, 73728
    s_waitcnt vmcnt(11)
    s_barrier
    s_add_u32 m0, s26, 90112
    s_nop 0
    buffer_load_dwordx4 v10, s[8:11], s20 offen offset:0 lds
    buffer_load_dwordx4 v11, s[8:11], s20 offen offset:1024 lds
    s_add_u32 m0, s27, 90112
    s_nop 0
    buffer_load_dwordx4 v14, s[12:15], s21 offen offset:0 lds
    buffer_load_dwordx4 v15, s[12:15], s21 offen offset:1024 lds
    buffer_load_dwordx4 v16, s[12:15], s21 offen offset:2048 lds
    buffer_load_dwordx4 v17, s[12:15], s21 offen offset:3072 lds
    s_add_u32 m0, s27, 94208
    s_nop 0
    buffer_load_dwordx4 v18, s[12:15], s21 offen offset:0 lds
    buffer_load_dwordx4 v19, s[12:15], s21 offen offset:1024 lds
    buffer_load_dwordx4 v20, s[12:15], s21 offen offset:2048 lds
    buffer_load_dwordx4 v21, s[12:15], s21 offen offset:3072 lds
    s_add_u32 m0, s27, 98304
    s_nop 0
    buffer_load_dwordx4 v22, s[12:15], s21 offen offset:0 lds
    s_add_u32 s20, s20, 262144
    s_add_u32 s21, s21, 73728
    s_waitcnt vmcnt(11)
    s_barrier
    s_add_u32 m0, s26, 0
    s_nop 0
    buffer_load_dwordx4 v10, s[8:11], s20 offen offset:0 lds
    buffer_load_dwordx4 v11, s[8:11], s20 offen offset:1024 lds
    s_add_u32 m0, s27, 0
    s_nop 0
    buffer_load_dwordx4 v14, s[12:15], s21 offen offset:0 lds
    buffer_load_dwordx4 v15, s[12:15], s21 offen offset:1024 lds
    buffer_load_dwordx4 v16, s[12:15], s21 offen offset:2048 lds
    buffer_load_dwordx4 v17, s[12:15], s21 offen offset:3072 lds
    s_add_u32 m0, s27, 4096
    s_nop 0
    buffer_load_dwordx4 v18, s[12:15], s21 offen offset:0 lds
    buffer_load_dwordx4 v19, s[12:15], s21 offen offset:1024 lds
    buffer_load_dwordx4 v20, s[12:15], s21 offen offset:2048 lds
    buffer_load_dwordx4 v21, s[12:15], s21 offen offset:3072 lds
    s_add_u32 m0, s27, 8192
    s_nop 0
    buffer_load_dwordx4 v22, s[12:15], s21 offen offset:0 lds
    s_add_u32 s20, s20, 262144
    s_add_u32 s21, s21, 73728
    s_waitcnt vmcnt(11)
    s_barrier
    s_add_u32 m0, s26, 45056
    s_nop 0
    buffer_load_dwordx4 v10, s[8:11], s20 offen offset:0 lds
    buffer_load_dwordx4 v11, s[8:11], s20 offen offset:1024 lds
    s_add_u32 m0, s27, 45056
    s_nop 0
    buffer_load_dwordx4 v14, s[12:15], s21 offen offset:0 lds
    buffer_load_dwordx4 v15, s[12:15], s21 offen offset:1024 lds
    buffer_load_dwordx4 v16, s[12:15], s21 offen offset:2048 lds
    buffer_load_dwordx4 v17, s[12:15], s21 offen offset:3072 lds
    s_add_u32 m0, s27, 49152
    s_nop 0
    buffer_load_dwordx4 v18, s[12:15], s21 offen offset:0 lds
    buffer_load_dwordx4 v19, s[12:15], s21 offen offset:1024 lds
    buffer_load_dwordx4 v20, s[12:15], s21 offen offset:2048 lds
    buffer_load_dwordx4 v21, s[12:15], s21 offen offset:3072 lds
    s_add_u32 m0, s27, 53248
    s_nop 0
    buffer_load_dwordx4 v22, s[12:15], s21 offen offset:0 lds
    s_add_u32 s20, s20, 262144
    s_add_u32 s21, s21, 73728
    s_waitcnt vmcnt(11)
    s_barrier
    s_add_u32 m0, s26, 90112
    s_nop 0
    buffer_load_dwordx4 v10, s[8:11], s20 offen offset:0 lds
    buffer_load_dwordx4 v11, s[8:11], s20 offen offset:1024 lds
    s_add_u32 m0, s27, 90112
    s_nop 0
    buffer_load_dwordx4 v14, s[12:15], s21 offen offset:0 lds
    buffer_load_dwordx4 v15, s[12:15], s21 offen offset:1024 lds
    buffer_load_dwordx4 v16, s[12:15], s21 offen offset:2048 lds
    buffer_load_dwordx4 v17, s[12:15], s21 offen offset:3072 lds
    s_add_u32 m0, s27, 94208
    s_nop 0
    buffer_load_dwordx4 v18, s[12:15], s21 offen offset:0 lds
    buffer_load_dwordx4 v19, s[12:15], s21 offen offset:1024 lds
    buffer_load_dwordx4 v20, s[12:15], s21 offen offset:2048 lds
    buffer_load_dwordx4 v21, s[12:15], s21 offen offset:3072 lds
    s_add_u32 m0, s27, 98304
    s_nop 0
    buffer_load_dwordx4 v22, s[12:15], s21 offen offset:0 lds
    s_add_u32 s20, s20, 262144
    s_add_u32 s21, s21, 73728
    s_waitcnt vmcnt(11)
    s_barrier
    s_waitcnt vmcnt(0)
    s_barrier
    s_barrier
    s_barrier
    s_add_u32 s5, s5, 4
ffn2_kernel_store:
    s_barrier
    s_mul_i32 s25, s5, 4736
    s_add_u32 s25, s25, 81920
    s_mul_i32 s26, s5, 9216
    s_add_u32 s22, s22, s26
    v_add_u32 v28, 0, v1
    v_mul_u32_u24 v29, 1821, v28
    v_lshrrev_b32 v29, 16, v29
    v_mul_u32_u24 v30, 36, v29
    v_sub_u32 v28, v28, v30
    v_lshlrev_b32 v28, 4, v28
    v_mul_u32_u24 v30, 592, v29
    v_add3_u32 v30, v30, v28, s25
    ds_read_b128 v[32:35], v30
    v_mul_u32_u24 v30, 1152, v29
    v_add_u32 v5, v30, v28
    v_add_u32 v28, 64, v1
    v_mul_u32_u24 v29, 1821, v28
    v_lshrrev_b32 v29, 16, v29
    v_mul_u32_u24 v30, 36, v29
    v_sub_u32 v28, v28, v30
    v_lshlrev_b32 v28, 4, v28
    v_mul_u32_u24 v30, 592, v29
    v_add3_u32 v30, v30, v28, s25
    ds_read_b128 v[36:39], v30
    v_mul_u32_u24 v30, 1152, v29
    v_add_u32 v6, v30, v28
    v_add_u32 v28, 128, v1
    v_mul_u32_u24 v29, 1821, v28
    v_lshrrev_b32 v29, 16, v29
    v_mul_u32_u24 v30, 36, v29
    v_sub_u32 v28, v28, v30
    v_lshlrev_b32 v28, 4, v28
    v_mul_u32_u24 v30, 592, v29
    v_add3_u32 v30, v30, v28, s25
    ds_read_b128 v[40:43], v30
    v_mul_u32_u24 v30, 1152, v29
    v_add_u32 v7, v30, v28
    v_add_u32 v28, 192, v1
    v_mul_u32_u24 v29, 1821, v28
    v_lshrrev_b32 v29, 16, v29
    v_mul_u32_u24 v30, 36, v29
    v_sub_u32 v28, v28, v30
    v_lshlrev_b32 v28, 4, v28
    v_mul_u32_u24 v30, 592, v29
    v_add3_u32 v30, v30, v28, s25
    ds_read_b128 v[44:47], v30
    v_mul_u32_u24 v30, 1152, v29
    v_add_u32 v8, v30, v28
    s_mov_b64 exec, 0xffffffff
    v_add_u32 v28, 256, v1
    v_mul_u32_u24 v29, 1821, v28
    v_lshrrev_b32 v29, 16, v29
    v_mul_u32_u24 v30, 36, v29
    v_sub_u32 v28, v28, v30
    v_lshlrev_b32 v28, 4, v28
    v_mul_u32_u24 v30, 592, v29
    v_add3_u32 v30, v30, v28, s25
    ds_read_b128 v[48:51], v30
    v_mul_u32_u24 v30, 1152, v29
    v_add_u32 v9, v30, v28
    s_mov_b64 exec, -1
    s_waitcnt lgkmcnt(4)
    buffer_store_dwordx4 v[32:35], v5, s[16:19], s22 offen sc1
    s_waitcnt lgkmcnt(3)
    buffer_store_dwordx4 v[36:39], v6, s[16:19], s22 offen sc1
    s_waitcnt lgkmcnt(2)
    buffer_store_dwordx4 v[40:43], v7, s[16:19], s22 offen sc1
    s_waitcnt lgkmcnt(1)
    buffer_store_dwordx4 v[44:47], v8, s[16:19], s22 offen sc1
    s_mov_b64 exec, 0xffffffff
    s_waitcnt lgkmcnt(0)
    buffer_store_dwordx4 v[48:51], v9, s[16:19], s22 offen sc1
    s_mov_b64 exec, -1
ffn2_kernel_fin:
ffn2_kernel_done:
    s_endpgm

.globl final_kernel
.p2align 8
.type final_kernel,@function
final_kernel:
    s_cmp_ge_u32 s2, 1152
    s_cbranch_scc1 final_done
    s_load_dwordx2 s[8:9], s[0:1], 96
    s_load_dwordx2 s[12:13], s[0:1], 96
    s_load_dwordx2 s[16:17], s[0:1], 80
    s_load_dwordx2 s[28:29], s[0:1], 96
    s_lshl_b32 s3, s2, 8
    v_add_u32 v1, s3, v0
    s_mov_b32 s4, 0x1c71c72
    v_mul_hi_u32 v2, v1, s4
    s_movk_i32 s5, 144
    v_mul_lo_u32 v2, v2, s5
    v_sub_u32 v2, v1, v2
    v_lshlrev_b32 v2, 4, v2
    v_lshlrev_b32 v3, 4, v1
    v_lshlrev_b32 v4, 3, v1
    s_mov_b32 s48, 0
    s_mov_b32 s49, 2359296
    s_mov_b32 s50, 4718592
    s_mov_b32 s51, 7077888
    s_movk_i32 s6, 11520
    s_waitcnt lgkmcnt(0)
    s_add_u32 s8, s8, 0x400000
    s_addc_u32 s9, s9, 0
    s_and_b32 s9, s9, 0xffff
    s_mov_b32 s10, 0x240000
    s_mov_b32 s11, 0x00020000
    s_and_b32 s13, s13, 0xffff
    s_mov_b32 s14, 0x3600
    s_mov_b32 s15, 0x00020000
    s_and_b32 s17, s17, 0xffff
    s_mov_b32 s18, 0x240000
    s_mov_b32 s19, 0x00020000
    s_add_u32 s28, s28, 0x5000000
    s_addc_u32 s29, s29, 0
    s_and_b32 s29, s29, 0xffff
    s_mov_b32 s30, 0x900000
    s_mov_b32 s31, 0x00020000
    buffer_load_dwordx2 v[16:17], v4, s[28:31], s48 offen
    buffer_load_dwordx2 v[20:21], v4, s[28:31], s49 offen
    buffer_load_dwordx2 v[24:25], v4, s[28:31], s50 offen
    buffer_load_dwordx2 v[28:29], v4, s[28:31], s51 offen
    buffer_load_dwordx2 v[6:7], v4, s[8:11], 0 offen
    buffer_load_dwordx4 v[8:11], v2, s[12:15], s6 offen
    s_waitcnt vmcnt(0)
    v_and_b32 v19, 0xffff0000, v17
    v_lshlrev_b32 v18, 16, v17
    v_and_b32 v17, 0xffff0000, v16
    v_lshlrev_b32 v16, 16, v16
    v_and_b32 v23, 0xffff0000, v21
    v_lshlrev_b32 v22, 16, v21
    v_and_b32 v21, 0xffff0000, v20
    v_lshlrev_b32 v20, 16, v20
    v_and_b32 v27, 0xffff0000, v25
    v_lshlrev_b32 v26, 16, v25
    v_and_b32 v25, 0xffff0000, v24
    v_lshlrev_b32 v24, 16, v24
    v_and_b32 v31, 0xffff0000, v29
    v_lshlrev_b32 v30, 16, v29
    v_and_b32 v29, 0xffff0000, v28
    v_lshlrev_b32 v28, 16, v28
    v_add_f32 v16, v16, v20
    v_add_f32 v16, v16, v24
    v_add_f32 v16, v16, v28
    v_add_f32 v17, v17, v21
    v_add_f32 v17, v17, v25
    v_add_f32 v17, v17, v29
    v_add_f32 v18, v18, v22
    v_add_f32 v18, v18, v26
    v_add_f32 v18, v18, v30
    v_add_f32 v19, v19, v23
    v_add_f32 v19, v19, v27
    v_add_f32 v19, v19, v31
    v_cvt_pk_bf16_f32 v32, v16, v17
    v_lshlrev_b32 v16, 16, v32
    v_and_b32 v17, 0xffff0000, v32
    v_mul_f32 v16, v16, v8
    v_mul_f32 v17, v17, v9
    v_cvt_pk_bf16_f32 v32, v16, v17
    v_lshlrev_b32 v16, 16, v32
    v_and_b32 v17, 0xffff0000, v32
    v_lshlrev_b32 v33, 16, v6
    v_and_b32 v34, 0xffff0000, v6
    v_add_f32 v16, v16, v33
    v_add_f32 v17, v17, v34
    v_cvt_pk_bf16_f32 v12, v16, v17
    v_cvt_pk_bf16_f32 v32, v18, v19
    v_lshlrev_b32 v18, 16, v32
    v_and_b32 v19, 0xffff0000, v32
    v_mul_f32 v18, v18, v10
    v_mul_f32 v19, v19, v11
    v_cvt_pk_bf16_f32 v32, v18, v19
    v_lshlrev_b32 v18, 16, v32
    v_and_b32 v19, 0xffff0000, v32
    v_lshlrev_b32 v33, 16, v7
    v_and_b32 v34, 0xffff0000, v7
    v_add_f32 v18, v18, v33
    v_add_f32 v19, v19, v34
    v_cvt_pk_bf16_f32 v13, v18, v19
    buffer_store_dwordx2 v[12:13], v4, s[16:19], 0 offen
final_done:
    s_endpgm

.section .rodata,"a"
.p2align 6
.amdhsa_kernel mod_kernel
  .amdhsa_next_free_vgpr 40
  .amdhsa_next_free_sgpr 102
  .amdhsa_accum_offset 40
  .amdhsa_group_segment_fixed_size 0
  .amdhsa_kernarg_size 104
  .amdhsa_user_sgpr_count 2
  .amdhsa_user_sgpr_kernarg_segment_ptr 1
  .amdhsa_system_sgpr_workgroup_id_x 1
  .amdhsa_float_denorm_mode_32 3
  .amdhsa_float_denorm_mode_16_64 3
.end_amdhsa_kernel

.p2align 6
.amdhsa_kernel ln1_kernel
  .amdhsa_next_free_vgpr 64
  .amdhsa_next_free_sgpr 102
  .amdhsa_accum_offset 64
  .amdhsa_group_segment_fixed_size 0
  .amdhsa_kernarg_size 104
  .amdhsa_user_sgpr_count 2
  .amdhsa_user_sgpr_kernarg_segment_ptr 1
  .amdhsa_system_sgpr_workgroup_id_x 1
  .amdhsa_float_denorm_mode_32 3
  .amdhsa_float_denorm_mode_16_64 3
.end_amdhsa_kernel

.p2align 6
.amdhsa_kernel attn_kernel
  .amdhsa_next_free_vgpr 512
  .amdhsa_next_free_sgpr 102
  .amdhsa_accum_offset 256
  .amdhsa_group_segment_fixed_size 0
  .amdhsa_kernarg_size 104
  .amdhsa_user_sgpr_count 2
  .amdhsa_user_sgpr_kernarg_segment_ptr 1
  .amdhsa_system_sgpr_workgroup_id_x 1
  .amdhsa_float_denorm_mode_32 3
  .amdhsa_float_denorm_mode_16_64 3
.end_amdhsa_kernel

.p2align 6
.amdhsa_kernel oproj_kernel
  .amdhsa_next_free_vgpr 256
  .amdhsa_next_free_sgpr 102
  .amdhsa_accum_offset 256
  .amdhsa_group_segment_fixed_size 0
  .amdhsa_kernarg_size 104
  .amdhsa_user_sgpr_count 2
  .amdhsa_user_sgpr_kernarg_segment_ptr 1
  .amdhsa_system_sgpr_workgroup_id_x 1
  .amdhsa_float_denorm_mode_32 3
  .amdhsa_float_denorm_mode_16_64 3
.end_amdhsa_kernel

.p2align 6
.amdhsa_kernel ln2_kernel
  .amdhsa_next_free_vgpr 104
  .amdhsa_next_free_sgpr 102
  .amdhsa_accum_offset 104
  .amdhsa_group_segment_fixed_size 0
  .amdhsa_kernarg_size 104
  .amdhsa_user_sgpr_count 2
  .amdhsa_user_sgpr_kernarg_segment_ptr 1
  .amdhsa_system_sgpr_workgroup_id_x 1
  .amdhsa_float_denorm_mode_32 3
  .amdhsa_float_denorm_mode_16_64 3
.end_amdhsa_kernel

.p2align 6
.amdhsa_kernel ffn1_kernel
  .amdhsa_next_free_vgpr 256
  .amdhsa_next_free_sgpr 102
  .amdhsa_accum_offset 256
  .amdhsa_group_segment_fixed_size 0
  .amdhsa_kernarg_size 104
  .amdhsa_user_sgpr_count 2
  .amdhsa_user_sgpr_kernarg_segment_ptr 1
  .amdhsa_system_sgpr_workgroup_id_x 1
  .amdhsa_float_denorm_mode_32 3
  .amdhsa_float_denorm_mode_16_64 3
.end_amdhsa_kernel

.p2align 6
.amdhsa_kernel ffn2_kernel
  .amdhsa_next_free_vgpr 256
  .amdhsa_next_free_sgpr 102
  .amdhsa_accum_offset 256
  .amdhsa_group_segment_fixed_size 0
  .amdhsa_kernarg_size 104
  .amdhsa_user_sgpr_count 2
  .amdhsa_user_sgpr_kernarg_segment_ptr 1
  .amdhsa_system_sgpr_workgroup_id_x 1
  .amdhsa_float_denorm_mode_32 3
  .amdhsa_float_denorm_mode_16_64 3
.end_amdhsa_kernel

.p2align 6
.amdhsa_kernel final_kernel
  .amdhsa_next_free_vgpr 48
  .amdhsa_next_free_sgpr 102
  .amdhsa_accum_offset 48
  .amdhsa_group_segment_fixed_size 0
  .amdhsa_kernarg_size 104
  .amdhsa_user_sgpr_count 2
  .amdhsa_user_sgpr_kernarg_segment_ptr 1
  .amdhsa_system_sgpr_workgroup_id_x 1
  .amdhsa_float_denorm_mode_32 3
  .amdhsa_float_denorm_mode_16_64 3
.end_amdhsa_kernel
```
